```python
import torch

def _softmax(x, axis=-1):
    return torch.softmax(x, dim=axis)
def _gelu(x):
    return torch.nn.functional.gelu(x, approximate="tanh")
def _silu(x):
    return torch.nn.functional.silu(x)
def _sigmoid(x):
    return torch.sigmoid(x)
def _layernorm(x, axis=-1, eps=1e-5):
    m = x.mean(dim=axis, keepdim=True)
    v = x.var(dim=axis, keepdim=True, unbiased=False)
    return (x - m) / torch.sqrt(v + eps)
def _scatter_add(tgt, idx, src, axis=0):
    return tgt.clone().index_add_(axis, idx, src)
def _segment_sum(src, seg, n):
    out = torch.zeros((n,) + src.shape[1:], dtype=src.dtype)
    return out.index_add_(0, seg, src)
def _pad(x, pw):
    flat = tuple(v for pair in reversed(pw) for v in pair)
    return torch.nn.functional.pad(x, flat)

kernel_name = 'concat_heads__gqa_block_cached__gqa_block_cached__near_ridge'

def setup_inputs():

    _w = (lambda a: (lambda t: t.to(torch.bfloat16) if t.is_floating_point() else t)(torch.as_tensor(a)))
    def _A_setup():
        B, Sq, D = 16, 96, 640
        Hq, Hkv, Sk, Dh = 32, 32, 512, 128
        assert Hq % Hkv == 0, (Hq, Hkv)
        return {
            "x": _w((lambda *s: torch.randn(*s, dtype=torch.bfloat16) * 0.8)(B, Sq, D)),
            "k_cache": _w((lambda *s: torch.randn(*s, dtype=torch.bfloat16) * 0.8)(B, Hkv, Sk, Dh)),
            "v_cache": _w((lambda *s: torch.randn(*s, dtype=torch.bfloat16) * 0.05)(B, Hkv, Sk, Dh)),
            "wq": _w((lambda *s: torch.randn(*s, dtype=torch.bfloat16) * 0.8)(D, Hq * Dh) * (D ** -0.5)),
            "wo": _w((lambda *s: torch.randn(*s, dtype=torch.bfloat16) * 0.05)(Hq * Dh, D) * ((Hq * Dh) ** -0.5)),
        }
    _A_in = _A_setup()

    def _B_setup():
        B, Sq, D = 16, 96, 640
        Hq, Hkv, Sk, Dh = 32, 32, 512, 128
        assert Hq % Hkv == 0, (Hq, Hkv)
        return {
            "x": _w((lambda *s: torch.randn(*s, dtype=torch.bfloat16) * 0.8)(B, Sq, D)),
            "k_cache": _w((lambda *s: torch.randn(*s, dtype=torch.bfloat16) * 0.8)(B, Hkv, Sk, Dh)),
            "v_cache": _w((lambda *s: torch.randn(*s, dtype=torch.bfloat16) * 0.05)(B, Hkv, Sk, Dh)),
            "wq": _w((lambda *s: torch.randn(*s, dtype=torch.bfloat16) * 0.8)(D, Hq * Dh) * (D ** -0.5)),
            "wo": _w((lambda *s: torch.randn(*s, dtype=torch.bfloat16) * 0.05)(Hq * Dh, D) * ((Hq * Dh) ** -0.5)),
        }
    _B_in = _B_setup()

    return {
        "A_x": _A_in["x"],
        "A_k_cache": _A_in["k_cache"],
        "A_v_cache": _A_in["v_cache"],
        "A_wq": _A_in["wq"],
        "A_wo": _A_in["wo"],
        "B_x": _B_in["x"],
        "B_k_cache": _B_in["k_cache"],
        "B_v_cache": _B_in["v_cache"],
        "B_wq": _B_in["wq"],
        "B_wo": _B_in["wo"],
    }

def reference(A_x, A_k_cache, A_v_cache, A_wq, A_wo, B_x, B_k_cache, B_v_cache, B_wq, B_wo):
    def _A_ref(x, k_cache, v_cache, wq, wo):
        B, Sq, D = x.shape
        Hq, Dh = 32, 128
        Hkv = k_cache.shape[1]
        rep = Hq // Hkv
        q = (lambda x, *d: x.permute(*d))((x @ wq).reshape(B, Sq, Hq, Dh), 0, 2, 1, 3)
        k = (lambda x, n, axis: torch.repeat_interleave(x, n, dim=axis))(k_cache, rep, axis=1)
        v = (lambda x, n, axis: torch.repeat_interleave(x, n, dim=axis))(v_cache, rep, axis=1)
        scores = torch.einsum("bhqd,bhkd->bhqk", q, k) * (Dh ** -0.5)
        p = _softmax(scores, axis=-1)
        o = torch.einsum("bhqk,bhkd->bhqd", p, v)
        return (lambda x, *d: x.permute(*d))(o, 0, 2, 1, 3).reshape(B, Sq, Hq * Dh) @ wo

    def _B_ref(x, k_cache, v_cache, wq, wo):
        B, Sq, D = x.shape
        Hq, Dh = 32, 128
        Hkv = k_cache.shape[1]
        rep = Hq // Hkv
        q = (lambda x, *d: x.permute(*d))((x @ wq).reshape(B, Sq, Hq, Dh), 0, 2, 1, 3)
        k = (lambda x, n, axis: torch.repeat_interleave(x, n, dim=axis))(k_cache, rep, axis=1)
        v = (lambda x, n, axis: torch.repeat_interleave(x, n, dim=axis))(v_cache, rep, axis=1)
        scores = torch.einsum("bhqd,bhkd->bhqk", q, k) * (Dh ** -0.5)
        p = _softmax(scores, axis=-1)
        o = torch.einsum("bhqk,bhkd->bhqd", p, v)
        return (lambda x, *d: x.permute(*d))(o, 0, 2, 1, 3).reshape(B, Sq, Hq * Dh) @ wo

    a = _A_ref(A_x, A_k_cache, A_v_cache, A_wq, A_wo)
    b = _B_ref(B_x, B_k_cache, B_v_cache, B_wq, B_wo)
    return torch.concatenate([a, b], axis=-1)
```

```asm
; @launch grid=(256,1,1) block=(256,1,1) lds=163840
.amdgcn_target "amdgcn-amd-amdhsa--gfx950"
.text
.globl concat_heads__gqa_block_cached__gqa_block_cached__near_ridge_kernel
.p2align 8
.type concat_heads__gqa_block_cached__gqa_block_cached__near_ridge_kernel,@function
concat_heads__gqa_block_cached__gqa_block_cached__near_ridge_kernel:
    s_cmp_ge_u32 s2, 256
    s_cbranch_scc1 L_exit
    s_load_dwordx16 s[36:51], s[0:1], 0
    s_load_dwordx4 s[52:55], s[0:1], 64
    s_load_dwordx2 s[56:57], s[0:1], 96
    s_getpc_b64 s[34:35]
L_pw:
    s_lshr_b32 s32, s2, 3
    v_lshrrev_b32 v1, 6, v0
    v_lshl_add_u32 v1, s32, 2, v1
    v_and_b32 v2, 7, v0
    v_lshl_add_u32 v2, v1, 3, v2
    v_lshlrev_b32 v2, 7, v2
    v_min_u32 v2, L_exit-L_pw, v2
    v_add_u32 v2, L_pw-L_pw, v2
    global_load_dword a248, v2, s[34:35]
    v_lshrrev_b32 v1, 6, v0
    v_and_b32 v7, 63, v0
    v_readfirstlane_b32 s3, v1
    s_and_b32 s4, s2, 7
    s_lshr_b32 s5, s2, 3
    s_lshr_b32 s6, s5, 4
    s_lshl_b32 s4, s4, 1
    s_add_u32 s4, s4, s6
    s_and_b32 s5, s5, 15
    s_lshr_b32 s6, s4, 3
    s_and_b32 s4, s4, 7
    v_lshlrev_b32 v0, 4, v7
    v_lshrrev_b32 v8, 4, v7
    v_and_b32 v9, 0xf0, v0
    v_mul_u32_u24 v4, 1280, v8
    v_add_u32 v4, v4, v9
    v_and_b32 v8, 0x18, v7
    v_lshlrev_b32 v40, 13, v8
    v_lshrrev_b32 v8, 5, v7
    v_lshlrev_b32 v8, 15, v8
    v_and_b32 v9, 0x70, v0
    v_add3_u32 v40, v40, v8, v9
    s_lshl_b32 s32, s3, 8
    v_add_u32 v40, s32, v40
    v_add_u32 v41, 0x2000, v40
    v_add_u32 v42, 0x4000, v40
    v_add_u32 v43, 0x6000, v40
    s_and_b32 s32, s4, 1
    s_mul_i32 s32, s32, 0
    s_add_u32 s32, s32, s5
    s_mul_i32 s33, s32, 52
    s_lshr_b32 s33, s33, 8
    s_mul_i32 s33, s33, 5
    s_sub_u32 s32, s32, s33
    s_mul_i32 s34, s3, 30720
    s_lshl_b32 s60, s32, 20
    s_lshl_b32 s33, s32, 8
    s_add_u32 s65, s33, s34
    s_add_u32 s32, s32, 1
    s_cmp_eq_u32 s32, 5
    s_cselect_b32 s32, 0, s32
    s_lshl_b32 s61, s32, 20
    s_lshl_b32 s33, s32, 8
    s_add_u32 s66, s33, s34
    s_add_u32 s32, s32, 1
    s_cmp_eq_u32 s32, 5
    s_cselect_b32 s32, 0, s32
    s_lshl_b32 s62, s32, 20
    s_lshl_b32 s33, s32, 8
    s_add_u32 s67, s33, s34
    s_add_u32 s32, s32, 1
    s_cmp_eq_u32 s32, 5
    s_cselect_b32 s32, 0, s32
    s_lshl_b32 s63, s32, 20
    s_lshl_b32 s33, s32, 8
    s_add_u32 s68, s33, s34
    s_add_u32 s32, s32, 1
    s_cmp_eq_u32 s32, 5
    s_cselect_b32 s32, 0, s32
    s_lshl_b32 s64, s32, 20
    s_lshl_b32 s33, s32, 8
    s_add_u32 s69, s33, s34
    s_add_u32 s32, s32, 1
    s_cmp_eq_u32 s32, 5
    s_cselect_b32 s32, 0, s32
    s_mul_i32 s70, s3, 6336
    s_mul_i32 s71, s3, 21120
    s_add_u32 s71, s71, 50688
    s_mul_i32 s72, s3, 2112
    s_lshl_b32 s74, s3, 11
    s_mov_b32 s76, 0x3e0293ee
    s_mov_b32 s77, 0x3e0293ee
    s_waitcnt lgkmcnt(0)
    s_cmp_eq_u32 s6, 0
    s_cselect_b32 s16, s36, s46
    s_cselect_b32 s17, s37, s47
    s_cselect_b32 s20, s42, s52
    s_cselect_b32 s21, s43, s53
    s_cselect_b32 s8, s38, s48
    s_cselect_b32 s9, s39, s49
    s_cselect_b32 s12, s40, s50
    s_cselect_b32 s13, s41, s51
    s_cselect_b32 s24, s44, s54
    s_cselect_b32 s25, s45, s55
    s_mul_i32 s32, s5, 122880
    s_add_u32 s16, s16, s32
    s_addc_u32 s17, s17, 0
    s_mov_b32 s18, 122880
    s_mov_b32 s19, 0x20000
    s_lshl_b32 s32, s4, 10
    s_add_u32 s20, s20, s32
    s_addc_u32 s21, s21, 0
    s_sub_u32 s22, 5242880, s32
    s_mov_b32 s23, 0x20000
    s_add_u32 s73, s60, 0
    s_add_u32 m0, s71, 0
    s_nop 0
    buffer_load_dwordx4 v40, s[20:23], s73 offen nt lds
    s_add_u32 m0, s71, 1056
    s_nop 0
    buffer_load_dwordx4 v41, s[20:23], s73 offen nt lds
    s_add_u32 m0, s71, 2112
    s_nop 0
    buffer_load_dwordx4 v42, s[20:23], s73 offen nt lds
    s_add_u32 m0, s71, 3168
    s_nop 0
    buffer_load_dwordx4 v43, s[20:23], s73 offen nt lds
    s_add_u32 m0, s70, 0
    s_add_u32 s75, s65, 0
    buffer_load_dwordx4 v4, s[16:19], s75 offen nt lds
    s_add_u32 m0, s70, 1056
    s_add_u32 s75, s65, 5120
    buffer_load_dwordx4 v4, s[16:19], s75 offen nt lds
    s_add_u32 m0, s70, 2112
    s_add_u32 s75, s65, 10240
    buffer_load_dwordx4 v4, s[16:19], s75 offen nt lds
    s_add_u32 m0, s70, 3168
    s_add_u32 s75, s65, 15360
    buffer_load_dwordx4 v4, s[16:19], s75 offen nt lds
    s_add_u32 m0, s70, 4224
    s_add_u32 s75, s65, 20480
    buffer_load_dwordx4 v4, s[16:19], s75 offen nt lds
    s_add_u32 m0, s70, 5280
    s_add_u32 s75, s65, 25600
    buffer_load_dwordx4 v4, s[16:19], s75 offen nt lds
    s_add_u32 s73, s60, 128
    s_add_u32 m0, s71, 4224
    s_nop 0
    buffer_load_dwordx4 v40, s[20:23], s73 offen nt lds
    s_add_u32 m0, s71, 5280
    s_nop 0
    buffer_load_dwordx4 v41, s[20:23], s73 offen nt lds
    s_add_u32 m0, s71, 6336
    s_nop 0
    buffer_load_dwordx4 v42, s[20:23], s73 offen nt lds
    s_add_u32 m0, s71, 7392
    s_nop 0
    buffer_load_dwordx4 v43, s[20:23], s73 offen nt lds
    s_lshl_b32 s32, s5, 3
    s_add_u32 s32, s32, s4
    s_lshl_b32 s32, s32, 19
    s_add_u32 s8, s8, s32
    s_addc_u32 s9, s9, 0
    s_mov_b32 s10, 524288
    s_mov_b32 s11, 0x20000
    s_add_u32 s12, s12, s32
    s_addc_u32 s13, s13, 0
    s_mov_b32 s14, 524288
    s_mov_b32 s15, 0x20000
    s_mul_i32 s32, s4, 655360
    s_add_u32 s24, s24, s32
    s_addc_u32 s25, s25, 0
    s_mov_b32 s26, 655360
    s_mov_b32 s27, 0x20000
    s_lshl_b32 s32, s6, 4
    s_add_u32 s32, s32, s5
    s_mul_i32 s32, s32, 1050624
    s_add_u32 s28, s56, s32
    s_addc_u32 s29, s57, 0
    s_mov_b32 s30, 1050624
    s_mov_b32 s31, 0x20000
    v_and_b32 v5, 7, v7
    v_mul_u32_u24 v1, 1056, v5
    v_bfe_u32 v5, v7, 3, 1
    v_lshl_add_u32 v1, v5, 8, v1
    v_and_b32 v5, 0x30, v7
    v_add_u32 v1, v1, v5
    v_bfe_u32 v5, v7, 2, 2
    v_mul_u32_u24 v3, 1056, v5
    v_lshrrev_b32 v5, 4, v7
    v_lshl_add_u32 v3, v5, 7, v3
    v_and_b32 v5, 3, v7
    v_lshl_add_u32 v3, v5, 3, v3
    v_add_u32 v3, s71, v3
    v_lshrrev_b32 v5, 5, v7
    v_and_b32 v2, 0xf0, v0
    v_lshl_add_u32 v2, v5, 8, v2
    v_bfe_u32 v5, v7, 4, 1
    v_lshl_add_u32 v2, v5, 3, v2
    s_load_dwordx4 s[56:59], s[0:1], 80
    v_add_u32 v1, 0, v1
    s_mul_i32 s33, s5, 40960
    s_mul_i32 s32, s3, 10240
    s_add_u32 s33, s33, s32
    s_waitcnt vmcnt(4)
    s_barrier
    ds_read_b128 a[0:3], v1 offset:0
    ds_read_b64_tr_b16 v[8:9], v3 offset:0
    ds_read_b64_tr_b16 v[10:11], v3 offset:512
    ds_read_b128 a[4:7], v1 offset:512
    ds_read_b128 a[8:11], v1 offset:8448
    ds_read_b128 a[12:15], v1 offset:8960
    ds_read_b128 a[16:19], v1 offset:16896
    ds_read_b128 a[20:23], v1 offset:17408
    ds_read_b64_tr_b16 v[12:13], v3 offset:32
    ds_read_b64_tr_b16 v[14:15], v3 offset:544
    ds_read_b64_tr_b16 v[16:17], v3 offset:64
    ds_read_b64_tr_b16 v[18:19], v3 offset:576
    ds_read_b64_tr_b16 v[20:21], v3 offset:96
    ds_read_b64_tr_b16 v[22:23], v3 offset:608
    s_add_u32 s73, s60, 262144
    s_add_u32 m0, s71, 8448
    s_nop 0
    buffer_load_dwordx4 v40, s[20:23], s73 offen nt lds
    s_add_u32 m0, s71, 9504
    s_nop 0
    buffer_load_dwordx4 v41, s[20:23], s73 offen nt lds
    s_add_u32 m0, s71, 10560
    s_nop 0
    buffer_load_dwordx4 v42, s[20:23], s73 offen nt lds
    s_add_u32 m0, s71, 11616
    s_nop 0
    buffer_load_dwordx4 v43, s[20:23], s73 offen nt lds
    s_add_u32 s73, s60, 262272
    s_add_u32 m0, s71, 12672
    s_nop 0
    buffer_load_dwordx4 v40, s[20:23], s73 offen nt lds
    s_add_u32 m0, s71, 13728
    s_nop 0
    buffer_load_dwordx4 v41, s[20:23], s73 offen nt lds
    s_add_u32 m0, s71, 14784
    s_nop 0
    buffer_load_dwordx4 v42, s[20:23], s73 offen nt lds
    s_add_u32 m0, s71, 15840
    s_nop 0
    buffer_load_dwordx4 v43, s[20:23], s73 offen nt lds
    s_add_u32 s73, s60, 524288
    s_add_u32 m0, s71, 16896
    s_nop 0
    buffer_load_dwordx4 v40, s[20:23], s73 offen nt lds
    s_add_u32 m0, s71, 17952
    s_nop 0
    buffer_load_dwordx4 v41, s[20:23], s73 offen nt lds
    s_add_u32 m0, s71, 19008
    s_nop 0
    buffer_load_dwordx4 v42, s[20:23], s73 offen nt lds
    s_add_u32 m0, s71, 20064
    s_nop 0
    buffer_load_dwordx4 v43, s[20:23], s73 offen nt lds
    s_waitcnt vmcnt(12)
    s_waitcnt lgkmcnt(0)
    v_mfma_f32_16x16x32_bf16 v[64:67], v[8:11], a[0:3], 0
    ds_read_b64_tr_b16 v[24:25], v3 offset:4224
    ds_read_b64_tr_b16 v[26:27], v3 offset:4736
    v_mfma_f32_16x16x32_bf16 v[68:71], v[8:11], a[4:7], 0
    ds_read_b64_tr_b16 v[28:29], v3 offset:4256
    ds_read_b64_tr_b16 v[30:31], v3 offset:4768
    v_mfma_f32_16x16x32_bf16 v[72:75], v[8:11], a[8:11], 0
    ds_read_b64_tr_b16 v[32:33], v3 offset:4288
    ds_read_b64_tr_b16 v[34:35], v3 offset:4800
    v_mfma_f32_16x16x32_bf16 v[76:79], v[8:11], a[12:15], 0
    ds_read_b64_tr_b16 v[36:37], v3 offset:4320
    ds_read_b64_tr_b16 v[38:39], v3 offset:4832
    v_mfma_f32_16x16x32_bf16 v[80:83], v[8:11], a[16:19], 0
    ds_read_b128 a[24:27], v1 offset:64
    ds_read_b128 a[28:31], v1 offset:576
    v_mfma_f32_16x16x32_bf16 v[84:87], v[8:11], a[20:23], 0
    ds_read_b128 a[32:35], v1 offset:8512
    v_mfma_f32_16x16x32_bf16 v[88:91], v[12:15], a[0:3], 0
    v_mfma_f32_16x16x32_bf16 v[92:95], v[12:15], a[4:7], 0
    v_mfma_f32_16x16x32_bf16 v[96:99], v[12:15], a[8:11], 0
    s_add_u32 s73, s60, 524416
    s_add_u32 m0, s71, 0
    v_mfma_f32_16x16x32_bf16 v[100:103], v[12:15], a[12:15], 0
    buffer_load_dwordx4 v40, s[20:23], s73 offen nt lds
    v_mfma_f32_16x16x32_bf16 v[104:107], v[12:15], a[16:19], 0
    v_mfma_f32_16x16x32_bf16 v[108:111], v[12:15], a[20:23], 0
    s_add_u32 m0, s71, 1056
    v_mfma_f32_16x16x32_bf16 v[112:115], v[16:19], a[0:3], 0
    buffer_load_dwordx4 v41, s[20:23], s73 offen nt lds
    v_mfma_f32_16x16x32_bf16 v[116:119], v[16:19], a[4:7], 0
    v_mfma_f32_16x16x32_bf16 v[120:123], v[16:19], a[8:11], 0
    s_add_u32 m0, s71, 2112
    v_mfma_f32_16x16x32_bf16 v[124:127], v[16:19], a[12:15], 0
    buffer_load_dwordx4 v42, s[20:23], s73 offen nt lds
    v_mfma_f32_16x16x32_bf16 v[128:131], v[16:19], a[16:19], 0
    v_mfma_f32_16x16x32_bf16 v[132:135], v[16:19], a[20:23], 0
    v_mfma_f32_16x16x32_bf16 v[136:139], v[20:23], a[0:3], 0
    s_add_u32 m0, s71, 3168
    v_mfma_f32_16x16x32_bf16 v[140:143], v[20:23], a[4:7], 0
    buffer_load_dwordx4 v43, s[20:23], s73 offen nt lds
    v_mfma_f32_16x16x32_bf16 v[144:147], v[20:23], a[8:11], 0
    v_mfma_f32_16x16x32_bf16 v[148:151], v[20:23], a[12:15], 0
    s_waitcnt lgkmcnt(3)
    s_add_u32 s73, s60, 786432
    s_add_u32 m0, s71, 4224
    v_mfma_f32_16x16x32_bf16 v[152:155], v[20:23], a[16:19], 0
    buffer_load_dwordx4 v40, s[20:23], s73 offen nt lds
    v_mfma_f32_16x16x32_bf16 v[156:159], v[20:23], a[20:23], 0
    s_waitcnt vmcnt(13)
    s_waitcnt lgkmcnt(0)
    v_mfma_f32_16x16x32_bf16 v[160:163], v[24:27], a[0:3], 0
    ds_read_b64_tr_b16 v[8:9], v3 offset:8448
    ds_read_b64_tr_b16 v[10:11], v3 offset:8960
    v_mfma_f32_16x16x32_bf16 v[164:167], v[24:27], a[4:7], 0
    ds_read_b64_tr_b16 v[12:13], v3 offset:8480
    ds_read_b64_tr_b16 v[14:15], v3 offset:8992
    v_mfma_f32_16x16x32_bf16 v[168:171], v[24:27], a[8:11], 0
    ds_read_b64_tr_b16 v[16:17], v3 offset:8512
    ds_read_b64_tr_b16 v[18:19], v3 offset:9024
    v_mfma_f32_16x16x32_bf16 v[172:175], v[24:27], a[12:15], 0
    ds_read_b64_tr_b16 v[20:21], v3 offset:8544
    ds_read_b64_tr_b16 v[22:23], v3 offset:9056
    v_mfma_f32_16x16x32_bf16 v[176:179], v[24:27], a[16:19], 0
    ds_read_b128 a[36:39], v1 offset:9024
    ds_read_b128 a[40:43], v1 offset:16960
    s_add_u32 m0, s71, 5280
    v_mfma_f32_16x16x32_bf16 v[180:183], v[24:27], a[20:23], 0
    ds_read_b128 a[44:47], v1 offset:17472
    buffer_load_dwordx4 v41, s[20:23], s73 offen nt lds
    v_mfma_f32_16x16x32_bf16 v[184:187], v[28:31], a[0:3], 0
    v_mfma_f32_16x16x32_bf16 v[188:191], v[28:31], a[4:7], 0
    s_add_u32 m0, s71, 6336
    v_mfma_f32_16x16x32_bf16 v[192:195], v[28:31], a[8:11], 0
    buffer_load_dwordx4 v42, s[20:23], s73 offen nt lds
    v_mfma_f32_16x16x32_bf16 v[196:199], v[28:31], a[12:15], 0
    v_mfma_f32_16x16x32_bf16 v[200:203], v[28:31], a[16:19], 0
    s_add_u32 m0, s71, 7392
    v_mfma_f32_16x16x32_bf16 v[204:207], v[28:31], a[20:23], 0
    buffer_load_dwordx4 v43, s[20:23], s73 offen nt lds
    v_mfma_f32_16x16x32_bf16 v[208:211], v[32:35], a[0:3], 0
    v_mfma_f32_16x16x32_bf16 v[212:215], v[32:35], a[4:7], 0
    s_waitcnt lgkmcnt(3)
    s_add_u32 s73, s60, 786560
    s_add_u32 m0, s71, 8448
    v_mfma_f32_16x16x32_bf16 v[216:219], v[32:35], a[8:11], 0
    buffer_load_dwordx4 v40, s[20:23], s73 offen nt lds
    v_mfma_f32_16x16x32_bf16 v[220:223], v[32:35], a[12:15], 0
    v_mfma_f32_16x16x32_bf16 v[224:227], v[32:35], a[16:19], 0
    v_mfma_f32_16x16x32_bf16 v[228:231], v[32:35], a[20:23], 0
    s_add_u32 m0, s71, 9504
    v_mfma_f32_16x16x32_bf16 v[232:235], v[36:39], a[0:3], 0
    buffer_load_dwordx4 v41, s[20:23], s73 offen nt lds
    v_mfma_f32_16x16x32_bf16 v[236:239], v[36:39], a[4:7], 0
    v_mfma_f32_16x16x32_bf16 v[240:243], v[36:39], a[8:11], 0
    s_add_u32 m0, s71, 10560
    v_mfma_f32_16x16x32_bf16 v[244:247], v[36:39], a[12:15], 0
    buffer_load_dwordx4 v42, s[20:23], s73 offen nt lds
    v_mfma_f32_16x16x32_bf16 v[248:251], v[36:39], a[16:19], 0
    v_mfma_f32_16x16x32_bf16 v[252:255], v[36:39], a[20:23], 0
    s_waitcnt vmcnt(15)
    s_waitcnt lgkmcnt(0)
    v_mfma_f32_16x16x32_bf16 v[64:67], v[8:11], a[24:27], v[64:67]
    ds_read_b64_tr_b16 v[24:25], v3 offset:12672
    ds_read_b64_tr_b16 v[26:27], v3 offset:13184
    v_mfma_f32_16x16x32_bf16 v[68:71], v[8:11], a[28:31], v[68:71]
    ds_read_b64_tr_b16 v[28:29], v3 offset:12704
    ds_read_b64_tr_b16 v[30:31], v3 offset:13216
    v_mfma_f32_16x16x32_bf16 v[72:75], v[8:11], a[32:35], v[72:75]
    ds_read_b64_tr_b16 v[32:33], v3 offset:12736
    ds_read_b64_tr_b16 v[34:35], v3 offset:13248
    v_mfma_f32_16x16x32_bf16 v[76:79], v[8:11], a[36:39], v[76:79]
    ds_read_b64_tr_b16 v[36:37], v3 offset:12768
    ds_read_b64_tr_b16 v[38:39], v3 offset:13280
    v_mfma_f32_16x16x32_bf16 v[80:83], v[8:11], a[40:43], v[80:83]
    ds_read_b128 a[0:3], v1 offset:128
    ds_read_b128 a[4:7], v1 offset:640
    s_add_u32 m0, s71, 11616
    v_mfma_f32_16x16x32_bf16 v[84:87], v[8:11], a[44:47], v[84:87]
    ds_read_b128 a[8:11], v1 offset:8576
    buffer_load_dwordx4 v43, s[20:23], s73 offen nt lds
    v_mfma_f32_16x16x32_bf16 v[88:91], v[12:15], a[24:27], v[88:91]
    v_mfma_f32_16x16x32_bf16 v[92:95], v[12:15], a[28:31], v[92:95]
    s_add_u32 m0, s70, 25344
    s_add_u32 s75, s66, 0
    v_mfma_f32_16x16x32_bf16 v[96:99], v[12:15], a[32:35], v[96:99]
    buffer_load_dwordx4 v4, s[16:19], s75 offen nt lds
    v_mfma_f32_16x16x32_bf16 v[100:103], v[12:15], a[36:39], v[100:103]
    v_mfma_f32_16x16x32_bf16 v[104:107], v[12:15], a[40:43], v[104:107]
    s_add_u32 m0, s70, 26400
    s_add_u32 s75, s66, 5120
    v_mfma_f32_16x16x32_bf16 v[108:111], v[12:15], a[44:47], v[108:111]
    buffer_load_dwordx4 v4, s[16:19], s75 offen nt lds
    v_mfma_f32_16x16x32_bf16 v[112:115], v[16:19], a[24:27], v[112:115]
    v_mfma_f32_16x16x32_bf16 v[116:119], v[16:19], a[28:31], v[116:119]
    s_add_u32 m0, s70, 27456
    s_add_u32 s75, s66, 10240
    v_mfma_f32_16x16x32_bf16 v[120:123], v[16:19], a[32:35], v[120:123]
    buffer_load_dwordx4 v4, s[16:19], s75 offen nt lds
    v_mfma_f32_16x16x32_bf16 v[124:127], v[16:19], a[36:39], v[124:127]
    v_mfma_f32_16x16x32_bf16 v[128:131], v[16:19], a[40:43], v[128:131]
    v_mfma_f32_16x16x32_bf16 v[132:135], v[16:19], a[44:47], v[132:135]
    s_add_u32 m0, s70, 28512
    s_add_u32 s75, s66, 15360
    v_mfma_f32_16x16x32_bf16 v[136:139], v[20:23], a[24:27], v[136:139]
    buffer_load_dwordx4 v4, s[16:19], s75 offen nt lds
    v_mfma_f32_16x16x32_bf16 v[140:143], v[20:23], a[28:31], v[140:143]
    v_mfma_f32_16x16x32_bf16 v[144:147], v[20:23], a[32:35], v[144:147]
    s_add_u32 m0, s70, 29568
    s_add_u32 s75, s66, 20480
    v_mfma_f32_16x16x32_bf16 v[148:151], v[20:23], a[36:39], v[148:151]
    buffer_load_dwordx4 v4, s[16:19], s75 offen nt lds
    v_mfma_f32_16x16x32_bf16 v[152:155], v[20:23], a[40:43], v[152:155]
    v_mfma_f32_16x16x32_bf16 v[156:159], v[20:23], a[44:47], v[156:159]
    s_waitcnt vmcnt(17)
    s_waitcnt lgkmcnt(0)
    v_mfma_f32_16x16x32_bf16 v[160:163], v[24:27], a[24:27], v[160:163]
    ds_read_b64_tr_b16 v[8:9], v3 offset:16896
    ds_read_b64_tr_b16 v[10:11], v3 offset:17408
    v_mfma_f32_16x16x32_bf16 v[164:167], v[24:27], a[28:31], v[164:167]
    ds_read_b64_tr_b16 v[12:13], v3 offset:16928
    ds_read_b64_tr_b16 v[14:15], v3 offset:17440
    v_mfma_f32_16x16x32_bf16 v[168:171], v[24:27], a[32:35], v[168:171]
    ds_read_b64_tr_b16 v[16:17], v3 offset:16960
    ds_read_b64_tr_b16 v[18:19], v3 offset:17472
    v_mfma_f32_16x16x32_bf16 v[172:175], v[24:27], a[36:39], v[172:175]
    ds_read_b64_tr_b16 v[20:21], v3 offset:16992
    ds_read_b64_tr_b16 v[22:23], v3 offset:17504
    v_mfma_f32_16x16x32_bf16 v[176:179], v[24:27], a[40:43], v[176:179]
    ds_read_b128 a[12:15], v1 offset:9088
    ds_read_b128 a[16:19], v1 offset:17024
    s_add_u32 m0, s70, 30624
    s_add_u32 s75, s66, 25600
    v_mfma_f32_16x16x32_bf16 v[180:183], v[24:27], a[44:47], v[180:183]
    ds_read_b128 a[20:23], v1 offset:17536
    buffer_load_dwordx4 v4, s[16:19], s75 offen nt lds
    v_mfma_f32_16x16x32_bf16 v[184:187], v[28:31], a[24:27], v[184:187]
    v_mfma_f32_16x16x32_bf16 v[188:191], v[28:31], a[28:31], v[188:191]
    s_add_u32 s75, s74, 0
    v_mfma_f32_16x16x32_bf16 v[192:195], v[28:31], a[32:35], v[192:195]
    buffer_load_dwordx4 v[48:51], v0, s[8:11], s75 offen offset:0 nt
    v_mfma_f32_16x16x32_bf16 v[196:199], v[28:31], a[36:39], v[196:199]
    v_mfma_f32_16x16x32_bf16 v[200:203], v[28:31], a[40:43], v[200:203]
    v_mfma_f32_16x16x32_bf16 v[204:207], v[28:31], a[44:47], v[204:207]
    buffer_load_dwordx4 v[52:55], v0, s[8:11], s75 offen offset:1024 nt
    v_mfma_f32_16x16x32_bf16 v[208:211], v[32:35], a[24:27], v[208:211]
    v_mfma_f32_16x16x32_bf16 v[212:215], v[32:35], a[28:31], v[212:215]
    s_add_u32 s75, s74, 8192
    v_mfma_f32_16x16x32_bf16 v[216:219], v[32:35], a[32:35], v[216:219]
    buffer_load_dwordx4 v[56:59], v0, s[8:11], s75 offen offset:0 nt
    v_mfma_f32_16x16x32_bf16 v[220:223], v[32:35], a[36:39], v[220:223]
    v_mfma_f32_16x16x32_bf16 v[224:227], v[32:35], a[40:43], v[224:227]
    v_mfma_f32_16x16x32_bf16 v[228:231], v[32:35], a[44:47], v[228:231]
    v_mfma_f32_16x16x32_bf16 v[232:235], v[36:39], a[24:27], v[232:235]
    buffer_load_dwordx4 v[60:63], v0, s[8:11], s75 offen offset:1024 nt
    v_mfma_f32_16x16x32_bf16 v[236:239], v[36:39], a[28:31], v[236:239]
    v_mfma_f32_16x16x32_bf16 v[240:243], v[36:39], a[32:35], v[240:243]
    s_add_u32 s75, s74, 0
    v_mfma_f32_16x16x32_bf16 v[244:247], v[36:39], a[36:39], v[244:247]
    buffer_load_dwordx4 a[48:51], v0, s[12:15], s75 offen offset:0 nt
    v_mfma_f32_16x16x32_bf16 v[248:251], v[36:39], a[40:43], v[248:251]
    v_mfma_f32_16x16x32_bf16 v[252:255], v[36:39], a[44:47], v[252:255]
    s_waitcnt vmcnt(19)
    s_waitcnt lgkmcnt(0)
    v_mfma_f32_16x16x32_bf16 v[64:67], v[8:11], a[0:3], v[64:67]
    ds_read_b64_tr_b16 v[24:25], v3 offset:0
    ds_read_b64_tr_b16 v[26:27], v3 offset:512
    v_mfma_f32_16x16x32_bf16 v[68:71], v[8:11], a[4:7], v[68:71]
    ds_read_b64_tr_b16 v[28:29], v3 offset:32
    ds_read_b64_tr_b16 v[30:31], v3 offset:544
    v_mfma_f32_16x16x32_bf16 v[72:75], v[8:11], a[8:11], v[72:75]
    ds_read_b64_tr_b16 v[32:33], v3 offset:64
    ds_read_b64_tr_b16 v[34:35], v3 offset:576
    v_mfma_f32_16x16x32_bf16 v[76:79], v[8:11], a[12:15], v[76:79]
    ds_read_b64_tr_b16 v[36:37], v3 offset:96
    ds_read_b64_tr_b16 v[38:39], v3 offset:608
    v_mfma_f32_16x16x32_bf16 v[80:83], v[8:11], a[16:19], v[80:83]
    ds_read_b128 a[24:27], v1 offset:192
    ds_read_b128 a[28:31], v1 offset:704
    v_mfma_f32_16x16x32_bf16 v[84:87], v[8:11], a[20:23], v[84:87]
    ds_read_b128 a[32:35], v1 offset:8640
    buffer_load_dwordx4 a[52:55], v0, s[12:15], s75 offen offset:1024 nt
    v_mfma_f32_16x16x32_bf16 v[88:91], v[12:15], a[0:3], v[88:91]
    v_mfma_f32_16x16x32_bf16 v[92:95], v[12:15], a[4:7], v[92:95]
    s_add_u32 s73, s61, 0
    s_add_u32 m0, s71, 12672
    v_mfma_f32_16x16x32_bf16 v[96:99], v[12:15], a[8:11], v[96:99]
    buffer_load_dwordx4 v40, s[20:23], s73 offen lds
    v_mfma_f32_16x16x32_bf16 v[100:103], v[12:15], a[12:15], v[100:103]
    v_mfma_f32_16x16x32_bf16 v[104:107], v[12:15], a[16:19], v[104:107]
    s_add_u32 m0, s71, 13728
    v_mfma_f32_16x16x32_bf16 v[108:111], v[12:15], a[20:23], v[108:111]
    buffer_load_dwordx4 v41, s[20:23], s73 offen lds
    v_mfma_f32_16x16x32_bf16 v[112:115], v[16:19], a[0:3], v[112:115]
    v_mfma_f32_16x16x32_bf16 v[116:119], v[16:19], a[4:7], v[116:119]
    s_add_u32 m0, s71, 14784
    v_mfma_f32_16x16x32_bf16 v[120:123], v[16:19], a[8:11], v[120:123]
    buffer_load_dwordx4 v42, s[20:23], s73 offen lds
    v_mfma_f32_16x16x32_bf16 v[124:127], v[16:19], a[12:15], v[124:127]
    v_mfma_f32_16x16x32_bf16 v[128:131], v[16:19], a[16:19], v[128:131]
    v_mfma_f32_16x16x32_bf16 v[132:135], v[16:19], a[20:23], v[132:135]
    s_add_u32 m0, s71, 15840
    v_mfma_f32_16x16x32_bf16 v[136:139], v[20:23], a[0:3], v[136:139]
    buffer_load_dwordx4 v43, s[20:23], s73 offen lds
    v_mfma_f32_16x16x32_bf16 v[140:143], v[20:23], a[4:7], v[140:143]
    v_mfma_f32_16x16x32_bf16 v[144:147], v[20:23], a[8:11], v[144:147]
    s_add_u32 s73, s61, 128
    s_add_u32 m0, s71, 16896
    v_mfma_f32_16x16x32_bf16 v[148:151], v[20:23], a[12:15], v[148:151]
    buffer_load_dwordx4 v40, s[20:23], s73 offen lds
    v_mfma_f32_16x16x32_bf16 v[152:155], v[20:23], a[16:19], v[152:155]
    v_mfma_f32_16x16x32_bf16 v[156:159], v[20:23], a[20:23], v[156:159]
    s_waitcnt vmcnt(21)
    s_waitcnt lgkmcnt(0)
    v_mfma_f32_16x16x32_bf16 v[160:163], v[24:27], a[0:3], v[160:163]
    ds_read_b64_tr_b16 v[8:9], v3 offset:4224
    ds_read_b64_tr_b16 v[10:11], v3 offset:4736
    v_mfma_f32_16x16x32_bf16 v[164:167], v[24:27], a[4:7], v[164:167]
    ds_read_b64_tr_b16 v[12:13], v3 offset:4256
    ds_read_b64_tr_b16 v[14:15], v3 offset:4768
    v_mfma_f32_16x16x32_bf16 v[168:171], v[24:27], a[8:11], v[168:171]
    ds_read_b64_tr_b16 v[16:17], v3 offset:4288
    ds_read_b64_tr_b16 v[18:19], v3 offset:4800
    v_mfma_f32_16x16x32_bf16 v[172:175], v[24:27], a[12:15], v[172:175]
    ds_read_b64_tr_b16 v[20:21], v3 offset:4320
    ds_read_b64_tr_b16 v[22:23], v3 offset:4832
    v_mfma_f32_16x16x32_bf16 v[176:179], v[24:27], a[16:19], v[176:179]
    ds_read_b128 a[36:39], v1 offset:9152
    ds_read_b128 a[40:43], v1 offset:17088
    s_add_u32 m0, s71, 17952
    v_mfma_f32_16x16x32_bf16 v[180:183], v[24:27], a[20:23], v[180:183]
    ds_read_b128 a[44:47], v1 offset:17600
    buffer_load_dwordx4 v41, s[20:23], s73 offen lds
    v_mfma_f32_16x16x32_bf16 v[184:187], v[28:31], a[0:3], v[184:187]
    v_mfma_f32_16x16x32_bf16 v[188:191], v[28:31], a[4:7], v[188:191]
    s_add_u32 m0, s71, 19008
    v_mfma_f32_16x16x32_bf16 v[192:195], v[28:31], a[8:11], v[192:195]
    buffer_load_dwordx4 v42, s[20:23], s73 offen lds
    v_mfma_f32_16x16x32_bf16 v[196:199], v[28:31], a[12:15], v[196:199]
    v_mfma_f32_16x16x32_bf16 v[200:203], v[28:31], a[16:19], v[200:203]
    s_add_u32 m0, s71, 20064
    v_mfma_f32_16x16x32_bf16 v[204:207], v[28:31], a[20:23], v[204:207]
    buffer_load_dwordx4 v43, s[20:23], s73 offen lds
    v_mfma_f32_16x16x32_bf16 v[208:211], v[32:35], a[0:3], v[208:211]
    v_mfma_f32_16x16x32_bf16 v[212:215], v[32:35], a[4:7], v[212:215]
    s_add_u32 s73, s61, 262144
    s_add_u32 m0, s71, 0
    v_mfma_f32_16x16x32_bf16 v[216:219], v[32:35], a[8:11], v[216:219]
    buffer_load_dwordx4 v40, s[20:23], s73 offen lds
    v_mfma_f32_16x16x32_bf16 v[220:223], v[32:35], a[12:15], v[220:223]
    v_mfma_f32_16x16x32_bf16 v[224:227], v[32:35], a[16:19], v[224:227]
    v_mfma_f32_16x16x32_bf16 v[228:231], v[32:35], a[20:23], v[228:231]
    s_add_u32 m0, s71, 1056
    v_mfma_f32_16x16x32_bf16 v[232:235], v[36:39], a[0:3], v[232:235]
    buffer_load_dwordx4 v41, s[20:23], s73 offen lds
    v_mfma_f32_16x16x32_bf16 v[236:239], v[36:39], a[4:7], v[236:239]
    v_mfma_f32_16x16x32_bf16 v[240:243], v[36:39], a[8:11], v[240:243]
    s_add_u32 m0, s71, 2112
    v_mfma_f32_16x16x32_bf16 v[244:247], v[36:39], a[12:15], v[244:247]
    buffer_load_dwordx4 v42, s[20:23], s73 offen lds
    v_mfma_f32_16x16x32_bf16 v[248:251], v[36:39], a[16:19], v[248:251]
    v_mfma_f32_16x16x32_bf16 v[252:255], v[36:39], a[20:23], v[252:255]
    s_waitcnt vmcnt(17)
    s_waitcnt lgkmcnt(0)
    s_barrier
    v_add_u32 v1, 25344, v1
    v_mfma_f32_16x16x32_bf16 v[64:67], v[8:11], a[24:27], v[64:67]
    ds_read_b64_tr_b16 v[24:25], v3 offset:8448
    ds_read_b64_tr_b16 v[26:27], v3 offset:8960
    v_mfma_f32_16x16x32_bf16 v[68:71], v[8:11], a[28:31], v[68:71]
    ds_read_b64_tr_b16 v[28:29], v3 offset:8480
    ds_read_b64_tr_b16 v[30:31], v3 offset:8992
    v_mfma_f32_16x16x32_bf16 v[72:75], v[8:11], a[32:35], v[72:75]
    ds_read_b64_tr_b16 v[32:33], v3 offset:8512
    ds_read_b64_tr_b16 v[34:35], v3 offset:9024
    v_mfma_f32_16x16x32_bf16 v[76:79], v[8:11], a[36:39], v[76:79]
    ds_read_b64_tr_b16 v[36:37], v3 offset:8544
    ds_read_b64_tr_b16 v[38:39], v3 offset:9056
    v_mfma_f32_16x16x32_bf16 v[80:83], v[8:11], a[40:43], v[80:83]
    ds_read_b128 a[0:3], v1 offset:0
    ds_read_b128 a[4:7], v1 offset:512
    s_add_u32 m0, s71, 3168
    v_mfma_f32_16x16x32_bf16 v[84:87], v[8:11], a[44:47], v[84:87]
    ds_read_b128 a[8:11], v1 offset:8448
    buffer_load_dwordx4 v43, s[20:23], s73 offen lds
    v_mfma_f32_16x16x32_bf16 v[88:91], v[12:15], a[24:27], v[88:91]
    v_mfma_f32_16x16x32_bf16 v[92:95], v[12:15], a[28:31], v[92:95]
    s_add_u32 s73, s61, 262272
    s_add_u32 m0, s71, 4224
    v_mfma_f32_16x16x32_bf16 v[96:99], v[12:15], a[32:35], v[96:99]
    buffer_load_dwordx4 v40, s[20:23], s73 offen lds
    v_mfma_f32_16x16x32_bf16 v[100:103], v[12:15], a[36:39], v[100:103]
    v_mfma_f32_16x16x32_bf16 v[104:107], v[12:15], a[40:43], v[104:107]
    s_add_u32 m0, s71, 5280
    v_mfma_f32_16x16x32_bf16 v[108:111], v[12:15], a[44:47], v[108:111]
    buffer_load_dwordx4 v41, s[20:23], s73 offen lds
    v_mfma_f32_16x16x32_bf16 v[112:115], v[16:19], a[24:27], v[112:115]
    v_mfma_f32_16x16x32_bf16 v[116:119], v[16:19], a[28:31], v[116:119]
    s_add_u32 m0, s71, 6336
    v_mfma_f32_16x16x32_bf16 v[120:123], v[16:19], a[32:35], v[120:123]
    buffer_load_dwordx4 v42, s[20:23], s73 offen lds
    v_mfma_f32_16x16x32_bf16 v[124:127], v[16:19], a[36:39], v[124:127]
    v_mfma_f32_16x16x32_bf16 v[128:131], v[16:19], a[40:43], v[128:131]
    v_mfma_f32_16x16x32_bf16 v[132:135], v[16:19], a[44:47], v[132:135]
    s_add_u32 m0, s71, 7392
    v_mfma_f32_16x16x32_bf16 v[136:139], v[20:23], a[24:27], v[136:139]
    buffer_load_dwordx4 v43, s[20:23], s73 offen lds
    v_mfma_f32_16x16x32_bf16 v[140:143], v[20:23], a[28:31], v[140:143]
    v_mfma_f32_16x16x32_bf16 v[144:147], v[20:23], a[32:35], v[144:147]
    s_waitcnt lgkmcnt(3)
    s_add_u32 s73, s61, 524288
    s_add_u32 m0, s71, 8448
    v_mfma_f32_16x16x32_bf16 v[148:151], v[20:23], a[36:39], v[148:151]
    buffer_load_dwordx4 v40, s[20:23], s73 offen lds
    v_mfma_f32_16x16x32_bf16 v[152:155], v[20:23], a[40:43], v[152:155]
    v_mfma_f32_16x16x32_bf16 v[156:159], v[20:23], a[44:47], v[156:159]
    s_waitcnt vmcnt(13)
    s_waitcnt lgkmcnt(0)
    v_mfma_f32_16x16x32_bf16 v[160:163], v[24:27], a[24:27], v[160:163]
    ds_read_b64_tr_b16 v[8:9], v3 offset:12672
    ds_read_b64_tr_b16 v[10:11], v3 offset:13184
    v_mfma_f32_16x16x32_bf16 v[164:167], v[24:27], a[28:31], v[164:167]
    ds_read_b64_tr_b16 v[12:13], v3 offset:12704
    ds_read_b64_tr_b16 v[14:15], v3 offset:13216
    v_mfma_f32_16x16x32_bf16 v[168:171], v[24:27], a[32:35], v[168:171]
    ds_read_b64_tr_b16 v[16:17], v3 offset:12736
    ds_read_b64_tr_b16 v[18:19], v3 offset:13248
    v_mfma_f32_16x16x32_bf16 v[172:175], v[24:27], a[36:39], v[172:175]
    ds_read_b64_tr_b16 v[20:21], v3 offset:12768
    ds_read_b64_tr_b16 v[22:23], v3 offset:13280
    v_mfma_f32_16x16x32_bf16 v[176:179], v[24:27], a[40:43], v[176:179]
    ds_read_b128 a[12:15], v1 offset:8960
    ds_read_b128 a[16:19], v1 offset:16896
    s_add_u32 m0, s71, 9504
    v_mfma_f32_16x16x32_bf16 v[180:183], v[24:27], a[44:47], v[180:183]
    ds_read_b128 a[20:23], v1 offset:17408
    buffer_load_dwordx4 v41, s[20:23], s73 offen lds
    v_mfma_f32_16x16x32_bf16 v[184:187], v[28:31], a[24:27], v[184:187]
    v_mfma_f32_16x16x32_bf16 v[188:191], v[28:31], a[28:31], v[188:191]
    s_add_u32 m0, s71, 10560
    v_mfma_f32_16x16x32_bf16 v[192:195], v[28:31], a[32:35], v[192:195]
    buffer_load_dwordx4 v42, s[20:23], s73 offen lds
    v_mfma_f32_16x16x32_bf16 v[196:199], v[28:31], a[36:39], v[196:199]
    v_mfma_f32_16x16x32_bf16 v[200:203], v[28:31], a[40:43], v[200:203]
    s_add_u32 m0, s71, 11616
    v_mfma_f32_16x16x32_bf16 v[204:207], v[28:31], a[44:47], v[204:207]
    buffer_load_dwordx4 v43, s[20:23], s73 offen lds
    v_mfma_f32_16x16x32_bf16 v[208:211], v[32:35], a[24:27], v[208:211]
    v_mfma_f32_16x16x32_bf16 v[212:215], v[32:35], a[28:31], v[212:215]
    s_waitcnt lgkmcnt(3)
    s_add_u32 s73, s61, 524416
    s_add_u32 m0, s71, 12672
    v_mfma_f32_16x16x32_bf16 v[216:219], v[32:35], a[32:35], v[216:219]
    buffer_load_dwordx4 v40, s[20:23], s73 offen lds
    v_mfma_f32_16x16x32_bf16 v[220:223], v[32:35], a[36:39], v[220:223]
    v_mfma_f32_16x16x32_bf16 v[224:227], v[32:35], a[40:43], v[224:227]
    v_mfma_f32_16x16x32_bf16 v[228:231], v[32:35], a[44:47], v[228:231]
    s_add_u32 m0, s71, 13728
    v_mfma_f32_16x16x32_bf16 v[232:235], v[36:39], a[24:27], v[232:235]
    buffer_load_dwordx4 v41, s[20:23], s73 offen lds
    v_mfma_f32_16x16x32_bf16 v[236:239], v[36:39], a[28:31], v[236:239]
    v_mfma_f32_16x16x32_bf16 v[240:243], v[36:39], a[32:35], v[240:243]
    s_add_u32 m0, s71, 14784
    v_mfma_f32_16x16x32_bf16 v[244:247], v[36:39], a[36:39], v[244:247]
    buffer_load_dwordx4 v42, s[20:23], s73 offen lds
    v_mfma_f32_16x16x32_bf16 v[248:251], v[36:39], a[40:43], v[248:251]
    v_mfma_f32_16x16x32_bf16 v[252:255], v[36:39], a[44:47], v[252:255]
    s_waitcnt vmcnt(15)
    s_waitcnt lgkmcnt(0)
    v_mfma_f32_16x16x32_bf16 v[64:67], v[8:11], a[0:3], v[64:67]
    ds_read_b64_tr_b16 v[24:25], v3 offset:16896
    ds_read_b64_tr_b16 v[26:27], v3 offset:17408
    v_mfma_f32_16x16x32_bf16 v[68:71], v[8:11], a[4:7], v[68:71]
    ds_read_b64_tr_b16 v[28:29], v3 offset:16928
    ds_read_b64_tr_b16 v[30:31], v3 offset:17440
    v_mfma_f32_16x16x32_bf16 v[72:75], v[8:11], a[8:11], v[72:75]
    ds_read_b64_tr_b16 v[32:33], v3 offset:16960
    ds_read_b64_tr_b16 v[34:35], v3 offset:17472
    v_mfma_f32_16x16x32_bf16 v[76:79], v[8:11], a[12:15], v[76:79]
    ds_read_b64_tr_b16 v[36:37], v3 offset:16992
    ds_read_b64_tr_b16 v[38:39], v3 offset:17504
    v_mfma_f32_16x16x32_bf16 v[80:83], v[8:11], a[16:19], v[80:83]
    ds_read_b128 a[24:27], v1 offset:64
    ds_read_b128 a[28:31], v1 offset:576
    s_add_u32 m0, s71, 15840
    v_mfma_f32_16x16x32_bf16 v[84:87], v[8:11], a[20:23], v[84:87]
    ds_read_b128 a[32:35], v1 offset:8512
    buffer_load_dwordx4 v43, s[20:23], s73 offen lds
    v_mfma_f32_16x16x32_bf16 v[88:91], v[12:15], a[0:3], v[88:91]
    v_mfma_f32_16x16x32_bf16 v[92:95], v[12:15], a[4:7], v[92:95]
    v_mfma_f32_16x16x32_bf16 v[96:99], v[12:15], a[8:11], v[96:99]
    v_mfma_f32_16x16x32_bf16 v[100:103], v[12:15], a[12:15], v[100:103]
    s_waitcnt lgkmcnt(3)
    s_add_u32 s73, s61, 786432
    s_add_u32 m0, s71, 16896
    v_mfma_f32_16x16x32_bf16 v[104:107], v[12:15], a[16:19], v[104:107]
    buffer_load_dwordx4 v40, s[20:23], s73 offen lds
    s_add_u32 m0, s71, 17952
    v_mfma_f32_16x16x32_bf16 v[108:111], v[12:15], a[20:23], v[108:111]
    buffer_load_dwordx4 v41, s[20:23], s73 offen lds
    s_add_u32 m0, s71, 19008
    v_mfma_f32_16x16x32_bf16 v[112:115], v[16:19], a[0:3], v[112:115]
    buffer_load_dwordx4 v42, s[20:23], s73 offen lds
    s_add_u32 m0, s71, 20064
    v_mfma_f32_16x16x32_bf16 v[116:119], v[16:19], a[4:7], v[116:119]
    buffer_load_dwordx4 v43, s[20:23], s73 offen lds
    v_mfma_f32_16x16x32_bf16 v[120:123], v[16:19], a[8:11], v[120:123]
    v_mfma_f32_16x16x32_bf16 v[124:127], v[16:19], a[12:15], v[124:127]
    v_mfma_f32_16x16x32_bf16 v[128:131], v[16:19], a[16:19], v[128:131]
    v_mfma_f32_16x16x32_bf16 v[132:135], v[16:19], a[20:23], v[132:135]
    v_mfma_f32_16x16x32_bf16 v[136:139], v[20:23], a[0:3], v[136:139]
    v_mfma_f32_16x16x32_bf16 v[140:143], v[20:23], a[4:7], v[140:143]
    v_mfma_f32_16x16x32_bf16 v[144:147], v[20:23], a[8:11], v[144:147]
    v_mfma_f32_16x16x32_bf16 v[148:151], v[20:23], a[12:15], v[148:151]
    v_mfma_f32_16x16x32_bf16 v[152:155], v[20:23], a[16:19], v[152:155]
    v_mfma_f32_16x16x32_bf16 v[156:159], v[20:23], a[20:23], v[156:159]
    s_waitcnt vmcnt(16)
    s_waitcnt lgkmcnt(0)
    s_or_b32 s32, s4, s3
    s_cbranch_scc1 L_notag
    s_memrealtime s[34:35]
    s_lshl_b32 s32, s6, 4
    s_add_u32 s32, s32, s5
    s_lshl_b32 s32, s32, 3
    v_mov_b32 v46, s32
    s_waitcnt lgkmcnt(0)
    s_or_b32 s34, s34, 1
    v_mov_b32 v44, s34
    v_mov_b32 v45, s35
    s_mov_b64 exec, 1
    global_store_dwordx2 v46, v[44:45], s[58:59] sc1
    s_mov_b64 exec, -1
L_notag:
    v_mfma_f32_16x16x32_bf16 v[160:163], v[24:27], a[0:3], v[160:163]
    ds_read_b64_tr_b16 v[8:9], v3 offset:0
    ds_read_b64_tr_b16 v[10:11], v3 offset:512
    v_mfma_f32_16x16x32_bf16 v[164:167], v[24:27], a[4:7], v[164:167]
    ds_read_b64_tr_b16 v[12:13], v3 offset:32
    ds_read_b64_tr_b16 v[14:15], v3 offset:544
    v_mfma_f32_16x16x32_bf16 v[168:171], v[24:27], a[8:11], v[168:171]
    ds_read_b64_tr_b16 v[16:17], v3 offset:64
    ds_read_b64_tr_b16 v[18:19], v3 offset:576
    v_mfma_f32_16x16x32_bf16 v[172:175], v[24:27], a[12:15], v[172:175]
    ds_read_b64_tr_b16 v[20:21], v3 offset:96
    ds_read_b64_tr_b16 v[22:23], v3 offset:608
    v_mfma_f32_16x16x32_bf16 v[176:179], v[24:27], a[16:19], v[176:179]
    ds_read_b128 a[36:39], v1 offset:9024
    ds_read_b128 a[40:43], v1 offset:16960
    v_mfma_f32_16x16x32_bf16 v[180:183], v[24:27], a[20:23], v[180:183]
    ds_read_b128 a[44:47], v1 offset:17472
    v_mfma_f32_16x16x32_bf16 v[184:187], v[28:31], a[0:3], v[184:187]
    v_mfma_f32_16x16x32_bf16 v[188:191], v[28:31], a[4:7], v[188:191]
    v_mfma_f32_16x16x32_bf16 v[192:195], v[28:31], a[8:11], v[192:195]
    v_mfma_f32_16x16x32_bf16 v[196:199], v[28:31], a[12:15], v[196:199]
    s_waitcnt lgkmcnt(3)
    s_add_u32 s73, s61, 786560
    s_add_u32 m0, s71, 0
    v_mfma_f32_16x16x32_bf16 v[200:203], v[28:31], a[16:19], v[200:203]
    buffer_load_dwordx4 v40, s[20:23], s73 offen lds
    s_add_u32 m0, s71, 1056
    v_mfma_f32_16x16x32_bf16 v[204:207], v[28:31], a[20:23], v[204:207]
    buffer_load_dwordx4 v41, s[20:23], s73 offen lds
    s_add_u32 m0, s71, 2112
    v_mfma_f32_16x16x32_bf16 v[208:211], v[32:35], a[0:3], v[208:211]
    buffer_load_dwordx4 v42, s[20:23], s73 offen lds
    s_add_u32 m0, s71, 3168
    v_mfma_f32_16x16x32_bf16 v[212:215], v[32:35], a[4:7], v[212:215]
    buffer_load_dwordx4 v43, s[20:23], s73 offen lds
    v_mfma_f32_16x16x32_bf16 v[216:219], v[32:35], a[8:11], v[216:219]
    v_mfma_f32_16x16x32_bf16 v[220:223], v[32:35], a[12:15], v[220:223]
    s_add_u32 m0, s70, 0
    s_add_u32 s75, s67, 0
    v_mfma_f32_16x16x32_bf16 v[224:227], v[32:35], a[16:19], v[224:227]
    buffer_load_dwordx4 v4, s[16:19], s75 offen nt lds
    v_mfma_f32_16x16x32_bf16 v[228:231], v[32:35], a[20:23], v[228:231]
    v_mfma_f32_16x16x32_bf16 v[232:235], v[36:39], a[0:3], v[232:235]
    s_add_u32 m0, s70, 1056
    s_add_u32 s75, s67, 5120
    v_mfma_f32_16x16x32_bf16 v[236:239], v[36:39], a[4:7], v[236:239]
    buffer_load_dwordx4 v4, s[16:19], s75 offen nt lds
    v_mfma_f32_16x16x32_bf16 v[240:243], v[36:39], a[8:11], v[240:243]
    v_mfma_f32_16x16x32_bf16 v[244:247], v[36:39], a[12:15], v[244:247]
    s_add_u32 m0, s70, 2112
    s_add_u32 s75, s67, 10240
    v_mfma_f32_16x16x32_bf16 v[248:251], v[36:39], a[16:19], v[248:251]
    buffer_load_dwordx4 v4, s[16:19], s75 offen nt lds
    v_mfma_f32_16x16x32_bf16 v[252:255], v[36:39], a[20:23], v[252:255]
    s_waitcnt vmcnt(19)
    s_waitcnt lgkmcnt(0)
    v_mfma_f32_16x16x32_bf16 v[64:67], v[8:11], a[24:27], v[64:67]
    ds_read_b64_tr_b16 v[24:25], v3 offset:4224
    ds_read_b64_tr_b16 v[26:27], v3 offset:4736
    v_mfma_f32_16x16x32_bf16 v[68:71], v[8:11], a[28:31], v[68:71]
    ds_read_b64_tr_b16 v[28:29], v3 offset:4256
    ds_read_b64_tr_b16 v[30:31], v3 offset:4768
    v_mfma_f32_16x16x32_bf16 v[72:75], v[8:11], a[32:35], v[72:75]
    ds_read_b64_tr_b16 v[32:33], v3 offset:4288
    ds_read_b64_tr_b16 v[34:35], v3 offset:4800
    v_mfma_f32_16x16x32_bf16 v[76:79], v[8:11], a[36:39], v[76:79]
    ds_read_b64_tr_b16 v[36:37], v3 offset:4320
    ds_read_b64_tr_b16 v[38:39], v3 offset:4832
    v_mfma_f32_16x16x32_bf16 v[80:83], v[8:11], a[40:43], v[80:83]
    ds_read_b128 a[0:3], v1 offset:128
    ds_read_b128 a[4:7], v1 offset:640
    s_add_u32 m0, s70, 3168
    s_add_u32 s75, s67, 15360
    v_mfma_f32_16x16x32_bf16 v[84:87], v[8:11], a[44:47], v[84:87]
    ds_read_b128 a[8:11], v1 offset:8576
    buffer_load_dwordx4 v4, s[16:19], s75 offen nt lds
    v_mfma_f32_16x16x32_bf16 v[88:91], v[12:15], a[24:27], v[88:91]
    v_mfma_f32_16x16x32_bf16 v[92:95], v[12:15], a[28:31], v[92:95]
    s_add_u32 m0, s70, 4224
    s_add_u32 s75, s67, 20480
    v_mfma_f32_16x16x32_bf16 v[96:99], v[12:15], a[32:35], v[96:99]
    buffer_load_dwordx4 v4, s[16:19], s75 offen nt lds
    v_mfma_f32_16x16x32_bf16 v[100:103], v[12:15], a[36:39], v[100:103]
    v_mfma_f32_16x16x32_bf16 v[104:107], v[12:15], a[40:43], v[104:107]
    s_add_u32 m0, s70, 5280
    s_add_u32 s75, s67, 25600
    v_mfma_f32_16x16x32_bf16 v[108:111], v[12:15], a[44:47], v[108:111]
    buffer_load_dwordx4 v4, s[16:19], s75 offen nt lds
    v_mfma_f32_16x16x32_bf16 v[112:115], v[16:19], a[24:27], v[112:115]
    v_mfma_f32_16x16x32_bf16 v[116:119], v[16:19], a[28:31], v[116:119]
    s_add_u32 s75, s74, 16384
    v_mfma_f32_16x16x32_bf16 v[120:123], v[16:19], a[32:35], v[120:123]
    buffer_load_dwordx4 a[56:59], v0, s[8:11], s75 offen offset:0 nt
    v_mfma_f32_16x16x32_bf16 v[124:127], v[16:19], a[36:39], v[124:127]
    v_mfma_f32_16x16x32_bf16 v[128:131], v[16:19], a[40:43], v[128:131]
    v_mfma_f32_16x16x32_bf16 v[132:135], v[16:19], a[44:47], v[132:135]
    v_mfma_f32_16x16x32_bf16 v[136:139], v[20:23], a[24:27], v[136:139]
    buffer_load_dwordx4 a[60:63], v0, s[8:11], s75 offen offset:1024 nt
    v_mfma_f32_16x16x32_bf16 v[140:143], v[20:23], a[28:31], v[140:143]
    v_mfma_f32_16x16x32_bf16 v[144:147], v[20:23], a[32:35], v[144:147]
    s_add_u32 s75, s74, 8192
    v_mfma_f32_16x16x32_bf16 v[148:151], v[20:23], a[36:39], v[148:151]
    buffer_load_dwordx4 a[64:67], v0, s[12:15], s75 offen offset:0 nt
    v_mfma_f32_16x16x32_bf16 v[152:155], v[20:23], a[40:43], v[152:155]
    v_mfma_f32_16x16x32_bf16 v[156:159], v[20:23], a[44:47], v[156:159]
    s_waitcnt vmcnt(21)
    s_waitcnt lgkmcnt(0)
    v_mfma_f32_16x16x32_bf16 v[160:163], v[24:27], a[24:27], v[160:163]
    ds_read_b64_tr_b16 v[8:9], v3 offset:8448
    ds_read_b64_tr_b16 v[10:11], v3 offset:8960
    v_mfma_f32_16x16x32_bf16 v[164:167], v[24:27], a[28:31], v[164:167]
    ds_read_b64_tr_b16 v[12:13], v3 offset:8480
    ds_read_b64_tr_b16 v[14:15], v3 offset:8992
    v_mfma_f32_16x16x32_bf16 v[168:171], v[24:27], a[32:35], v[168:171]
    ds_read_b64_tr_b16 v[16:17], v3 offset:8512
    ds_read_b64_tr_b16 v[18:19], v3 offset:9024
    v_mfma_f32_16x16x32_bf16 v[172:175], v[24:27], a[36:39], v[172:175]
    ds_read_b64_tr_b16 v[20:21], v3 offset:8544
    ds_read_b64_tr_b16 v[22:23], v3 offset:9056
    v_mfma_f32_16x16x32_bf16 v[176:179], v[24:27], a[40:43], v[176:179]
    ds_read_b128 a[12:15], v1 offset:9088
    ds_read_b128 a[16:19], v1 offset:17024
    v_mfma_f32_16x16x32_bf16 v[180:183], v[24:27], a[44:47], v[180:183]
    ds_read_b128 a[20:23], v1 offset:17536
    buffer_load_dwordx4 a[68:71], v0, s[12:15], s75 offen offset:1024 nt
    v_mfma_f32_16x16x32_bf16 v[184:187], v[28:31], a[24:27], v[184:187]
    v_mfma_f32_16x16x32_bf16 v[188:191], v[28:31], a[28:31], v[188:191]
    s_add_u32 s75, s74, 24576
    v_mfma_f32_16x16x32_bf16 v[192:195], v[28:31], a[32:35], v[192:195]
    buffer_load_dwordx4 a[72:75], v0, s[8:11], s75 offen offset:0 nt
    v_mfma_f32_16x16x32_bf16 v[196:199], v[28:31], a[36:39], v[196:199]
    v_mfma_f32_16x16x32_bf16 v[200:203], v[28:31], a[40:43], v[200:203]
    v_mfma_f32_16x16x32_bf16 v[204:207], v[28:31], a[44:47], v[204:207]
    buffer_load_dwordx4 a[76:79], v0, s[8:11], s75 offen offset:1024 nt
    v_mfma_f32_16x16x32_bf16 v[208:211], v[32:35], a[24:27], v[208:211]
    v_mfma_f32_16x16x32_bf16 v[212:215], v[32:35], a[28:31], v[212:215]
    s_add_u32 s75, s74, 16384
    v_mfma_f32_16x16x32_bf16 v[216:219], v[32:35], a[32:35], v[216:219]
    buffer_load_dwordx4 a[80:83], v0, s[12:15], s75 offen offset:0 nt
    v_mfma_f32_16x16x32_bf16 v[220:223], v[32:35], a[36:39], v[220:223]
    v_mfma_f32_16x16x32_bf16 v[224:227], v[32:35], a[40:43], v[224:227]
    v_mfma_f32_16x16x32_bf16 v[228:231], v[32:35], a[44:47], v[228:231]
    v_mfma_f32_16x16x32_bf16 v[232:235], v[36:39], a[24:27], v[232:235]
    buffer_load_dwordx4 a[84:87], v0, s[12:15], s75 offen offset:1024 nt
    v_mfma_f32_16x16x32_bf16 v[236:239], v[36:39], a[28:31], v[236:239]
    v_mfma_f32_16x16x32_bf16 v[240:243], v[36:39], a[32:35], v[240:243]
    s_add_u32 s75, s74, 32768
    v_mfma_f32_16x16x32_bf16 v[244:247], v[36:39], a[36:39], v[244:247]
    buffer_load_dwordx4 a[88:91], v0, s[8:11], s75 offen offset:0 nt
    v_mfma_f32_16x16x32_bf16 v[248:251], v[36:39], a[40:43], v[248:251]
    v_mfma_f32_16x16x32_bf16 v[252:255], v[36:39], a[44:47], v[252:255]
    s_waitcnt vmcnt(23)
    s_waitcnt lgkmcnt(0)
    v_mfma_f32_16x16x32_bf16 v[64:67], v[8:11], a[0:3], v[64:67]
    ds_read_b64_tr_b16 v[24:25], v3 offset:12672
    ds_read_b64_tr_b16 v[26:27], v3 offset:13184
    v_mfma_f32_16x16x32_bf16 v[68:71], v[8:11], a[4:7], v[68:71]
    ds_read_b64_tr_b16 v[28:29], v3 offset:12704
    ds_read_b64_tr_b16 v[30:31], v3 offset:13216
    v_mfma_f32_16x16x32_bf16 v[72:75], v[8:11], a[8:11], v[72:75]
    ds_read_b64_tr_b16 v[32:33], v3 offset:12736
    ds_read_b64_tr_b16 v[34:35], v3 offset:13248
    v_mfma_f32_16x16x32_bf16 v[76:79], v[8:11], a[12:15], v[76:79]
    ds_read_b64_tr_b16 v[36:37], v3 offset:12768
    ds_read_b64_tr_b16 v[38:39], v3 offset:13280
    v_mfma_f32_16x16x32_bf16 v[80:83], v[8:11], a[16:19], v[80:83]
    ds_read_b128 a[24:27], v1 offset:192
    ds_read_b128 a[28:31], v1 offset:704
    v_mfma_f32_16x16x32_bf16 v[84:87], v[8:11], a[20:23], v[84:87]
    ds_read_b128 a[32:35], v1 offset:8640
    buffer_load_dwordx4 a[92:95], v0, s[8:11], s75 offen offset:1024 nt
    v_mfma_f32_16x16x32_bf16 v[88:91], v[12:15], a[0:3], v[88:91]
    v_mfma_f32_16x16x32_bf16 v[92:95], v[12:15], a[4:7], v[92:95]
    s_add_u32 s73, s62, 0
    s_add_u32 m0, s71, 4224
    v_mfma_f32_16x16x32_bf16 v[96:99], v[12:15], a[8:11], v[96:99]
    buffer_load_dwordx4 v40, s[20:23], s73 offen lds
    v_mfma_f32_16x16x32_bf16 v[100:103], v[12:15], a[12:15], v[100:103]
    v_mfma_f32_16x16x32_bf16 v[104:107], v[12:15], a[16:19], v[104:107]
    s_add_u32 m0, s71, 5280
    v_mfma_f32_16x16x32_bf16 v[108:111], v[12:15], a[20:23], v[108:111]
    buffer_load_dwordx4 v41, s[20:23], s73 offen lds
    v_mfma_f32_16x16x32_bf16 v[112:115], v[16:19], a[0:3], v[112:115]
    v_mfma_f32_16x16x32_bf16 v[116:119], v[16:19], a[4:7], v[116:119]
    s_add_u32 m0, s71, 6336
    v_mfma_f32_16x16x32_bf16 v[120:123], v[16:19], a[8:11], v[120:123]
    buffer_load_dwordx4 v42, s[20:23], s73 offen lds
    v_mfma_f32_16x16x32_bf16 v[124:127], v[16:19], a[12:15], v[124:127]
    v_mfma_f32_16x16x32_bf16 v[128:131], v[16:19], a[16:19], v[128:131]
    v_mfma_f32_16x16x32_bf16 v[132:135], v[16:19], a[20:23], v[132:135]
    s_add_u32 m0, s71, 7392
    v_mfma_f32_16x16x32_bf16 v[136:139], v[20:23], a[0:3], v[136:139]
    buffer_load_dwordx4 v43, s[20:23], s73 offen lds
    v_mfma_f32_16x16x32_bf16 v[140:143], v[20:23], a[4:7], v[140:143]
    v_mfma_f32_16x16x32_bf16 v[144:147], v[20:23], a[8:11], v[144:147]
    s_add_u32 s73, s62, 128
    s_add_u32 m0, s71, 8448
    v_mfma_f32_16x16x32_bf16 v[148:151], v[20:23], a[12:15], v[148:151]
    buffer_load_dwordx4 v40, s[20:23], s73 offen lds
    v_mfma_f32_16x16x32_bf16 v[152:155], v[20:23], a[16:19], v[152:155]
    v_mfma_f32_16x16x32_bf16 v[156:159], v[20:23], a[20:23], v[156:159]
    s_waitcnt vmcnt(25)
    s_waitcnt lgkmcnt(0)
    v_mfma_f32_16x16x32_bf16 v[160:163], v[24:27], a[0:3], v[160:163]
    ds_read_b64_tr_b16 v[8:9], v3 offset:16896
    ds_read_b64_tr_b16 v[10:11], v3 offset:17408
    v_mfma_f32_16x16x32_bf16 v[164:167], v[24:27], a[4:7], v[164:167]
    ds_read_b64_tr_b16 v[12:13], v3 offset:16928
    ds_read_b64_tr_b16 v[14:15], v3 offset:17440
    v_mfma_f32_16x16x32_bf16 v[168:171], v[24:27], a[8:11], v[168:171]
    ds_read_b64_tr_b16 v[16:17], v3 offset:16960
    ds_read_b64_tr_b16 v[18:19], v3 offset:17472
    v_mfma_f32_16x16x32_bf16 v[172:175], v[24:27], a[12:15], v[172:175]
    ds_read_b64_tr_b16 v[20:21], v3 offset:16992
    ds_read_b64_tr_b16 v[22:23], v3 offset:17504
    v_mfma_f32_16x16x32_bf16 v[176:179], v[24:27], a[16:19], v[176:179]
    ds_read_b128 a[36:39], v1 offset:9152
    ds_read_b128 a[40:43], v1 offset:17088
    s_add_u32 m0, s71, 9504
    v_mfma_f32_16x16x32_bf16 v[180:183], v[24:27], a[20:23], v[180:183]
    ds_read_b128 a[44:47], v1 offset:17600
    buffer_load_dwordx4 v41, s[20:23], s73 offen lds
    v_mfma_f32_16x16x32_bf16 v[184:187], v[28:31], a[0:3], v[184:187]
    v_mfma_f32_16x16x32_bf16 v[188:191], v[28:31], a[4:7], v[188:191]
    s_add_u32 m0, s71, 10560
    v_mfma_f32_16x16x32_bf16 v[192:195], v[28:31], a[8:11], v[192:195]
    buffer_load_dwordx4 v42, s[20:23], s73 offen lds
    v_mfma_f32_16x16x32_bf16 v[196:199], v[28:31], a[12:15], v[196:199]
    v_mfma_f32_16x16x32_bf16 v[200:203], v[28:31], a[16:19], v[200:203]
    s_add_u32 m0, s71, 11616
    v_mfma_f32_16x16x32_bf16 v[204:207], v[28:31], a[20:23], v[204:207]
    buffer_load_dwordx4 v43, s[20:23], s73 offen lds
    v_mfma_f32_16x16x32_bf16 v[208:211], v[32:35], a[0:3], v[208:211]
    v_mfma_f32_16x16x32_bf16 v[212:215], v[32:35], a[4:7], v[212:215]
    s_add_u32 s73, s62, 262144
    s_add_u32 m0, s71, 12672
    v_mfma_f32_16x16x32_bf16 v[216:219], v[32:35], a[8:11], v[216:219]
    buffer_load_dwordx4 v40, s[20:23], s73 offen lds
    v_mfma_f32_16x16x32_bf16 v[220:223], v[32:35], a[12:15], v[220:223]
    v_mfma_f32_16x16x32_bf16 v[224:227], v[32:35], a[16:19], v[224:227]
    v_mfma_f32_16x16x32_bf16 v[228:231], v[32:35], a[20:23], v[228:231]
    s_add_u32 m0, s71, 13728
    v_mfma_f32_16x16x32_bf16 v[232:235], v[36:39], a[0:3], v[232:235]
    buffer_load_dwordx4 v41, s[20:23], s73 offen lds
    v_mfma_f32_16x16x32_bf16 v[236:239], v[36:39], a[4:7], v[236:239]
    v_mfma_f32_16x16x32_bf16 v[240:243], v[36:39], a[8:11], v[240:243]
    s_add_u32 m0, s71, 14784
    v_mfma_f32_16x16x32_bf16 v[244:247], v[36:39], a[12:15], v[244:247]
    buffer_load_dwordx4 v42, s[20:23], s73 offen lds
    v_mfma_f32_16x16x32_bf16 v[248:251], v[36:39], a[16:19], v[248:251]
    v_mfma_f32_16x16x32_bf16 v[252:255], v[36:39], a[20:23], v[252:255]
    s_waitcnt vmcnt(21)
    s_waitcnt lgkmcnt(0)
    s_barrier
    v_add_u32 v1, 4294941952, v1
    v_mfma_f32_16x16x32_bf16 v[64:67], v[8:11], a[24:27], v[64:67]
    ds_read_b64_tr_b16 v[24:25], v3 offset:0
    ds_read_b64_tr_b16 v[26:27], v3 offset:512
    v_mfma_f32_16x16x32_bf16 v[68:71], v[8:11], a[28:31], v[68:71]
    ds_read_b64_tr_b16 v[28:29], v3 offset:32
    ds_read_b64_tr_b16 v[30:31], v3 offset:544
    v_mfma_f32_16x16x32_bf16 v[72:75], v[8:11], a[32:35], v[72:75]
    ds_read_b64_tr_b16 v[32:33], v3 offset:64
    ds_read_b64_tr_b16 v[34:35], v3 offset:576
    v_mfma_f32_16x16x32_bf16 v[76:79], v[8:11], a[36:39], v[76:79]
    ds_read_b64_tr_b16 v[36:37], v3 offset:96
    ds_read_b64_tr_b16 v[38:39], v3 offset:608
    v_mfma_f32_16x16x32_bf16 v[80:83], v[8:11], a[40:43], v[80:83]
    ds_read_b128 a[0:3], v1 offset:0
    ds_read_b128 a[4:7], v1 offset:512
    s_add_u32 m0, s71, 15840
    v_mfma_f32_16x16x32_bf16 v[84:87], v[8:11], a[44:47], v[84:87]
    ds_read_b128 a[8:11], v1 offset:8448
    buffer_load_dwordx4 v43, s[20:23], s73 offen lds
    v_mfma_f32_16x16x32_bf16 v[88:91], v[12:15], a[24:27], v[88:91]
    v_mfma_f32_16x16x32_bf16 v[92:95], v[12:15], a[28:31], v[92:95]
    s_add_u32 s73, s62, 262272
    s_add_u32 m0, s71, 16896
    v_mfma_f32_16x16x32_bf16 v[96:99], v[12:15], a[32:35], v[96:99]
    buffer_load_dwordx4 v40, s[20:23], s73 offen lds
    v_mfma_f32_16x16x32_bf16 v[100:103], v[12:15], a[36:39], v[100:103]
    v_mfma_f32_16x16x32_bf16 v[104:107], v[12:15], a[40:43], v[104:107]
    s_add_u32 m0, s71, 17952
    v_mfma_f32_16x16x32_bf16 v[108:111], v[12:15], a[44:47], v[108:111]
    buffer_load_dwordx4 v41, s[20:23], s73 offen lds
    v_mfma_f32_16x16x32_bf16 v[112:115], v[16:19], a[24:27], v[112:115]
    v_mfma_f32_16x16x32_bf16 v[116:119], v[16:19], a[28:31], v[116:119]
    s_add_u32 m0, s71, 19008
    v_mfma_f32_16x16x32_bf16 v[120:123], v[16:19], a[32:35], v[120:123]
    buffer_load_dwordx4 v42, s[20:23], s73 offen lds
    v_mfma_f32_16x16x32_bf16 v[124:127], v[16:19], a[36:39], v[124:127]
    v_mfma_f32_16x16x32_bf16 v[128:131], v[16:19], a[40:43], v[128:131]
    v_mfma_f32_16x16x32_bf16 v[132:135], v[16:19], a[44:47], v[132:135]
    s_add_u32 m0, s71, 20064
    v_mfma_f32_16x16x32_bf16 v[136:139], v[20:23], a[24:27], v[136:139]
    buffer_load_dwordx4 v43, s[20:23], s73 offen lds
    v_mfma_f32_16x16x32_bf16 v[140:143], v[20:23], a[28:31], v[140:143]
    v_mfma_f32_16x16x32_bf16 v[144:147], v[20:23], a[32:35], v[144:147]
    s_waitcnt lgkmcnt(3)
    s_add_u32 s73, s62, 524288
    s_add_u32 m0, s71, 0
    v_mfma_f32_16x16x32_bf16 v[148:151], v[20:23], a[36:39], v[148:151]
    buffer_load_dwordx4 v40, s[20:23], s73 offen lds
    v_mfma_f32_16x16x32_bf16 v[152:155], v[20:23], a[40:43], v[152:155]
    v_mfma_f32_16x16x32_bf16 v[156:159], v[20:23], a[44:47], v[156:159]
    s_waitcnt vmcnt(13)
    s_waitcnt lgkmcnt(0)
    v_mfma_f32_16x16x32_bf16 v[160:163], v[24:27], a[24:27], v[160:163]
    ds_read_b64_tr_b16 v[8:9], v3 offset:4224
    ds_read_b64_tr_b16 v[10:11], v3 offset:4736
    v_mfma_f32_16x16x32_bf16 v[164:167], v[24:27], a[28:31], v[164:167]
    ds_read_b64_tr_b16 v[12:13], v3 offset:4256
    ds_read_b64_tr_b16 v[14:15], v3 offset:4768
    v_mfma_f32_16x16x32_bf16 v[168:171], v[24:27], a[32:35], v[168:171]
    ds_read_b64_tr_b16 v[16:17], v3 offset:4288
    ds_read_b64_tr_b16 v[18:19], v3 offset:4800
    v_mfma_f32_16x16x32_bf16 v[172:175], v[24:27], a[36:39], v[172:175]
    ds_read_b64_tr_b16 v[20:21], v3 offset:4320
    ds_read_b64_tr_b16 v[22:23], v3 offset:4832
    v_mfma_f32_16x16x32_bf16 v[176:179], v[24:27], a[40:43], v[176:179]
    ds_read_b128 a[12:15], v1 offset:8960
    ds_read_b128 a[16:19], v1 offset:16896
    s_add_u32 m0, s71, 1056
    v_mfma_f32_16x16x32_bf16 v[180:183], v[24:27], a[44:47], v[180:183]
    ds_read_b128 a[20:23], v1 offset:17408
    buffer_load_dwordx4 v41, s[20:23], s73 offen lds
    v_mfma_f32_16x16x32_bf16 v[184:187], v[28:31], a[24:27], v[184:187]
    v_mfma_f32_16x16x32_bf16 v[188:191], v[28:31], a[28:31], v[188:191]
    s_add_u32 m0, s71, 2112
    v_mfma_f32_16x16x32_bf16 v[192:195], v[28:31], a[32:35], v[192:195]
    buffer_load_dwordx4 v42, s[20:23], s73 offen lds
    v_mfma_f32_16x16x32_bf16 v[196:199], v[28:31], a[36:39], v[196:199]
    v_mfma_f32_16x16x32_bf16 v[200:203], v[28:31], a[40:43], v[200:203]
    s_add_u32 m0, s71, 3168
    v_mfma_f32_16x16x32_bf16 v[204:207], v[28:31], a[44:47], v[204:207]
    buffer_load_dwordx4 v43, s[20:23], s73 offen lds
    v_mfma_f32_16x16x32_bf16 v[208:211], v[32:35], a[24:27], v[208:211]
    v_mfma_f32_16x16x32_bf16 v[212:215], v[32:35], a[28:31], v[212:215]
    s_waitcnt lgkmcnt(3)
    s_add_u32 s73, s62, 524416
    s_add_u32 m0, s71, 4224
    v_mfma_f32_16x16x32_bf16 v[216:219], v[32:35], a[32:35], v[216:219]
    buffer_load_dwordx4 v40, s[20:23], s73 offen lds
    v_mfma_f32_16x16x32_bf16 v[220:223], v[32:35], a[36:39], v[220:223]
    v_mfma_f32_16x16x32_bf16 v[224:227], v[32:35], a[40:43], v[224:227]
    v_mfma_f32_16x16x32_bf16 v[228:231], v[32:35], a[44:47], v[228:231]
    s_add_u32 m0, s71, 5280
    v_mfma_f32_16x16x32_bf16 v[232:235], v[36:39], a[24:27], v[232:235]
    buffer_load_dwordx4 v41, s[20:23], s73 offen lds
    v_mfma_f32_16x16x32_bf16 v[236:239], v[36:39], a[28:31], v[236:239]
    v_mfma_f32_16x16x32_bf16 v[240:243], v[36:39], a[32:35], v[240:243]
    s_add_u32 m0, s71, 6336
    v_mfma_f32_16x16x32_bf16 v[244:247], v[36:39], a[36:39], v[244:247]
    buffer_load_dwordx4 v42, s[20:23], s73 offen lds
    v_mfma_f32_16x16x32_bf16 v[248:251], v[36:39], a[40:43], v[248:251]
    v_mfma_f32_16x16x32_bf16 v[252:255], v[36:39], a[44:47], v[252:255]
    s_waitcnt vmcnt(15)
    s_waitcnt lgkmcnt(0)
    v_mfma_f32_16x16x32_bf16 v[64:67], v[8:11], a[0:3], v[64:67]
    ds_read_b64_tr_b16 v[24:25], v3 offset:8448
    ds_read_b64_tr_b16 v[26:27], v3 offset:8960
    v_mfma_f32_16x16x32_bf16 v[68:71], v[8:11], a[4:7], v[68:71]
    ds_read_b64_tr_b16 v[28:29], v3 offset:8480
    ds_read_b64_tr_b16 v[30:31], v3 offset:8992
    v_mfma_f32_16x16x32_bf16 v[72:75], v[8:11], a[8:11], v[72:75]
    ds_read_b64_tr_b16 v[32:33], v3 offset:8512
    ds_read_b64_tr_b16 v[34:35], v3 offset:9024
    v_mfma_f32_16x16x32_bf16 v[76:79], v[8:11], a[12:15], v[76:79]
    ds_read_b64_tr_b16 v[36:37], v3 offset:8544
    ds_read_b64_tr_b16 v[38:39], v3 offset:9056
    v_mfma_f32_16x16x32_bf16 v[80:83], v[8:11], a[16:19], v[80:83]
    ds_read_b128 a[24:27], v1 offset:64
    ds_read_b128 a[28:31], v1 offset:576
    s_add_u32 m0, s71, 7392
    v_mfma_f32_16x16x32_bf16 v[84:87], v[8:11], a[20:23], v[84:87]
    ds_read_b128 a[32:35], v1 offset:8512
    buffer_load_dwordx4 v43, s[20:23], s73 offen lds
    v_mfma_f32_16x16x32_bf16 v[88:91], v[12:15], a[0:3], v[88:91]
    v_mfma_f32_16x16x32_bf16 v[92:95], v[12:15], a[4:7], v[92:95]
    v_mfma_f32_16x16x32_bf16 v[96:99], v[12:15], a[8:11], v[96:99]
    v_mfma_f32_16x16x32_bf16 v[100:103], v[12:15], a[12:15], v[100:103]
    s_waitcnt lgkmcnt(3)
    s_add_u32 s73, s62, 786432
    s_add_u32 m0, s71, 8448
    v_mfma_f32_16x16x32_bf16 v[104:107], v[12:15], a[16:19], v[104:107]
    buffer_load_dwordx4 v40, s[20:23], s73 offen lds
    s_add_u32 m0, s71, 9504
    v_mfma_f32_16x16x32_bf16 v[108:111], v[12:15], a[20:23], v[108:111]
    buffer_load_dwordx4 v41, s[20:23], s73 offen lds
    s_add_u32 m0, s71, 10560
    v_mfma_f32_16x16x32_bf16 v[112:115], v[16:19], a[0:3], v[112:115]
    buffer_load_dwordx4 v42, s[20:23], s73 offen lds
    s_add_u32 m0, s71, 11616
    v_mfma_f32_16x16x32_bf16 v[116:119], v[16:19], a[4:7], v[116:119]
    buffer_load_dwordx4 v43, s[20:23], s73 offen lds
    v_mfma_f32_16x16x32_bf16 v[120:123], v[16:19], a[8:11], v[120:123]
    v_mfma_f32_16x16x32_bf16 v[124:127], v[16:19], a[12:15], v[124:127]
    v_mfma_f32_16x16x32_bf16 v[128:131], v[16:19], a[16:19], v[128:131]
    v_mfma_f32_16x16x32_bf16 v[132:135], v[16:19], a[20:23], v[132:135]
    v_mfma_f32_16x16x32_bf16 v[136:139], v[20:23], a[0:3], v[136:139]
    v_mfma_f32_16x16x32_bf16 v[140:143], v[20:23], a[4:7], v[140:143]
    v_mfma_f32_16x16x32_bf16 v[144:147], v[20:23], a[8:11], v[144:147]
    v_mfma_f32_16x16x32_bf16 v[148:151], v[20:23], a[12:15], v[148:151]
    v_mfma_f32_16x16x32_bf16 v[152:155], v[20:23], a[16:19], v[152:155]
    v_mfma_f32_16x16x32_bf16 v[156:159], v[20:23], a[20:23], v[156:159]
    s_waitcnt vmcnt(16)
    s_waitcnt lgkmcnt(0)
    v_mfma_f32_16x16x32_bf16 v[160:163], v[24:27], a[0:3], v[160:163]
    ds_read_b64_tr_b16 v[8:9], v3 offset:12672
    ds_read_b64_tr_b16 v[10:11], v3 offset:13184
    v_mfma_f32_16x16x32_bf16 v[164:167], v[24:27], a[4:7], v[164:167]
    ds_read_b64_tr_b16 v[12:13], v3 offset:12704
    ds_read_b64_tr_b16 v[14:15], v3 offset:13216
    v_mfma_f32_16x16x32_bf16 v[168:171], v[24:27], a[8:11], v[168:171]
    ds_read_b64_tr_b16 v[16:17], v3 offset:12736
    ds_read_b64_tr_b16 v[18:19], v3 offset:13248
    v_mfma_f32_16x16x32_bf16 v[172:175], v[24:27], a[12:15], v[172:175]
    ds_read_b64_tr_b16 v[20:21], v3 offset:12768
    ds_read_b64_tr_b16 v[22:23], v3 offset:13280
    v_mfma_f32_16x16x32_bf16 v[176:179], v[24:27], a[16:19], v[176:179]
    ds_read_b128 a[36:39], v1 offset:9024
    ds_read_b128 a[40:43], v1 offset:16960
    v_mfma_f32_16x16x32_bf16 v[180:183], v[24:27], a[20:23], v[180:183]
    ds_read_b128 a[44:47], v1 offset:17472
    v_mfma_f32_16x16x32_bf16 v[184:187], v[28:31], a[0:3], v[184:187]
    v_mfma_f32_16x16x32_bf16 v[188:191], v[28:31], a[4:7], v[188:191]
    v_mfma_f32_16x16x32_bf16 v[192:195], v[28:31], a[8:11], v[192:195]
    v_mfma_f32_16x16x32_bf16 v[196:199], v[28:31], a[12:15], v[196:199]
    s_waitcnt lgkmcnt(3)
    s_add_u32 s73, s62, 786560
    s_add_u32 m0, s71, 12672
    v_mfma_f32_16x16x32_bf16 v[200:203], v[28:31], a[16:19], v[200:203]
    buffer_load_dwordx4 v40, s[20:23], s73 offen lds
    s_add_u32 m0, s71, 13728
    v_mfma_f32_16x16x32_bf16 v[204:207], v[28:31], a[20:23], v[204:207]
    buffer_load_dwordx4 v41, s[20:23], s73 offen lds
    s_add_u32 m0, s71, 14784
    v_mfma_f32_16x16x32_bf16 v[208:211], v[32:35], a[0:3], v[208:211]
    buffer_load_dwordx4 v42, s[20:23], s73 offen lds
    s_add_u32 m0, s71, 15840
    v_mfma_f32_16x16x32_bf16 v[212:215], v[32:35], a[4:7], v[212:215]
    buffer_load_dwordx4 v43, s[20:23], s73 offen lds
    v_mfma_f32_16x16x32_bf16 v[216:219], v[32:35], a[8:11], v[216:219]
    v_mfma_f32_16x16x32_bf16 v[220:223], v[32:35], a[12:15], v[220:223]
    s_add_u32 m0, s70, 25344
    s_add_u32 s75, s68, 0
    v_mfma_f32_16x16x32_bf16 v[224:227], v[32:35], a[16:19], v[224:227]
    buffer_load_dwordx4 v4, s[16:19], s75 offen nt lds
    v_mfma_f32_16x16x32_bf16 v[228:231], v[32:35], a[20:23], v[228:231]
    v_mfma_f32_16x16x32_bf16 v[232:235], v[36:39], a[0:3], v[232:235]
    s_add_u32 m0, s70, 26400
    s_add_u32 s75, s68, 5120
    v_mfma_f32_16x16x32_bf16 v[236:239], v[36:39], a[4:7], v[236:239]
    buffer_load_dwordx4 v4, s[16:19], s75 offen nt lds
    v_mfma_f32_16x16x32_bf16 v[240:243], v[36:39], a[8:11], v[240:243]
    v_mfma_f32_16x16x32_bf16 v[244:247], v[36:39], a[12:15], v[244:247]
    s_add_u32 m0, s70, 27456
    s_add_u32 s75, s68, 10240
    v_mfma_f32_16x16x32_bf16 v[248:251], v[36:39], a[16:19], v[248:251]
    buffer_load_dwordx4 v4, s[16:19], s75 offen nt lds
    v_mfma_f32_16x16x32_bf16 v[252:255], v[36:39], a[20:23], v[252:255]
    s_waitcnt vmcnt(19)
    s_waitcnt lgkmcnt(0)
    v_mfma_f32_16x16x32_bf16 v[64:67], v[8:11], a[24:27], v[64:67]
    ds_read_b64_tr_b16 v[24:25], v3 offset:16896
    ds_read_b64_tr_b16 v[26:27], v3 offset:17408
    v_mfma_f32_16x16x32_bf16 v[68:71], v[8:11], a[28:31], v[68:71]
    ds_read_b64_tr_b16 v[28:29], v3 offset:16928
    ds_read_b64_tr_b16 v[30:31], v3 offset:17440
    v_mfma_f32_16x16x32_bf16 v[72:75], v[8:11], a[32:35], v[72:75]
    ds_read_b64_tr_b16 v[32:33], v3 offset:16960
    ds_read_b64_tr_b16 v[34:35], v3 offset:17472
    v_mfma_f32_16x16x32_bf16 v[76:79], v[8:11], a[36:39], v[76:79]
    ds_read_b64_tr_b16 v[36:37], v3 offset:16992
    ds_read_b64_tr_b16 v[38:39], v3 offset:17504
    v_mfma_f32_16x16x32_bf16 v[80:83], v[8:11], a[40:43], v[80:83]
    ds_read_b128 a[0:3], v1 offset:128
    ds_read_b128 a[4:7], v1 offset:640
    s_add_u32 m0, s70, 28512
    s_add_u32 s75, s68, 15360
    v_mfma_f32_16x16x32_bf16 v[84:87], v[8:11], a[44:47], v[84:87]
    ds_read_b128 a[8:11], v1 offset:8576
    buffer_load_dwordx4 v4, s[16:19], s75 offen nt lds
    v_mfma_f32_16x16x32_bf16 v[88:91], v[12:15], a[24:27], v[88:91]
    v_mfma_f32_16x16x32_bf16 v[92:95], v[12:15], a[28:31], v[92:95]
    s_add_u32 m0, s70, 29568
    s_add_u32 s75, s68, 20480
    v_mfma_f32_16x16x32_bf16 v[96:99], v[12:15], a[32:35], v[96:99]
    buffer_load_dwordx4 v4, s[16:19], s75 offen nt lds
    v_mfma_f32_16x16x32_bf16 v[100:103], v[12:15], a[36:39], v[100:103]
    v_mfma_f32_16x16x32_bf16 v[104:107], v[12:15], a[40:43], v[104:107]
    s_add_u32 m0, s70, 30624
    s_add_u32 s75, s68, 25600
    v_mfma_f32_16x16x32_bf16 v[108:111], v[12:15], a[44:47], v[108:111]
    buffer_load_dwordx4 v4, s[16:19], s75 offen nt lds
    v_mfma_f32_16x16x32_bf16 v[112:115], v[16:19], a[24:27], v[112:115]
    v_mfma_f32_16x16x32_bf16 v[116:119], v[16:19], a[28:31], v[116:119]
    s_add_u32 s75, s74, 24576
    v_mfma_f32_16x16x32_bf16 v[120:123], v[16:19], a[32:35], v[120:123]
    buffer_load_dwordx4 a[96:99], v0, s[12:15], s75 offen offset:0 nt
    v_mfma_f32_16x16x32_bf16 v[124:127], v[16:19], a[36:39], v[124:127]
    v_mfma_f32_16x16x32_bf16 v[128:131], v[16:19], a[40:43], v[128:131]
    v_mfma_f32_16x16x32_bf16 v[132:135], v[16:19], a[44:47], v[132:135]
    v_mfma_f32_16x16x32_bf16 v[136:139], v[20:23], a[24:27], v[136:139]
    buffer_load_dwordx4 a[100:103], v0, s[12:15], s75 offen offset:1024 nt
    v_mfma_f32_16x16x32_bf16 v[140:143], v[20:23], a[28:31], v[140:143]
    v_mfma_f32_16x16x32_bf16 v[144:147], v[20:23], a[32:35], v[144:147]
    s_add_u32 s75, s74, 40960
    v_mfma_f32_16x16x32_bf16 v[148:151], v[20:23], a[36:39], v[148:151]
    buffer_load_dwordx4 a[104:107], v0, s[8:11], s75 offen offset:0 nt
    v_mfma_f32_16x16x32_bf16 v[152:155], v[20:23], a[40:43], v[152:155]
    v_mfma_f32_16x16x32_bf16 v[156:159], v[20:23], a[44:47], v[156:159]
    s_waitcnt vmcnt(21)
    s_waitcnt lgkmcnt(0)
    v_mfma_f32_16x16x32_bf16 v[160:163], v[24:27], a[24:27], v[160:163]
    ds_read_b64_tr_b16 v[8:9], v3 offset:0
    ds_read_b64_tr_b16 v[10:11], v3 offset:512
    v_mfma_f32_16x16x32_bf16 v[164:167], v[24:27], a[28:31], v[164:167]
    ds_read_b64_tr_b16 v[12:13], v3 offset:32
    ds_read_b64_tr_b16 v[14:15], v3 offset:544
    v_mfma_f32_16x16x32_bf16 v[168:171], v[24:27], a[32:35], v[168:171]
    ds_read_b64_tr_b16 v[16:17], v3 offset:64
    ds_read_b64_tr_b16 v[18:19], v3 offset:576
    v_mfma_f32_16x16x32_bf16 v[172:175], v[24:27], a[36:39], v[172:175]
    ds_read_b64_tr_b16 v[20:21], v3 offset:96
    ds_read_b64_tr_b16 v[22:23], v3 offset:608
    v_mfma_f32_16x16x32_bf16 v[176:179], v[24:27], a[40:43], v[176:179]
    ds_read_b128 a[12:15], v1 offset:9088
    ds_read_b128 a[16:19], v1 offset:17024
    v_mfma_f32_16x16x32_bf16 v[180:183], v[24:27], a[44:47], v[180:183]
    ds_read_b128 a[20:23], v1 offset:17536
    buffer_load_dwordx4 a[108:111], v0, s[8:11], s75 offen offset:1024 nt
    v_mfma_f32_16x16x32_bf16 v[184:187], v[28:31], a[24:27], v[184:187]
    v_mfma_f32_16x16x32_bf16 v[188:191], v[28:31], a[28:31], v[188:191]
    s_add_u32 s75, s74, 32768
    v_mfma_f32_16x16x32_bf16 v[192:195], v[28:31], a[32:35], v[192:195]
    buffer_load_dwordx4 a[112:115], v0, s[12:15], s75 offen offset:0 nt
    v_mfma_f32_16x16x32_bf16 v[196:199], v[28:31], a[36:39], v[196:199]
    v_mfma_f32_16x16x32_bf16 v[200:203], v[28:31], a[40:43], v[200:203]
    v_mfma_f32_16x16x32_bf16 v[204:207], v[28:31], a[44:47], v[204:207]
    buffer_load_dwordx4 a[116:119], v0, s[12:15], s75 offen offset:1024 nt
    v_mfma_f32_16x16x32_bf16 v[208:211], v[32:35], a[24:27], v[208:211]
    v_mfma_f32_16x16x32_bf16 v[212:215], v[32:35], a[28:31], v[212:215]
    s_add_u32 s75, s74, 49152
    v_mfma_f32_16x16x32_bf16 v[216:219], v[32:35], a[32:35], v[216:219]
    buffer_load_dwordx4 a[120:123], v0, s[8:11], s75 offen offset:0 nt
    v_mfma_f32_16x16x32_bf16 v[220:223], v[32:35], a[36:39], v[220:223]
    v_mfma_f32_16x16x32_bf16 v[224:227], v[32:35], a[40:43], v[224:227]
    v_mfma_f32_16x16x32_bf16 v[228:231], v[32:35], a[44:47], v[228:231]
    v_mfma_f32_16x16x32_bf16 v[232:235], v[36:39], a[24:27], v[232:235]
    buffer_load_dwordx4 a[124:127], v0, s[8:11], s75 offen offset:1024 nt
    v_mfma_f32_16x16x32_bf16 v[236:239], v[36:39], a[28:31], v[236:239]
    v_mfma_f32_16x16x32_bf16 v[240:243], v[36:39], a[32:35], v[240:243]
    s_add_u32 s75, s74, 40960
    v_mfma_f32_16x16x32_bf16 v[244:247], v[36:39], a[36:39], v[244:247]
    buffer_load_dwordx4 a[128:131], v0, s[12:15], s75 offen offset:0 nt
    v_mfma_f32_16x16x32_bf16 v[248:251], v[36:39], a[40:43], v[248:251]
    v_mfma_f32_16x16x32_bf16 v[252:255], v[36:39], a[44:47], v[252:255]
    s_waitcnt vmcnt(23)
    s_waitcnt lgkmcnt(0)
    v_mfma_f32_16x16x32_bf16 v[64:67], v[8:11], a[0:3], v[64:67]
    ds_read_b64_tr_b16 v[24:25], v3 offset:4224
    ds_read_b64_tr_b16 v[26:27], v3 offset:4736
    v_mfma_f32_16x16x32_bf16 v[68:71], v[8:11], a[4:7], v[68:71]
    ds_read_b64_tr_b16 v[28:29], v3 offset:4256
    ds_read_b64_tr_b16 v[30:31], v3 offset:4768
    v_mfma_f32_16x16x32_bf16 v[72:75], v[8:11], a[8:11], v[72:75]
    ds_read_b64_tr_b16 v[32:33], v3 offset:4288
    ds_read_b64_tr_b16 v[34:35], v3 offset:4800
    v_mfma_f32_16x16x32_bf16 v[76:79], v[8:11], a[12:15], v[76:79]
    ds_read_b64_tr_b16 v[36:37], v3 offset:4320
    ds_read_b64_tr_b16 v[38:39], v3 offset:4832
    v_mfma_f32_16x16x32_bf16 v[80:83], v[8:11], a[16:19], v[80:83]
    ds_read_b128 a[24:27], v1 offset:192
    ds_read_b128 a[28:31], v1 offset:704
    v_mfma_f32_16x16x32_bf16 v[84:87], v[8:11], a[20:23], v[84:87]
    ds_read_b128 a[32:35], v1 offset:8640
    buffer_load_dwordx4 a[132:135], v0, s[12:15], s75 offen offset:1024 nt
    v_mfma_f32_16x16x32_bf16 v[88:91], v[12:15], a[0:3], v[88:91]
    v_mfma_f32_16x16x32_bf16 v[92:95], v[12:15], a[4:7], v[92:95]
    s_add_u32 s73, s63, 0
    s_add_u32 m0, s71, 16896
    v_mfma_f32_16x16x32_bf16 v[96:99], v[12:15], a[8:11], v[96:99]
    buffer_load_dwordx4 v40, s[20:23], s73 offen lds
    v_mfma_f32_16x16x32_bf16 v[100:103], v[12:15], a[12:15], v[100:103]
    v_mfma_f32_16x16x32_bf16 v[104:107], v[12:15], a[16:19], v[104:107]
    s_add_u32 m0, s71, 17952
    v_mfma_f32_16x16x32_bf16 v[108:111], v[12:15], a[20:23], v[108:111]
    buffer_load_dwordx4 v41, s[20:23], s73 offen lds
    v_mfma_f32_16x16x32_bf16 v[112:115], v[16:19], a[0:3], v[112:115]
    v_mfma_f32_16x16x32_bf16 v[116:119], v[16:19], a[4:7], v[116:119]
    s_add_u32 m0, s71, 19008
    v_mfma_f32_16x16x32_bf16 v[120:123], v[16:19], a[8:11], v[120:123]
    buffer_load_dwordx4 v42, s[20:23], s73 offen lds
    v_mfma_f32_16x16x32_bf16 v[124:127], v[16:19], a[12:15], v[124:127]
    v_mfma_f32_16x16x32_bf16 v[128:131], v[16:19], a[16:19], v[128:131]
    v_mfma_f32_16x16x32_bf16 v[132:135], v[16:19], a[20:23], v[132:135]
    s_add_u32 m0, s71, 20064
    v_mfma_f32_16x16x32_bf16 v[136:139], v[20:23], a[0:3], v[136:139]
    buffer_load_dwordx4 v43, s[20:23], s73 offen lds
    v_mfma_f32_16x16x32_bf16 v[140:143], v[20:23], a[4:7], v[140:143]
    v_mfma_f32_16x16x32_bf16 v[144:147], v[20:23], a[8:11], v[144:147]
    s_add_u32 s73, s63, 128
    s_add_u32 m0, s71, 0
    v_mfma_f32_16x16x32_bf16 v[148:151], v[20:23], a[12:15], v[148:151]
    buffer_load_dwordx4 v40, s[20:23], s73 offen lds
    v_mfma_f32_16x16x32_bf16 v[152:155], v[20:23], a[16:19], v[152:155]
    v_mfma_f32_16x16x32_bf16 v[156:159], v[20:23], a[20:23], v[156:159]
    s_waitcnt vmcnt(25)
    s_waitcnt lgkmcnt(0)
    v_mfma_f32_16x16x32_bf16 v[160:163], v[24:27], a[0:3], v[160:163]
    ds_read_b64_tr_b16 v[8:9], v3 offset:8448
    ds_read_b64_tr_b16 v[10:11], v3 offset:8960
    v_mfma_f32_16x16x32_bf16 v[164:167], v[24:27], a[4:7], v[164:167]
    ds_read_b64_tr_b16 v[12:13], v3 offset:8480
    ds_read_b64_tr_b16 v[14:15], v3 offset:8992
    v_mfma_f32_16x16x32_bf16 v[168:171], v[24:27], a[8:11], v[168:171]
    ds_read_b64_tr_b16 v[16:17], v3 offset:8512
    ds_read_b64_tr_b16 v[18:19], v3 offset:9024
    v_mfma_f32_16x16x32_bf16 v[172:175], v[24:27], a[12:15], v[172:175]
    ds_read_b64_tr_b16 v[20:21], v3 offset:8544
    ds_read_b64_tr_b16 v[22:23], v3 offset:9056
    v_mfma_f32_16x16x32_bf16 v[176:179], v[24:27], a[16:19], v[176:179]
    ds_read_b128 a[36:39], v1 offset:9152
    ds_read_b128 a[40:43], v1 offset:17088
    s_add_u32 m0, s71, 1056
    v_mfma_f32_16x16x32_bf16 v[180:183], v[24:27], a[20:23], v[180:183]
    ds_read_b128 a[44:47], v1 offset:17600
    buffer_load_dwordx4 v41, s[20:23], s73 offen lds
    v_mfma_f32_16x16x32_bf16 v[184:187], v[28:31], a[0:3], v[184:187]
    v_mfma_f32_16x16x32_bf16 v[188:191], v[28:31], a[4:7], v[188:191]
    s_add_u32 m0, s71, 2112
    v_mfma_f32_16x16x32_bf16 v[192:195], v[28:31], a[8:11], v[192:195]
    buffer_load_dwordx4 v42, s[20:23], s73 offen lds
    v_mfma_f32_16x16x32_bf16 v[196:199], v[28:31], a[12:15], v[196:199]
    v_mfma_f32_16x16x32_bf16 v[200:203], v[28:31], a[16:19], v[200:203]
    s_add_u32 m0, s71, 3168
    v_mfma_f32_16x16x32_bf16 v[204:207], v[28:31], a[20:23], v[204:207]
    buffer_load_dwordx4 v43, s[20:23], s73 offen lds
    v_mfma_f32_16x16x32_bf16 v[208:211], v[32:35], a[0:3], v[208:211]
    v_mfma_f32_16x16x32_bf16 v[212:215], v[32:35], a[4:7], v[212:215]
    s_add_u32 s73, s63, 262144
    s_add_u32 m0, s71, 4224
    v_mfma_f32_16x16x32_bf16 v[216:219], v[32:35], a[8:11], v[216:219]
    buffer_load_dwordx4 v40, s[20:23], s73 offen lds
    v_mfma_f32_16x16x32_bf16 v[220:223], v[32:35], a[12:15], v[220:223]
    v_mfma_f32_16x16x32_bf16 v[224:227], v[32:35], a[16:19], v[224:227]
    v_mfma_f32_16x16x32_bf16 v[228:231], v[32:35], a[20:23], v[228:231]
    s_add_u32 m0, s71, 5280
    v_mfma_f32_16x16x32_bf16 v[232:235], v[36:39], a[0:3], v[232:235]
    buffer_load_dwordx4 v41, s[20:23], s73 offen lds
    v_mfma_f32_16x16x32_bf16 v[236:239], v[36:39], a[4:7], v[236:239]
    v_mfma_f32_16x16x32_bf16 v[240:243], v[36:39], a[8:11], v[240:243]
    s_add_u32 m0, s71, 6336
    v_mfma_f32_16x16x32_bf16 v[244:247], v[36:39], a[12:15], v[244:247]
    buffer_load_dwordx4 v42, s[20:23], s73 offen lds
    v_mfma_f32_16x16x32_bf16 v[248:251], v[36:39], a[16:19], v[248:251]
    v_mfma_f32_16x16x32_bf16 v[252:255], v[36:39], a[20:23], v[252:255]
    s_waitcnt vmcnt(21)
    s_waitcnt lgkmcnt(0)
    s_barrier
    v_add_u32 v1, 25344, v1
    v_mfma_f32_16x16x32_bf16 v[64:67], v[8:11], a[24:27], v[64:67]
    ds_read_b64_tr_b16 v[24:25], v3 offset:12672
    ds_read_b64_tr_b16 v[26:27], v3 offset:13184
    v_mfma_f32_16x16x32_bf16 v[68:71], v[8:11], a[28:31], v[68:71]
    ds_read_b64_tr_b16 v[28:29], v3 offset:12704
    ds_read_b64_tr_b16 v[30:31], v3 offset:13216
    v_mfma_f32_16x16x32_bf16 v[72:75], v[8:11], a[32:35], v[72:75]
    ds_read_b64_tr_b16 v[32:33], v3 offset:12736
    ds_read_b64_tr_b16 v[34:35], v3 offset:13248
    v_mfma_f32_16x16x32_bf16 v[76:79], v[8:11], a[36:39], v[76:79]
    ds_read_b64_tr_b16 v[36:37], v3 offset:12768
    ds_read_b64_tr_b16 v[38:39], v3 offset:13280
    v_mfma_f32_16x16x32_bf16 v[80:83], v[8:11], a[40:43], v[80:83]
    ds_read_b128 a[0:3], v1 offset:0
    ds_read_b128 a[4:7], v1 offset:512
    s_add_u32 m0, s71, 7392
    v_mfma_f32_16x16x32_bf16 v[84:87], v[8:11], a[44:47], v[84:87]
    ds_read_b128 a[8:11], v1 offset:8448
    buffer_load_dwordx4 v43, s[20:23], s73 offen lds
    v_mfma_f32_16x16x32_bf16 v[88:91], v[12:15], a[24:27], v[88:91]
    v_mfma_f32_16x16x32_bf16 v[92:95], v[12:15], a[28:31], v[92:95]
    s_add_u32 s73, s63, 262272
    s_add_u32 m0, s71, 8448
    v_mfma_f32_16x16x32_bf16 v[96:99], v[12:15], a[32:35], v[96:99]
    buffer_load_dwordx4 v40, s[20:23], s73 offen lds
    v_mfma_f32_16x16x32_bf16 v[100:103], v[12:15], a[36:39], v[100:103]
    v_mfma_f32_16x16x32_bf16 v[104:107], v[12:15], a[40:43], v[104:107]
    s_add_u32 m0, s71, 9504
    v_mfma_f32_16x16x32_bf16 v[108:111], v[12:15], a[44:47], v[108:111]
    buffer_load_dwordx4 v41, s[20:23], s73 offen lds
    v_mfma_f32_16x16x32_bf16 v[112:115], v[16:19], a[24:27], v[112:115]
    v_mfma_f32_16x16x32_bf16 v[116:119], v[16:19], a[28:31], v[116:119]
    s_add_u32 m0, s71, 10560
    v_mfma_f32_16x16x32_bf16 v[120:123], v[16:19], a[32:35], v[120:123]
    buffer_load_dwordx4 v42, s[20:23], s73 offen lds
    v_mfma_f32_16x16x32_bf16 v[124:127], v[16:19], a[36:39], v[124:127]
    v_mfma_f32_16x16x32_bf16 v[128:131], v[16:19], a[40:43], v[128:131]
    v_mfma_f32_16x16x32_bf16 v[132:135], v[16:19], a[44:47], v[132:135]
    s_add_u32 m0, s71, 11616
    v_mfma_f32_16x16x32_bf16 v[136:139], v[20:23], a[24:27], v[136:139]
    buffer_load_dwordx4 v43, s[20:23], s73 offen lds
    v_mfma_f32_16x16x32_bf16 v[140:143], v[20:23], a[28:31], v[140:143]
    v_mfma_f32_16x16x32_bf16 v[144:147], v[20:23], a[32:35], v[144:147]
    s_waitcnt lgkmcnt(3)
    s_add_u32 s73, s63, 524288
    s_add_u32 m0, s71, 12672
    v_mfma_f32_16x16x32_bf16 v[148:151], v[20:23], a[36:39], v[148:151]
    buffer_load_dwordx4 v40, s[20:23], s73 offen lds
    v_mfma_f32_16x16x32_bf16 v[152:155], v[20:23], a[40:43], v[152:155]
    v_mfma_f32_16x16x32_bf16 v[156:159], v[20:23], a[44:47], v[156:159]
    s_waitcnt vmcnt(13)
    s_waitcnt lgkmcnt(0)
    v_mfma_f32_16x16x32_bf16 v[160:163], v[24:27], a[24:27], v[160:163]
    ds_read_b64_tr_b16 v[8:9], v3 offset:16896
    ds_read_b64_tr_b16 v[10:11], v3 offset:17408
    v_mfma_f32_16x16x32_bf16 v[164:167], v[24:27], a[28:31], v[164:167]
    ds_read_b64_tr_b16 v[12:13], v3 offset:16928
    ds_read_b64_tr_b16 v[14:15], v3 offset:17440
    v_mfma_f32_16x16x32_bf16 v[168:171], v[24:27], a[32:35], v[168:171]
    ds_read_b64_tr_b16 v[16:17], v3 offset:16960
    ds_read_b64_tr_b16 v[18:19], v3 offset:17472
    v_mfma_f32_16x16x32_bf16 v[172:175], v[24:27], a[36:39], v[172:175]
    ds_read_b64_tr_b16 v[20:21], v3 offset:16992
    ds_read_b64_tr_b16 v[22:23], v3 offset:17504
    v_mfma_f32_16x16x32_bf16 v[176:179], v[24:27], a[40:43], v[176:179]
    ds_read_b128 a[12:15], v1 offset:8960
    ds_read_b128 a[16:19], v1 offset:16896
    s_add_u32 m0, s71, 13728
    v_mfma_f32_16x16x32_bf16 v[180:183], v[24:27], a[44:47], v[180:183]
    ds_read_b128 a[20:23], v1 offset:17408
    buffer_load_dwordx4 v41, s[20:23], s73 offen lds
    v_mfma_f32_16x16x32_bf16 v[184:187], v[28:31], a[24:27], v[184:187]
    v_mfma_f32_16x16x32_bf16 v[188:191], v[28:31], a[28:31], v[188:191]
    s_add_u32 m0, s71, 14784
    v_mfma_f32_16x16x32_bf16 v[192:195], v[28:31], a[32:35], v[192:195]
    buffer_load_dwordx4 v42, s[20:23], s73 offen lds
    v_mfma_f32_16x16x32_bf16 v[196:199], v[28:31], a[36:39], v[196:199]
    v_mfma_f32_16x16x32_bf16 v[200:203], v[28:31], a[40:43], v[200:203]
    s_add_u32 m0, s71, 15840
    v_mfma_f32_16x16x32_bf16 v[204:207], v[28:31], a[44:47], v[204:207]
    buffer_load_dwordx4 v43, s[20:23], s73 offen lds
    v_mfma_f32_16x16x32_bf16 v[208:211], v[32:35], a[24:27], v[208:211]
    v_mfma_f32_16x16x32_bf16 v[212:215], v[32:35], a[28:31], v[212:215]
    s_waitcnt lgkmcnt(3)
    s_add_u32 s73, s63, 524416
    s_add_u32 m0, s71, 16896
    v_mfma_f32_16x16x32_bf16 v[216:219], v[32:35], a[32:35], v[216:219]
    buffer_load_dwordx4 v40, s[20:23], s73 offen lds
    v_mfma_f32_16x16x32_bf16 v[220:223], v[32:35], a[36:39], v[220:223]
    v_mfma_f32_16x16x32_bf16 v[224:227], v[32:35], a[40:43], v[224:227]
    v_mfma_f32_16x16x32_bf16 v[228:231], v[32:35], a[44:47], v[228:231]
    s_add_u32 m0, s71, 17952
    v_mfma_f32_16x16x32_bf16 v[232:235], v[36:39], a[24:27], v[232:235]
    buffer_load_dwordx4 v41, s[20:23], s73 offen lds
    v_mfma_f32_16x16x32_bf16 v[236:239], v[36:39], a[28:31], v[236:239]
    v_mfma_f32_16x16x32_bf16 v[240:243], v[36:39], a[32:35], v[240:243]
    s_add_u32 m0, s71, 19008
    v_mfma_f32_16x16x32_bf16 v[244:247], v[36:39], a[36:39], v[244:247]
    buffer_load_dwordx4 v42, s[20:23], s73 offen lds
    v_mfma_f32_16x16x32_bf16 v[248:251], v[36:39], a[40:43], v[248:251]
    v_mfma_f32_16x16x32_bf16 v[252:255], v[36:39], a[44:47], v[252:255]
    s_waitcnt vmcnt(15)
    s_waitcnt lgkmcnt(0)
    v_mfma_f32_16x16x32_bf16 v[64:67], v[8:11], a[0:3], v[64:67]
    ds_read_b64_tr_b16 v[24:25], v3 offset:0
    ds_read_b64_tr_b16 v[26:27], v3 offset:512
    v_mfma_f32_16x16x32_bf16 v[68:71], v[8:11], a[4:7], v[68:71]
    ds_read_b64_tr_b16 v[28:29], v3 offset:32
    ds_read_b64_tr_b16 v[30:31], v3 offset:544
    v_mfma_f32_16x16x32_bf16 v[72:75], v[8:11], a[8:11], v[72:75]
    ds_read_b64_tr_b16 v[32:33], v3 offset:64
    ds_read_b64_tr_b16 v[34:35], v3 offset:576
    v_mfma_f32_16x16x32_bf16 v[76:79], v[8:11], a[12:15], v[76:79]
    ds_read_b64_tr_b16 v[36:37], v3 offset:96
    ds_read_b64_tr_b16 v[38:39], v3 offset:608
    v_mfma_f32_16x16x32_bf16 v[80:83], v[8:11], a[16:19], v[80:83]
    ds_read_b128 a[24:27], v1 offset:64
    ds_read_b128 a[28:31], v1 offset:576
    s_add_u32 m0, s71, 20064
    v_mfma_f32_16x16x32_bf16 v[84:87], v[8:11], a[20:23], v[84:87]
    ds_read_b128 a[32:35], v1 offset:8512
    buffer_load_dwordx4 v43, s[20:23], s73 offen lds
    v_mfma_f32_16x16x32_bf16 v[88:91], v[12:15], a[0:3], v[88:91]
    v_mfma_f32_16x16x32_bf16 v[92:95], v[12:15], a[4:7], v[92:95]
    v_mfma_f32_16x16x32_bf16 v[96:99], v[12:15], a[8:11], v[96:99]
    v_mfma_f32_16x16x32_bf16 v[100:103], v[12:15], a[12:15], v[100:103]
    s_waitcnt lgkmcnt(3)
    s_add_u32 s73, s63, 786432
    s_add_u32 m0, s71, 0
    v_mfma_f32_16x16x32_bf16 v[104:107], v[12:15], a[16:19], v[104:107]
    buffer_load_dwordx4 v40, s[20:23], s73 offen lds
    s_add_u32 m0, s71, 1056
    v_mfma_f32_16x16x32_bf16 v[108:111], v[12:15], a[20:23], v[108:111]
    buffer_load_dwordx4 v41, s[20:23], s73 offen lds
    s_add_u32 m0, s71, 2112
    v_mfma_f32_16x16x32_bf16 v[112:115], v[16:19], a[0:3], v[112:115]
    buffer_load_dwordx4 v42, s[20:23], s73 offen lds
    s_add_u32 m0, s71, 3168
    v_mfma_f32_16x16x32_bf16 v[116:119], v[16:19], a[4:7], v[116:119]
    buffer_load_dwordx4 v43, s[20:23], s73 offen lds
    v_mfma_f32_16x16x32_bf16 v[120:123], v[16:19], a[8:11], v[120:123]
    v_mfma_f32_16x16x32_bf16 v[124:127], v[16:19], a[12:15], v[124:127]
    v_mfma_f32_16x16x32_bf16 v[128:131], v[16:19], a[16:19], v[128:131]
    v_mfma_f32_16x16x32_bf16 v[132:135], v[16:19], a[20:23], v[132:135]
    v_mfma_f32_16x16x32_bf16 v[136:139], v[20:23], a[0:3], v[136:139]
    v_mfma_f32_16x16x32_bf16 v[140:143], v[20:23], a[4:7], v[140:143]
    v_mfma_f32_16x16x32_bf16 v[144:147], v[20:23], a[8:11], v[144:147]
    v_mfma_f32_16x16x32_bf16 v[148:151], v[20:23], a[12:15], v[148:151]
    v_mfma_f32_16x16x32_bf16 v[152:155], v[20:23], a[16:19], v[152:155]
    v_mfma_f32_16x16x32_bf16 v[156:159], v[20:23], a[20:23], v[156:159]
    s_waitcnt vmcnt(16)
    s_waitcnt lgkmcnt(0)
    v_mfma_f32_16x16x32_bf16 v[160:163], v[24:27], a[0:3], v[160:163]
    ds_read_b64_tr_b16 v[8:9], v3 offset:4224
    ds_read_b64_tr_b16 v[10:11], v3 offset:4736
    v_mfma_f32_16x16x32_bf16 v[164:167], v[24:27], a[4:7], v[164:167]
    ds_read_b64_tr_b16 v[12:13], v3 offset:4256
    ds_read_b64_tr_b16 v[14:15], v3 offset:4768
    v_mfma_f32_16x16x32_bf16 v[168:171], v[24:27], a[8:11], v[168:171]
    ds_read_b64_tr_b16 v[16:17], v3 offset:4288
    ds_read_b64_tr_b16 v[18:19], v3 offset:4800
    v_mfma_f32_16x16x32_bf16 v[172:175], v[24:27], a[12:15], v[172:175]
    ds_read_b64_tr_b16 v[20:21], v3 offset:4320
    ds_read_b64_tr_b16 v[22:23], v3 offset:4832
    v_mfma_f32_16x16x32_bf16 v[176:179], v[24:27], a[16:19], v[176:179]
    ds_read_b128 a[36:39], v1 offset:9024
    ds_read_b128 a[40:43], v1 offset:16960
    v_mfma_f32_16x16x32_bf16 v[180:183], v[24:27], a[20:23], v[180:183]
    ds_read_b128 a[44:47], v1 offset:17472
    v_mfma_f32_16x16x32_bf16 v[184:187], v[28:31], a[0:3], v[184:187]
    v_mfma_f32_16x16x32_bf16 v[188:191], v[28:31], a[4:7], v[188:191]
    v_mfma_f32_16x16x32_bf16 v[192:195], v[28:31], a[8:11], v[192:195]
    v_mfma_f32_16x16x32_bf16 v[196:199], v[28:31], a[12:15], v[196:199]
    s_waitcnt lgkmcnt(3)
    s_add_u32 s73, s63, 786560
    s_add_u32 m0, s71, 4224
    v_mfma_f32_16x16x32_bf16 v[200:203], v[28:31], a[16:19], v[200:203]
    buffer_load_dwordx4 v40, s[20:23], s73 offen lds
    s_add_u32 m0, s71, 5280
    v_mfma_f32_16x16x32_bf16 v[204:207], v[28:31], a[20:23], v[204:207]
    buffer_load_dwordx4 v41, s[20:23], s73 offen lds
    s_add_u32 m0, s71, 6336
    v_mfma_f32_16x16x32_bf16 v[208:211], v[32:35], a[0:3], v[208:211]
    buffer_load_dwordx4 v42, s[20:23], s73 offen lds
    s_add_u32 m0, s71, 7392
    v_mfma_f32_16x16x32_bf16 v[212:215], v[32:35], a[4:7], v[212:215]
    buffer_load_dwordx4 v43, s[20:23], s73 offen lds
    v_mfma_f32_16x16x32_bf16 v[216:219], v[32:35], a[8:11], v[216:219]
    v_mfma_f32_16x16x32_bf16 v[220:223], v[32:35], a[12:15], v[220:223]
    s_add_u32 m0, s70, 0
    s_add_u32 s75, s69, 0
    v_mfma_f32_16x16x32_bf16 v[224:227], v[32:35], a[16:19], v[224:227]
    buffer_load_dwordx4 v4, s[16:19], s75 offen nt lds
    v_mfma_f32_16x16x32_bf16 v[228:231], v[32:35], a[20:23], v[228:231]
    v_mfma_f32_16x16x32_bf16 v[232:235], v[36:39], a[0:3], v[232:235]
    s_add_u32 m0, s70, 1056
    s_add_u32 s75, s69, 5120
    v_mfma_f32_16x16x32_bf16 v[236:239], v[36:39], a[4:7], v[236:239]
    buffer_load_dwordx4 v4, s[16:19], s75 offen nt lds
    v_mfma_f32_16x16x32_bf16 v[240:243], v[36:39], a[8:11], v[240:243]
    v_mfma_f32_16x16x32_bf16 v[244:247], v[36:39], a[12:15], v[244:247]
    s_add_u32 m0, s70, 2112
    s_add_u32 s75, s69, 10240
    v_mfma_f32_16x16x32_bf16 v[248:251], v[36:39], a[16:19], v[248:251]
    buffer_load_dwordx4 v4, s[16:19], s75 offen nt lds
    v_mfma_f32_16x16x32_bf16 v[252:255], v[36:39], a[20:23], v[252:255]
    s_waitcnt vmcnt(19)
    s_waitcnt lgkmcnt(0)
    v_mfma_f32_16x16x32_bf16 v[64:67], v[8:11], a[24:27], v[64:67]
    ds_read_b64_tr_b16 v[24:25], v3 offset:8448
    ds_read_b64_tr_b16 v[26:27], v3 offset:8960
    v_mfma_f32_16x16x32_bf16 v[68:71], v[8:11], a[28:31], v[68:71]
    ds_read_b64_tr_b16 v[28:29], v3 offset:8480
    ds_read_b64_tr_b16 v[30:31], v3 offset:8992
    v_mfma_f32_16x16x32_bf16 v[72:75], v[8:11], a[32:35], v[72:75]
    ds_read_b64_tr_b16 v[32:33], v3 offset:8512
    ds_read_b64_tr_b16 v[34:35], v3 offset:9024
    v_mfma_f32_16x16x32_bf16 v[76:79], v[8:11], a[36:39], v[76:79]
    ds_read_b64_tr_b16 v[36:37], v3 offset:8544
    ds_read_b64_tr_b16 v[38:39], v3 offset:9056
    v_mfma_f32_16x16x32_bf16 v[80:83], v[8:11], a[40:43], v[80:83]
    ds_read_b128 a[0:3], v1 offset:128
    ds_read_b128 a[4:7], v1 offset:640
    s_add_u32 m0, s70, 3168
    s_add_u32 s75, s69, 15360
    v_mfma_f32_16x16x32_bf16 v[84:87], v[8:11], a[44:47], v[84:87]
    ds_read_b128 a[8:11], v1 offset:8576
    buffer_load_dwordx4 v4, s[16:19], s75 offen nt lds
    v_mfma_f32_16x16x32_bf16 v[88:91], v[12:15], a[24:27], v[88:91]
    v_mfma_f32_16x16x32_bf16 v[92:95], v[12:15], a[28:31], v[92:95]
    s_add_u32 m0, s70, 4224
    s_add_u32 s75, s69, 20480
    v_mfma_f32_16x16x32_bf16 v[96:99], v[12:15], a[32:35], v[96:99]
    buffer_load_dwordx4 v4, s[16:19], s75 offen nt lds
    v_mfma_f32_16x16x32_bf16 v[100:103], v[12:15], a[36:39], v[100:103]
    v_mfma_f32_16x16x32_bf16 v[104:107], v[12:15], a[40:43], v[104:107]
    s_add_u32 m0, s70, 5280
    s_add_u32 s75, s69, 25600
    v_mfma_f32_16x16x32_bf16 v[108:111], v[12:15], a[44:47], v[108:111]
    buffer_load_dwordx4 v4, s[16:19], s75 offen nt lds
    v_mfma_f32_16x16x32_bf16 v[112:115], v[16:19], a[24:27], v[112:115]
    v_mfma_f32_16x16x32_bf16 v[116:119], v[16:19], a[28:31], v[116:119]
    s_add_u32 s75, s74, 57344
    v_mfma_f32_16x16x32_bf16 v[120:123], v[16:19], a[32:35], v[120:123]
    buffer_load_dwordx4 a[136:139], v0, s[8:11], s75 offen offset:0 nt
    v_mfma_f32_16x16x32_bf16 v[124:127], v[16:19], a[36:39], v[124:127]
    v_mfma_f32_16x16x32_bf16 v[128:131], v[16:19], a[40:43], v[128:131]
    v_mfma_f32_16x16x32_bf16 v[132:135], v[16:19], a[44:47], v[132:135]
    v_mfma_f32_16x16x32_bf16 v[136:139], v[20:23], a[24:27], v[136:139]
    buffer_load_dwordx4 a[140:143], v0, s[8:11], s75 offen offset:1024 nt
    v_mfma_f32_16x16x32_bf16 v[140:143], v[20:23], a[28:31], v[140:143]
    v_mfma_f32_16x16x32_bf16 v[144:147], v[20:23], a[32:35], v[144:147]
    s_add_u32 s75, s74, 49152
    v_mfma_f32_16x16x32_bf16 v[148:151], v[20:23], a[36:39], v[148:151]
    buffer_load_dwordx4 a[144:147], v0, s[12:15], s75 offen offset:0 nt
    v_mfma_f32_16x16x32_bf16 v[152:155], v[20:23], a[40:43], v[152:155]
    v_mfma_f32_16x16x32_bf16 v[156:159], v[20:23], a[44:47], v[156:159]
    s_waitcnt vmcnt(21)
    s_waitcnt lgkmcnt(0)
    v_mfma_f32_16x16x32_bf16 v[160:163], v[24:27], a[24:27], v[160:163]
    ds_read_b64_tr_b16 v[8:9], v3 offset:12672
    ds_read_b64_tr_b16 v[10:11], v3 offset:13184
    v_mfma_f32_16x16x32_bf16 v[164:167], v[24:27], a[28:31], v[164:167]
    ds_read_b64_tr_b16 v[12:13], v3 offset:12704
    ds_read_b64_tr_b16 v[14:15], v3 offset:13216
    v_mfma_f32_16x16x32_bf16 v[168:171], v[24:27], a[32:35], v[168:171]
    ds_read_b64_tr_b16 v[16:17], v3 offset:12736
    ds_read_b64_tr_b16 v[18:19], v3 offset:13248
    v_mfma_f32_16x16x32_bf16 v[172:175], v[24:27], a[36:39], v[172:175]
    ds_read_b64_tr_b16 v[20:21], v3 offset:12768
    ds_read_b64_tr_b16 v[22:23], v3 offset:13280
    v_mfma_f32_16x16x32_bf16 v[176:179], v[24:27], a[40:43], v[176:179]
    ds_read_b128 a[12:15], v1 offset:9088
    ds_read_b128 a[16:19], v1 offset:17024
    v_mfma_f32_16x16x32_bf16 v[180:183], v[24:27], a[44:47], v[180:183]
    ds_read_b128 a[20:23], v1 offset:17536
    buffer_load_dwordx4 a[148:151], v0, s[12:15], s75 offen offset:1024 nt
    v_mfma_f32_16x16x32_bf16 v[184:187], v[28:31], a[24:27], v[184:187]
    v_mfma_f32_16x16x32_bf16 v[188:191], v[28:31], a[28:31], v[188:191]
    s_add_u32 s75, s74, 65536
    v_mfma_f32_16x16x32_bf16 v[192:195], v[28:31], a[32:35], v[192:195]
    buffer_load_dwordx4 a[152:155], v0, s[8:11], s75 offen offset:0 nt
    v_mfma_f32_16x16x32_bf16 v[196:199], v[28:31], a[36:39], v[196:199]
    v_mfma_f32_16x16x32_bf16 v[200:203], v[28:31], a[40:43], v[200:203]
    v_mfma_f32_16x16x32_bf16 v[204:207], v[28:31], a[44:47], v[204:207]
    buffer_load_dwordx4 a[156:159], v0, s[8:11], s75 offen offset:1024 nt
    v_mfma_f32_16x16x32_bf16 v[208:211], v[32:35], a[24:27], v[208:211]
    v_mfma_f32_16x16x32_bf16 v[212:215], v[32:35], a[28:31], v[212:215]
    s_add_u32 s75, s74, 57344
    v_mfma_f32_16x16x32_bf16 v[216:219], v[32:35], a[32:35], v[216:219]
    buffer_load_dwordx4 a[160:163], v0, s[12:15], s75 offen offset:0 nt
    v_mfma_f32_16x16x32_bf16 v[220:223], v[32:35], a[36:39], v[220:223]
    v_mfma_f32_16x16x32_bf16 v[224:227], v[32:35], a[40:43], v[224:227]
    v_mfma_f32_16x16x32_bf16 v[228:231], v[32:35], a[44:47], v[228:231]
    v_mfma_f32_16x16x32_bf16 v[232:235], v[36:39], a[24:27], v[232:235]
    buffer_load_dwordx4 a[164:167], v0, s[12:15], s75 offen offset:1024 nt
    v_mfma_f32_16x16x32_bf16 v[236:239], v[36:39], a[28:31], v[236:239]
    v_mfma_f32_16x16x32_bf16 v[240:243], v[36:39], a[32:35], v[240:243]
    s_add_u32 s75, s74, 73728
    v_mfma_f32_16x16x32_bf16 v[244:247], v[36:39], a[36:39], v[244:247]
    buffer_load_dwordx4 a[168:171], v0, s[8:11], s75 offen offset:0 nt
    v_mfma_f32_16x16x32_bf16 v[248:251], v[36:39], a[40:43], v[248:251]
    v_mfma_f32_16x16x32_bf16 v[252:255], v[36:39], a[44:47], v[252:255]
    s_waitcnt vmcnt(23)
    s_waitcnt lgkmcnt(0)
    v_mfma_f32_16x16x32_bf16 v[64:67], v[8:11], a[0:3], v[64:67]
    ds_read_b64_tr_b16 v[24:25], v3 offset:16896
    ds_read_b64_tr_b16 v[26:27], v3 offset:17408
    v_mfma_f32_16x16x32_bf16 v[68:71], v[8:11], a[4:7], v[68:71]
    ds_read_b64_tr_b16 v[28:29], v3 offset:16928
    ds_read_b64_tr_b16 v[30:31], v3 offset:17440
    v_mfma_f32_16x16x32_bf16 v[72:75], v[8:11], a[8:11], v[72:75]
    ds_read_b64_tr_b16 v[32:33], v3 offset:16960
    ds_read_b64_tr_b16 v[34:35], v3 offset:17472
    v_mfma_f32_16x16x32_bf16 v[76:79], v[8:11], a[12:15], v[76:79]
    ds_read_b64_tr_b16 v[36:37], v3 offset:16992
    ds_read_b64_tr_b16 v[38:39], v3 offset:17504
    v_mfma_f32_16x16x32_bf16 v[80:83], v[8:11], a[16:19], v[80:83]
    ds_read_b128 a[24:27], v1 offset:192
    ds_read_b128 a[28:31], v1 offset:704
    v_mfma_f32_16x16x32_bf16 v[84:87], v[8:11], a[20:23], v[84:87]
    ds_read_b128 a[32:35], v1 offset:8640
    buffer_load_dwordx4 a[172:175], v0, s[8:11], s75 offen offset:1024 nt
    v_mfma_f32_16x16x32_bf16 v[88:91], v[12:15], a[0:3], v[88:91]
    v_mfma_f32_16x16x32_bf16 v[92:95], v[12:15], a[4:7], v[92:95]
    s_add_u32 s73, s64, 0
    s_add_u32 m0, s71, 8448
    v_mfma_f32_16x16x32_bf16 v[96:99], v[12:15], a[8:11], v[96:99]
    buffer_load_dwordx4 v40, s[20:23], s73 offen lds
    v_mfma_f32_16x16x32_bf16 v[100:103], v[12:15], a[12:15], v[100:103]
    v_mfma_f32_16x16x32_bf16 v[104:107], v[12:15], a[16:19], v[104:107]
    s_add_u32 m0, s71, 9504
    v_mfma_f32_16x16x32_bf16 v[108:111], v[12:15], a[20:23], v[108:111]
    buffer_load_dwordx4 v41, s[20:23], s73 offen lds
    v_mfma_f32_16x16x32_bf16 v[112:115], v[16:19], a[0:3], v[112:115]
    v_mfma_f32_16x16x32_bf16 v[116:119], v[16:19], a[4:7], v[116:119]
    s_add_u32 m0, s71, 10560
    v_mfma_f32_16x16x32_bf16 v[120:123], v[16:19], a[8:11], v[120:123]
    buffer_load_dwordx4 v42, s[20:23], s73 offen lds
    v_mfma_f32_16x16x32_bf16 v[124:127], v[16:19], a[12:15], v[124:127]
    v_mfma_f32_16x16x32_bf16 v[128:131], v[16:19], a[16:19], v[128:131]
    v_mfma_f32_16x16x32_bf16 v[132:135], v[16:19], a[20:23], v[132:135]
    s_add_u32 m0, s71, 11616
    v_mfma_f32_16x16x32_bf16 v[136:139], v[20:23], a[0:3], v[136:139]
    buffer_load_dwordx4 v43, s[20:23], s73 offen lds
    v_mfma_f32_16x16x32_bf16 v[140:143], v[20:23], a[4:7], v[140:143]
    v_mfma_f32_16x16x32_bf16 v[144:147], v[20:23], a[8:11], v[144:147]
    s_add_u32 s73, s64, 128
    s_add_u32 m0, s71, 12672
    v_mfma_f32_16x16x32_bf16 v[148:151], v[20:23], a[12:15], v[148:151]
    buffer_load_dwordx4 v40, s[20:23], s73 offen lds
    v_mfma_f32_16x16x32_bf16 v[152:155], v[20:23], a[16:19], v[152:155]
    v_mfma_f32_16x16x32_bf16 v[156:159], v[20:23], a[20:23], v[156:159]
    s_waitcnt vmcnt(25)
    s_waitcnt lgkmcnt(0)
    v_mfma_f32_16x16x32_bf16 v[160:163], v[24:27], a[0:3], v[160:163]
    ds_read_b64_tr_b16 v[8:9], v3 offset:0
    ds_read_b64_tr_b16 v[10:11], v3 offset:512
    v_mfma_f32_16x16x32_bf16 v[164:167], v[24:27], a[4:7], v[164:167]
    ds_read_b64_tr_b16 v[12:13], v3 offset:32
    ds_read_b64_tr_b16 v[14:15], v3 offset:544
    v_mfma_f32_16x16x32_bf16 v[168:171], v[24:27], a[8:11], v[168:171]
    ds_read_b64_tr_b16 v[16:17], v3 offset:64
    ds_read_b64_tr_b16 v[18:19], v3 offset:576
    v_mfma_f32_16x16x32_bf16 v[172:175], v[24:27], a[12:15], v[172:175]
    ds_read_b64_tr_b16 v[20:21], v3 offset:96
    ds_read_b64_tr_b16 v[22:23], v3 offset:608
    v_mfma_f32_16x16x32_bf16 v[176:179], v[24:27], a[16:19], v[176:179]
    ds_read_b128 a[36:39], v1 offset:9152
    ds_read_b128 a[40:43], v1 offset:17088
    s_add_u32 m0, s71, 13728
    v_mfma_f32_16x16x32_bf16 v[180:183], v[24:27], a[20:23], v[180:183]
    ds_read_b128 a[44:47], v1 offset:17600
    buffer_load_dwordx4 v41, s[20:23], s73 offen lds
    v_mfma_f32_16x16x32_bf16 v[184:187], v[28:31], a[0:3], v[184:187]
    v_mfma_f32_16x16x32_bf16 v[188:191], v[28:31], a[4:7], v[188:191]
    s_add_u32 m0, s71, 14784
    v_mfma_f32_16x16x32_bf16 v[192:195], v[28:31], a[8:11], v[192:195]
    buffer_load_dwordx4 v42, s[20:23], s73 offen lds
    v_mfma_f32_16x16x32_bf16 v[196:199], v[28:31], a[12:15], v[196:199]
    v_mfma_f32_16x16x32_bf16 v[200:203], v[28:31], a[16:19], v[200:203]
    s_add_u32 m0, s71, 15840
    v_mfma_f32_16x16x32_bf16 v[204:207], v[28:31], a[20:23], v[204:207]
    buffer_load_dwordx4 v43, s[20:23], s73 offen lds
    v_mfma_f32_16x16x32_bf16 v[208:211], v[32:35], a[0:3], v[208:211]
    v_mfma_f32_16x16x32_bf16 v[212:215], v[32:35], a[4:7], v[212:215]
    s_add_u32 s73, s64, 262144
    s_add_u32 m0, s71, 16896
    v_mfma_f32_16x16x32_bf16 v[216:219], v[32:35], a[8:11], v[216:219]
    buffer_load_dwordx4 v40, s[20:23], s73 offen lds
    v_mfma_f32_16x16x32_bf16 v[220:223], v[32:35], a[12:15], v[220:223]
    v_mfma_f32_16x16x32_bf16 v[224:227], v[32:35], a[16:19], v[224:227]
    v_mfma_f32_16x16x32_bf16 v[228:231], v[32:35], a[20:23], v[228:231]
    s_add_u32 m0, s71, 17952
    v_mfma_f32_16x16x32_bf16 v[232:235], v[36:39], a[0:3], v[232:235]
    buffer_load_dwordx4 v41, s[20:23], s73 offen lds
    v_mfma_f32_16x16x32_bf16 v[236:239], v[36:39], a[4:7], v[236:239]
    v_mfma_f32_16x16x32_bf16 v[240:243], v[36:39], a[8:11], v[240:243]
    s_add_u32 m0, s71, 19008
    v_mfma_f32_16x16x32_bf16 v[244:247], v[36:39], a[12:15], v[244:247]
    buffer_load_dwordx4 v42, s[20:23], s73 offen lds
    v_mfma_f32_16x16x32_bf16 v[248:251], v[36:39], a[16:19], v[248:251]
    v_mfma_f32_16x16x32_bf16 v[252:255], v[36:39], a[20:23], v[252:255]
    s_waitcnt vmcnt(21)
    s_waitcnt lgkmcnt(0)
    s_barrier
    v_add_u32 v1, 4294941952, v1
    v_mfma_f32_16x16x32_bf16 v[64:67], v[8:11], a[24:27], v[64:67]
    ds_read_b64_tr_b16 v[24:25], v3 offset:4224
    ds_read_b64_tr_b16 v[26:27], v3 offset:4736
    v_mfma_f32_16x16x32_bf16 v[68:71], v[8:11], a[28:31], v[68:71]
    ds_read_b64_tr_b16 v[28:29], v3 offset:4256
    ds_read_b64_tr_b16 v[30:31], v3 offset:4768
    v_mfma_f32_16x16x32_bf16 v[72:75], v[8:11], a[32:35], v[72:75]
    ds_read_b64_tr_b16 v[32:33], v3 offset:4288
    ds_read_b64_tr_b16 v[34:35], v3 offset:4800
    v_mfma_f32_16x16x32_bf16 v[76:79], v[8:11], a[36:39], v[76:79]
    ds_read_b64_tr_b16 v[36:37], v3 offset:4320
    ds_read_b64_tr_b16 v[38:39], v3 offset:4832
    v_mfma_f32_16x16x32_bf16 v[80:83], v[8:11], a[40:43], v[80:83]
    ds_read_b128 a[0:3], v1 offset:0
    ds_read_b128 a[4:7], v1 offset:512
    s_add_u32 m0, s71, 20064
    v_mfma_f32_16x16x32_bf16 v[84:87], v[8:11], a[44:47], v[84:87]
    ds_read_b128 a[8:11], v1 offset:8448
    buffer_load_dwordx4 v43, s[20:23], s73 offen lds
    v_mfma_f32_16x16x32_bf16 v[88:91], v[12:15], a[24:27], v[88:91]
    v_mfma_f32_16x16x32_bf16 v[92:95], v[12:15], a[28:31], v[92:95]
    s_add_u32 s73, s64, 262272
    s_add_u32 m0, s71, 0
    v_mfma_f32_16x16x32_bf16 v[96:99], v[12:15], a[32:35], v[96:99]
    buffer_load_dwordx4 v40, s[20:23], s73 offen lds
    v_mfma_f32_16x16x32_bf16 v[100:103], v[12:15], a[36:39], v[100:103]
    v_mfma_f32_16x16x32_bf16 v[104:107], v[12:15], a[40:43], v[104:107]
    s_add_u32 m0, s71, 1056
    v_mfma_f32_16x16x32_bf16 v[108:111], v[12:15], a[44:47], v[108:111]
    buffer_load_dwordx4 v41, s[20:23], s73 offen lds
    v_mfma_f32_16x16x32_bf16 v[112:115], v[16:19], a[24:27], v[112:115]
    v_mfma_f32_16x16x32_bf16 v[116:119], v[16:19], a[28:31], v[116:119]
    s_add_u32 m0, s71, 2112
    v_mfma_f32_16x16x32_bf16 v[120:123], v[16:19], a[32:35], v[120:123]
    buffer_load_dwordx4 v42, s[20:23], s73 offen lds
    v_mfma_f32_16x16x32_bf16 v[124:127], v[16:19], a[36:39], v[124:127]
    v_mfma_f32_16x16x32_bf16 v[128:131], v[16:19], a[40:43], v[128:131]
    v_mfma_f32_16x16x32_bf16 v[132:135], v[16:19], a[44:47], v[132:135]
    s_add_u32 m0, s71, 3168
    v_mfma_f32_16x16x32_bf16 v[136:139], v[20:23], a[24:27], v[136:139]
    buffer_load_dwordx4 v43, s[20:23], s73 offen lds
    v_mfma_f32_16x16x32_bf16 v[140:143], v[20:23], a[28:31], v[140:143]
    v_mfma_f32_16x16x32_bf16 v[144:147], v[20:23], a[32:35], v[144:147]
    s_waitcnt lgkmcnt(3)
    s_add_u32 s73, s64, 524288
    s_add_u32 m0, s71, 4224
    v_mfma_f32_16x16x32_bf16 v[148:151], v[20:23], a[36:39], v[148:151]
    buffer_load_dwordx4 v40, s[20:23], s73 offen lds
    v_mfma_f32_16x16x32_bf16 v[152:155], v[20:23], a[40:43], v[152:155]
    v_mfma_f32_16x16x32_bf16 v[156:159], v[20:23], a[44:47], v[156:159]
    s_waitcnt vmcnt(13)
    s_waitcnt lgkmcnt(0)
    v_mfma_f32_16x16x32_bf16 v[160:163], v[24:27], a[24:27], v[160:163]
    ds_read_b64_tr_b16 v[8:9], v3 offset:8448
    ds_read_b64_tr_b16 v[10:11], v3 offset:8960
    v_mfma_f32_16x16x32_bf16 v[164:167], v[24:27], a[28:31], v[164:167]
    ds_read_b64_tr_b16 v[12:13], v3 offset:8480
    ds_read_b64_tr_b16 v[14:15], v3 offset:8992
    v_mfma_f32_16x16x32_bf16 v[168:171], v[24:27], a[32:35], v[168:171]
    ds_read_b64_tr_b16 v[16:17], v3 offset:8512
    ds_read_b64_tr_b16 v[18:19], v3 offset:9024
    v_mfma_f32_16x16x32_bf16 v[172:175], v[24:27], a[36:39], v[172:175]
    ds_read_b64_tr_b16 v[20:21], v3 offset:8544
    ds_read_b64_tr_b16 v[22:23], v3 offset:9056
    v_mfma_f32_16x16x32_bf16 v[176:179], v[24:27], a[40:43], v[176:179]
    ds_read_b128 a[12:15], v1 offset:8960
    ds_read_b128 a[16:19], v1 offset:16896
    s_add_u32 m0, s71, 5280
    v_mfma_f32_16x16x32_bf16 v[180:183], v[24:27], a[44:47], v[180:183]
    ds_read_b128 a[20:23], v1 offset:17408
    buffer_load_dwordx4 v41, s[20:23], s73 offen lds
    v_mfma_f32_16x16x32_bf16 v[184:187], v[28:31], a[24:27], v[184:187]
    v_mfma_f32_16x16x32_bf16 v[188:191], v[28:31], a[28:31], v[188:191]
    s_add_u32 m0, s71, 6336
    v_mfma_f32_16x16x32_bf16 v[192:195], v[28:31], a[32:35], v[192:195]
    buffer_load_dwordx4 v42, s[20:23], s73 offen lds
    v_mfma_f32_16x16x32_bf16 v[196:199], v[28:31], a[36:39], v[196:199]
    v_mfma_f32_16x16x32_bf16 v[200:203], v[28:31], a[40:43], v[200:203]
    s_add_u32 m0, s71, 7392
    v_mfma_f32_16x16x32_bf16 v[204:207], v[28:31], a[44:47], v[204:207]
    buffer_load_dwordx4 v43, s[20:23], s73 offen lds
    v_mfma_f32_16x16x32_bf16 v[208:211], v[32:35], a[24:27], v[208:211]
    v_mfma_f32_16x16x32_bf16 v[212:215], v[32:35], a[28:31], v[212:215]
    s_waitcnt lgkmcnt(3)
    s_add_u32 s73, s64, 524416
    s_add_u32 m0, s71, 8448
    v_mfma_f32_16x16x32_bf16 v[216:219], v[32:35], a[32:35], v[216:219]
    buffer_load_dwordx4 v40, s[20:23], s73 offen lds
    v_mfma_f32_16x16x32_bf16 v[220:223], v[32:35], a[36:39], v[220:223]
    v_mfma_f32_16x16x32_bf16 v[224:227], v[32:35], a[40:43], v[224:227]
    v_mfma_f32_16x16x32_bf16 v[228:231], v[32:35], a[44:47], v[228:231]
    s_add_u32 m0, s71, 9504
    v_mfma_f32_16x16x32_bf16 v[232:235], v[36:39], a[24:27], v[232:235]
    buffer_load_dwordx4 v41, s[20:23], s73 offen lds
    v_mfma_f32_16x16x32_bf16 v[236:239], v[36:39], a[28:31], v[236:239]
    v_mfma_f32_16x16x32_bf16 v[240:243], v[36:39], a[32:35], v[240:243]
    s_add_u32 m0, s71, 10560
    v_mfma_f32_16x16x32_bf16 v[244:247], v[36:39], a[36:39], v[244:247]
    buffer_load_dwordx4 v42, s[20:23], s73 offen lds
    v_mfma_f32_16x16x32_bf16 v[248:251], v[36:39], a[40:43], v[248:251]
    v_mfma_f32_16x16x32_bf16 v[252:255], v[36:39], a[44:47], v[252:255]
    s_waitcnt vmcnt(15)
    s_waitcnt lgkmcnt(0)
    v_mfma_f32_16x16x32_bf16 v[64:67], v[8:11], a[0:3], v[64:67]
    ds_read_b64_tr_b16 v[24:25], v3 offset:12672
    ds_read_b64_tr_b16 v[26:27], v3 offset:13184
    v_mfma_f32_16x16x32_bf16 v[68:71], v[8:11], a[4:7], v[68:71]
    ds_read_b64_tr_b16 v[28:29], v3 offset:12704
    ds_read_b64_tr_b16 v[30:31], v3 offset:13216
    v_mfma_f32_16x16x32_bf16 v[72:75], v[8:11], a[8:11], v[72:75]
    ds_read_b64_tr_b16 v[32:33], v3 offset:12736
    ds_read_b64_tr_b16 v[34:35], v3 offset:13248
    v_mfma_f32_16x16x32_bf16 v[76:79], v[8:11], a[12:15], v[76:79]
    ds_read_b64_tr_b16 v[36:37], v3 offset:12768
    ds_read_b64_tr_b16 v[38:39], v3 offset:13280
    v_mfma_f32_16x16x32_bf16 v[80:83], v[8:11], a[16:19], v[80:83]
    ds_read_b128 a[24:27], v1 offset:64
    ds_read_b128 a[28:31], v1 offset:576
    s_add_u32 m0, s71, 11616
    v_mfma_f32_16x16x32_bf16 v[84:87], v[8:11], a[20:23], v[84:87]
    ds_read_b128 a[32:35], v1 offset:8512
    buffer_load_dwordx4 v43, s[20:23], s73 offen lds
    v_mfma_f32_16x16x32_bf16 v[88:91], v[12:15], a[0:3], v[88:91]
    v_mfma_f32_16x16x32_bf16 v[92:95], v[12:15], a[4:7], v[92:95]
    v_mfma_f32_16x16x32_bf16 v[96:99], v[12:15], a[8:11], v[96:99]
    v_mfma_f32_16x16x32_bf16 v[100:103], v[12:15], a[12:15], v[100:103]
    s_waitcnt lgkmcnt(3)
    s_add_u32 s73, s64, 786432
    s_add_u32 m0, s71, 12672
    v_mfma_f32_16x16x32_bf16 v[104:107], v[12:15], a[16:19], v[104:107]
    buffer_load_dwordx4 v40, s[20:23], s73 offen lds
    s_add_u32 m0, s71, 13728
    v_mfma_f32_16x16x32_bf16 v[108:111], v[12:15], a[20:23], v[108:111]
    buffer_load_dwordx4 v41, s[20:23], s73 offen lds
    s_add_u32 m0, s71, 14784
    v_mfma_f32_16x16x32_bf16 v[112:115], v[16:19], a[0:3], v[112:115]
    buffer_load_dwordx4 v42, s[20:23], s73 offen lds
    s_add_u32 m0, s71, 15840
    v_mfma_f32_16x16x32_bf16 v[116:119], v[16:19], a[4:7], v[116:119]
    buffer_load_dwordx4 v43, s[20:23], s73 offen lds
    v_mfma_f32_16x16x32_bf16 v[120:123], v[16:19], a[8:11], v[120:123]
    v_mfma_f32_16x16x32_bf16 v[124:127], v[16:19], a[12:15], v[124:127]
    v_mfma_f32_16x16x32_bf16 v[128:131], v[16:19], a[16:19], v[128:131]
    v_mfma_f32_16x16x32_bf16 v[132:135], v[16:19], a[20:23], v[132:135]
    v_mfma_f32_16x16x32_bf16 v[136:139], v[20:23], a[0:3], v[136:139]
    v_mfma_f32_16x16x32_bf16 v[140:143], v[20:23], a[4:7], v[140:143]
    v_mfma_f32_16x16x32_bf16 v[144:147], v[20:23], a[8:11], v[144:147]
    v_mfma_f32_16x16x32_bf16 v[148:151], v[20:23], a[12:15], v[148:151]
    v_mfma_f32_16x16x32_bf16 v[152:155], v[20:23], a[16:19], v[152:155]
    v_mfma_f32_16x16x32_bf16 v[156:159], v[20:23], a[20:23], v[156:159]
    s_waitcnt vmcnt(16)
    s_waitcnt lgkmcnt(0)
    v_mfma_f32_16x16x32_bf16 v[160:163], v[24:27], a[0:3], v[160:163]
    ds_read_b64_tr_b16 v[8:9], v3 offset:16896
    ds_read_b64_tr_b16 v[10:11], v3 offset:17408
    v_mfma_f32_16x16x32_bf16 v[164:167], v[24:27], a[4:7], v[164:167]
    ds_read_b64_tr_b16 v[12:13], v3 offset:16928
    ds_read_b64_tr_b16 v[14:15], v3 offset:17440
    v_mfma_f32_16x16x32_bf16 v[168:171], v[24:27], a[8:11], v[168:171]
    ds_read_b64_tr_b16 v[16:17], v3 offset:16960
    ds_read_b64_tr_b16 v[18:19], v3 offset:17472
    v_mfma_f32_16x16x32_bf16 v[172:175], v[24:27], a[12:15], v[172:175]
    ds_read_b64_tr_b16 v[20:21], v3 offset:16992
    ds_read_b64_tr_b16 v[22:23], v3 offset:17504
    v_mfma_f32_16x16x32_bf16 v[176:179], v[24:27], a[16:19], v[176:179]
    ds_read_b128 a[36:39], v1 offset:9024
    ds_read_b128 a[40:43], v1 offset:16960
    v_mfma_f32_16x16x32_bf16 v[180:183], v[24:27], a[20:23], v[180:183]
    ds_read_b128 a[44:47], v1 offset:17472
    v_mfma_f32_16x16x32_bf16 v[184:187], v[28:31], a[0:3], v[184:187]
    v_mfma_f32_16x16x32_bf16 v[188:191], v[28:31], a[4:7], v[188:191]
    v_mfma_f32_16x16x32_bf16 v[192:195], v[28:31], a[8:11], v[192:195]
    v_mfma_f32_16x16x32_bf16 v[196:199], v[28:31], a[12:15], v[196:199]
    s_waitcnt lgkmcnt(3)
    s_add_u32 s73, s64, 786560
    s_add_u32 m0, s71, 16896
    v_mfma_f32_16x16x32_bf16 v[200:203], v[28:31], a[16:19], v[200:203]
    buffer_load_dwordx4 v40, s[20:23], s73 offen lds
    s_add_u32 m0, s71, 17952
    v_mfma_f32_16x16x32_bf16 v[204:207], v[28:31], a[20:23], v[204:207]
    buffer_load_dwordx4 v41, s[20:23], s73 offen lds
    s_add_u32 m0, s71, 19008
    v_mfma_f32_16x16x32_bf16 v[208:211], v[32:35], a[0:3], v[208:211]
    buffer_load_dwordx4 v42, s[20:23], s73 offen lds
    s_add_u32 m0, s71, 20064
    v_mfma_f32_16x16x32_bf16 v[212:215], v[32:35], a[4:7], v[212:215]
    buffer_load_dwordx4 v43, s[20:23], s73 offen lds
    v_mfma_f32_16x16x32_bf16 v[216:219], v[32:35], a[8:11], v[216:219]
    v_mfma_f32_16x16x32_bf16 v[220:223], v[32:35], a[12:15], v[220:223]
    s_add_u32 s75, s74, 65536
    v_mfma_f32_16x16x32_bf16 v[224:227], v[32:35], a[16:19], v[224:227]
    buffer_load_dwordx4 a[176:179], v0, s[12:15], s75 offen offset:0 nt
    v_mfma_f32_16x16x32_bf16 v[228:231], v[32:35], a[20:23], v[228:231]
    v_mfma_f32_16x16x32_bf16 v[232:235], v[36:39], a[0:3], v[232:235]
    v_mfma_f32_16x16x32_bf16 v[236:239], v[36:39], a[4:7], v[236:239]
    buffer_load_dwordx4 a[180:183], v0, s[12:15], s75 offen offset:1024 nt
    v_mfma_f32_16x16x32_bf16 v[240:243], v[36:39], a[8:11], v[240:243]
    v_mfma_f32_16x16x32_bf16 v[244:247], v[36:39], a[12:15], v[244:247]
    s_add_u32 s75, s74, 81920
    v_mfma_f32_16x16x32_bf16 v[248:251], v[36:39], a[16:19], v[248:251]
    buffer_load_dwordx4 a[184:187], v0, s[8:11], s75 offen offset:0 nt
    v_mfma_f32_16x16x32_bf16 v[252:255], v[36:39], a[20:23], v[252:255]
    s_waitcnt vmcnt(19)
    s_waitcnt lgkmcnt(0)
    v_mfma_f32_16x16x32_bf16 v[64:67], v[8:11], a[24:27], v[64:67]
    ds_read_b64_tr_b16 v[24:25], v3 offset:0
    ds_read_b64_tr_b16 v[26:27], v3 offset:512
    v_mfma_f32_16x16x32_bf16 v[68:71], v[8:11], a[28:31], v[68:71]
    ds_read_b64_tr_b16 v[28:29], v3 offset:32
    ds_read_b64_tr_b16 v[30:31], v3 offset:544
    v_mfma_f32_16x16x32_bf16 v[72:75], v[8:11], a[32:35], v[72:75]
    ds_read_b64_tr_b16 v[32:33], v3 offset:64
    ds_read_b64_tr_b16 v[34:35], v3 offset:576
    v_mfma_f32_16x16x32_bf16 v[76:79], v[8:11], a[36:39], v[76:79]
    ds_read_b64_tr_b16 v[36:37], v3 offset:96
    ds_read_b64_tr_b16 v[38:39], v3 offset:608
    v_mfma_f32_16x16x32_bf16 v[80:83], v[8:11], a[40:43], v[80:83]
    ds_read_b128 a[0:3], v1 offset:128
    ds_read_b128 a[4:7], v1 offset:640
    v_mfma_f32_16x16x32_bf16 v[84:87], v[8:11], a[44:47], v[84:87]
    ds_read_b128 a[8:11], v1 offset:8576
    buffer_load_dwordx4 a[188:191], v0, s[8:11], s75 offen offset:1024 nt
    v_mfma_f32_16x16x32_bf16 v[88:91], v[12:15], a[24:27], v[88:91]
    v_mfma_f32_16x16x32_bf16 v[92:95], v[12:15], a[28:31], v[92:95]
    s_add_u32 s75, s74, 73728
    v_mfma_f32_16x16x32_bf16 v[96:99], v[12:15], a[32:35], v[96:99]
    buffer_load_dwordx4 a[192:195], v0, s[12:15], s75 offen offset:0 nt
    v_mfma_f32_16x16x32_bf16 v[100:103], v[12:15], a[36:39], v[100:103]
    v_mfma_f32_16x16x32_bf16 v[104:107], v[12:15], a[40:43], v[104:107]
    v_mfma_f32_16x16x32_bf16 v[108:111], v[12:15], a[44:47], v[108:111]
    buffer_load_dwordx4 a[196:199], v0, s[12:15], s75 offen offset:1024 nt
    v_mfma_f32_16x16x32_bf16 v[112:115], v[16:19], a[24:27], v[112:115]
    v_mfma_f32_16x16x32_bf16 v[116:119], v[16:19], a[28:31], v[116:119]
    v_mfma_f32_16x16x32_bf16 v[120:123], v[16:19], a[32:35], v[120:123]
    v_mfma_f32_16x16x32_bf16 v[124:127], v[16:19], a[36:39], v[124:127]
    v_mfma_f32_16x16x32_bf16 v[128:131], v[16:19], a[40:43], v[128:131]
    v_mfma_f32_16x16x32_bf16 v[132:135], v[16:19], a[44:47], v[132:135]
    v_mfma_f32_16x16x32_bf16 v[136:139], v[20:23], a[24:27], v[136:139]
    v_mfma_f32_16x16x32_bf16 v[140:143], v[20:23], a[28:31], v[140:143]
    s_add_u32 s75, s74, 90112
    v_mfma_f32_16x16x32_bf16 v[144:147], v[20:23], a[32:35], v[144:147]
    buffer_load_dwordx4 a[200:203], v0, s[8:11], s75 offen offset:0 nt
    v_mfma_f32_16x16x32_bf16 v[148:151], v[20:23], a[36:39], v[148:151]
    v_mfma_f32_16x16x32_bf16 v[152:155], v[20:23], a[40:43], v[152:155]
    v_mfma_f32_16x16x32_bf16 v[156:159], v[20:23], a[44:47], v[156:159]
    s_waitcnt vmcnt(19)
    s_waitcnt lgkmcnt(0)
    v_mfma_f32_16x16x32_bf16 v[160:163], v[24:27], a[24:27], v[160:163]
    ds_read_b64_tr_b16 v[8:9], v3 offset:4224
    ds_read_b64_tr_b16 v[10:11], v3 offset:4736
    v_mfma_f32_16x16x32_bf16 v[164:167], v[24:27], a[28:31], v[164:167]
    ds_read_b64_tr_b16 v[12:13], v3 offset:4256
    ds_read_b64_tr_b16 v[14:15], v3 offset:4768
    v_mfma_f32_16x16x32_bf16 v[168:171], v[24:27], a[32:35], v[168:171]
    ds_read_b64_tr_b16 v[16:17], v3 offset:4288
    ds_read_b64_tr_b16 v[18:19], v3 offset:4800
    v_mfma_f32_16x16x32_bf16 v[172:175], v[24:27], a[36:39], v[172:175]
    ds_read_b64_tr_b16 v[20:21], v3 offset:4320
    ds_read_b64_tr_b16 v[22:23], v3 offset:4832
    v_mfma_f32_16x16x32_bf16 v[176:179], v[24:27], a[40:43], v[176:179]
    ds_read_b128 a[12:15], v1 offset:9088
    ds_read_b128 a[16:19], v1 offset:17024
    v_mfma_f32_16x16x32_bf16 v[180:183], v[24:27], a[44:47], v[180:183]
    ds_read_b128 a[20:23], v1 offset:17536
    buffer_load_dwordx4 a[204:207], v0, s[8:11], s75 offen offset:1024 nt
    v_mfma_f32_16x16x32_bf16 v[184:187], v[28:31], a[24:27], v[184:187]
    v_mfma_f32_16x16x32_bf16 v[188:191], v[28:31], a[28:31], v[188:191]
    v_mfma_f32_16x16x32_bf16 v[192:195], v[28:31], a[32:35], v[192:195]
    v_mfma_f32_16x16x32_bf16 v[196:199], v[28:31], a[36:39], v[196:199]
    v_mfma_f32_16x16x32_bf16 v[200:203], v[28:31], a[40:43], v[200:203]
    v_mfma_f32_16x16x32_bf16 v[204:207], v[28:31], a[44:47], v[204:207]
    v_mfma_f32_16x16x32_bf16 v[208:211], v[32:35], a[24:27], v[208:211]
    v_mfma_f32_16x16x32_bf16 v[212:215], v[32:35], a[28:31], v[212:215]
    s_add_u32 s75, s74, 81920
    v_mfma_f32_16x16x32_bf16 v[216:219], v[32:35], a[32:35], v[216:219]
    buffer_load_dwordx4 a[208:211], v0, s[12:15], s75 offen offset:0 nt
    v_mfma_f32_16x16x32_bf16 v[220:223], v[32:35], a[36:39], v[220:223]
    v_mfma_f32_16x16x32_bf16 v[224:227], v[32:35], a[40:43], v[224:227]
    v_mfma_f32_16x16x32_bf16 v[228:231], v[32:35], a[44:47], v[228:231]
    v_mfma_f32_16x16x32_bf16 v[232:235], v[36:39], a[24:27], v[232:235]
    v_mfma_f32_16x16x32_bf16 v[236:239], v[36:39], a[28:31], v[236:239]
    v_mfma_f32_16x16x32_bf16 v[240:243], v[36:39], a[32:35], v[240:243]
    v_mfma_f32_16x16x32_bf16 v[244:247], v[36:39], a[36:39], v[244:247]
    v_mfma_f32_16x16x32_bf16 v[248:251], v[36:39], a[40:43], v[248:251]
    v_mfma_f32_16x16x32_bf16 v[252:255], v[36:39], a[44:47], v[252:255]
    buffer_load_dwordx4 a[212:215], v0, s[12:15], s75 offen offset:1024 nt
    s_waitcnt vmcnt(18)
    s_waitcnt lgkmcnt(0)
    v_mfma_f32_16x16x32_bf16 v[64:67], v[8:11], a[0:3], v[64:67]
    ds_read_b64_tr_b16 v[24:25], v3 offset:8448
    ds_read_b64_tr_b16 v[26:27], v3 offset:8960
    v_mfma_f32_16x16x32_bf16 v[68:71], v[8:11], a[4:7], v[68:71]
    ds_read_b64_tr_b16 v[28:29], v3 offset:8480
    ds_read_b64_tr_b16 v[30:31], v3 offset:8992
    v_mfma_f32_16x16x32_bf16 v[72:75], v[8:11], a[8:11], v[72:75]
    ds_read_b64_tr_b16 v[32:33], v3 offset:8512
    ds_read_b64_tr_b16 v[34:35], v3 offset:9024
    v_mfma_f32_16x16x32_bf16 v[76:79], v[8:11], a[12:15], v[76:79]
    ds_read_b64_tr_b16 v[36:37], v3 offset:8544
    ds_read_b64_tr_b16 v[38:39], v3 offset:9056
    v_mfma_f32_16x16x32_bf16 v[80:83], v[8:11], a[16:19], v[80:83]
    ds_read_b128 a[24:27], v1 offset:192
    ds_read_b128 a[28:31], v1 offset:704
    v_mfma_f32_16x16x32_bf16 v[84:87], v[8:11], a[20:23], v[84:87]
    ds_read_b128 a[32:35], v1 offset:8640
    v_mfma_f32_16x16x32_bf16 v[88:91], v[12:15], a[0:3], v[88:91]
    v_mfma_f32_16x16x32_bf16 v[92:95], v[12:15], a[4:7], v[92:95]
    s_add_u32 s75, s74, 98304
    v_mfma_f32_16x16x32_bf16 v[96:99], v[12:15], a[8:11], v[96:99]
    buffer_load_dwordx4 a[216:219], v0, s[8:11], s75 offen offset:0 nt
    v_mfma_f32_16x16x32_bf16 v[100:103], v[12:15], a[12:15], v[100:103]
    v_mfma_f32_16x16x32_bf16 v[104:107], v[12:15], a[16:19], v[104:107]
    v_mfma_f32_16x16x32_bf16 v[108:111], v[12:15], a[20:23], v[108:111]
    v_mfma_f32_16x16x32_bf16 v[112:115], v[16:19], a[0:3], v[112:115]
    v_mfma_f32_16x16x32_bf16 v[116:119], v[16:19], a[4:7], v[116:119]
    v_mfma_f32_16x16x32_bf16 v[120:123], v[16:19], a[8:11], v[120:123]
    v_mfma_f32_16x16x32_bf16 v[124:127], v[16:19], a[12:15], v[124:127]
    v_mfma_f32_16x16x32_bf16 v[128:131], v[16:19], a[16:19], v[128:131]
    v_mfma_f32_16x16x32_bf16 v[132:135], v[16:19], a[20:23], v[132:135]
    buffer_load_dwordx4 a[220:223], v0, s[8:11], s75 offen offset:1024 nt
    v_mfma_f32_16x16x32_bf16 v[136:139], v[20:23], a[0:3], v[136:139]
    v_mfma_f32_16x16x32_bf16 v[140:143], v[20:23], a[4:7], v[140:143]
    v_mfma_f32_16x16x32_bf16 v[144:147], v[20:23], a[8:11], v[144:147]
    v_mfma_f32_16x16x32_bf16 v[148:151], v[20:23], a[12:15], v[148:151]
    v_mfma_f32_16x16x32_bf16 v[152:155], v[20:23], a[16:19], v[152:155]
    v_mfma_f32_16x16x32_bf16 v[156:159], v[20:23], a[20:23], v[156:159]
    s_waitcnt vmcnt(16)
    s_waitcnt lgkmcnt(0)
    v_mfma_f32_16x16x32_bf16 v[160:163], v[24:27], a[0:3], v[160:163]
    ds_read_b64_tr_b16 v[8:9], v3 offset:12672
    ds_read_b64_tr_b16 v[10:11], v3 offset:13184
    v_mfma_f32_16x16x32_bf16 v[164:167], v[24:27], a[4:7], v[164:167]
    ds_read_b64_tr_b16 v[12:13], v3 offset:12704
    ds_read_b64_tr_b16 v[14:15], v3 offset:13216
    v_mfma_f32_16x16x32_bf16 v[168:171], v[24:27], a[8:11], v[168:171]
    ds_read_b64_tr_b16 v[16:17], v3 offset:12736
    ds_read_b64_tr_b16 v[18:19], v3 offset:13248
    v_mfma_f32_16x16x32_bf16 v[172:175], v[24:27], a[12:15], v[172:175]
    ds_read_b64_tr_b16 v[20:21], v3 offset:12768
    ds_read_b64_tr_b16 v[22:23], v3 offset:13280
    v_mfma_f32_16x16x32_bf16 v[176:179], v[24:27], a[16:19], v[176:179]
    ds_read_b128 a[36:39], v1 offset:9152
    ds_read_b128 a[40:43], v1 offset:17088
    s_add_u32 s75, s74, 90112
    v_mfma_f32_16x16x32_bf16 v[180:183], v[24:27], a[20:23], v[180:183]
    ds_read_b128 a[44:47], v1 offset:17600
    buffer_load_dwordx4 a[224:227], v0, s[12:15], s75 offen offset:0 nt
    v_mfma_f32_16x16x32_bf16 v[184:187], v[28:31], a[0:3], v[184:187]
    v_mfma_f32_16x16x32_bf16 v[188:191], v[28:31], a[4:7], v[188:191]
    v_mfma_f32_16x16x32_bf16 v[192:195], v[28:31], a[8:11], v[192:195]
    v_mfma_f32_16x16x32_bf16 v[196:199], v[28:31], a[12:15], v[196:199]
    v_mfma_f32_16x16x32_bf16 v[200:203], v[28:31], a[16:19], v[200:203]
    v_mfma_f32_16x16x32_bf16 v[204:207], v[28:31], a[20:23], v[204:207]
    v_mfma_f32_16x16x32_bf16 v[208:211], v[32:35], a[0:3], v[208:211]
    v_mfma_f32_16x16x32_bf16 v[212:215], v[32:35], a[4:7], v[212:215]
    v_mfma_f32_16x16x32_bf16 v[216:219], v[32:35], a[8:11], v[216:219]
    buffer_load_dwordx4 a[228:231], v0, s[12:15], s75 offen offset:1024 nt
    v_mfma_f32_16x16x32_bf16 v[220:223], v[32:35], a[12:15], v[220:223]
    v_mfma_f32_16x16x32_bf16 v[224:227], v[32:35], a[16:19], v[224:227]
    v_mfma_f32_16x16x32_bf16 v[228:231], v[32:35], a[20:23], v[228:231]
    v_mfma_f32_16x16x32_bf16 v[232:235], v[36:39], a[0:3], v[232:235]
    v_mfma_f32_16x16x32_bf16 v[236:239], v[36:39], a[4:7], v[236:239]
    v_mfma_f32_16x16x32_bf16 v[240:243], v[36:39], a[8:11], v[240:243]
    v_mfma_f32_16x16x32_bf16 v[244:247], v[36:39], a[12:15], v[244:247]
    v_mfma_f32_16x16x32_bf16 v[248:251], v[36:39], a[16:19], v[248:251]
    s_add_u32 s75, s74, 106496
    v_mfma_f32_16x16x32_bf16 v[252:255], v[36:39], a[20:23], v[252:255]
    buffer_load_dwordx4 a[232:235], v0, s[8:11], s75 offen offset:0 nt
    s_waitcnt vmcnt(15)
    s_waitcnt lgkmcnt(0)
    v_mfma_f32_16x16x32_bf16 v[64:67], v[8:11], a[24:27], v[64:67]
    ds_read_b64_tr_b16 v[24:25], v3 offset:16896
    ds_read_b64_tr_b16 v[26:27], v3 offset:17408
    v_mfma_f32_16x16x32_bf16 v[68:71], v[8:11], a[28:31], v[68:71]
    ds_read_b64_tr_b16 v[28:29], v3 offset:16928
    ds_read_b64_tr_b16 v[30:31], v3 offset:17440
    v_mfma_f32_16x16x32_bf16 v[72:75], v[8:11], a[32:35], v[72:75]
    ds_read_b64_tr_b16 v[32:33], v3 offset:16960
    ds_read_b64_tr_b16 v[34:35], v3 offset:17472
    v_mfma_f32_16x16x32_bf16 v[76:79], v[8:11], a[36:39], v[76:79]
    ds_read_b64_tr_b16 v[36:37], v3 offset:16992
    ds_read_b64_tr_b16 v[38:39], v3 offset:17504
    v_mfma_f32_16x16x32_bf16 v[80:83], v[8:11], a[40:43], v[80:83]
    v_mfma_f32_16x16x32_bf16 v[84:87], v[8:11], a[44:47], v[84:87]
    v_mfma_f32_16x16x32_bf16 v[88:91], v[12:15], a[24:27], v[88:91]
    v_mfma_f32_16x16x32_bf16 v[92:95], v[12:15], a[28:31], v[92:95]
    v_mfma_f32_16x16x32_bf16 v[96:99], v[12:15], a[32:35], v[96:99]
    buffer_load_dwordx4 a[236:239], v0, s[8:11], s75 offen offset:1024 nt
    v_mfma_f32_16x16x32_bf16 v[100:103], v[12:15], a[36:39], v[100:103]
    v_mfma_f32_16x16x32_bf16 v[104:107], v[12:15], a[40:43], v[104:107]
    v_mfma_f32_16x16x32_bf16 v[108:111], v[12:15], a[44:47], v[108:111]
    v_mfma_f32_16x16x32_bf16 v[112:115], v[16:19], a[24:27], v[112:115]
    v_mfma_f32_16x16x32_bf16 v[116:119], v[16:19], a[28:31], v[116:119]
    v_mfma_f32_16x16x32_bf16 v[120:123], v[16:19], a[32:35], v[120:123]
    v_mfma_f32_16x16x32_bf16 v[124:127], v[16:19], a[36:39], v[124:127]
    v_mfma_f32_16x16x32_bf16 v[128:131], v[16:19], a[40:43], v[128:131]
    s_add_u32 s75, s74, 98304
    v_mfma_f32_16x16x32_bf16 v[132:135], v[16:19], a[44:47], v[132:135]
    buffer_load_dwordx4 a[240:243], v0, s[12:15], s75 offen offset:0 nt
    v_mfma_f32_16x16x32_bf16 v[136:139], v[20:23], a[24:27], v[136:139]
    v_mfma_f32_16x16x32_bf16 v[140:143], v[20:23], a[28:31], v[140:143]
    v_mfma_f32_16x16x32_bf16 v[144:147], v[20:23], a[32:35], v[144:147]
    v_mfma_f32_16x16x32_bf16 v[148:151], v[20:23], a[36:39], v[148:151]
    v_mfma_f32_16x16x32_bf16 v[152:155], v[20:23], a[40:43], v[152:155]
    v_mfma_f32_16x16x32_bf16 v[156:159], v[20:23], a[44:47], v[156:159]
    s_waitcnt lgkmcnt(6)
    v_mfma_f32_16x16x32_bf16 v[160:163], v[24:27], a[24:27], v[160:163]
    v_mfma_f32_16x16x32_bf16 v[164:167], v[24:27], a[28:31], v[164:167]
    v_mfma_f32_16x16x32_bf16 v[168:171], v[24:27], a[32:35], v[168:171]
    v_pk_mul_f32 v[64:65], v[64:65], s[76:77]
    v_pk_mul_f32 v[66:67], v[66:67], s[76:77]
    v_mfma_f32_16x16x32_bf16 v[172:175], v[24:27], a[36:39], v[172:175]
    v_pk_mul_f32 v[68:69], v[68:69], s[76:77]
    v_pk_mul_f32 v[70:71], v[70:71], s[76:77]
    v_mfma_f32_16x16x32_bf16 v[176:179], v[24:27], a[40:43], v[176:179]
    v_cvt_pk_bf16_f32 v64, v64, v65
    v_cvt_pk_bf16_f32 v65, v66, v67
    v_mfma_f32_16x16x32_bf16 v[180:183], v[24:27], a[44:47], v[180:183]
    buffer_load_dwordx4 a[244:247], v0, s[12:15], s75 offen offset:1024 nt
    v_pk_mul_f32 v[72:73], v[72:73], s[76:77]
    v_pk_mul_f32 v[74:75], v[74:75], s[76:77]
    s_waitcnt lgkmcnt(4)
    v_mfma_f32_16x16x32_bf16 v[184:187], v[28:31], a[24:27], v[184:187]
    v_cvt_pk_bf16_f32 v66, v68, v69
    v_cvt_pk_bf16_f32 v67, v70, v71
    v_mfma_f32_16x16x32_bf16 v[188:191], v[28:31], a[28:31], v[188:191]
    v_pk_mul_f32 v[76:77], v[76:77], s[76:77]
    v_pk_mul_f32 v[78:79], v[78:79], s[76:77]
    v_mfma_f32_16x16x32_bf16 v[192:195], v[28:31], a[32:35], v[192:195]
    v_cvt_pk_bf16_f32 v68, v72, v73
    v_cvt_pk_bf16_f32 v69, v74, v75
    v_mfma_f32_16x16x32_bf16 v[196:199], v[28:31], a[36:39], v[196:199]
    v_pk_mul_f32 v[80:81], v[80:81], s[76:77]
    v_pk_mul_f32 v[82:83], v[82:83], s[76:77]
    v_mfma_f32_16x16x32_bf16 v[200:203], v[28:31], a[40:43], v[200:203]
    v_cvt_pk_bf16_f32 v70, v76, v77
    v_cvt_pk_bf16_f32 v71, v78, v79
    v_mfma_f32_16x16x32_bf16 v[204:207], v[28:31], a[44:47], v[204:207]
    v_pk_mul_f32 v[84:85], v[84:85], s[76:77]
    v_pk_mul_f32 v[86:87], v[86:87], s[76:77]
    s_waitcnt lgkmcnt(2)
    v_mfma_f32_16x16x32_bf16 v[208:211], v[32:35], a[24:27], v[208:211]
    v_cvt_pk_bf16_f32 v72, v80, v81
    v_cvt_pk_bf16_f32 v73, v82, v83
    v_mfma_f32_16x16x32_bf16 v[212:215], v[32:35], a[28:31], v[212:215]
    v_pk_mul_f32 v[88:89], v[88:89], s[76:77]
    v_pk_mul_f32 v[90:91], v[90:91], s[76:77]
    v_mfma_f32_16x16x32_bf16 v[216:219], v[32:35], a[32:35], v[216:219]
    v_cvt_pk_bf16_f32 v74, v84, v85
    v_cvt_pk_bf16_f32 v75, v86, v87
    v_mfma_f32_16x16x32_bf16 v[220:223], v[32:35], a[36:39], v[220:223]
    v_pk_mul_f32 v[92:93], v[92:93], s[76:77]
    v_pk_mul_f32 v[94:95], v[94:95], s[76:77]
    v_mfma_f32_16x16x32_bf16 v[224:227], v[32:35], a[40:43], v[224:227]
    v_cvt_pk_bf16_f32 v76, v88, v89
    v_cvt_pk_bf16_f32 v77, v90, v91
    v_mfma_f32_16x16x32_bf16 v[228:231], v[32:35], a[44:47], v[228:231]
    v_pk_mul_f32 v[96:97], v[96:97], s[76:77]
    v_pk_mul_f32 v[98:99], v[98:99], s[76:77]
    s_waitcnt lgkmcnt(0)
    v_mfma_f32_16x16x32_bf16 v[232:235], v[36:39], a[24:27], v[232:235]
    v_cvt_pk_bf16_f32 v78, v92, v93
    v_cvt_pk_bf16_f32 v79, v94, v95
    v_mfma_f32_16x16x32_bf16 v[236:239], v[36:39], a[28:31], v[236:239]
    v_pk_mul_f32 v[100:101], v[100:101], s[76:77]
    v_pk_mul_f32 v[102:103], v[102:103], s[76:77]
    v_mfma_f32_16x16x32_bf16 v[240:243], v[36:39], a[32:35], v[240:243]
    v_cvt_pk_bf16_f32 v80, v96, v97
    v_cvt_pk_bf16_f32 v81, v98, v99
    v_mfma_f32_16x16x32_bf16 v[244:247], v[36:39], a[36:39], v[244:247]
    v_pk_mul_f32 v[104:105], v[104:105], s[76:77]
    v_pk_mul_f32 v[106:107], v[106:107], s[76:77]
    v_mfma_f32_16x16x32_bf16 v[248:251], v[36:39], a[40:43], v[248:251]
    v_cvt_pk_bf16_f32 v82, v100, v101
    v_cvt_pk_bf16_f32 v83, v102, v103
    v_mfma_f32_16x16x32_bf16 v[252:255], v[36:39], a[44:47], v[252:255]
    v_pk_mul_f32 v[108:109], v[108:109], s[76:77]
    v_pk_mul_f32 v[110:111], v[110:111], s[76:77]
    s_mov_b32 s32, 67584
    s_cmp_eq_u32 s3, 1
    s_cselect_b32 s32, 109824, s32
    s_cmp_eq_u32 s3, 2
    s_cselect_b32 s32, 139264, s32
    v_add_u32 v4, s32, v2
    s_mov_b32 s34, s74
    v_cvt_pk_bf16_f32 v84, v104, v105
    v_cvt_pk_bf16_f32 v85, v106, v107
    v_pk_mul_f32 v[112:113], v[112:113], s[76:77]
    v_pk_mul_f32 v[114:115], v[114:115], s[76:77]
    v_cvt_pk_bf16_f32 v86, v108, v109
    v_cvt_pk_bf16_f32 v87, v110, v111
    v_pk_mul_f32 v[116:117], v[116:117], s[76:77]
    v_pk_mul_f32 v[118:119], v[118:119], s[76:77]
    v_cvt_pk_bf16_f32 v88, v112, v113
    v_cvt_pk_bf16_f32 v89, v114, v115
    v_pk_mul_f32 v[120:121], v[120:121], s[76:77]
    v_pk_mul_f32 v[122:123], v[122:123], s[76:77]
    v_cvt_pk_bf16_f32 v90, v116, v117
    v_cvt_pk_bf16_f32 v91, v118, v119
    v_pk_mul_f32 v[124:125], v[124:125], s[76:77]
    v_pk_mul_f32 v[126:127], v[126:127], s[76:77]
    v_cvt_pk_bf16_f32 v92, v120, v121
    v_cvt_pk_bf16_f32 v93, v122, v123
    v_pk_mul_f32 v[128:129], v[128:129], s[76:77]
    v_pk_mul_f32 v[130:131], v[130:131], s[76:77]
    v_cvt_pk_bf16_f32 v94, v124, v125
    v_cvt_pk_bf16_f32 v95, v126, v127
    v_pk_mul_f32 v[132:133], v[132:133], s[76:77]
    v_pk_mul_f32 v[134:135], v[134:135], s[76:77]
    v_cvt_pk_bf16_f32 v96, v128, v129
    v_cvt_pk_bf16_f32 v97, v130, v131
    v_pk_mul_f32 v[136:137], v[136:137], s[76:77]
    v_pk_mul_f32 v[138:139], v[138:139], s[76:77]
    v_cvt_pk_bf16_f32 v98, v132, v133
    v_cvt_pk_bf16_f32 v99, v134, v135
    v_pk_mul_f32 v[140:141], v[140:141], s[76:77]
    v_pk_mul_f32 v[142:143], v[142:143], s[76:77]
    v_cvt_pk_bf16_f32 v100, v136, v137
    v_cvt_pk_bf16_f32 v101, v138, v139
    v_pk_mul_f32 v[144:145], v[144:145], s[76:77]
    v_pk_mul_f32 v[146:147], v[146:147], s[76:77]
    v_cvt_pk_bf16_f32 v102, v140, v141
    v_cvt_pk_bf16_f32 v103, v142, v143
    v_pk_mul_f32 v[148:149], v[148:149], s[76:77]
    v_pk_mul_f32 v[150:151], v[150:151], s[76:77]
    v_cvt_pk_bf16_f32 v104, v144, v145
    v_cvt_pk_bf16_f32 v105, v146, v147
    v_pk_mul_f32 v[152:153], v[152:153], s[76:77]
    v_pk_mul_f32 v[154:155], v[154:155], s[76:77]
    v_cvt_pk_bf16_f32 v106, v148, v149
    v_cvt_pk_bf16_f32 v107, v150, v151
    v_pk_mul_f32 v[156:157], v[156:157], s[76:77]
    v_pk_mul_f32 v[158:159], v[158:159], s[76:77]
    v_cvt_pk_bf16_f32 v108, v152, v153
    v_cvt_pk_bf16_f32 v109, v154, v155
    v_cvt_pk_bf16_f32 v110, v156, v157
    v_cvt_pk_bf16_f32 v111, v158, v159
    v_pk_mul_f32 v[160:161], v[160:161], s[76:77]
    v_pk_mul_f32 v[162:163], v[162:163], s[76:77]
    v_pk_mul_f32 v[164:165], v[164:165], s[76:77]
    v_pk_mul_f32 v[166:167], v[166:167], s[76:77]
    v_cvt_pk_bf16_f32 v112, v160, v161
    v_cvt_pk_bf16_f32 v113, v162, v163
    v_pk_mul_f32 v[168:169], v[168:169], s[76:77]
    v_pk_mul_f32 v[170:171], v[170:171], s[76:77]
    v_cvt_pk_bf16_f32 v114, v164, v165
    v_cvt_pk_bf16_f32 v115, v166, v167
    v_pk_mul_f32 v[172:173], v[172:173], s[76:77]
    v_pk_mul_f32 v[174:175], v[174:175], s[76:77]
    v_cvt_pk_bf16_f32 v116, v168, v169
    v_cvt_pk_bf16_f32 v117, v170, v171
    v_pk_mul_f32 v[176:177], v[176:177], s[76:77]
    v_pk_mul_f32 v[178:179], v[178:179], s[76:77]
    v_cvt_pk_bf16_f32 v118, v172, v173
    v_cvt_pk_bf16_f32 v119, v174, v175
    v_pk_mul_f32 v[180:181], v[180:181], s[76:77]
    v_pk_mul_f32 v[182:183], v[182:183], s[76:77]
    v_cvt_pk_bf16_f32 v120, v176, v177
    v_cvt_pk_bf16_f32 v121, v178, v179
    v_pk_mul_f32 v[184:185], v[184:185], s[76:77]
    v_pk_mul_f32 v[186:187], v[186:187], s[76:77]
    v_cvt_pk_bf16_f32 v122, v180, v181
    v_cvt_pk_bf16_f32 v123, v182, v183
    v_pk_mul_f32 v[188:189], v[188:189], s[76:77]
    v_pk_mul_f32 v[190:191], v[190:191], s[76:77]
    v_cvt_pk_bf16_f32 v124, v184, v185
    v_cvt_pk_bf16_f32 v125, v186, v187
    v_pk_mul_f32 v[192:193], v[192:193], s[76:77]
    v_pk_mul_f32 v[194:195], v[194:195], s[76:77]
    v_cvt_pk_bf16_f32 v126, v188, v189
    v_cvt_pk_bf16_f32 v127, v190, v191
    v_pk_mul_f32 v[196:197], v[196:197], s[76:77]
    v_pk_mul_f32 v[198:199], v[198:199], s[76:77]
    v_cvt_pk_bf16_f32 v128, v192, v193
    v_cvt_pk_bf16_f32 v129, v194, v195
    v_pk_mul_f32 v[200:201], v[200:201], s[76:77]
    v_pk_mul_f32 v[202:203], v[202:203], s[76:77]
    v_cvt_pk_bf16_f32 v130, v196, v197
    v_cvt_pk_bf16_f32 v131, v198, v199
    v_pk_mul_f32 v[204:205], v[204:205], s[76:77]
    v_pk_mul_f32 v[206:207], v[206:207], s[76:77]
    v_cvt_pk_bf16_f32 v132, v200, v201
    v_cvt_pk_bf16_f32 v133, v202, v203
    v_pk_mul_f32 v[208:209], v[208:209], s[76:77]
    v_pk_mul_f32 v[210:211], v[210:211], s[76:77]
    v_cvt_pk_bf16_f32 v134, v204, v205
    v_cvt_pk_bf16_f32 v135, v206, v207
    v_pk_mul_f32 v[212:213], v[212:213], s[76:77]
    v_pk_mul_f32 v[214:215], v[214:215], s[76:77]
    v_cvt_pk_bf16_f32 v136, v208, v209
    v_cvt_pk_bf16_f32 v137, v210, v211
    v_pk_mul_f32 v[216:217], v[216:217], s[76:77]
    v_pk_mul_f32 v[218:219], v[218:219], s[76:77]
    v_cvt_pk_bf16_f32 v138, v212, v213
    v_cvt_pk_bf16_f32 v139, v214, v215
    v_pk_mul_f32 v[220:221], v[220:221], s[76:77]
    v_pk_mul_f32 v[222:223], v[222:223], s[76:77]
    v_cvt_pk_bf16_f32 v140, v216, v217
    v_cvt_pk_bf16_f32 v141, v218, v219
    v_pk_mul_f32 v[224:225], v[224:225], s[76:77]
    v_pk_mul_f32 v[226:227], v[226:227], s[76:77]
    v_cvt_pk_bf16_f32 v142, v220, v221
    v_cvt_pk_bf16_f32 v143, v222, v223
    v_pk_mul_f32 v[228:229], v[228:229], s[76:77]
    v_pk_mul_f32 v[230:231], v[230:231], s[76:77]
    v_cvt_pk_bf16_f32 v144, v224, v225
    v_cvt_pk_bf16_f32 v145, v226, v227
    v_pk_mul_f32 v[232:233], v[232:233], s[76:77]
    v_pk_mul_f32 v[234:235], v[234:235], s[76:77]
    v_cvt_pk_bf16_f32 v146, v228, v229
    v_cvt_pk_bf16_f32 v147, v230, v231
    v_pk_mul_f32 v[236:237], v[236:237], s[76:77]
    v_pk_mul_f32 v[238:239], v[238:239], s[76:77]
    v_cvt_pk_bf16_f32 v148, v232, v233
    v_cvt_pk_bf16_f32 v149, v234, v235
    v_pk_mul_f32 v[240:241], v[240:241], s[76:77]
    v_pk_mul_f32 v[242:243], v[242:243], s[76:77]
    v_cvt_pk_bf16_f32 v150, v236, v237
    v_cvt_pk_bf16_f32 v151, v238, v239
    v_pk_mul_f32 v[244:245], v[244:245], s[76:77]
    v_pk_mul_f32 v[246:247], v[246:247], s[76:77]
    v_cvt_pk_bf16_f32 v152, v240, v241
    v_cvt_pk_bf16_f32 v153, v242, v243
    v_pk_mul_f32 v[248:249], v[248:249], s[76:77]
    v_pk_mul_f32 v[250:251], v[250:251], s[76:77]
    v_cvt_pk_bf16_f32 v154, v244, v245
    v_cvt_pk_bf16_f32 v155, v246, v247
    v_pk_mul_f32 v[252:253], v[252:253], s[76:77]
    v_pk_mul_f32 v[254:255], v[254:255], s[76:77]
    v_cvt_pk_bf16_f32 v156, v248, v249
    v_cvt_pk_bf16_f32 v157, v250, v251
    v_cvt_pk_bf16_f32 v158, v252, v253
    v_cvt_pk_bf16_f32 v159, v254, v255
    v_add_u32 v32, s72, v0
    s_mov_b32 s76, s33
    v_mov_b64 v[36:37], 0
    v_mov_b64 v[38:39], 0
    s_barrier
    ds_write_b128 v32, v[48:51] offset:0
    ds_write_b128 v32, v[52:55] offset:1056
    ds_write_b128 v32, v[56:59] offset:16896
    ds_write_b128 v32, v[60:63] offset:17952
    s_cmp_eq_u32 s3, 3
    s_cbranch_scc1 L_loader
    ds_write_b64 v4, v[64:65] offset:0
    ds_write_b64 v4, v[76:77] offset:512
    ds_write_b64 v4, v[88:89] offset:1024
    ds_write_b64 v4, v[100:101] offset:1536
    ds_write_b64 v4, v[112:113] offset:2048
    ds_write_b64 v4, v[124:125] offset:2560
    ds_write_b64 v4, v[136:137] offset:3072
    ds_write_b64 v4, v[148:149] offset:3584
    ds_write_b64 v4, v[66:67] offset:4096
    ds_write_b64 v4, v[78:79] offset:4608
    ds_write_b64 v4, v[90:91] offset:5120
    ds_write_b64 v4, v[102:103] offset:5632
    ds_write_b64 v4, v[114:115] offset:6144
    ds_write_b64 v4, v[126:127] offset:6656
    ds_write_b64 v4, v[138:139] offset:7168
    ds_write_b64 v4, v[150:151] offset:7680
    ds_write_b64 v4, v[68:69] offset:8192
    ds_write_b64 v4, v[80:81] offset:8704
    ds_write_b64 v4, v[92:93] offset:9216
    ds_write_b64 v4, v[104:105] offset:9728
    ds_write_b64 v4, v[116:117] offset:10240
    ds_write_b64 v4, v[128:129] offset:10752
    ds_write_b64 v4, v[140:141] offset:11264
    ds_write_b64 v4, v[152:153] offset:11776
    ds_write_b64 v4, v[70:71] offset:12288
    ds_write_b64 v4, v[82:83] offset:12800
    ds_write_b64 v4, v[94:95] offset:13312
    ds_write_b64 v4, v[106:107] offset:13824
    ds_write_b64 v4, v[118:119] offset:14336
    ds_write_b64 v4, v[130:131] offset:14848
    ds_write_b64 v4, v[142:143] offset:15360
    ds_write_b64 v4, v[154:155] offset:15872
    ds_write_b64 v4, v[72:73] offset:16384
    ds_write_b64 v4, v[84:85] offset:16896
    ds_write_b64 v4, v[96:97] offset:17408
    ds_write_b64 v4, v[108:109] offset:17920
    ds_write_b64 v4, v[120:121] offset:18432
    ds_write_b64 v4, v[132:133] offset:18944
    ds_write_b64 v4, v[144:145] offset:19456
    ds_write_b64 v4, v[156:157] offset:19968
    ds_write_b64 v4, v[74:75] offset:20480
    ds_write_b64 v4, v[86:87] offset:20992
    ds_write_b64 v4, v[98:99] offset:21504
    ds_write_b64 v4, v[110:111] offset:22016
    ds_write_b64 v4, v[122:123] offset:22528
    ds_write_b64 v4, v[134:135] offset:23040
    ds_write_b64 v4, v[146:147] offset:23552
    ds_write_b64 v4, v[158:159] offset:24064
    s_waitcnt lgkmcnt(0)
    s_barrier
    s_lshl_b32 s32, s3, 13
    s_add_u32 s32, s32, 67584
    v_add_u32 v13, s32, v0
    v_add_u32 v1, 0, v1
    ds_read_b128 v[128:131], v13 offset:0
    ds_read_b128 v[132:135], v13 offset:1024
    ds_read_b128 v[136:139], v13 offset:2048
    ds_read_b128 v[140:143], v13 offset:3072
    ds_read_b128 v[144:147], v13 offset:4096
    ds_read_b128 v[148:151], v13 offset:5120
    ds_read_b128 v[152:155], v13 offset:6144
    ds_read_b128 v[156:159], v13 offset:7168
    ds_read_b128 v[48:51], v1 offset:0
    ds_read_b128 v[52:55], v1 offset:512
    ds_read_b128 v[56:59], v1 offset:64
    ds_read_b128 v[60:63], v1 offset:576
    ds_read_b128 v[16:19], v1 offset:128
    ds_read_b128 v[20:23], v1 offset:640
    ds_read_b128 v[24:27], v1 offset:192
    ds_read_b128 v[28:31], v1 offset:704
    v_bfe_u32 v14, v7, 2, 3
    v_mul_u32_u24 v2, 1056, v14
    v_lshrrev_b32 v14, 5, v7
    v_lshl_add_u32 v2, v14, 8, v2
    v_and_b32 v14, 3, v7
    v_lshl_add_u32 v2, v14, 3, v2
    s_lshl_b32 s32, s3, 6
    s_add_u32 s32, s32, 67584
    v_add_u32 v3, s32, v2
    v_add_u32 v4, 139264, v0
    s_lshl_b32 s32, s3, 13
    v_add_u32 v5, s32, v4
    v_add_u32 v6, 4294937856, v5
    v_mov_b32 v8, 0x3f803f80
    s_mov_b32 s77, 0x40004000
    v_accvgpr_write_b32 a252, v8
    v_accvgpr_write_b32 a253, v8
    v_accvgpr_write_b32 a254, v8
    v_accvgpr_write_b32 a255, v8
    s_waitcnt lgkmcnt(7)
    v_mfma_f32_16x16x32_bf16 v[96:99], v[48:51], v[128:131], 0
    v_mfma_f32_16x16x32_bf16 v[104:107], v[48:51], v[144:147], 0
    s_waitcnt lgkmcnt(6)
    v_mfma_f32_16x16x32_bf16 v[100:103], v[52:55], v[128:131], 0
    v_mfma_f32_16x16x32_bf16 v[108:111], v[52:55], v[144:147], 0
    s_waitcnt lgkmcnt(5)
    v_mfma_f32_16x16x32_bf16 v[96:99], v[56:59], v[132:135], v[96:99]
    v_mfma_f32_16x16x32_bf16 v[104:107], v[56:59], v[148:151], v[104:107]
    s_waitcnt lgkmcnt(4)
    v_mfma_f32_16x16x32_bf16 v[100:103], v[60:63], v[132:135], v[100:103]
    v_mfma_f32_16x16x32_bf16 v[108:111], v[60:63], v[148:151], v[108:111]
    s_waitcnt lgkmcnt(3)
    v_mfma_f32_16x16x32_bf16 v[96:99], v[16:19], v[136:139], v[96:99]
    v_mfma_f32_16x16x32_bf16 v[104:107], v[16:19], v[152:155], v[104:107]
    s_waitcnt lgkmcnt(2)
    v_mfma_f32_16x16x32_bf16 v[100:103], v[20:23], v[136:139], v[100:103]
    v_mfma_f32_16x16x32_bf16 v[108:111], v[20:23], v[152:155], v[108:111]
    s_waitcnt lgkmcnt(1)
    v_mfma_f32_16x16x32_bf16 v[96:99], v[24:27], v[140:143], v[96:99]
    v_mfma_f32_16x16x32_bf16 v[104:107], v[24:27], v[156:159], v[104:107]
    s_waitcnt lgkmcnt(0)
    v_mfma_f32_16x16x32_bf16 v[100:103], v[28:31], v[140:143], v[100:103]
    v_mfma_f32_16x16x32_bf16 v[108:111], v[28:31], v[156:159], v[108:111]
    ds_write_b128 v32, a[48:51] offset:25344
    ds_write_b128 v32, a[52:55] offset:26400
    ds_write_b128 v32, a[56:59] offset:33792
    ds_write_b128 v32, a[60:63] offset:34848
    ds_write_b128 v32, a[64:67] offset:42240
    ds_write_b128 v32, a[68:71] offset:43296
    v_max3_f32 v188, v96, v97, v98
    v_max3_f32 v189, v104, v105, v106
    v_max3_f32 v188, v188, v99, v100
    v_max3_f32 v189, v189, v107, v108
    v_max3_f32 v188, v188, v101, v102
    v_max3_f32 v189, v189, v109, v110
    v_max_f32 v188, v188, v103
    v_max_f32 v189, v189, v111
    s_nop 1
    v_permlane32_swap_b32 v188, v189
    v_max_f32 v189, v188, v189
    v_mov_b32 v190, v189
    s_nop 1
    v_permlane16_swap_b32 v190, v189
    v_max_f32 v189, v190, v189
    v_sub_f32 v176, 0xc1800000, v189
    v_sub_f32 v180, 0xc1800000, v189
    s_nop 1
    v_permlane32_swap_b32 v176, v180
    v_mov_b32 v177, v176
    v_mov_b32 v181, v180
    v_mov_b32 v178, v176
    v_mov_b32 v182, v180
    v_mov_b32 v179, v176
    v_mov_b32 v183, v180
    v_pk_add_f32 v[96:97], v[96:97], v[176:177]
    v_pk_add_f32 v[98:99], v[98:99], v[176:177]
    v_pk_add_f32 v[100:101], v[100:101], v[176:177]
    v_pk_add_f32 v[102:103], v[102:103], v[176:177]
    v_pk_add_f32 v[104:105], v[104:105], v[180:181]
    v_pk_add_f32 v[106:107], v[106:107], v[180:181]
    v_pk_add_f32 v[108:109], v[108:109], v[180:181]
    v_pk_add_f32 v[110:111], v[110:111], v[180:181]
    s_waitcnt lgkmcnt(0)
    s_mov_b32 s80, 1
    s_barrier
    ds_read_b128 v[48:51], v1 offset:16896
    ds_read_b128 v[52:55], v1 offset:17408
    ds_read_b128 v[56:59], v1 offset:16960
    ds_read_b128 v[60:63], v1 offset:17472
    ds_read_b128 v[16:19], v1 offset:17024
    ds_read_b128 v[20:23], v1 offset:17536
    ds_read_b128 v[24:27], v1 offset:17088
    ds_read_b128 v[28:31], v1 offset:17600
    s_waitcnt lgkmcnt(6)
    v_mfma_f32_16x16x32_bf16 v[112:115], v[48:51], v[128:131], v[176:179]
    ds_read_b64_tr_b16 v[80:81], v2 offset:25472
    ds_read_b64_tr_b16 v[82:83], v2 offset:25984
    v_mfma_f32_16x16x32_bf16 v[120:123], v[48:51], v[144:147], v[180:183]
    ds_read_b64_tr_b16 v[84:85], v2 offset:25504
    ds_read_b64_tr_b16 v[86:87], v2 offset:26016
    v_exp_f32 v160, v96
    v_mfma_f32_16x16x32_bf16 v[116:119], v[52:55], v[128:131], v[176:179]
    ds_read_b64_tr_b16 v[88:89], v2 offset:25536
    ds_read_b64_tr_b16 v[90:91], v2 offset:26048
    v_exp_f32 v161, v97
    v_mfma_f32_16x16x32_bf16 v[124:127], v[52:55], v[144:147], v[180:183]
    s_waitcnt lgkmcnt(10)
    ds_read_b64_tr_b16 v[92:93], v2 offset:25568
    ds_read_b64_tr_b16 v[94:95], v2 offset:26080
    v_exp_f32 v162, v98
    v_cvt_pk_bf16_f32 v40, v160, v161
    v_mfma_f32_16x16x32_bf16 v[112:115], v[56:59], v[132:135], v[112:115]
    ds_read_b64_tr_b16 v[64:65], v2 offset:25344
    ds_read_b64_tr_b16 v[66:67], v2 offset:25856
    v_exp_f32 v163, v99
    v_mfma_f32_16x16x32_bf16 v[120:123], v[56:59], v[148:151], v[120:123]
    ds_read_b64_tr_b16 v[68:69], v2 offset:25376
    ds_read_b64_tr_b16 v[70:71], v2 offset:25888
    v_exp_f32 v164, v100
    v_cvt_pk_bf16_f32 v41, v162, v163
    v_mfma_f32_16x16x32_bf16 v[116:119], v[60:63], v[132:135], v[116:119]
    ds_read_b64_tr_b16 v[72:73], v2 offset:25408
    ds_read_b64_tr_b16 v[74:75], v2 offset:25920
    v_exp_f32 v165, v101
    v_exp_f32 v166, v102
    v_mfma_f32_16x16x32_bf16 v[124:127], v[60:63], v[148:151], v[124:127]
    s_waitcnt lgkmcnt(14)
    ds_read_b64_tr_b16 v[76:77], v2 offset:25440
    ds_read_b64_tr_b16 v[78:79], v2 offset:25952
    v_cvt_pk_bf16_f32 v42, v164, v165
    v_or3_b32 v186, v40, v41, v42
    v_mfma_f32_16x16x32_bf16 v[112:115], v[16:19], v[136:139], v[112:115]
    ds_write_b128 v32, a[72:75] offset:50688
    v_exp_f32 v167, v103
    v_mfma_f32_16x16x32_bf16 v[120:123], v[16:19], v[152:155], v[120:123]
    v_exp_f32 v168, v104
    v_cvt_pk_bf16_f32 v43, v166, v167
    v_exp_f32 v169, v105
    v_mfma_f32_16x16x32_bf16 v[116:119], v[20:23], v[136:139], v[116:119]
    ds_write_b128 v32, a[76:79] offset:51744
    v_exp_f32 v170, v106
    v_mfma_f32_16x16x32_bf16 v[124:127], v[20:23], v[152:155], v[124:127]
    v_cvt_pk_bf16_f32 v44, v168, v169
    v_or3_b32 v186, v186, v43, v44
    v_exp_f32 v171, v107
    v_mfma_f32_16x16x32_bf16 v[112:115], v[24:27], v[140:143], v[112:115]
    ds_write_b128 v32, a[80:83] offset:59136
    v_exp_f32 v172, v108
    v_mfma_f32_16x16x32_bf16 v[120:123], v[24:27], v[156:159], v[120:123]
    v_cvt_pk_bf16_f32 v45, v170, v171
    v_exp_f32 v173, v109
    v_exp_f32 v174, v110
    v_cvt_pk_bf16_f32 v46, v172, v173
    v_mfma_f32_16x16x32_bf16 v[116:119], v[28:31], v[140:143], v[116:119]
    ds_write_b128 v32, a[84:87] offset:60192
    v_or3_b32 v186, v186, v45, v46
    v_mfma_f32_16x16x32_bf16 v[124:127], v[28:31], v[156:159], v[124:127]
    v_exp_f32 v175, v111
    s_nop 0
    v_cvt_pk_bf16_f32 v47, v174, v175
    v_bitop3_b32 v186, v186, v47, s77 bitop3:0xa8
    v_cmp_ne_u32 vcc, 0, v186
    s_cbranch_vccnz L_rs_a0
L_rr_a0:
    v_mfma_f32_16x16x32_bf16 v[8:11], a[252:255], v[40:43], 0
    s_waitcnt lgkmcnt(12)
    v_exp_f32 v160, v112
    v_mfma_f32_16x16x32_bf16 v[208:211], v[80:83], v[40:43], 0
    v_exp_f32 v161, v113
    v_mfma_f32_16x16x32_bf16 v[212:215], v[84:87], v[40:43], 0
    v_exp_f32 v162, v114
    v_mfma_f32_16x16x32_bf16 v[216:219], v[88:91], v[40:43], 0
    v_exp_f32 v163, v115
    v_mfma_f32_16x16x32_bf16 v[220:223], v[92:95], v[40:43], 0
    s_waitcnt lgkmcnt(4)
    v_exp_f32 v164, v116
    v_mfma_f32_16x16x32_bf16 v[192:195], v[64:67], v[40:43], 0
    v_exp_f32 v165, v117
    v_mfma_f32_16x16x32_bf16 v[196:199], v[68:71], v[40:43], 0
    v_exp_f32 v166, v118
    v_mfma_f32_16x16x32_bf16 v[200:203], v[72:75], v[40:43], 0
    v_exp_f32 v167, v119
    v_mfma_f32_16x16x32_bf16 v[204:207], v[76:79], v[40:43], 0
    s_waitcnt lgkmcnt(0)
    s_barrier
    v_mfma_f32_16x16x32_bf16 v[12:15], a[252:255], v[44:47], 0
    s_add_u32 s75, s34, 114688
    ds_read_b128 v[48:51], v1 offset:33792
    ds_read_b128 v[52:55], v1 offset:34304
    buffer_load_dwordx4 a[0:3], v0, s[8:11], s75 offen offset:0 nt
    v_cvt_pk_bf16_f32 v40, v160, v161
    v_mfma_f32_16x16x32_bf16 v[224:227], v[64:67], v[44:47], 0
    ds_read_b128 v[56:59], v1 offset:33856
    ds_read_b128 v[60:63], v1 offset:34368
    v_cvt_pk_bf16_f32 v41, v162, v163
    v_mfma_f32_16x16x32_bf16 v[228:231], v[68:71], v[44:47], 0
    ds_read_b128 v[16:19], v1 offset:33920
    ds_read_b128 v[20:23], v1 offset:34432
    v_cvt_pk_bf16_f32 v42, v164, v165
    v_mfma_f32_16x16x32_bf16 v[232:235], v[72:75], v[44:47], 0
    ds_read_b128 v[24:27], v1 offset:33984
    ds_read_b128 v[28:31], v1 offset:34496
    v_or3_b32 v186, v40, v41, v42
    v_mfma_f32_16x16x32_bf16 v[236:239], v[76:79], v[44:47], 0
    buffer_load_dwordx4 a[4:7], v0, s[8:11], s75 offen offset:1024 nt
    v_cvt_pk_bf16_f32 v43, v166, v167
    v_mfma_f32_16x16x32_bf16 v[240:243], v[80:83], v[44:47], 0
    v_exp_f32 v168, v120
    v_mfma_f32_16x16x32_bf16 v[244:247], v[84:87], v[44:47], 0
    v_exp_f32 v169, v121
    v_mfma_f32_16x16x32_bf16 v[248:251], v[88:91], v[44:47], 0
    v_exp_f32 v170, v122
    v_mfma_f32_16x16x32_bf16 v[252:255], v[92:95], v[44:47], 0
    s_waitcnt lgkmcnt(6)
    v_exp_f32 v171, v123
    v_exp_f32 v172, v124
    v_mfma_f32_16x16x32_bf16 v[96:99], v[48:51], v[128:131], v[176:179]
    s_add_u32 s75, s34, 106496
    buffer_load_dwordx4 a[8:11], v0, s[12:15], s75 offen offset:0 nt
    v_cvt_pk_bf16_f32 v44, v168, v169
    v_or3_b32 v186, v186, v43, v44
    v_mfma_f32_16x16x32_bf16 v[104:107], v[48:51], v[144:147], v[180:183]
    ds_read_b64_tr_b16 v[80:81], v2 offset:42368
    ds_read_b64_tr_b16 v[82:83], v2 offset:42880
    v_cvt_pk_bf16_f32 v45, v170, v171
    v_mfma_f32_16x16x32_bf16 v[100:103], v[52:55], v[128:131], v[176:179]
    ds_read_b64_tr_b16 v[84:85], v2 offset:42400
    ds_read_b64_tr_b16 v[86:87], v2 offset:42912
    v_mfma_f32_16x16x32_bf16 v[108:111], v[52:55], v[144:147], v[180:183]
    s_waitcnt lgkmcnt(8)
    ds_read_b64_tr_b16 v[88:89], v2 offset:42432
    ds_read_b64_tr_b16 v[90:91], v2 offset:42944
    v_mfma_f32_16x16x32_bf16 v[96:99], v[56:59], v[132:135], v[96:99]
    ds_read_b64_tr_b16 v[92:93], v2 offset:42464
    ds_read_b64_tr_b16 v[94:95], v2 offset:42976
    buffer_load_dwordx4 a[12:15], v0, s[12:15], s75 offen offset:1024 nt
    v_mfma_f32_16x16x32_bf16 v[104:107], v[56:59], v[148:151], v[104:107]
    ds_read_b64_tr_b16 v[64:65], v2 offset:42240
    ds_read_b64_tr_b16 v[66:67], v2 offset:42752
    v_mfma_f32_16x16x32_bf16 v[100:103], v[60:63], v[132:135], v[100:103]
    ds_read_b64_tr_b16 v[68:69], v2 offset:42272
    ds_read_b64_tr_b16 v[70:71], v2 offset:42784
    v_mfma_f32_16x16x32_bf16 v[108:111], v[60:63], v[148:151], v[108:111]
    s_waitcnt lgkmcnt(12)
    ds_read_b64_tr_b16 v[72:73], v2 offset:42304
    ds_read_b64_tr_b16 v[74:75], v2 offset:42816
    v_mfma_f32_16x16x32_bf16 v[96:99], v[16:19], v[136:139], v[96:99]
    ds_read_b64_tr_b16 v[76:77], v2 offset:42336
    ds_read_b64_tr_b16 v[78:79], v2 offset:42848
    v_mfma_f32_16x16x32_bf16 v[104:107], v[16:19], v[152:155], v[104:107]
    ds_write_b128 v32, a[88:91] offset:0
    v_mfma_f32_16x16x32_bf16 v[100:103], v[20:23], v[136:139], v[100:103]
    v_exp_f32 v173, v125
    v_mfma_f32_16x16x32_bf16 v[108:111], v[20:23], v[152:155], v[108:111]
    ds_write_b128 v32, a[92:95] offset:1056
    v_mfma_f32_32x32x16_bf16 a[64:79], v[36:39], v[36:39], 0
    v_exp_f32 v174, v126
    v_cvt_pk_bf16_f32 v46, v172, v173
    v_or3_b32 v186, v186, v45, v46
    v_exp_f32 v175, v127
    v_mfma_f32_16x16x32_bf16 v[96:99], v[24:27], v[140:143], v[96:99]
    ds_write_b128 v32, a[96:99] offset:8448
    v_mfma_f32_16x16x32_bf16 v[104:107], v[24:27], v[156:159], v[104:107]
    v_cvt_pk_bf16_f32 v47, v174, v175
    v_bitop3_b32 v186, v186, v47, s77 bitop3:0xa8
    v_mfma_f32_16x16x32_bf16 v[100:103], v[28:31], v[140:143], v[100:103]
    ds_write_b128 v32, a[100:103] offset:9504
    v_mfma_f32_16x16x32_bf16 v[108:111], v[28:31], v[156:159], v[108:111]
    v_cmp_ne_u32 vcc, 0, v186
    s_cbranch_vccnz L_rs_a1
L_rr_a1:
    v_mfma_f32_16x16x32_bf16 v[8:11], a[252:255], v[40:43], v[8:11]
    s_waitcnt lgkmcnt(12)
    v_exp_f32 v160, v96
    v_mfma_f32_16x16x32_bf16 v[208:211], v[80:83], v[40:43], v[208:211]
    v_exp_f32 v161, v97
    v_mfma_f32_16x16x32_bf16 v[212:215], v[84:87], v[40:43], v[212:215]
    v_exp_f32 v162, v98
    v_mfma_f32_16x16x32_bf16 v[216:219], v[88:91], v[40:43], v[216:219]
    v_exp_f32 v163, v99
    v_mfma_f32_16x16x32_bf16 v[220:223], v[92:95], v[40:43], v[220:223]
    s_waitcnt lgkmcnt(4)
    v_exp_f32 v164, v100
    v_mfma_f32_16x16x32_bf16 v[192:195], v[64:67], v[40:43], v[192:195]
    v_exp_f32 v165, v101
    v_mfma_f32_16x16x32_bf16 v[196:199], v[68:71], v[40:43], v[196:199]
    v_exp_f32 v166, v102
    v_mfma_f32_16x16x32_bf16 v[200:203], v[72:75], v[40:43], v[200:203]
    v_exp_f32 v167, v103
    v_mfma_f32_16x16x32_bf16 v[204:207], v[76:79], v[40:43], v[204:207]
    s_waitcnt lgkmcnt(0)
    s_barrier
    v_mfma_f32_16x16x32_bf16 v[12:15], a[252:255], v[44:47], v[12:15]
    s_add_u32 s75, s76, 0
    ds_read_b128 v[48:51], v1 offset:50688
    ds_read_b128 v[52:55], v1 offset:51200
    buffer_load_dwordx4 a[248:251], v0, s[24:27], s75 offen
    v_cvt_pk_bf16_f32 v40, v160, v161
    v_mfma_f32_16x16x32_bf16 v[224:227], v[64:67], v[44:47], v[224:227]
    ds_read_b128 v[56:59], v1 offset:50752
    ds_read_b128 v[60:63], v1 offset:51264
    v_cvt_pk_bf16_f32 v41, v162, v163
    v_mfma_f32_16x16x32_bf16 v[228:231], v[68:71], v[44:47], v[228:231]
    ds_read_b128 v[16:19], v1 offset:50816
    ds_read_b128 v[20:23], v1 offset:51328
    v_cvt_pk_bf16_f32 v42, v164, v165
    v_mfma_f32_16x16x32_bf16 v[232:235], v[72:75], v[44:47], v[232:235]
    ds_read_b128 v[24:27], v1 offset:50880
    ds_read_b128 v[28:31], v1 offset:51392
    v_or3_b32 v186, v40, v41, v42
    v_mfma_f32_16x16x32_bf16 v[236:239], v[76:79], v[44:47], v[236:239]
    v_cvt_pk_bf16_f32 v43, v166, v167
    v_mfma_f32_16x16x32_bf16 v[240:243], v[80:83], v[44:47], v[240:243]
    v_exp_f32 v168, v104
    v_mfma_f32_16x16x32_bf16 v[244:247], v[84:87], v[44:47], v[244:247]
    v_exp_f32 v169, v105
    v_mfma_f32_16x16x32_bf16 v[248:251], v[88:91], v[44:47], v[248:251]
    v_exp_f32 v170, v106
    v_mfma_f32_16x16x32_bf16 v[252:255], v[92:95], v[44:47], v[252:255]
    s_waitcnt lgkmcnt(6)
    v_exp_f32 v171, v107
    v_exp_f32 v172, v108
    v_mfma_f32_16x16x32_bf16 v[112:115], v[48:51], v[128:131], v[176:179]
    s_add_u32 s75, s76, 1024
    buffer_load_dwordx4 a[248:251], v0, s[24:27], s75 offen
    v_cvt_pk_bf16_f32 v44, v168, v169
    v_or3_b32 v186, v186, v43, v44
    v_mfma_f32_16x16x32_bf16 v[120:123], v[48:51], v[144:147], v[180:183]
    ds_read_b64_tr_b16 v[80:81], v2 offset:59264
    ds_read_b64_tr_b16 v[82:83], v2 offset:59776
    v_cvt_pk_bf16_f32 v45, v170, v171
    v_mfma_f32_16x16x32_bf16 v[116:119], v[52:55], v[128:131], v[176:179]
    ds_read_b64_tr_b16 v[84:85], v2 offset:59296
    ds_read_b64_tr_b16 v[86:87], v2 offset:59808
    v_mfma_f32_16x16x32_bf16 v[124:127], v[52:55], v[144:147], v[180:183]
    s_waitcnt lgkmcnt(8)
    ds_read_b64_tr_b16 v[88:89], v2 offset:59328
    ds_read_b64_tr_b16 v[90:91], v2 offset:59840
    v_mfma_f32_16x16x32_bf16 v[112:115], v[56:59], v[132:135], v[112:115]
    ds_read_b64_tr_b16 v[92:93], v2 offset:59360
    ds_read_b64_tr_b16 v[94:95], v2 offset:59872
    v_mfma_f32_16x16x32_bf16 v[120:123], v[56:59], v[148:151], v[120:123]
    ds_read_b64_tr_b16 v[64:65], v2 offset:59136
    ds_read_b64_tr_b16 v[66:67], v2 offset:59648
    v_mfma_f32_16x16x32_bf16 v[116:119], v[60:63], v[132:135], v[116:119]
    ds_read_b64_tr_b16 v[68:69], v2 offset:59168
    ds_read_b64_tr_b16 v[70:71], v2 offset:59680
    v_mfma_f32_16x16x32_bf16 v[124:127], v[60:63], v[148:151], v[124:127]
    s_waitcnt lgkmcnt(12)
    ds_read_b64_tr_b16 v[72:73], v2 offset:59200
    ds_read_b64_tr_b16 v[74:75], v2 offset:59712
    v_mfma_f32_16x16x32_bf16 v[112:115], v[16:19], v[136:139], v[112:115]
    ds_read_b64_tr_b16 v[76:77], v2 offset:59232
    ds_read_b64_tr_b16 v[78:79], v2 offset:59744
    v_mfma_f32_16x16x32_bf16 v[120:123], v[16:19], v[152:155], v[120:123]
    ds_write_b128 v32, a[104:107] offset:16896
    v_mfma_f32_16x16x32_bf16 v[116:119], v[20:23], v[136:139], v[116:119]
    v_exp_f32 v173, v109
    v_mfma_f32_16x16x32_bf16 v[124:127], v[20:23], v[152:155], v[124:127]
    ds_write_b128 v32, a[108:111] offset:17952
    v_mfma_f32_32x32x16_bf16 a[80:95], v[36:39], v[36:39], 0
    v_exp_f32 v174, v110
    v_cvt_pk_bf16_f32 v46, v172, v173
    v_or3_b32 v186, v186, v45, v46
    v_exp_f32 v175, v111
    v_mfma_f32_16x16x32_bf16 v[112:115], v[24:27], v[140:143], v[112:115]
    ds_write_b128 v32, a[112:115] offset:25344
    v_mfma_f32_16x16x32_bf16 v[120:123], v[24:27], v[156:159], v[120:123]
    v_cvt_pk_bf16_f32 v47, v174, v175
    v_bitop3_b32 v186, v186, v47, s77 bitop3:0xa8
    v_mfma_f32_16x16x32_bf16 v[116:119], v[28:31], v[140:143], v[116:119]
    ds_write_b128 v32, a[116:119] offset:26400
    v_mfma_f32_16x16x32_bf16 v[124:127], v[28:31], v[156:159], v[124:127]
    v_cmp_ne_u32 vcc, 0, v186
    s_cbranch_vccnz L_rs_a2
L_rr_a2:
    v_mfma_f32_16x16x32_bf16 v[8:11], a[252:255], v[40:43], v[8:11]
    s_waitcnt lgkmcnt(12)
    v_exp_f32 v160, v112
    v_mfma_f32_16x16x32_bf16 v[208:211], v[80:83], v[40:43], v[208:211]
    v_exp_f32 v161, v113
    v_mfma_f32_16x16x32_bf16 v[212:215], v[84:87], v[40:43], v[212:215]
    v_exp_f32 v162, v114
    v_mfma_f32_16x16x32_bf16 v[216:219], v[88:91], v[40:43], v[216:219]
    v_exp_f32 v163, v115
    v_mfma_f32_16x16x32_bf16 v[220:223], v[92:95], v[40:43], v[220:223]
    s_waitcnt lgkmcnt(4)
    v_exp_f32 v164, v116
    v_mfma_f32_16x16x32_bf16 v[192:195], v[64:67], v[40:43], v[192:195]
    v_exp_f32 v165, v117
    v_mfma_f32_16x16x32_bf16 v[196:199], v[68:71], v[40:43], v[196:199]
    v_exp_f32 v166, v118
    v_mfma_f32_16x16x32_bf16 v[200:203], v[72:75], v[40:43], v[200:203]
    v_exp_f32 v167, v119
    v_mfma_f32_16x16x32_bf16 v[204:207], v[76:79], v[40:43], v[204:207]
    s_waitcnt lgkmcnt(0)
    s_barrier
    v_mfma_f32_16x16x32_bf16 v[12:15], a[252:255], v[44:47], v[12:15]
    s_add_u32 s75, s34, 122880
    ds_read_b128 v[48:51], v1 offset:0
    ds_read_b128 v[52:55], v1 offset:512
    buffer_load_dwordx4 a[16:19], v0, s[8:11], s75 offen offset:0 nt
    v_cvt_pk_bf16_f32 v40, v160, v161
    v_mfma_f32_16x16x32_bf16 v[224:227], v[64:67], v[44:47], v[224:227]
    ds_read_b128 v[56:59], v1 offset:64
    ds_read_b128 v[60:63], v1 offset:576
    v_cvt_pk_bf16_f32 v41, v162, v163
    v_mfma_f32_16x16x32_bf16 v[228:231], v[68:71], v[44:47], v[228:231]
    ds_read_b128 v[16:19], v1 offset:128
    ds_read_b128 v[20:23], v1 offset:640
    v_cvt_pk_bf16_f32 v42, v164, v165
    v_mfma_f32_16x16x32_bf16 v[232:235], v[72:75], v[44:47], v[232:235]
    ds_read_b128 v[24:27], v1 offset:192
    ds_read_b128 v[28:31], v1 offset:704
    v_or3_b32 v186, v40, v41, v42
    v_mfma_f32_16x16x32_bf16 v[236:239], v[76:79], v[44:47], v[236:239]
    buffer_load_dwordx4 a[20:23], v0, s[8:11], s75 offen offset:1024 nt
    v_cvt_pk_bf16_f32 v43, v166, v167
    v_mfma_f32_16x16x32_bf16 v[240:243], v[80:83], v[44:47], v[240:243]
    v_exp_f32 v168, v120
    v_mfma_f32_16x16x32_bf16 v[244:247], v[84:87], v[44:47], v[244:247]
    v_exp_f32 v169, v121
    v_mfma_f32_16x16x32_bf16 v[248:251], v[88:91], v[44:47], v[248:251]
    v_exp_f32 v170, v122
    v_mfma_f32_16x16x32_bf16 v[252:255], v[92:95], v[44:47], v[252:255]
    s_waitcnt lgkmcnt(6)
    v_exp_f32 v171, v123
    v_exp_f32 v172, v124
    v_mfma_f32_16x16x32_bf16 v[96:99], v[48:51], v[128:131], v[176:179]
    s_add_u32 s75, s34, 114688
    buffer_load_dwordx4 a[24:27], v0, s[12:15], s75 offen offset:0 nt
    v_cvt_pk_bf16_f32 v44, v168, v169
    v_or3_b32 v186, v186, v43, v44
    v_mfma_f32_16x16x32_bf16 v[104:107], v[48:51], v[144:147], v[180:183]
    ds_read_b64_tr_b16 v[80:81], v2 offset:8576
    ds_read_b64_tr_b16 v[82:83], v2 offset:9088
    v_cvt_pk_bf16_f32 v45, v170, v171
    v_mfma_f32_16x16x32_bf16 v[100:103], v[52:55], v[128:131], v[176:179]
    ds_read_b64_tr_b16 v[84:85], v2 offset:8608
    ds_read_b64_tr_b16 v[86:87], v2 offset:9120
    v_mfma_f32_16x16x32_bf16 v[108:111], v[52:55], v[144:147], v[180:183]
    s_waitcnt lgkmcnt(8)
    ds_read_b64_tr_b16 v[88:89], v2 offset:8640
    ds_read_b64_tr_b16 v[90:91], v2 offset:9152
    v_mfma_f32_16x16x32_bf16 v[96:99], v[56:59], v[132:135], v[96:99]
    ds_read_b64_tr_b16 v[92:93], v2 offset:8672
    ds_read_b64_tr_b16 v[94:95], v2 offset:9184
    buffer_load_dwordx4 a[28:31], v0, s[12:15], s75 offen offset:1024 nt
    v_mfma_f32_16x16x32_bf16 v[104:107], v[56:59], v[148:151], v[104:107]
    ds_read_b64_tr_b16 v[64:65], v2 offset:8448
    ds_read_b64_tr_b16 v[66:67], v2 offset:8960
    v_mfma_f32_16x16x32_bf16 v[100:103], v[60:63], v[132:135], v[100:103]
    ds_read_b64_tr_b16 v[68:69], v2 offset:8480
    ds_read_b64_tr_b16 v[70:71], v2 offset:8992
    v_mfma_f32_16x16x32_bf16 v[108:111], v[60:63], v[148:151], v[108:111]
    s_waitcnt lgkmcnt(12)
    ds_read_b64_tr_b16 v[72:73], v2 offset:8512
    ds_read_b64_tr_b16 v[74:75], v2 offset:9024
    v_mfma_f32_16x16x32_bf16 v[96:99], v[16:19], v[136:139], v[96:99]
    ds_read_b64_tr_b16 v[76:77], v2 offset:8544
    ds_read_b64_tr_b16 v[78:79], v2 offset:9056
    v_mfma_f32_16x16x32_bf16 v[104:107], v[16:19], v[152:155], v[104:107]
    ds_write_b128 v32, a[120:123] offset:33792
    v_mfma_f32_16x16x32_bf16 v[100:103], v[20:23], v[136:139], v[100:103]
    v_exp_f32 v173, v125
    v_mfma_f32_16x16x32_bf16 v[108:111], v[20:23], v[152:155], v[108:111]
    ds_write_b128 v32, a[124:127] offset:34848
    v_mfma_f32_32x32x16_bf16 a[96:111], v[36:39], v[36:39], 0
    v_exp_f32 v174, v126
    v_cvt_pk_bf16_f32 v46, v172, v173
    v_or3_b32 v186, v186, v45, v46
    v_exp_f32 v175, v127
    v_mfma_f32_16x16x32_bf16 v[96:99], v[24:27], v[140:143], v[96:99]
    ds_write_b128 v32, a[128:131] offset:42240
    v_mfma_f32_16x16x32_bf16 v[104:107], v[24:27], v[156:159], v[104:107]
    v_cvt_pk_bf16_f32 v47, v174, v175
    v_bitop3_b32 v186, v186, v47, s77 bitop3:0xa8
    v_mfma_f32_16x16x32_bf16 v[100:103], v[28:31], v[140:143], v[100:103]
    ds_write_b128 v32, a[132:135] offset:43296
    v_mfma_f32_16x16x32_bf16 v[108:111], v[28:31], v[156:159], v[108:111]
    v_cmp_ne_u32 vcc, 0, v186
    s_cbranch_vccnz L_rs_a3
L_rr_a3:
    v_mfma_f32_16x16x32_bf16 v[8:11], a[252:255], v[40:43], v[8:11]
    s_waitcnt lgkmcnt(12)
    v_exp_f32 v160, v96
    v_mfma_f32_16x16x32_bf16 v[208:211], v[80:83], v[40:43], v[208:211]
    v_exp_f32 v161, v97
    v_mfma_f32_16x16x32_bf16 v[212:215], v[84:87], v[40:43], v[212:215]
    v_exp_f32 v162, v98
    v_mfma_f32_16x16x32_bf16 v[216:219], v[88:91], v[40:43], v[216:219]
    v_exp_f32 v163, v99
    v_mfma_f32_16x16x32_bf16 v[220:223], v[92:95], v[40:43], v[220:223]
    s_waitcnt lgkmcnt(4)
    v_exp_f32 v164, v100
    v_mfma_f32_16x16x32_bf16 v[192:195], v[64:67], v[40:43], v[192:195]
    v_exp_f32 v165, v101
    v_mfma_f32_16x16x32_bf16 v[196:199], v[68:71], v[40:43], v[196:199]
    v_exp_f32 v166, v102
    v_mfma_f32_16x16x32_bf16 v[200:203], v[72:75], v[40:43], v[200:203]
    v_exp_f32 v167, v103
    v_mfma_f32_16x16x32_bf16 v[204:207], v[76:79], v[40:43], v[204:207]
    s_waitcnt lgkmcnt(0)
    s_barrier
    v_mfma_f32_16x16x32_bf16 v[12:15], a[252:255], v[44:47], v[12:15]
    s_add_u32 s75, s76, 2048
    ds_read_b128 v[48:51], v1 offset:16896
    ds_read_b128 v[52:55], v1 offset:17408
    buffer_load_dwordx4 a[248:251], v0, s[24:27], s75 offen
    v_cvt_pk_bf16_f32 v40, v160, v161
    v_mfma_f32_16x16x32_bf16 v[224:227], v[64:67], v[44:47], v[224:227]
    ds_read_b128 v[56:59], v1 offset:16960
    ds_read_b128 v[60:63], v1 offset:17472
    v_cvt_pk_bf16_f32 v41, v162, v163
    v_mfma_f32_16x16x32_bf16 v[228:231], v[68:71], v[44:47], v[228:231]
    ds_read_b128 v[16:19], v1 offset:17024
    ds_read_b128 v[20:23], v1 offset:17536
    v_cvt_pk_bf16_f32 v42, v164, v165
    v_mfma_f32_16x16x32_bf16 v[232:235], v[72:75], v[44:47], v[232:235]
    ds_read_b128 v[24:27], v1 offset:17088
    ds_read_b128 v[28:31], v1 offset:17600
    v_or3_b32 v186, v40, v41, v42
    v_mfma_f32_16x16x32_bf16 v[236:239], v[76:79], v[44:47], v[236:239]
    v_cvt_pk_bf16_f32 v43, v166, v167
    v_mfma_f32_16x16x32_bf16 v[240:243], v[80:83], v[44:47], v[240:243]
    v_exp_f32 v168, v104
    v_mfma_f32_16x16x32_bf16 v[244:247], v[84:87], v[44:47], v[244:247]
    v_exp_f32 v169, v105
    v_mfma_f32_16x16x32_bf16 v[248:251], v[88:91], v[44:47], v[248:251]
    v_exp_f32 v170, v106
    v_mfma_f32_16x16x32_bf16 v[252:255], v[92:95], v[44:47], v[252:255]
    s_waitcnt lgkmcnt(6)
    v_exp_f32 v171, v107
    v_exp_f32 v172, v108
    v_mfma_f32_16x16x32_bf16 v[112:115], v[48:51], v[128:131], v[176:179]
    s_add_u32 s75, s76, 3072
    buffer_load_dwordx4 a[248:251], v0, s[24:27], s75 offen
    v_cvt_pk_bf16_f32 v44, v168, v169
    v_or3_b32 v186, v186, v43, v44
    v_mfma_f32_16x16x32_bf16 v[120:123], v[48:51], v[144:147], v[180:183]
    ds_read_b64_tr_b16 v[80:81], v2 offset:25472
    ds_read_b64_tr_b16 v[82:83], v2 offset:25984
    v_cvt_pk_bf16_f32 v45, v170, v171
    v_mfma_f32_16x16x32_bf16 v[116:119], v[52:55], v[128:131], v[176:179]
    ds_read_b64_tr_b16 v[84:85], v2 offset:25504
    ds_read_b64_tr_b16 v[86:87], v2 offset:26016
    v_mfma_f32_16x16x32_bf16 v[124:127], v[52:55], v[144:147], v[180:183]
    s_waitcnt lgkmcnt(8)
    ds_read_b64_tr_b16 v[88:89], v2 offset:25536
    ds_read_b64_tr_b16 v[90:91], v2 offset:26048
    v_mfma_f32_16x16x32_bf16 v[112:115], v[56:59], v[132:135], v[112:115]
    ds_read_b64_tr_b16 v[92:93], v2 offset:25568
    ds_read_b64_tr_b16 v[94:95], v2 offset:26080
    v_mfma_f32_16x16x32_bf16 v[120:123], v[56:59], v[148:151], v[120:123]
    ds_read_b64_tr_b16 v[64:65], v2 offset:25344
    ds_read_b64_tr_b16 v[66:67], v2 offset:25856
    v_mfma_f32_16x16x32_bf16 v[116:119], v[60:63], v[132:135], v[116:119]
    ds_read_b64_tr_b16 v[68:69], v2 offset:25376
    ds_read_b64_tr_b16 v[70:71], v2 offset:25888
    v_mfma_f32_16x16x32_bf16 v[124:127], v[60:63], v[148:151], v[124:127]
    s_waitcnt lgkmcnt(12)
    ds_read_b64_tr_b16 v[72:73], v2 offset:25408
    ds_read_b64_tr_b16 v[74:75], v2 offset:25920
    v_mfma_f32_16x16x32_bf16 v[112:115], v[16:19], v[136:139], v[112:115]
    ds_read_b64_tr_b16 v[76:77], v2 offset:25440
    ds_read_b64_tr_b16 v[78:79], v2 offset:25952
    v_mfma_f32_16x16x32_bf16 v[120:123], v[16:19], v[152:155], v[120:123]
    ds_write_b128 v32, a[136:139] offset:50688
    v_mfma_f32_16x16x32_bf16 v[116:119], v[20:23], v[136:139], v[116:119]
    v_exp_f32 v173, v109
    v_mfma_f32_16x16x32_bf16 v[124:127], v[20:23], v[152:155], v[124:127]
    ds_write_b128 v32, a[140:143] offset:51744
    v_mfma_f32_32x32x16_bf16 a[112:127], v[36:39], v[36:39], 0
    v_exp_f32 v174, v110
    v_cvt_pk_bf16_f32 v46, v172, v173
    v_or3_b32 v186, v186, v45, v46
    v_exp_f32 v175, v111
    v_mfma_f32_16x16x32_bf16 v[112:115], v[24:27], v[140:143], v[112:115]
    ds_write_b128 v32, a[144:147] offset:59136
    v_mfma_f32_16x16x32_bf16 v[120:123], v[24:27], v[156:159], v[120:123]
    v_cvt_pk_bf16_f32 v47, v174, v175
    v_bitop3_b32 v186, v186, v47, s77 bitop3:0xa8
    v_mfma_f32_16x16x32_bf16 v[116:119], v[28:31], v[140:143], v[116:119]
    ds_write_b128 v32, a[148:151] offset:60192
    v_mfma_f32_16x16x32_bf16 v[124:127], v[28:31], v[156:159], v[124:127]
    v_cmp_ne_u32 vcc, 0, v186
    s_cbranch_vccnz L_rs_a4
L_rr_a4:
    v_mfma_f32_16x16x32_bf16 v[8:11], a[252:255], v[40:43], v[8:11]
    s_waitcnt lgkmcnt(12)
    v_exp_f32 v160, v112
    v_mfma_f32_16x16x32_bf16 v[208:211], v[80:83], v[40:43], v[208:211]
    v_exp_f32 v161, v113
    v_mfma_f32_16x16x32_bf16 v[212:215], v[84:87], v[40:43], v[212:215]
    v_exp_f32 v162, v114
    v_mfma_f32_16x16x32_bf16 v[216:219], v[88:91], v[40:43], v[216:219]
    v_exp_f32 v163, v115
    v_mfma_f32_16x16x32_bf16 v[220:223], v[92:95], v[40:43], v[220:223]
    s_waitcnt lgkmcnt(4)
    v_exp_f32 v164, v116
    v_mfma_f32_16x16x32_bf16 v[192:195], v[64:67], v[40:43], v[192:195]
    v_exp_f32 v165, v117
    v_mfma_f32_16x16x32_bf16 v[196:199], v[68:71], v[40:43], v[196:199]
    v_exp_f32 v166, v118
    v_mfma_f32_16x16x32_bf16 v[200:203], v[72:75], v[40:43], v[200:203]
    v_exp_f32 v167, v119
    v_mfma_f32_16x16x32_bf16 v[204:207], v[76:79], v[40:43], v[204:207]
    s_waitcnt lgkmcnt(0)
    s_barrier
    v_mfma_f32_16x16x32_bf16 v[12:15], a[252:255], v[44:47], v[12:15]
    s_add_u32 s75, s34, 131072
    ds_read_b128 v[48:51], v1 offset:33792
    ds_read_b128 v[52:55], v1 offset:34304
    buffer_load_dwordx4 a[32:35], v0, s[8:11], s75 offen offset:0 nt
    v_cvt_pk_bf16_f32 v40, v160, v161
    v_mfma_f32_16x16x32_bf16 v[224:227], v[64:67], v[44:47], v[224:227]
    ds_read_b128 v[56:59], v1 offset:33856
    ds_read_b128 v[60:63], v1 offset:34368
    v_cvt_pk_bf16_f32 v41, v162, v163
    v_mfma_f32_16x16x32_bf16 v[228:231], v[68:71], v[44:47], v[228:231]
    ds_read_b128 v[16:19], v1 offset:33920
    ds_read_b128 v[20:23], v1 offset:34432
    v_cvt_pk_bf16_f32 v42, v164, v165
    v_mfma_f32_16x16x32_bf16 v[232:235], v[72:75], v[44:47], v[232:235]
    ds_read_b128 v[24:27], v1 offset:33984
    ds_read_b128 v[28:31], v1 offset:34496
    v_or3_b32 v186, v40, v41, v42
    v_mfma_f32_16x16x32_bf16 v[236:239], v[76:79], v[44:47], v[236:239]
    buffer_load_dwordx4 a[36:39], v0, s[8:11], s75 offen offset:1024 nt
    v_cvt_pk_bf16_f32 v43, v166, v167
    v_mfma_f32_16x16x32_bf16 v[240:243], v[80:83], v[44:47], v[240:243]
    v_exp_f32 v168, v120
    v_mfma_f32_16x16x32_bf16 v[244:247], v[84:87], v[44:47], v[244:247]
    v_exp_f32 v169, v121
    v_mfma_f32_16x16x32_bf16 v[248:251], v[88:91], v[44:47], v[248:251]
    v_exp_f32 v170, v122
    v_mfma_f32_16x16x32_bf16 v[252:255], v[92:95], v[44:47], v[252:255]
    s_waitcnt lgkmcnt(6)
    v_exp_f32 v171, v123
    v_exp_f32 v172, v124
    v_mfma_f32_16x16x32_bf16 v[96:99], v[48:51], v[128:131], v[176:179]
    s_add_u32 s75, s34, 122880
    buffer_load_dwordx4 a[40:43], v0, s[12:15], s75 offen offset:0 nt
    v_cvt_pk_bf16_f32 v44, v168, v169
    v_or3_b32 v186, v186, v43, v44
    v_mfma_f32_16x16x32_bf16 v[104:107], v[48:51], v[144:147], v[180:183]
    ds_read_b64_tr_b16 v[80:81], v2 offset:42368
    ds_read_b64_tr_b16 v[82:83], v2 offset:42880
    v_cvt_pk_bf16_f32 v45, v170, v171
    v_mfma_f32_16x16x32_bf16 v[100:103], v[52:55], v[128:131], v[176:179]
    ds_read_b64_tr_b16 v[84:85], v2 offset:42400
    ds_read_b64_tr_b16 v[86:87], v2 offset:42912
    v_mfma_f32_16x16x32_bf16 v[108:111], v[52:55], v[144:147], v[180:183]
    s_waitcnt lgkmcnt(8)
    ds_read_b64_tr_b16 v[88:89], v2 offset:42432
    ds_read_b64_tr_b16 v[90:91], v2 offset:42944
    v_mfma_f32_16x16x32_bf16 v[96:99], v[56:59], v[132:135], v[96:99]
    ds_read_b64_tr_b16 v[92:93], v2 offset:42464
    ds_read_b64_tr_b16 v[94:95], v2 offset:42976
    buffer_load_dwordx4 a[44:47], v0, s[12:15], s75 offen offset:1024 nt
    v_mfma_f32_16x16x32_bf16 v[104:107], v[56:59], v[148:151], v[104:107]
    ds_read_b64_tr_b16 v[64:65], v2 offset:42240
    ds_read_b64_tr_b16 v[66:67], v2 offset:42752
    v_mfma_f32_16x16x32_bf16 v[100:103], v[60:63], v[132:135], v[100:103]
    ds_read_b64_tr_b16 v[68:69], v2 offset:42272
    ds_read_b64_tr_b16 v[70:71], v2 offset:42784
    v_mfma_f32_16x16x32_bf16 v[108:111], v[60:63], v[148:151], v[108:111]
    s_waitcnt lgkmcnt(12)
    ds_read_b64_tr_b16 v[72:73], v2 offset:42304
    ds_read_b64_tr_b16 v[74:75], v2 offset:42816
    v_mfma_f32_16x16x32_bf16 v[96:99], v[16:19], v[136:139], v[96:99]
    ds_read_b64_tr_b16 v[76:77], v2 offset:42336
    ds_read_b64_tr_b16 v[78:79], v2 offset:42848
    v_mfma_f32_16x16x32_bf16 v[104:107], v[16:19], v[152:155], v[104:107]
    ds_write_b128 v32, a[152:155] offset:0
    v_mfma_f32_16x16x32_bf16 v[100:103], v[20:23], v[136:139], v[100:103]
    v_exp_f32 v173, v125
    v_mfma_f32_16x16x32_bf16 v[108:111], v[20:23], v[152:155], v[108:111]
    ds_write_b128 v32, a[156:159] offset:1056
    v_mfma_f32_32x32x16_bf16 a[128:143], v[36:39], v[36:39], 0
    v_exp_f32 v174, v126
    v_cvt_pk_bf16_f32 v46, v172, v173
    v_or3_b32 v186, v186, v45, v46
    v_exp_f32 v175, v127
    v_mfma_f32_16x16x32_bf16 v[96:99], v[24:27], v[140:143], v[96:99]
    ds_write_b128 v32, a[160:163] offset:8448
    v_mfma_f32_16x16x32_bf16 v[104:107], v[24:27], v[156:159], v[104:107]
    v_cvt_pk_bf16_f32 v47, v174, v175
    v_bitop3_b32 v186, v186, v47, s77 bitop3:0xa8
    v_mfma_f32_16x16x32_bf16 v[100:103], v[28:31], v[140:143], v[100:103]
    ds_write_b128 v32, a[164:167] offset:9504
    v_mfma_f32_16x16x32_bf16 v[108:111], v[28:31], v[156:159], v[108:111]
    v_cmp_ne_u32 vcc, 0, v186
    s_cbranch_vccnz L_rs_a5
L_rr_a5:
    v_mfma_f32_16x16x32_bf16 v[8:11], a[252:255], v[40:43], v[8:11]
    s_waitcnt lgkmcnt(12)
    v_exp_f32 v160, v96
    v_mfma_f32_16x16x32_bf16 v[208:211], v[80:83], v[40:43], v[208:211]
    v_exp_f32 v161, v97
    v_mfma_f32_16x16x32_bf16 v[212:215], v[84:87], v[40:43], v[212:215]
    v_exp_f32 v162, v98
    v_mfma_f32_16x16x32_bf16 v[216:219], v[88:91], v[40:43], v[216:219]
    v_exp_f32 v163, v99
    v_mfma_f32_16x16x32_bf16 v[220:223], v[92:95], v[40:43], v[220:223]
    s_waitcnt lgkmcnt(4)
    v_exp_f32 v164, v100
    v_mfma_f32_16x16x32_bf16 v[192:195], v[64:67], v[40:43], v[192:195]
    v_exp_f32 v165, v101
    v_mfma_f32_16x16x32_bf16 v[196:199], v[68:71], v[40:43], v[196:199]
    v_exp_f32 v166, v102
    v_mfma_f32_16x16x32_bf16 v[200:203], v[72:75], v[40:43], v[200:203]
    v_exp_f32 v167, v103
    v_mfma_f32_16x16x32_bf16 v[204:207], v[76:79], v[40:43], v[204:207]
    s_waitcnt lgkmcnt(0)
    s_barrier
    v_mfma_f32_16x16x32_bf16 v[12:15], a[252:255], v[44:47], v[12:15]
    s_add_u32 s75, s76, 4096
    ds_read_b128 v[48:51], v1 offset:50688
    ds_read_b128 v[52:55], v1 offset:51200
    buffer_load_dwordx4 a[248:251], v0, s[24:27], s75 offen
    v_cvt_pk_bf16_f32 v40, v160, v161
    v_mfma_f32_16x16x32_bf16 v[224:227], v[64:67], v[44:47], v[224:227]
    ds_read_b128 v[56:59], v1 offset:50752
    ds_read_b128 v[60:63], v1 offset:51264
    v_cvt_pk_bf16_f32 v41, v162, v163
    v_mfma_f32_16x16x32_bf16 v[228:231], v[68:71], v[44:47], v[228:231]
    ds_read_b128 v[16:19], v1 offset:50816
    ds_read_b128 v[20:23], v1 offset:51328
    v_cvt_pk_bf16_f32 v42, v164, v165
    v_mfma_f32_16x16x32_bf16 v[232:235], v[72:75], v[44:47], v[232:235]
    ds_read_b128 v[24:27], v1 offset:50880
    ds_read_b128 v[28:31], v1 offset:51392
    v_or3_b32 v186, v40, v41, v42
    v_mfma_f32_16x16x32_bf16 v[236:239], v[76:79], v[44:47], v[236:239]
    v_cvt_pk_bf16_f32 v43, v166, v167
    v_mfma_f32_16x16x32_bf16 v[240:243], v[80:83], v[44:47], v[240:243]
    v_exp_f32 v168, v104
    v_mfma_f32_16x16x32_bf16 v[244:247], v[84:87], v[44:47], v[244:247]
    v_exp_f32 v169, v105
    v_mfma_f32_16x16x32_bf16 v[248:251], v[88:91], v[44:47], v[248:251]
    v_exp_f32 v170, v106
    v_mfma_f32_16x16x32_bf16 v[252:255], v[92:95], v[44:47], v[252:255]
    s_waitcnt lgkmcnt(6)
    v_exp_f32 v171, v107
    v_mfma_f32_16x16x32_bf16 v[112:115], v[48:51], v[128:131], v[176:179]
    s_add_u32 s75, s76, 5120
    buffer_load_dwordx4 a[248:251], v0, s[24:27], s75 offen
    v_cvt_pk_bf16_f32 v44, v168, v169
    v_mfma_f32_16x16x32_bf16 v[120:123], v[48:51], v[144:147], v[180:183]
    ds_read_b64_tr_b16 v[80:81], v2 offset:59264
    ds_read_b64_tr_b16 v[82:83], v2 offset:59776
    v_or3_b32 v186, v186, v43, v44
    v_mfma_f32_16x16x32_bf16 v[116:119], v[52:55], v[128:131], v[176:179]
    ds_read_b64_tr_b16 v[84:85], v2 offset:59296
    ds_read_b64_tr_b16 v[86:87], v2 offset:59808
    v_cvt_pk_bf16_f32 v45, v170, v171
    v_mfma_f32_16x16x32_bf16 v[124:127], v[52:55], v[144:147], v[180:183]
    s_waitcnt lgkmcnt(8)
    ds_read_b64_tr_b16 v[88:89], v2 offset:59328
    ds_read_b64_tr_b16 v[90:91], v2 offset:59840
    v_mfma_f32_16x16x32_bf16 v[112:115], v[56:59], v[132:135], v[112:115]
    ds_read_b64_tr_b16 v[92:93], v2 offset:59360
    ds_read_b64_tr_b16 v[94:95], v2 offset:59872
    v_mfma_f32_16x16x32_bf16 v[120:123], v[56:59], v[148:151], v[120:123]
    ds_read_b64_tr_b16 v[64:65], v2 offset:59136
    ds_read_b64_tr_b16 v[66:67], v2 offset:59648
    v_mfma_f32_16x16x32_bf16 v[116:119], v[60:63], v[132:135], v[116:119]
    ds_read_b64_tr_b16 v[68:69], v2 offset:59168
    ds_read_b64_tr_b16 v[70:71], v2 offset:59680
    v_mfma_f32_16x16x32_bf16 v[124:127], v[60:63], v[148:151], v[124:127]
    s_waitcnt lgkmcnt(12)
    ds_read_b64_tr_b16 v[72:73], v2 offset:59200
    ds_read_b64_tr_b16 v[74:75], v2 offset:59712
    v_mfma_f32_16x16x32_bf16 v[112:115], v[16:19], v[136:139], v[112:115]
    ds_read_b64_tr_b16 v[76:77], v2 offset:59232
    ds_read_b64_tr_b16 v[78:79], v2 offset:59744
    v_mfma_f32_16x16x32_bf16 v[120:123], v[16:19], v[152:155], v[120:123]
    s_waitcnt vmcnt(34)
    v_exp_f32 v172, v108
    v_mfma_f32_16x16x32_bf16 v[116:119], v[20:23], v[136:139], v[116:119]
    v_exp_f32 v173, v109
    v_mfma_f32_16x16x32_bf16 v[124:127], v[20:23], v[152:155], v[124:127]
    ds_write_b128 v32, a[168:171] offset:16896
    v_mfma_f32_32x32x16_bf16 a[144:159], v[36:39], v[36:39], 0
    v_exp_f32 v174, v110
    v_cvt_pk_bf16_f32 v46, v172, v173
    v_or3_b32 v186, v186, v45, v46
    v_exp_f32 v175, v111
    v_mfma_f32_16x16x32_bf16 v[112:115], v[24:27], v[140:143], v[112:115]
    ds_write_b128 v32, a[172:175] offset:17952
    v_mfma_f32_16x16x32_bf16 v[120:123], v[24:27], v[156:159], v[120:123]
    v_cvt_pk_bf16_f32 v47, v174, v175
    v_bitop3_b32 v186, v186, v47, s77 bitop3:0xa8
    v_mfma_f32_16x16x32_bf16 v[116:119], v[28:31], v[140:143], v[116:119]
    ds_write_b128 v32, a[176:179] offset:25344
    v_mfma_f32_16x16x32_bf16 v[124:127], v[28:31], v[156:159], v[124:127]
    v_cmp_ne_u32 vcc, 0, v186
    s_cbranch_vccnz L_rs_a6
L_rr_a6:
    v_mfma_f32_16x16x32_bf16 v[8:11], a[252:255], v[40:43], v[8:11]
    s_waitcnt lgkmcnt(11)
    ds_write_b128 v32, a[180:183] offset:26400
    v_exp_f32 v160, v112
    v_mfma_f32_16x16x32_bf16 v[208:211], v[80:83], v[40:43], v[208:211]
    v_exp_f32 v161, v113
    v_mfma_f32_16x16x32_bf16 v[212:215], v[84:87], v[40:43], v[212:215]
    v_exp_f32 v162, v114
    v_mfma_f32_16x16x32_bf16 v[216:219], v[88:91], v[40:43], v[216:219]
    v_exp_f32 v163, v115
    v_mfma_f32_16x16x32_bf16 v[220:223], v[92:95], v[40:43], v[220:223]
    s_waitcnt lgkmcnt(4)
    v_exp_f32 v164, v116
    v_mfma_f32_16x16x32_bf16 v[192:195], v[64:67], v[40:43], v[192:195]
    v_exp_f32 v165, v117
    v_mfma_f32_16x16x32_bf16 v[196:199], v[68:71], v[40:43], v[196:199]
    v_exp_f32 v166, v118
    v_mfma_f32_16x16x32_bf16 v[200:203], v[72:75], v[40:43], v[200:203]
    v_exp_f32 v167, v119
    v_mfma_f32_16x16x32_bf16 v[204:207], v[76:79], v[40:43], v[204:207]
    s_waitcnt lgkmcnt(0)
    s_barrier
    v_mfma_f32_16x16x32_bf16 v[12:15], a[252:255], v[44:47], v[12:15]
    s_add_u32 s75, s76, 6144
    ds_read_b128 v[48:51], v1 offset:0
    ds_read_b128 v[52:55], v1 offset:512
    buffer_load_dwordx4 a[248:251], v0, s[24:27], s75 offen
    v_cvt_pk_bf16_f32 v40, v160, v161
    v_mfma_f32_16x16x32_bf16 v[224:227], v[64:67], v[44:47], v[224:227]
    ds_read_b128 v[56:59], v1 offset:64
    ds_read_b128 v[60:63], v1 offset:576
    v_cvt_pk_bf16_f32 v41, v162, v163
    v_mfma_f32_16x16x32_bf16 v[228:231], v[68:71], v[44:47], v[228:231]
    ds_read_b128 v[16:19], v1 offset:128
    ds_read_b128 v[20:23], v1 offset:640
    v_cvt_pk_bf16_f32 v42, v164, v165
    v_mfma_f32_16x16x32_bf16 v[232:235], v[72:75], v[44:47], v[232:235]
    ds_read_b128 v[24:27], v1 offset:192
    ds_read_b128 v[28:31], v1 offset:704
    v_or3_b32 v186, v40, v41, v42
    v_mfma_f32_16x16x32_bf16 v[236:239], v[76:79], v[44:47], v[236:239]
    v_cvt_pk_bf16_f32 v43, v166, v167
    v_mfma_f32_16x16x32_bf16 v[240:243], v[80:83], v[44:47], v[240:243]
    v_exp_f32 v168, v120
    v_mfma_f32_16x16x32_bf16 v[244:247], v[84:87], v[44:47], v[244:247]
    v_exp_f32 v169, v121
    v_mfma_f32_16x16x32_bf16 v[248:251], v[88:91], v[44:47], v[248:251]
    v_exp_f32 v170, v122
    v_mfma_f32_16x16x32_bf16 v[252:255], v[92:95], v[44:47], v[252:255]
    s_waitcnt lgkmcnt(6)
    v_exp_f32 v171, v123
    v_mfma_f32_16x16x32_bf16 v[96:99], v[48:51], v[128:131], v[176:179]
    s_add_u32 s75, s76, 7168
    buffer_load_dwordx4 a[248:251], v0, s[24:27], s75 offen
    v_cvt_pk_bf16_f32 v44, v168, v169
    v_mfma_f32_16x16x32_bf16 v[104:107], v[48:51], v[144:147], v[180:183]
    ds_read_b64_tr_b16 v[80:81], v2 offset:8576
    ds_read_b64_tr_b16 v[82:83], v2 offset:9088
    v_or3_b32 v186, v186, v43, v44
    v_mfma_f32_16x16x32_bf16 v[100:103], v[52:55], v[128:131], v[176:179]
    ds_read_b64_tr_b16 v[84:85], v2 offset:8608
    ds_read_b64_tr_b16 v[86:87], v2 offset:9120
    v_cvt_pk_bf16_f32 v45, v170, v171
    v_mfma_f32_16x16x32_bf16 v[108:111], v[52:55], v[144:147], v[180:183]
    s_waitcnt lgkmcnt(8)
    ds_read_b64_tr_b16 v[88:89], v2 offset:8640
    ds_read_b64_tr_b16 v[90:91], v2 offset:9152
    v_mfma_f32_16x16x32_bf16 v[96:99], v[56:59], v[132:135], v[96:99]
    ds_read_b64_tr_b16 v[92:93], v2 offset:8672
    ds_read_b64_tr_b16 v[94:95], v2 offset:9184
    v_mfma_f32_16x16x32_bf16 v[104:107], v[56:59], v[148:151], v[104:107]
    ds_read_b64_tr_b16 v[64:65], v2 offset:8448
    ds_read_b64_tr_b16 v[66:67], v2 offset:8960
    v_mfma_f32_16x16x32_bf16 v[100:103], v[60:63], v[132:135], v[100:103]
    ds_read_b64_tr_b16 v[68:69], v2 offset:8480
    ds_read_b64_tr_b16 v[70:71], v2 offset:8992
    v_mfma_f32_16x16x32_bf16 v[108:111], v[60:63], v[148:151], v[108:111]
    s_waitcnt lgkmcnt(12)
    ds_read_b64_tr_b16 v[72:73], v2 offset:8512
    ds_read_b64_tr_b16 v[74:75], v2 offset:9024
    v_mfma_f32_16x16x32_bf16 v[96:99], v[16:19], v[136:139], v[96:99]
    ds_read_b64_tr_b16 v[76:77], v2 offset:8544
    ds_read_b64_tr_b16 v[78:79], v2 offset:9056
    v_mfma_f32_16x16x32_bf16 v[104:107], v[16:19], v[152:155], v[104:107]
    s_waitcnt vmcnt(32)
    v_exp_f32 v172, v124
    v_mfma_f32_16x16x32_bf16 v[100:103], v[20:23], v[136:139], v[100:103]
    v_exp_f32 v173, v125
    v_mfma_f32_16x16x32_bf16 v[108:111], v[20:23], v[152:155], v[108:111]
    ds_write_b128 v32, a[184:187] offset:33792
    v_mfma_f32_32x32x16_bf16 a[160:175], v[36:39], v[36:39], 0
    v_exp_f32 v174, v126
    v_cvt_pk_bf16_f32 v46, v172, v173
    v_or3_b32 v186, v186, v45, v46
    v_exp_f32 v175, v127
    v_mfma_f32_16x16x32_bf16 v[96:99], v[24:27], v[140:143], v[96:99]
    ds_write_b128 v32, a[188:191] offset:34848
    v_mfma_f32_16x16x32_bf16 v[104:107], v[24:27], v[156:159], v[104:107]
    v_cvt_pk_bf16_f32 v47, v174, v175
    v_bitop3_b32 v186, v186, v47, s77 bitop3:0xa8
    v_mfma_f32_16x16x32_bf16 v[100:103], v[28:31], v[140:143], v[100:103]
    ds_write_b128 v32, a[192:195] offset:42240
    v_mfma_f32_16x16x32_bf16 v[108:111], v[28:31], v[156:159], v[108:111]
    v_cmp_ne_u32 vcc, 0, v186
    s_cbranch_vccnz L_rs_a7
L_rr_a7:
    v_mfma_f32_16x16x32_bf16 v[8:11], a[252:255], v[40:43], v[8:11]
    s_waitcnt lgkmcnt(11)
    ds_write_b128 v32, a[196:199] offset:43296
    v_exp_f32 v160, v96
    v_mfma_f32_16x16x32_bf16 v[208:211], v[80:83], v[40:43], v[208:211]
    v_exp_f32 v161, v97
    v_mfma_f32_16x16x32_bf16 v[212:215], v[84:87], v[40:43], v[212:215]
    v_exp_f32 v162, v98
    v_mfma_f32_16x16x32_bf16 v[216:219], v[88:91], v[40:43], v[216:219]
    v_exp_f32 v163, v99
    v_mfma_f32_16x16x32_bf16 v[220:223], v[92:95], v[40:43], v[220:223]
    s_waitcnt lgkmcnt(4)
    v_exp_f32 v164, v100
    v_mfma_f32_16x16x32_bf16 v[192:195], v[64:67], v[40:43], v[192:195]
    v_exp_f32 v165, v101
    v_mfma_f32_16x16x32_bf16 v[196:199], v[68:71], v[40:43], v[196:199]
    v_exp_f32 v166, v102
    v_mfma_f32_16x16x32_bf16 v[200:203], v[72:75], v[40:43], v[200:203]
    v_exp_f32 v167, v103
    v_mfma_f32_16x16x32_bf16 v[204:207], v[76:79], v[40:43], v[204:207]
    s_waitcnt lgkmcnt(0)
    s_barrier
    v_mfma_f32_16x16x32_bf16 v[12:15], a[252:255], v[44:47], v[12:15]
    s_add_u32 s75, s76, 8192
    ds_read_b128 v[48:51], v1 offset:16896
    ds_read_b128 v[52:55], v1 offset:17408
    buffer_load_dwordx4 a[248:251], v0, s[24:27], s75 offen
    v_cvt_pk_bf16_f32 v40, v160, v161
    v_mfma_f32_16x16x32_bf16 v[224:227], v[64:67], v[44:47], v[224:227]
    ds_read_b128 v[56:59], v1 offset:16960
    ds_read_b128 v[60:63], v1 offset:17472
    v_cvt_pk_bf16_f32 v41, v162, v163
    v_mfma_f32_16x16x32_bf16 v[228:231], v[68:71], v[44:47], v[228:231]
    ds_read_b128 v[16:19], v1 offset:17024
    ds_read_b128 v[20:23], v1 offset:17536
    v_cvt_pk_bf16_f32 v42, v164, v165
    v_mfma_f32_16x16x32_bf16 v[232:235], v[72:75], v[44:47], v[232:235]
    ds_read_b128 v[24:27], v1 offset:17088
    ds_read_b128 v[28:31], v1 offset:17600
    v_or3_b32 v186, v40, v41, v42
    v_mfma_f32_16x16x32_bf16 v[236:239], v[76:79], v[44:47], v[236:239]
    v_cvt_pk_bf16_f32 v43, v166, v167
    v_mfma_f32_16x16x32_bf16 v[240:243], v[80:83], v[44:47], v[240:243]
    v_exp_f32 v168, v104
    v_mfma_f32_16x16x32_bf16 v[244:247], v[84:87], v[44:47], v[244:247]
    v_exp_f32 v169, v105
    v_mfma_f32_16x16x32_bf16 v[248:251], v[88:91], v[44:47], v[248:251]
    v_exp_f32 v170, v106
    v_mfma_f32_16x16x32_bf16 v[252:255], v[92:95], v[44:47], v[252:255]
    s_waitcnt lgkmcnt(6)
    v_exp_f32 v171, v107
    v_mfma_f32_16x16x32_bf16 v[112:115], v[48:51], v[128:131], v[176:179]
    s_add_u32 s75, s76, 9216
    buffer_load_dwordx4 a[248:251], v0, s[24:27], s75 offen
    v_cvt_pk_bf16_f32 v44, v168, v169
    v_mfma_f32_16x16x32_bf16 v[120:123], v[48:51], v[144:147], v[180:183]
    ds_read_b64_tr_b16 v[80:81], v2 offset:25472
    ds_read_b64_tr_b16 v[82:83], v2 offset:25984
    v_or3_b32 v186, v186, v43, v44
    v_mfma_f32_16x16x32_bf16 v[116:119], v[52:55], v[128:131], v[176:179]
    ds_read_b64_tr_b16 v[84:85], v2 offset:25504
    ds_read_b64_tr_b16 v[86:87], v2 offset:26016
    v_cvt_pk_bf16_f32 v45, v170, v171
    v_mfma_f32_16x16x32_bf16 v[124:127], v[52:55], v[144:147], v[180:183]
    s_waitcnt lgkmcnt(8)
    ds_read_b64_tr_b16 v[88:89], v2 offset:25536
    ds_read_b64_tr_b16 v[90:91], v2 offset:26048
    v_mfma_f32_16x16x32_bf16 v[112:115], v[56:59], v[132:135], v[112:115]
    ds_read_b64_tr_b16 v[92:93], v2 offset:25568
    ds_read_b64_tr_b16 v[94:95], v2 offset:26080
    v_mfma_f32_16x16x32_bf16 v[120:123], v[56:59], v[148:151], v[120:123]
    ds_read_b64_tr_b16 v[64:65], v2 offset:25344
    ds_read_b64_tr_b16 v[66:67], v2 offset:25856
    v_mfma_f32_16x16x32_bf16 v[116:119], v[60:63], v[132:135], v[116:119]
    ds_read_b64_tr_b16 v[68:69], v2 offset:25376
    ds_read_b64_tr_b16 v[70:71], v2 offset:25888
    v_mfma_f32_16x16x32_bf16 v[124:127], v[60:63], v[148:151], v[124:127]
    s_waitcnt lgkmcnt(12)
    ds_read_b64_tr_b16 v[72:73], v2 offset:25408
    ds_read_b64_tr_b16 v[74:75], v2 offset:25920
    v_mfma_f32_16x16x32_bf16 v[112:115], v[16:19], v[136:139], v[112:115]
    ds_read_b64_tr_b16 v[76:77], v2 offset:25440
    ds_read_b64_tr_b16 v[78:79], v2 offset:25952
    v_mfma_f32_16x16x32_bf16 v[120:123], v[16:19], v[152:155], v[120:123]
    s_waitcnt vmcnt(30)
    v_exp_f32 v172, v108
    v_mfma_f32_16x16x32_bf16 v[116:119], v[20:23], v[136:139], v[116:119]
    v_exp_f32 v173, v109
    v_mfma_f32_16x16x32_bf16 v[124:127], v[20:23], v[152:155], v[124:127]
    ds_write_b128 v32, a[200:203] offset:50688
    v_mfma_f32_32x32x16_bf16 a[176:191], v[36:39], v[36:39], 0
    v_exp_f32 v174, v110
    v_cvt_pk_bf16_f32 v46, v172, v173
    v_or3_b32 v186, v186, v45, v46
    v_exp_f32 v175, v111
    v_mfma_f32_16x16x32_bf16 v[112:115], v[24:27], v[140:143], v[112:115]
    ds_write_b128 v32, a[204:207] offset:51744
    v_mfma_f32_16x16x32_bf16 v[120:123], v[24:27], v[156:159], v[120:123]
    v_cvt_pk_bf16_f32 v47, v174, v175
    v_bitop3_b32 v186, v186, v47, s77 bitop3:0xa8
    v_mfma_f32_16x16x32_bf16 v[116:119], v[28:31], v[140:143], v[116:119]
    ds_write_b128 v32, a[208:211] offset:59136
    v_mfma_f32_16x16x32_bf16 v[124:127], v[28:31], v[156:159], v[124:127]
    v_cmp_ne_u32 vcc, 0, v186
    s_cbranch_vccnz L_rs_a8
L_rr_a8:
    v_mfma_f32_16x16x32_bf16 v[8:11], a[252:255], v[40:43], v[8:11]
    s_waitcnt lgkmcnt(11)
    ds_write_b128 v32, a[212:215] offset:60192
    v_exp_f32 v160, v112
    v_mfma_f32_16x16x32_bf16 v[208:211], v[80:83], v[40:43], v[208:211]
    v_exp_f32 v161, v113
    v_mfma_f32_16x16x32_bf16 v[212:215], v[84:87], v[40:43], v[212:215]
    v_exp_f32 v162, v114
    v_mfma_f32_16x16x32_bf16 v[216:219], v[88:91], v[40:43], v[216:219]
    v_exp_f32 v163, v115
    v_mfma_f32_16x16x32_bf16 v[220:223], v[92:95], v[40:43], v[220:223]
    s_waitcnt lgkmcnt(4)
    v_exp_f32 v164, v116
    v_mfma_f32_16x16x32_bf16 v[192:195], v[64:67], v[40:43], v[192:195]
    v_exp_f32 v165, v117
    v_mfma_f32_16x16x32_bf16 v[196:199], v[68:71], v[40:43], v[196:199]
    v_exp_f32 v166, v118
    v_mfma_f32_16x16x32_bf16 v[200:203], v[72:75], v[40:43], v[200:203]
    v_exp_f32 v167, v119
    v_mfma_f32_16x16x32_bf16 v[204:207], v[76:79], v[40:43], v[204:207]
    s_waitcnt lgkmcnt(0)
    s_barrier
    v_mfma_f32_16x16x32_bf16 v[12:15], a[252:255], v[44:47], v[12:15]
    s_add_u32 s75, s34, 139264
    ds_read_b128 v[48:51], v1 offset:33792
    ds_read_b128 v[52:55], v1 offset:34304
    buffer_load_dwordx4 a[48:51], v0, s[8:11], s75 offen offset:0 nt
    v_cvt_pk_bf16_f32 v40, v160, v161
    v_mfma_f32_16x16x32_bf16 v[224:227], v[64:67], v[44:47], v[224:227]
    ds_read_b128 v[56:59], v1 offset:33856
    ds_read_b128 v[60:63], v1 offset:34368
    v_cvt_pk_bf16_f32 v41, v162, v163
    v_mfma_f32_16x16x32_bf16 v[228:231], v[68:71], v[44:47], v[228:231]
    ds_read_b128 v[16:19], v1 offset:33920
    ds_read_b128 v[20:23], v1 offset:34432
    v_cvt_pk_bf16_f32 v42, v164, v165
    v_mfma_f32_16x16x32_bf16 v[232:235], v[72:75], v[44:47], v[232:235]
    ds_read_b128 v[24:27], v1 offset:33984
    ds_read_b128 v[28:31], v1 offset:34496
    v_or3_b32 v186, v40, v41, v42
    v_mfma_f32_16x16x32_bf16 v[236:239], v[76:79], v[44:47], v[236:239]
    buffer_load_dwordx4 a[52:55], v0, s[8:11], s75 offen offset:1024 nt
    v_cvt_pk_bf16_f32 v43, v166, v167
    v_mfma_f32_16x16x32_bf16 v[240:243], v[80:83], v[44:47], v[240:243]
    v_exp_f32 v168, v120
    v_mfma_f32_16x16x32_bf16 v[244:247], v[84:87], v[44:47], v[244:247]
    v_exp_f32 v169, v121
    v_mfma_f32_16x16x32_bf16 v[248:251], v[88:91], v[44:47], v[248:251]
    v_exp_f32 v170, v122
    v_mfma_f32_16x16x32_bf16 v[252:255], v[92:95], v[44:47], v[252:255]
    s_waitcnt lgkmcnt(6)
    v_exp_f32 v171, v123
    v_mfma_f32_16x16x32_bf16 v[96:99], v[48:51], v[128:131], v[176:179]
    s_add_u32 s75, s34, 131072
    buffer_load_dwordx4 a[56:59], v0, s[12:15], s75 offen offset:0 nt
    v_cvt_pk_bf16_f32 v44, v168, v169
    v_mfma_f32_16x16x32_bf16 v[104:107], v[48:51], v[144:147], v[180:183]
    ds_read_b64_tr_b16 v[80:81], v2 offset:42368
    ds_read_b64_tr_b16 v[82:83], v2 offset:42880
    v_or3_b32 v186, v186, v43, v44
    v_mfma_f32_16x16x32_bf16 v[100:103], v[52:55], v[128:131], v[176:179]
    ds_read_b64_tr_b16 v[84:85], v2 offset:42400
    ds_read_b64_tr_b16 v[86:87], v2 offset:42912
    v_cvt_pk_bf16_f32 v45, v170, v171
    v_mfma_f32_16x16x32_bf16 v[108:111], v[52:55], v[144:147], v[180:183]
    s_waitcnt lgkmcnt(8)
    ds_read_b64_tr_b16 v[88:89], v2 offset:42432
    ds_read_b64_tr_b16 v[90:91], v2 offset:42944
    v_mfma_f32_16x16x32_bf16 v[96:99], v[56:59], v[132:135], v[96:99]
    ds_read_b64_tr_b16 v[92:93], v2 offset:42464
    ds_read_b64_tr_b16 v[94:95], v2 offset:42976
    buffer_load_dwordx4 a[60:63], v0, s[12:15], s75 offen offset:1024 nt
    v_mfma_f32_16x16x32_bf16 v[104:107], v[56:59], v[148:151], v[104:107]
    ds_read_b64_tr_b16 v[64:65], v2 offset:42240
    ds_read_b64_tr_b16 v[66:67], v2 offset:42752
    v_mfma_f32_16x16x32_bf16 v[100:103], v[60:63], v[132:135], v[100:103]
    ds_read_b64_tr_b16 v[68:69], v2 offset:42272
    ds_read_b64_tr_b16 v[70:71], v2 offset:42784
    v_mfma_f32_16x16x32_bf16 v[108:111], v[60:63], v[148:151], v[108:111]
    s_waitcnt lgkmcnt(12)
    ds_read_b64_tr_b16 v[72:73], v2 offset:42304
    ds_read_b64_tr_b16 v[74:75], v2 offset:42816
    v_mfma_f32_16x16x32_bf16 v[96:99], v[16:19], v[136:139], v[96:99]
    ds_read_b64_tr_b16 v[76:77], v2 offset:42336
    ds_read_b64_tr_b16 v[78:79], v2 offset:42848
    v_mfma_f32_16x16x32_bf16 v[104:107], v[16:19], v[152:155], v[104:107]
    s_waitcnt vmcnt(30)
    v_exp_f32 v172, v124
    v_mfma_f32_16x16x32_bf16 v[100:103], v[20:23], v[136:139], v[100:103]
    v_exp_f32 v173, v125
    v_mfma_f32_16x16x32_bf16 v[108:111], v[20:23], v[152:155], v[108:111]
    ds_write_b128 v32, a[216:219] offset:0
    v_mfma_f32_32x32x16_bf16 a[192:207], v[36:39], v[36:39], 0
    v_exp_f32 v174, v126
    v_cvt_pk_bf16_f32 v46, v172, v173
    v_or3_b32 v186, v186, v45, v46
    v_exp_f32 v175, v127
    v_mfma_f32_16x16x32_bf16 v[96:99], v[24:27], v[140:143], v[96:99]
    ds_write_b128 v32, a[220:223] offset:1056
    v_mfma_f32_16x16x32_bf16 v[104:107], v[24:27], v[156:159], v[104:107]
    v_cvt_pk_bf16_f32 v47, v174, v175
    v_bitop3_b32 v186, v186, v47, s77 bitop3:0xa8
    v_mfma_f32_16x16x32_bf16 v[100:103], v[28:31], v[140:143], v[100:103]
    ds_write_b128 v32, a[224:227] offset:8448
    v_mfma_f32_16x16x32_bf16 v[108:111], v[28:31], v[156:159], v[108:111]
    v_cmp_ne_u32 vcc, 0, v186
    s_cbranch_vccnz L_rs_a9
L_rr_a9:
    v_mfma_f32_16x16x32_bf16 v[8:11], a[252:255], v[40:43], v[8:11]
    s_waitcnt lgkmcnt(11)
    ds_write_b128 v32, a[228:231] offset:9504
    v_exp_f32 v160, v96
    v_mfma_f32_16x16x32_bf16 v[208:211], v[80:83], v[40:43], v[208:211]
    v_exp_f32 v161, v97
    v_mfma_f32_16x16x32_bf16 v[212:215], v[84:87], v[40:43], v[212:215]
    v_exp_f32 v162, v98
    v_mfma_f32_16x16x32_bf16 v[216:219], v[88:91], v[40:43], v[216:219]
    v_exp_f32 v163, v99
    v_mfma_f32_16x16x32_bf16 v[220:223], v[92:95], v[40:43], v[220:223]
    s_waitcnt lgkmcnt(4)
    v_exp_f32 v164, v100
    v_mfma_f32_16x16x32_bf16 v[192:195], v[64:67], v[40:43], v[192:195]
    v_exp_f32 v165, v101
    v_mfma_f32_16x16x32_bf16 v[196:199], v[68:71], v[40:43], v[196:199]
    v_exp_f32 v166, v102
    v_mfma_f32_16x16x32_bf16 v[200:203], v[72:75], v[40:43], v[200:203]
    v_exp_f32 v167, v103
    v_mfma_f32_16x16x32_bf16 v[204:207], v[76:79], v[40:43], v[204:207]
    s_waitcnt lgkmcnt(0)
    s_barrier
    v_mfma_f32_16x16x32_bf16 v[12:15], a[252:255], v[44:47], v[12:15]
    ds_read_b128 v[48:51], v1 offset:50688
    ds_read_b128 v[52:55], v1 offset:51200
    v_cvt_pk_bf16_f32 v40, v160, v161
    v_mfma_f32_16x16x32_bf16 v[224:227], v[64:67], v[44:47], v[224:227]
    ds_read_b128 v[56:59], v1 offset:50752
    ds_read_b128 v[60:63], v1 offset:51264
    v_cvt_pk_bf16_f32 v41, v162, v163
    v_mfma_f32_16x16x32_bf16 v[228:231], v[68:71], v[44:47], v[228:231]
    ds_read_b128 v[16:19], v1 offset:50816
    ds_read_b128 v[20:23], v1 offset:51328
    v_cvt_pk_bf16_f32 v42, v164, v165
    v_mfma_f32_16x16x32_bf16 v[232:235], v[72:75], v[44:47], v[232:235]
    ds_read_b128 v[24:27], v1 offset:50880
    ds_read_b128 v[28:31], v1 offset:51392
    v_or3_b32 v186, v40, v41, v42
    v_mfma_f32_16x16x32_bf16 v[236:239], v[76:79], v[44:47], v[236:239]
    v_cvt_pk_bf16_f32 v43, v166, v167
    v_mfma_f32_16x16x32_bf16 v[240:243], v[80:83], v[44:47], v[240:243]
    v_exp_f32 v168, v104
    v_mfma_f32_16x16x32_bf16 v[244:247], v[84:87], v[44:47], v[244:247]
    v_exp_f32 v169, v105
    v_mfma_f32_16x16x32_bf16 v[248:251], v[88:91], v[44:47], v[248:251]
    v_exp_f32 v170, v106
    v_mfma_f32_16x16x32_bf16 v[252:255], v[92:95], v[44:47], v[252:255]
    s_waitcnt lgkmcnt(6)
    v_exp_f32 v171, v107
    v_mfma_f32_16x16x32_bf16 v[112:115], v[48:51], v[128:131], v[176:179]
    v_cvt_pk_bf16_f32 v44, v168, v169
    v_or3_b32 v186, v186, v43, v44
    v_mfma_f32_16x16x32_bf16 v[120:123], v[48:51], v[144:147], v[180:183]
    ds_read_b64_tr_b16 v[80:81], v2 offset:59264
    ds_read_b64_tr_b16 v[82:83], v2 offset:59776
    v_cvt_pk_bf16_f32 v45, v170, v171
    v_mfma_f32_16x16x32_bf16 v[116:119], v[52:55], v[128:131], v[176:179]
    ds_read_b64_tr_b16 v[84:85], v2 offset:59296
    ds_read_b64_tr_b16 v[86:87], v2 offset:59808
    v_mfma_f32_16x16x32_bf16 v[124:127], v[52:55], v[144:147], v[180:183]
    s_waitcnt lgkmcnt(8)
    ds_read_b64_tr_b16 v[88:89], v2 offset:59328
    ds_read_b64_tr_b16 v[90:91], v2 offset:59840
    v_mfma_f32_16x16x32_bf16 v[112:115], v[56:59], v[132:135], v[112:115]
    ds_read_b64_tr_b16 v[92:93], v2 offset:59360
    ds_read_b64_tr_b16 v[94:95], v2 offset:59872
    v_mfma_f32_16x16x32_bf16 v[120:123], v[56:59], v[148:151], v[120:123]
    ds_read_b64_tr_b16 v[64:65], v2 offset:59136
    ds_read_b64_tr_b16 v[66:67], v2 offset:59648
    v_mfma_f32_16x16x32_bf16 v[116:119], v[60:63], v[132:135], v[116:119]
    ds_read_b64_tr_b16 v[68:69], v2 offset:59168
    ds_read_b64_tr_b16 v[70:71], v2 offset:59680
    v_mfma_f32_16x16x32_bf16 v[124:127], v[60:63], v[148:151], v[124:127]
    s_waitcnt lgkmcnt(12)
    ds_read_b64_tr_b16 v[72:73], v2 offset:59200
    ds_read_b64_tr_b16 v[74:75], v2 offset:59712
    v_mfma_f32_16x16x32_bf16 v[112:115], v[16:19], v[136:139], v[112:115]
    ds_read_b64_tr_b16 v[76:77], v2 offset:59232
    ds_read_b64_tr_b16 v[78:79], v2 offset:59744
    v_mfma_f32_16x16x32_bf16 v[120:123], v[16:19], v[152:155], v[120:123]
    s_waitcnt vmcnt(26)
    v_exp_f32 v172, v108
    v_mfma_f32_16x16x32_bf16 v[116:119], v[20:23], v[136:139], v[116:119]
    v_exp_f32 v173, v109
    v_mfma_f32_16x16x32_bf16 v[124:127], v[20:23], v[152:155], v[124:127]
    ds_write_b128 v32, a[232:235] offset:16896
    v_mfma_f32_32x32x16_bf16 a[208:223], v[36:39], v[36:39], 0
    v_exp_f32 v174, v110
    v_cvt_pk_bf16_f32 v46, v172, v173
    v_or3_b32 v186, v186, v45, v46
    v_exp_f32 v175, v111
    v_mfma_f32_16x16x32_bf16 v[112:115], v[24:27], v[140:143], v[112:115]
    ds_write_b128 v32, a[236:239] offset:17952
    v_mfma_f32_16x16x32_bf16 v[120:123], v[24:27], v[156:159], v[120:123]
    v_cvt_pk_bf16_f32 v47, v174, v175
    v_bitop3_b32 v186, v186, v47, s77 bitop3:0xa8
    v_mfma_f32_16x16x32_bf16 v[116:119], v[28:31], v[140:143], v[116:119]
    ds_write_b128 v32, a[240:243] offset:25344
    v_mfma_f32_16x16x32_bf16 v[124:127], v[28:31], v[156:159], v[124:127]
    v_cmp_ne_u32 vcc, 0, v186
    s_cbranch_vccnz L_rs_a10
L_rr_a10:
    v_mfma_f32_16x16x32_bf16 v[8:11], a[252:255], v[40:43], v[8:11]
    s_waitcnt lgkmcnt(11)
    ds_write_b128 v32, a[244:247] offset:26400
    v_exp_f32 v160, v112
    v_mfma_f32_16x16x32_bf16 v[208:211], v[80:83], v[40:43], v[208:211]
    v_exp_f32 v161, v113
    v_mfma_f32_16x16x32_bf16 v[212:215], v[84:87], v[40:43], v[212:215]
    v_exp_f32 v162, v114
    v_mfma_f32_16x16x32_bf16 v[216:219], v[88:91], v[40:43], v[216:219]
    v_exp_f32 v163, v115
    v_mfma_f32_16x16x32_bf16 v[220:223], v[92:95], v[40:43], v[220:223]
    s_waitcnt lgkmcnt(4)
    v_exp_f32 v164, v116
    v_mfma_f32_16x16x32_bf16 v[192:195], v[64:67], v[40:43], v[192:195]
    v_exp_f32 v165, v117
    v_mfma_f32_16x16x32_bf16 v[196:199], v[68:71], v[40:43], v[196:199]
    v_exp_f32 v166, v118
    v_mfma_f32_16x16x32_bf16 v[200:203], v[72:75], v[40:43], v[200:203]
    v_exp_f32 v167, v119
    v_mfma_f32_16x16x32_bf16 v[204:207], v[76:79], v[40:43], v[204:207]
    s_waitcnt lgkmcnt(0)
    s_barrier
    v_mfma_f32_16x16x32_bf16 v[12:15], a[252:255], v[44:47], v[12:15]
    ds_read_b128 v[48:51], v1 offset:0
    ds_read_b128 v[52:55], v1 offset:512
    v_cvt_pk_bf16_f32 v40, v160, v161
    v_mfma_f32_16x16x32_bf16 v[224:227], v[64:67], v[44:47], v[224:227]
    ds_read_b128 v[56:59], v1 offset:64
    ds_read_b128 v[60:63], v1 offset:576
    v_cvt_pk_bf16_f32 v41, v162, v163
    v_mfma_f32_16x16x32_bf16 v[228:231], v[68:71], v[44:47], v[228:231]
    ds_read_b128 v[16:19], v1 offset:128
    ds_read_b128 v[20:23], v1 offset:640
    v_cvt_pk_bf16_f32 v42, v164, v165
    v_mfma_f32_16x16x32_bf16 v[232:235], v[72:75], v[44:47], v[232:235]
    ds_read_b128 v[24:27], v1 offset:192
    ds_read_b128 v[28:31], v1 offset:704
    v_or3_b32 v186, v40, v41, v42
    v_mfma_f32_16x16x32_bf16 v[236:239], v[76:79], v[44:47], v[236:239]
    v_cvt_pk_bf16_f32 v43, v166, v167
    v_mfma_f32_16x16x32_bf16 v[240:243], v[80:83], v[44:47], v[240:243]
    v_exp_f32 v168, v120
    v_mfma_f32_16x16x32_bf16 v[244:247], v[84:87], v[44:47], v[244:247]
    v_exp_f32 v169, v121
    v_mfma_f32_16x16x32_bf16 v[248:251], v[88:91], v[44:47], v[248:251]
    v_exp_f32 v170, v122
    v_mfma_f32_16x16x32_bf16 v[252:255], v[92:95], v[44:47], v[252:255]
    s_waitcnt lgkmcnt(6)
    v_exp_f32 v171, v123
    v_mfma_f32_16x16x32_bf16 v[96:99], v[48:51], v[128:131], v[176:179]
    v_cvt_pk_bf16_f32 v44, v168, v169
    v_or3_b32 v186, v186, v43, v44
    v_mfma_f32_16x16x32_bf16 v[104:107], v[48:51], v[144:147], v[180:183]
    ds_read_b64_tr_b16 v[80:81], v2 offset:8576
    ds_read_b64_tr_b16 v[82:83], v2 offset:9088
    v_cvt_pk_bf16_f32 v45, v170, v171
    v_mfma_f32_16x16x32_bf16 v[100:103], v[52:55], v[128:131], v[176:179]
    ds_read_b64_tr_b16 v[84:85], v2 offset:8608
    ds_read_b64_tr_b16 v[86:87], v2 offset:9120
    v_mfma_f32_16x16x32_bf16 v[108:111], v[52:55], v[144:147], v[180:183]
    s_waitcnt lgkmcnt(8)
    ds_read_b64_tr_b16 v[88:89], v2 offset:8640
    ds_read_b64_tr_b16 v[90:91], v2 offset:9152
    v_mfma_f32_16x16x32_bf16 v[96:99], v[56:59], v[132:135], v[96:99]
    ds_read_b64_tr_b16 v[92:93], v2 offset:8672
    ds_read_b64_tr_b16 v[94:95], v2 offset:9184
    v_mfma_f32_16x16x32_bf16 v[104:107], v[56:59], v[148:151], v[104:107]
    ds_read_b64_tr_b16 v[64:65], v2 offset:8448
    ds_read_b64_tr_b16 v[66:67], v2 offset:8960
    v_mfma_f32_16x16x32_bf16 v[100:103], v[60:63], v[132:135], v[100:103]
    ds_read_b64_tr_b16 v[68:69], v2 offset:8480
    ds_read_b64_tr_b16 v[70:71], v2 offset:8992
    v_mfma_f32_16x16x32_bf16 v[108:111], v[60:63], v[148:151], v[108:111]
    s_waitcnt lgkmcnt(12)
    ds_read_b64_tr_b16 v[72:73], v2 offset:8512
    ds_read_b64_tr_b16 v[74:75], v2 offset:9024
    v_mfma_f32_16x16x32_bf16 v[96:99], v[16:19], v[136:139], v[96:99]
    ds_read_b64_tr_b16 v[76:77], v2 offset:8544
    ds_read_b64_tr_b16 v[78:79], v2 offset:9056
    v_mfma_f32_16x16x32_bf16 v[104:107], v[16:19], v[152:155], v[104:107]
    s_waitcnt vmcnt(22)
    v_exp_f32 v172, v124
    v_mfma_f32_16x16x32_bf16 v[100:103], v[20:23], v[136:139], v[100:103]
    v_exp_f32 v173, v125
    v_mfma_f32_16x16x32_bf16 v[108:111], v[20:23], v[152:155], v[108:111]
    ds_write_b128 v32, a[0:3] offset:33792
    v_mfma_f32_32x32x16_bf16 a[224:239], v[36:39], v[36:39], 0
    v_exp_f32 v174, v126
    v_cvt_pk_bf16_f32 v46, v172, v173
    v_or3_b32 v186, v186, v45, v46
    v_exp_f32 v175, v127
    v_mfma_f32_16x16x32_bf16 v[96:99], v[24:27], v[140:143], v[96:99]
    ds_write_b128 v32, a[4:7] offset:34848
    v_mfma_f32_16x16x32_bf16 v[104:107], v[24:27], v[156:159], v[104:107]
    v_cvt_pk_bf16_f32 v47, v174, v175
    v_bitop3_b32 v186, v186, v47, s77 bitop3:0xa8
    v_mfma_f32_16x16x32_bf16 v[100:103], v[28:31], v[140:143], v[100:103]
    ds_write_b128 v32, a[8:11] offset:42240
    v_mfma_f32_16x16x32_bf16 v[108:111], v[28:31], v[156:159], v[108:111]
    v_cmp_ne_u32 vcc, 0, v186
    s_cbranch_vccnz L_rs_a11
L_rr_a11:
    v_mfma_f32_16x16x32_bf16 v[8:11], a[252:255], v[40:43], v[8:11]
    s_waitcnt lgkmcnt(11)
    ds_write_b128 v32, a[12:15] offset:43296
    v_exp_f32 v160, v96
    v_mfma_f32_16x16x32_bf16 v[208:211], v[80:83], v[40:43], v[208:211]
    v_exp_f32 v161, v97
    v_mfma_f32_16x16x32_bf16 v[212:215], v[84:87], v[40:43], v[212:215]
    v_exp_f32 v162, v98
    v_mfma_f32_16x16x32_bf16 v[216:219], v[88:91], v[40:43], v[216:219]
    v_exp_f32 v163, v99
    v_mfma_f32_16x16x32_bf16 v[220:223], v[92:95], v[40:43], v[220:223]
    s_waitcnt lgkmcnt(4)
    v_exp_f32 v164, v100
    v_mfma_f32_16x16x32_bf16 v[192:195], v[64:67], v[40:43], v[192:195]
    v_exp_f32 v165, v101
    v_mfma_f32_16x16x32_bf16 v[196:199], v[68:71], v[40:43], v[196:199]
    v_exp_f32 v166, v102
    v_mfma_f32_16x16x32_bf16 v[200:203], v[72:75], v[40:43], v[200:203]
    v_exp_f32 v167, v103
    v_mfma_f32_16x16x32_bf16 v[204:207], v[76:79], v[40:43], v[204:207]
    s_waitcnt lgkmcnt(0)
    s_barrier
    v_mfma_f32_16x16x32_bf16 v[12:15], a[252:255], v[44:47], v[12:15]
    ds_read_b128 v[48:51], v1 offset:16896
    ds_read_b128 v[52:55], v1 offset:17408
    v_cvt_pk_bf16_f32 v40, v160, v161
    v_mfma_f32_16x16x32_bf16 v[224:227], v[64:67], v[44:47], v[224:227]
    ds_read_b128 v[56:59], v1 offset:16960
    ds_read_b128 v[60:63], v1 offset:17472
    v_cvt_pk_bf16_f32 v41, v162, v163
    v_mfma_f32_16x16x32_bf16 v[228:231], v[68:71], v[44:47], v[228:231]
    ds_read_b128 v[16:19], v1 offset:17024
    ds_read_b128 v[20:23], v1 offset:17536
    v_cvt_pk_bf16_f32 v42, v164, v165
    v_mfma_f32_16x16x32_bf16 v[232:235], v[72:75], v[44:47], v[232:235]
    ds_read_b128 v[24:27], v1 offset:17088
    ds_read_b128 v[28:31], v1 offset:17600
    v_or3_b32 v186, v40, v41, v42
    v_mfma_f32_16x16x32_bf16 v[236:239], v[76:79], v[44:47], v[236:239]
    v_cvt_pk_bf16_f32 v43, v166, v167
    v_mfma_f32_16x16x32_bf16 v[240:243], v[80:83], v[44:47], v[240:243]
    v_exp_f32 v168, v104
    v_mfma_f32_16x16x32_bf16 v[244:247], v[84:87], v[44:47], v[244:247]
    v_exp_f32 v169, v105
    v_mfma_f32_16x16x32_bf16 v[248:251], v[88:91], v[44:47], v[248:251]
    v_exp_f32 v170, v106
    v_mfma_f32_16x16x32_bf16 v[252:255], v[92:95], v[44:47], v[252:255]
    s_waitcnt lgkmcnt(6)
    v_exp_f32 v171, v107
    v_mfma_f32_16x16x32_bf16 v[112:115], v[48:51], v[128:131], v[176:179]
    v_cvt_pk_bf16_f32 v44, v168, v169
    v_or3_b32 v186, v186, v43, v44
    v_mfma_f32_16x16x32_bf16 v[120:123], v[48:51], v[144:147], v[180:183]
    ds_read_b64_tr_b16 v[80:81], v2 offset:25472
    ds_read_b64_tr_b16 v[82:83], v2 offset:25984
    v_cvt_pk_bf16_f32 v45, v170, v171
    v_mfma_f32_16x16x32_bf16 v[116:119], v[52:55], v[128:131], v[176:179]
    ds_read_b64_tr_b16 v[84:85], v2 offset:25504
    ds_read_b64_tr_b16 v[86:87], v2 offset:26016
    v_mfma_f32_16x16x32_bf16 v[124:127], v[52:55], v[144:147], v[180:183]
    s_waitcnt lgkmcnt(8)
    ds_read_b64_tr_b16 v[88:89], v2 offset:25536
    ds_read_b64_tr_b16 v[90:91], v2 offset:26048
    v_mfma_f32_16x16x32_bf16 v[112:115], v[56:59], v[132:135], v[112:115]
    ds_read_b64_tr_b16 v[92:93], v2 offset:25568
    ds_read_b64_tr_b16 v[94:95], v2 offset:26080
    v_mfma_f32_16x16x32_bf16 v[120:123], v[56:59], v[148:151], v[120:123]
    ds_read_b64_tr_b16 v[64:65], v2 offset:25344
    ds_read_b64_tr_b16 v[66:67], v2 offset:25856
    v_mfma_f32_16x16x32_bf16 v[116:119], v[60:63], v[132:135], v[116:119]
    ds_read_b64_tr_b16 v[68:69], v2 offset:25376
    ds_read_b64_tr_b16 v[70:71], v2 offset:25888
    v_mfma_f32_16x16x32_bf16 v[124:127], v[60:63], v[148:151], v[124:127]
    s_waitcnt lgkmcnt(12)
    ds_read_b64_tr_b16 v[72:73], v2 offset:25408
    ds_read_b64_tr_b16 v[74:75], v2 offset:25920
    v_mfma_f32_16x16x32_bf16 v[112:115], v[16:19], v[136:139], v[112:115]
    ds_read_b64_tr_b16 v[76:77], v2 offset:25440
    ds_read_b64_tr_b16 v[78:79], v2 offset:25952
    v_mfma_f32_16x16x32_bf16 v[120:123], v[16:19], v[152:155], v[120:123]
    s_waitcnt vmcnt(16)
    v_exp_f32 v172, v108
    v_mfma_f32_16x16x32_bf16 v[116:119], v[20:23], v[136:139], v[116:119]
    v_exp_f32 v173, v109
    v_mfma_f32_16x16x32_bf16 v[124:127], v[20:23], v[152:155], v[124:127]
    ds_write_b128 v32, a[16:19] offset:50688
    v_mfma_f32_32x32x16_bf16 a[0:15], v[36:39], v[36:39], 0
    v_exp_f32 v174, v110
    v_cvt_pk_bf16_f32 v46, v172, v173
    v_or3_b32 v186, v186, v45, v46
    v_exp_f32 v175, v111
    v_mfma_f32_16x16x32_bf16 v[112:115], v[24:27], v[140:143], v[112:115]
    ds_write_b128 v32, a[20:23] offset:51744
    v_mfma_f32_16x16x32_bf16 v[120:123], v[24:27], v[156:159], v[120:123]
    v_cvt_pk_bf16_f32 v47, v174, v175
    v_bitop3_b32 v186, v186, v47, s77 bitop3:0xa8
    v_mfma_f32_16x16x32_bf16 v[116:119], v[28:31], v[140:143], v[116:119]
    ds_write_b128 v32, a[24:27] offset:59136
    v_mfma_f32_16x16x32_bf16 v[124:127], v[28:31], v[156:159], v[124:127]
    v_cmp_ne_u32 vcc, 0, v186
    s_cbranch_vccnz L_rs_a12
L_rr_a12:
    v_mfma_f32_16x16x32_bf16 v[8:11], a[252:255], v[40:43], v[8:11]
    s_waitcnt lgkmcnt(11)
    ds_write_b128 v32, a[28:31] offset:60192
    v_exp_f32 v160, v112
    v_mfma_f32_16x16x32_bf16 v[208:211], v[80:83], v[40:43], v[208:211]
    v_exp_f32 v161, v113
    v_mfma_f32_16x16x32_bf16 v[212:215], v[84:87], v[40:43], v[212:215]
    v_exp_f32 v162, v114
    v_mfma_f32_16x16x32_bf16 v[216:219], v[88:91], v[40:43], v[216:219]
    v_exp_f32 v163, v115
    v_mfma_f32_16x16x32_bf16 v[220:223], v[92:95], v[40:43], v[220:223]
    s_waitcnt lgkmcnt(4)
    v_exp_f32 v164, v116
    v_mfma_f32_16x16x32_bf16 v[192:195], v[64:67], v[40:43], v[192:195]
    v_exp_f32 v165, v117
    v_mfma_f32_16x16x32_bf16 v[196:199], v[68:71], v[40:43], v[196:199]
    v_exp_f32 v166, v118
    v_mfma_f32_16x16x32_bf16 v[200:203], v[72:75], v[40:43], v[200:203]
    v_exp_f32 v167, v119
    v_mfma_f32_16x16x32_bf16 v[204:207], v[76:79], v[40:43], v[204:207]
    s_waitcnt lgkmcnt(0)
    s_barrier
    v_mfma_f32_16x16x32_bf16 v[12:15], a[252:255], v[44:47], v[12:15]
    ds_read_b128 v[48:51], v1 offset:33792
    ds_read_b128 v[52:55], v1 offset:34304
    v_cvt_pk_bf16_f32 v40, v160, v161
    v_mfma_f32_16x16x32_bf16 v[224:227], v[64:67], v[44:47], v[224:227]
    ds_read_b128 v[56:59], v1 offset:33856
    ds_read_b128 v[60:63], v1 offset:34368
    v_cvt_pk_bf16_f32 v41, v162, v163
    v_mfma_f32_16x16x32_bf16 v[228:231], v[68:71], v[44:47], v[228:231]
    ds_read_b128 v[16:19], v1 offset:33920
    ds_read_b128 v[20:23], v1 offset:34432
    v_cvt_pk_bf16_f32 v42, v164, v165
    v_mfma_f32_16x16x32_bf16 v[232:235], v[72:75], v[44:47], v[232:235]
    ds_read_b128 v[24:27], v1 offset:33984
    ds_read_b128 v[28:31], v1 offset:34496
    v_or3_b32 v186, v40, v41, v42
    v_mfma_f32_16x16x32_bf16 v[236:239], v[76:79], v[44:47], v[236:239]
    v_cvt_pk_bf16_f32 v43, v166, v167
    v_mfma_f32_16x16x32_bf16 v[240:243], v[80:83], v[44:47], v[240:243]
    v_exp_f32 v168, v120
    v_mfma_f32_16x16x32_bf16 v[244:247], v[84:87], v[44:47], v[244:247]
    v_exp_f32 v169, v121
    v_mfma_f32_16x16x32_bf16 v[248:251], v[88:91], v[44:47], v[248:251]
    v_exp_f32 v170, v122
    v_mfma_f32_16x16x32_bf16 v[252:255], v[92:95], v[44:47], v[252:255]
    s_waitcnt lgkmcnt(6)
    v_exp_f32 v171, v123
    v_mfma_f32_16x16x32_bf16 v[96:99], v[48:51], v[128:131], v[176:179]
    v_cvt_pk_bf16_f32 v44, v168, v169
    v_or3_b32 v186, v186, v43, v44
    v_mfma_f32_16x16x32_bf16 v[104:107], v[48:51], v[144:147], v[180:183]
    ds_read_b64_tr_b16 v[80:81], v2 offset:42368
    ds_read_b64_tr_b16 v[82:83], v2 offset:42880
    v_cvt_pk_bf16_f32 v45, v170, v171
    v_mfma_f32_16x16x32_bf16 v[100:103], v[52:55], v[128:131], v[176:179]
    ds_read_b64_tr_b16 v[84:85], v2 offset:42400
    ds_read_b64_tr_b16 v[86:87], v2 offset:42912
    v_mfma_f32_16x16x32_bf16 v[108:111], v[52:55], v[144:147], v[180:183]
    s_waitcnt lgkmcnt(8)
    ds_read_b64_tr_b16 v[88:89], v2 offset:42432
    ds_read_b64_tr_b16 v[90:91], v2 offset:42944
    v_mfma_f32_16x16x32_bf16 v[96:99], v[56:59], v[132:135], v[96:99]
    ds_read_b64_tr_b16 v[92:93], v2 offset:42464
    ds_read_b64_tr_b16 v[94:95], v2 offset:42976
    v_mfma_f32_16x16x32_bf16 v[104:107], v[56:59], v[148:151], v[104:107]
    ds_read_b64_tr_b16 v[64:65], v2 offset:42240
    ds_read_b64_tr_b16 v[66:67], v2 offset:42752
    v_mfma_f32_16x16x32_bf16 v[100:103], v[60:63], v[132:135], v[100:103]
    ds_read_b64_tr_b16 v[68:69], v2 offset:42272
    ds_read_b64_tr_b16 v[70:71], v2 offset:42784
    v_mfma_f32_16x16x32_bf16 v[108:111], v[60:63], v[148:151], v[108:111]
    s_waitcnt lgkmcnt(12)
    ds_read_b64_tr_b16 v[72:73], v2 offset:42304
    ds_read_b64_tr_b16 v[74:75], v2 offset:42816
    v_mfma_f32_16x16x32_bf16 v[96:99], v[16:19], v[136:139], v[96:99]
    ds_read_b64_tr_b16 v[76:77], v2 offset:42336
    ds_read_b64_tr_b16 v[78:79], v2 offset:42848
    v_mfma_f32_16x16x32_bf16 v[104:107], v[16:19], v[152:155], v[104:107]
    s_waitcnt vmcnt(10)
    v_exp_f32 v172, v124
    v_mfma_f32_16x16x32_bf16 v[100:103], v[20:23], v[136:139], v[100:103]
    v_exp_f32 v173, v125
    v_mfma_f32_16x16x32_bf16 v[108:111], v[20:23], v[152:155], v[108:111]
    ds_write_b128 v32, a[32:35] offset:0
    v_mfma_f32_32x32x16_bf16 a[16:31], v[36:39], v[36:39], 0
    v_exp_f32 v174, v126
    v_cvt_pk_bf16_f32 v46, v172, v173
    v_or3_b32 v186, v186, v45, v46
    v_exp_f32 v175, v127
    v_mfma_f32_16x16x32_bf16 v[96:99], v[24:27], v[140:143], v[96:99]
    ds_write_b128 v32, a[36:39] offset:1056
    v_mfma_f32_16x16x32_bf16 v[104:107], v[24:27], v[156:159], v[104:107]
    v_cvt_pk_bf16_f32 v47, v174, v175
    v_bitop3_b32 v186, v186, v47, s77 bitop3:0xa8
    v_mfma_f32_16x16x32_bf16 v[100:103], v[28:31], v[140:143], v[100:103]
    ds_write_b128 v32, a[40:43] offset:8448
    v_mfma_f32_16x16x32_bf16 v[108:111], v[28:31], v[156:159], v[108:111]
    v_cmp_ne_u32 vcc, 0, v186
    s_cbranch_vccnz L_rs_a13
L_rr_a13:
    v_mfma_f32_16x16x32_bf16 v[8:11], a[252:255], v[40:43], v[8:11]
    s_waitcnt lgkmcnt(11)
    ds_write_b128 v32, a[44:47] offset:9504
    v_exp_f32 v160, v96
    v_mfma_f32_16x16x32_bf16 v[208:211], v[80:83], v[40:43], v[208:211]
    v_exp_f32 v161, v97
    v_mfma_f32_16x16x32_bf16 v[212:215], v[84:87], v[40:43], v[212:215]
    v_exp_f32 v162, v98
    v_mfma_f32_16x16x32_bf16 v[216:219], v[88:91], v[40:43], v[216:219]
    v_exp_f32 v163, v99
    v_mfma_f32_16x16x32_bf16 v[220:223], v[92:95], v[40:43], v[220:223]
    s_waitcnt lgkmcnt(4)
    v_exp_f32 v164, v100
    v_mfma_f32_16x16x32_bf16 v[192:195], v[64:67], v[40:43], v[192:195]
    v_exp_f32 v165, v101
    v_mfma_f32_16x16x32_bf16 v[196:199], v[68:71], v[40:43], v[196:199]
    v_exp_f32 v166, v102
    v_mfma_f32_16x16x32_bf16 v[200:203], v[72:75], v[40:43], v[200:203]
    v_exp_f32 v167, v103
    v_mfma_f32_16x16x32_bf16 v[204:207], v[76:79], v[40:43], v[204:207]
    s_waitcnt lgkmcnt(0)
    s_barrier
    v_mfma_f32_16x16x32_bf16 v[12:15], a[252:255], v[44:47], v[12:15]
    ds_read_b128 v[48:51], v1 offset:50688
    ds_read_b128 v[52:55], v1 offset:51200
    v_cvt_pk_bf16_f32 v40, v160, v161
    v_mfma_f32_16x16x32_bf16 v[224:227], v[64:67], v[44:47], v[224:227]
    ds_read_b128 v[56:59], v1 offset:50752
    ds_read_b128 v[60:63], v1 offset:51264
    v_cvt_pk_bf16_f32 v41, v162, v163
    v_mfma_f32_16x16x32_bf16 v[228:231], v[68:71], v[44:47], v[228:231]
    ds_read_b128 v[16:19], v1 offset:50816
    ds_read_b128 v[20:23], v1 offset:51328
    v_cvt_pk_bf16_f32 v42, v164, v165
    v_mfma_f32_16x16x32_bf16 v[232:235], v[72:75], v[44:47], v[232:235]
    ds_read_b128 v[24:27], v1 offset:50880
    ds_read_b128 v[28:31], v1 offset:51392
    v_or3_b32 v186, v40, v41, v42
    v_mfma_f32_16x16x32_bf16 v[236:239], v[76:79], v[44:47], v[236:239]
    v_cvt_pk_bf16_f32 v43, v166, v167
    v_mfma_f32_16x16x32_bf16 v[240:243], v[80:83], v[44:47], v[240:243]
    v_exp_f32 v168, v104
    v_mfma_f32_16x16x32_bf16 v[244:247], v[84:87], v[44:47], v[244:247]
    v_exp_f32 v169, v105
    v_mfma_f32_16x16x32_bf16 v[248:251], v[88:91], v[44:47], v[248:251]
    v_exp_f32 v170, v106
    v_mfma_f32_16x16x32_bf16 v[252:255], v[92:95], v[44:47], v[252:255]
    s_waitcnt lgkmcnt(6)
    v_exp_f32 v171, v107
    v_mfma_f32_16x16x32_bf16 v[112:115], v[48:51], v[128:131], v[176:179]
    v_cvt_pk_bf16_f32 v44, v168, v169
    v_or3_b32 v186, v186, v43, v44
    v_mfma_f32_16x16x32_bf16 v[120:123], v[48:51], v[144:147], v[180:183]
    ds_read_b64_tr_b16 v[80:81], v2 offset:59264
    ds_read_b64_tr_b16 v[82:83], v2 offset:59776
    v_cvt_pk_bf16_f32 v45, v170, v171
    v_mfma_f32_16x16x32_bf16 v[116:119], v[52:55], v[128:131], v[176:179]
    ds_read_b64_tr_b16 v[84:85], v2 offset:59296
    ds_read_b64_tr_b16 v[86:87], v2 offset:59808
    v_mfma_f32_16x16x32_bf16 v[124:127], v[52:55], v[144:147], v[180:183]
    s_waitcnt lgkmcnt(8)
    ds_read_b64_tr_b16 v[88:89], v2 offset:59328
    ds_read_b64_tr_b16 v[90:91], v2 offset:59840
    v_mfma_f32_16x16x32_bf16 v[112:115], v[56:59], v[132:135], v[112:115]
    ds_read_b64_tr_b16 v[92:93], v2 offset:59360
    ds_read_b64_tr_b16 v[94:95], v2 offset:59872
    v_mfma_f32_16x16x32_bf16 v[120:123], v[56:59], v[148:151], v[120:123]
    ds_read_b64_tr_b16 v[64:65], v2 offset:59136
    ds_read_b64_tr_b16 v[66:67], v2 offset:59648
    v_mfma_f32_16x16x32_bf16 v[116:119], v[60:63], v[132:135], v[116:119]
    ds_read_b64_tr_b16 v[68:69], v2 offset:59168
    ds_read_b64_tr_b16 v[70:71], v2 offset:59680
    v_mfma_f32_16x16x32_bf16 v[124:127], v[60:63], v[148:151], v[124:127]
    s_waitcnt lgkmcnt(12)
    ds_read_b64_tr_b16 v[72:73], v2 offset:59200
    ds_read_b64_tr_b16 v[74:75], v2 offset:59712
    v_mfma_f32_16x16x32_bf16 v[112:115], v[16:19], v[136:139], v[112:115]
    ds_read_b64_tr_b16 v[76:77], v2 offset:59232
    ds_read_b64_tr_b16 v[78:79], v2 offset:59744
    v_mfma_f32_16x16x32_bf16 v[120:123], v[16:19], v[152:155], v[120:123]
    s_waitcnt vmcnt(0)
    v_exp_f32 v172, v108
    v_mfma_f32_16x16x32_bf16 v[116:119], v[20:23], v[136:139], v[116:119]
    v_exp_f32 v173, v109
    v_mfma_f32_16x16x32_bf16 v[124:127], v[20:23], v[152:155], v[124:127]
    ds_write_b128 v32, a[48:51] offset:16896
    v_mfma_f32_32x32x16_bf16 a[32:47], v[36:39], v[36:39], 0
    v_exp_f32 v174, v110
    v_cvt_pk_bf16_f32 v46, v172, v173
    v_or3_b32 v186, v186, v45, v46
    v_exp_f32 v175, v111
    v_mfma_f32_16x16x32_bf16 v[112:115], v[24:27], v[140:143], v[112:115]
    ds_write_b128 v32, a[52:55] offset:17952
    v_mfma_f32_16x16x32_bf16 v[120:123], v[24:27], v[156:159], v[120:123]
    v_cvt_pk_bf16_f32 v47, v174, v175
    v_bitop3_b32 v186, v186, v47, s77 bitop3:0xa8
    v_mfma_f32_16x16x32_bf16 v[116:119], v[28:31], v[140:143], v[116:119]
    ds_write_b128 v32, a[56:59] offset:25344
    v_mfma_f32_16x16x32_bf16 v[124:127], v[28:31], v[156:159], v[124:127]
    v_cmp_ne_u32 vcc, 0, v186
    s_cbranch_vccnz L_rs_a14
L_rr_a14:
    v_mfma_f32_16x16x32_bf16 v[8:11], a[252:255], v[40:43], v[8:11]
    s_waitcnt lgkmcnt(11)
    ds_read_b128 v[128:131], v6 offset:0
    ds_read_b128 v[132:135], v6 offset:1024
    ds_write_b128 v32, a[60:63] offset:26400
    v_exp_f32 v160, v112
    v_mfma_f32_16x16x32_bf16 v[208:211], v[80:83], v[40:43], v[208:211]
    ds_read_b128 v[136:139], v6 offset:2048
    ds_read_b128 v[140:143], v6 offset:3072
    v_exp_f32 v161, v113
    v_mfma_f32_16x16x32_bf16 v[212:215], v[84:87], v[40:43], v[212:215]
    ds_read_b128 v[144:147], v6 offset:4096
    ds_read_b128 v[148:151], v6 offset:5120
    v_exp_f32 v162, v114
    v_mfma_f32_16x16x32_bf16 v[216:219], v[88:91], v[40:43], v[216:219]
    ds_read_b128 v[152:155], v6 offset:6144
    ds_read_b128 v[156:159], v6 offset:7168
    v_exp_f32 v163, v115
    v_mfma_f32_16x16x32_bf16 v[220:223], v[92:95], v[40:43], v[220:223]
    s_waitcnt lgkmcnt(12)
    v_exp_f32 v164, v116
    v_mfma_f32_16x16x32_bf16 v[192:195], v[64:67], v[40:43], v[192:195]
    v_exp_f32 v165, v117
    v_mfma_f32_16x16x32_bf16 v[196:199], v[68:71], v[40:43], v[196:199]
    v_exp_f32 v166, v118
    v_mfma_f32_16x16x32_bf16 v[200:203], v[72:75], v[40:43], v[200:203]
    v_exp_f32 v167, v119
    v_mfma_f32_16x16x32_bf16 v[204:207], v[76:79], v[40:43], v[204:207]
    s_waitcnt lgkmcnt(0)
    s_barrier
    v_mfma_f32_16x16x32_bf16 v[12:15], a[252:255], v[44:47], v[12:15]
    ds_read_b128 v[48:51], v1 offset:0
    ds_read_b128 v[52:55], v1 offset:512
    v_cvt_pk_bf16_f32 v40, v160, v161
    v_mfma_f32_16x16x32_bf16 v[224:227], v[64:67], v[44:47], v[224:227]
    ds_read_b128 v[56:59], v1 offset:64
    ds_read_b128 v[60:63], v1 offset:576
    v_cvt_pk_bf16_f32 v41, v162, v163
    v_mfma_f32_16x16x32_bf16 v[228:231], v[68:71], v[44:47], v[228:231]
    ds_read_b128 v[16:19], v1 offset:128
    ds_read_b128 v[20:23], v1 offset:640
    v_cvt_pk_bf16_f32 v42, v164, v165
    v_mfma_f32_16x16x32_bf16 v[232:235], v[72:75], v[44:47], v[232:235]
    ds_read_b128 v[24:27], v1 offset:192
    ds_read_b128 v[28:31], v1 offset:704
    v_or3_b32 v186, v40, v41, v42
    v_mfma_f32_16x16x32_bf16 v[236:239], v[76:79], v[44:47], v[236:239]
    v_cvt_pk_bf16_f32 v43, v166, v167
    v_mfma_f32_16x16x32_bf16 v[240:243], v[80:83], v[44:47], v[240:243]
    v_exp_f32 v168, v120
    v_mfma_f32_16x16x32_bf16 v[244:247], v[84:87], v[44:47], v[244:247]
    v_exp_f32 v169, v121
    v_mfma_f32_16x16x32_bf16 v[248:251], v[88:91], v[44:47], v[248:251]
    v_exp_f32 v170, v122
    v_mfma_f32_16x16x32_bf16 v[252:255], v[92:95], v[44:47], v[252:255]
    s_waitcnt lgkmcnt(6)
    v_exp_f32 v171, v123
    v_mfma_f32_16x16x32_bf16 v[96:99], v[48:51], v[128:131], 0
    v_cvt_pk_bf16_f32 v44, v168, v169
    v_or3_b32 v186, v186, v43, v44
    v_mfma_f32_16x16x32_bf16 v[104:107], v[48:51], v[144:147], 0
    ds_read_b64_tr_b16 v[80:81], v2 offset:8576
    ds_read_b64_tr_b16 v[82:83], v2 offset:9088
    v_cvt_pk_bf16_f32 v45, v170, v171
    v_mfma_f32_16x16x32_bf16 v[100:103], v[52:55], v[128:131], 0
    ds_read_b64_tr_b16 v[84:85], v2 offset:8608
    ds_read_b64_tr_b16 v[86:87], v2 offset:9120
    v_mfma_f32_16x16x32_bf16 v[108:111], v[52:55], v[144:147], 0
    s_waitcnt lgkmcnt(8)
    ds_read_b64_tr_b16 v[88:89], v2 offset:8640
    ds_read_b64_tr_b16 v[90:91], v2 offset:9152
    v_mfma_f32_16x16x32_bf16 v[96:99], v[56:59], v[132:135], v[96:99]
    ds_read_b64_tr_b16 v[92:93], v2 offset:8672
    ds_read_b64_tr_b16 v[94:95], v2 offset:9184
    v_mfma_f32_16x16x32_bf16 v[104:107], v[56:59], v[148:151], v[104:107]
    ds_read_b64_tr_b16 v[64:65], v2 offset:8448
    ds_read_b64_tr_b16 v[66:67], v2 offset:8960
    v_mfma_f32_16x16x32_bf16 v[100:103], v[60:63], v[132:135], v[100:103]
    ds_read_b64_tr_b16 v[68:69], v2 offset:8480
    ds_read_b64_tr_b16 v[70:71], v2 offset:8992
    v_mfma_f32_16x16x32_bf16 v[108:111], v[60:63], v[148:151], v[108:111]
    s_waitcnt lgkmcnt(12)
    ds_read_b64_tr_b16 v[72:73], v2 offset:8512
    ds_read_b64_tr_b16 v[74:75], v2 offset:9024
    v_mfma_f32_16x16x32_bf16 v[96:99], v[16:19], v[136:139], v[96:99]
    ds_read_b64_tr_b16 v[76:77], v2 offset:8544
    ds_read_b64_tr_b16 v[78:79], v2 offset:9056
    v_mfma_f32_16x16x32_bf16 v[104:107], v[16:19], v[152:155], v[104:107]
    v_exp_f32 v172, v124
    v_mfma_f32_16x16x32_bf16 v[100:103], v[20:23], v[136:139], v[100:103]
    v_exp_f32 v173, v125
    v_mfma_f32_16x16x32_bf16 v[108:111], v[20:23], v[152:155], v[108:111]
    v_exp_f32 v174, v126
    v_mfma_f32_32x32x16_bf16 a[48:63], v[36:39], v[36:39], 0
    v_cvt_pk_bf16_f32 v46, v172, v173
    v_or3_b32 v186, v186, v45, v46
    v_exp_f32 v175, v127
    s_nop 0
    v_cvt_pk_bf16_f32 v47, v174, v175
    v_bitop3_b32 v186, v186, v47, s77 bitop3:0xa8
    v_mfma_f32_16x16x32_bf16 v[96:99], v[24:27], v[140:143], v[96:99]
    v_cmp_ne_u32 vcc, 0, v186
    v_mfma_f32_16x16x32_bf16 v[104:107], v[24:27], v[156:159], v[104:107]
    v_mfma_f32_16x16x32_bf16 v[100:103], v[28:31], v[140:143], v[100:103]
    v_mfma_f32_16x16x32_bf16 v[108:111], v[28:31], v[156:159], v[108:111]
    s_nop 3
    v_max3_f32 v188, v96, v97, v98
    s_nop 0
    v_max3_f32 v189, v104, v105, v106
    v_max3_f32 v188, v188, v99, v100
    v_max3_f32 v189, v189, v107, v108
    v_max3_f32 v188, v188, v101, v102
    v_max3_f32 v189, v189, v109, v110
    v_max_f32 v188, v188, v103
    v_max_f32 v189, v189, v111
    s_nop 1
    v_permlane32_swap_b32 v188, v189
    v_max_f32 v189, v188, v189
    v_mov_b32 v190, v189
    s_nop 1
    v_permlane16_swap_b32 v190, v189
    v_max_f32 v189, v190, v189
    v_sub_f32 v176, 0xc1800000, v189
    v_sub_f32 v180, 0xc1800000, v189
    s_nop 1
    v_permlane32_swap_b32 v176, v180
    v_mov_b32 v177, v176
    v_mov_b32 v181, v180
    v_mov_b32 v178, v176
    v_mov_b32 v182, v180
    v_mov_b32 v179, v176
    v_mov_b32 v183, v180
    v_pk_add_f32 v[96:97], v[96:97], v[176:177]
    v_pk_add_f32 v[98:99], v[98:99], v[176:177]
    v_pk_add_f32 v[100:101], v[100:101], v[176:177]
    v_pk_add_f32 v[102:103], v[102:103], v[176:177]
    v_pk_add_f32 v[104:105], v[104:105], v[180:181]
    v_pk_add_f32 v[106:107], v[106:107], v[180:181]
    v_pk_add_f32 v[108:109], v[108:109], v[180:181]
    v_pk_add_f32 v[110:111], v[110:111], v[180:181]
    s_cbranch_vccnz L_rs_a15
L_rr_a15:
    v_mfma_f32_16x16x32_bf16 v[8:11], a[252:255], v[40:43], v[8:11]
    s_waitcnt lgkmcnt(8)
    v_exp_f32 v160, v96
    v_mfma_f32_16x16x32_bf16 v[208:211], v[80:83], v[40:43], v[208:211]
    v_exp_f32 v161, v97
    v_mfma_f32_16x16x32_bf16 v[212:215], v[84:87], v[40:43], v[212:215]
    v_exp_f32 v162, v98
    v_mfma_f32_16x16x32_bf16 v[216:219], v[88:91], v[40:43], v[216:219]
    v_exp_f32 v163, v99
    v_mfma_f32_16x16x32_bf16 v[220:223], v[92:95], v[40:43], v[220:223]
    s_waitcnt lgkmcnt(0)
    v_exp_f32 v164, v100
    v_mfma_f32_16x16x32_bf16 v[192:195], v[64:67], v[40:43], v[192:195]
    v_exp_f32 v165, v101
    v_mfma_f32_16x16x32_bf16 v[196:199], v[68:71], v[40:43], v[196:199]
    v_exp_f32 v166, v102
    v_mfma_f32_16x16x32_bf16 v[200:203], v[72:75], v[40:43], v[200:203]
    v_exp_f32 v167, v103
    v_mfma_f32_16x16x32_bf16 v[204:207], v[76:79], v[40:43], v[204:207]
    s_waitcnt lgkmcnt(0)
    s_barrier
    v_mfma_f32_16x16x32_bf16 v[12:15], a[252:255], v[44:47], v[12:15]
    ds_read_b128 v[48:51], v1 offset:16896
    ds_read_b128 v[52:55], v1 offset:17408
    v_rcp_f32 v184, v8
    s_nop 0
    v_mul_f32 v192, v192, v184
    v_mul_f32 v193, v193, v184
    v_mfma_f32_16x16x32_bf16 v[224:227], v[64:67], v[44:47], v[224:227]
    ds_read_b128 v[56:59], v1 offset:16960
    ds_read_b128 v[60:63], v1 offset:17472
    v_mul_f32 v194, v194, v184
    v_mul_f32 v195, v195, v184
    v_mul_f32 v196, v196, v184
    v_mul_f32 v197, v197, v184
    v_mul_f32 v198, v198, v184
    v_mul_f32 v199, v199, v184
    v_mfma_f32_16x16x32_bf16 v[228:231], v[68:71], v[44:47], v[228:231]
    ds_read_b128 v[16:19], v1 offset:17024
    ds_read_b128 v[20:23], v1 offset:17536
    v_cvt_pk_bf16_f32 v192, v192, v193
    v_cvt_pk_bf16_f32 v193, v194, v195
    v_cvt_pk_bf16_f32 v194, v196, v197
    v_cvt_pk_bf16_f32 v195, v198, v199
    v_cvt_pk_bf16_f32 v40, v160, v161
    v_cvt_pk_bf16_f32 v41, v162, v163
    v_mfma_f32_16x16x32_bf16 v[232:235], v[72:75], v[44:47], v[232:235]
    ds_write_b128 v5, v[192:195] offset:0
    ds_read_b128 v[24:27], v1 offset:17088
    ds_read_b128 v[28:31], v1 offset:17600
    v_mul_f32 v200, v200, v184
    v_mfma_f32_16x16x32_bf16 v[236:239], v[76:79], v[44:47], v[236:239]
    v_mul_f32 v201, v201, v184
    v_mul_f32 v202, v202, v184
    v_mul_f32 v203, v203, v184
    v_mul_f32 v204, v204, v184
    v_mul_f32 v205, v205, v184
    v_mul_f32 v206, v206, v184
    v_mul_f32 v207, v207, v184
    v_cvt_pk_bf16_f32 v200, v200, v201
    v_mfma_f32_16x16x32_bf16 v[240:243], v[80:83], v[44:47], v[240:243]
    v_cvt_pk_bf16_f32 v201, v202, v203
    v_cvt_pk_bf16_f32 v202, v204, v205
    v_cvt_pk_bf16_f32 v203, v206, v207
    v_cvt_pk_bf16_f32 v42, v164, v165
    v_or3_b32 v186, v40, v41, v42
    v_cvt_pk_bf16_f32 v43, v166, v167
    v_exp_f32 v168, v104
    v_mfma_f32_16x16x32_bf16 v[244:247], v[84:87], v[44:47], v[244:247]
    ds_write_b128 v5, v[200:203] offset:1024
    v_mul_f32 v208, v208, v184
    v_mul_f32 v209, v209, v184
    v_mul_f32 v210, v210, v184
    v_mfma_f32_16x16x32_bf16 v[248:251], v[88:91], v[44:47], v[248:251]
    v_mul_f32 v211, v211, v184
    v_mul_f32 v212, v212, v184
    v_mul_f32 v213, v213, v184
    v_mul_f32 v214, v214, v184
    v_mul_f32 v215, v215, v184
    v_cvt_pk_bf16_f32 v208, v208, v209
    v_cvt_pk_bf16_f32 v209, v210, v211
    v_cvt_pk_bf16_f32 v210, v212, v213
    v_mfma_f32_16x16x32_bf16 v[252:255], v[92:95], v[44:47], v[252:255]
    s_waitcnt lgkmcnt(8)
    v_cvt_pk_bf16_f32 v211, v214, v215
    v_exp_f32 v169, v105
    v_exp_f32 v170, v106
    v_exp_f32 v171, v107
    v_mfma_f32_16x16x32_bf16 v[112:115], v[48:51], v[128:131], v[176:179]
    ds_write_b128 v5, v[208:211] offset:2048
    v_mul_f32 v216, v216, v184
    v_mul_f32 v217, v217, v184
    v_mul_f32 v218, v218, v184
    v_mfma_f32_16x16x32_bf16 v[120:123], v[48:51], v[144:147], v[180:183]
    ds_read_b64_tr_b16 v[80:81], v2 offset:25472
    ds_read_b64_tr_b16 v[82:83], v2 offset:25984
    v_mul_f32 v219, v219, v184
    v_mul_f32 v220, v220, v184
    v_mul_f32 v221, v221, v184
    v_mul_f32 v222, v222, v184
    v_mul_f32 v223, v223, v184
    v_cvt_pk_bf16_f32 v216, v216, v217
    v_mfma_f32_16x16x32_bf16 v[116:119], v[52:55], v[128:131], v[176:179]
    ds_read_b64_tr_b16 v[84:85], v2 offset:25504
    ds_read_b64_tr_b16 v[86:87], v2 offset:26016
    v_cvt_pk_bf16_f32 v217, v218, v219
    v_cvt_pk_bf16_f32 v218, v220, v221
    v_cvt_pk_bf16_f32 v219, v222, v223
    v_cvt_pk_bf16_f32 v44, v168, v169
    v_or3_b32 v186, v186, v43, v44
    v_cvt_pk_bf16_f32 v45, v170, v171
    v_mfma_f32_16x16x32_bf16 v[124:127], v[52:55], v[144:147], v[180:183]
    s_waitcnt lgkmcnt(11)
    ds_write_b128 v5, v[216:219] offset:3072
    ds_read_b64_tr_b16 v[88:89], v2 offset:25536
    ds_read_b64_tr_b16 v[90:91], v2 offset:26048
    v_mfma_f32_16x16x32_bf16 v[112:115], v[56:59], v[132:135], v[112:115]
    ds_read_b64_tr_b16 v[92:93], v2 offset:25568
    ds_read_b64_tr_b16 v[94:95], v2 offset:26080
    v_rcp_f32 v188, v12
    s_nop 0
    v_mul_f32 v224, v224, v188
    v_mul_f32 v225, v225, v188
    v_mul_f32 v226, v226, v188
    v_mfma_f32_16x16x32_bf16 v[120:123], v[56:59], v[148:151], v[120:123]
    ds_read_b64_tr_b16 v[64:65], v2 offset:25344
    ds_read_b64_tr_b16 v[66:67], v2 offset:25856
    v_mul_f32 v227, v227, v188
    v_mul_f32 v228, v228, v188
    v_mul_f32 v229, v229, v188
    v_mul_f32 v230, v230, v188
    v_mul_f32 v231, v231, v188
    v_cvt_pk_bf16_f32 v224, v224, v225
    v_mfma_f32_16x16x32_bf16 v[116:119], v[60:63], v[132:135], v[116:119]
    ds_read_b64_tr_b16 v[68:69], v2 offset:25376
    ds_read_b64_tr_b16 v[70:71], v2 offset:25888
    v_cvt_pk_bf16_f32 v225, v226, v227
    v_cvt_pk_bf16_f32 v226, v228, v229
    v_cvt_pk_bf16_f32 v227, v230, v231
    v_exp_f32 v172, v108
    v_mfma_f32_16x16x32_bf16 v[124:127], v[60:63], v[148:151], v[124:127]
    s_waitcnt lgkmcnt(15)
    ds_write_b128 v5, v[224:227] offset:4096
    ds_read_b64_tr_b16 v[72:73], v2 offset:25408
    ds_read_b64_tr_b16 v[74:75], v2 offset:25920
    v_mul_f32 v232, v232, v188
    v_mfma_f32_16x16x32_bf16 v[112:115], v[16:19], v[136:139], v[112:115]
    ds_read_b64_tr_b16 v[76:77], v2 offset:25440
    ds_read_b64_tr_b16 v[78:79], v2 offset:25952
    v_mul_f32 v233, v233, v188
    v_mul_f32 v234, v234, v188
    v_mul_f32 v235, v235, v188
    v_mul_f32 v236, v236, v188
    v_mul_f32 v237, v237, v188
    v_mul_f32 v238, v238, v188
    v_mfma_f32_16x16x32_bf16 v[120:123], v[16:19], v[152:155], v[120:123]
    v_mul_f32 v239, v239, v188
    v_cvt_pk_bf16_f32 v232, v232, v233
    v_cvt_pk_bf16_f32 v233, v234, v235
    v_cvt_pk_bf16_f32 v234, v236, v237
    v_cvt_pk_bf16_f32 v235, v238, v239
    v_exp_f32 v173, v109
    v_mfma_f32_16x16x32_bf16 v[116:119], v[20:23], v[136:139], v[116:119]
    ds_write_b128 v5, v[232:235] offset:5120
    v_mul_f32 v240, v240, v188
    v_mul_f32 v241, v241, v188
    v_mul_f32 v242, v242, v188
    v_mul_f32 v243, v243, v188
    v_mfma_f32_16x16x32_bf16 v[124:127], v[20:23], v[152:155], v[124:127]
    v_mul_f32 v244, v244, v188
    v_mul_f32 v245, v245, v188
    v_mul_f32 v246, v246, v188
    v_mul_f32 v247, v247, v188
    v_cvt_pk_bf16_f32 v240, v240, v241
    v_cvt_pk_bf16_f32 v241, v242, v243
    v_cvt_pk_bf16_f32 v242, v244, v245
    v_cvt_pk_bf16_f32 v243, v246, v247
    v_mfma_f32_16x16x32_bf16 v[112:115], v[24:27], v[140:143], v[112:115]
    ds_write_b128 v5, v[240:243] offset:6144
    v_mul_f32 v248, v248, v188
    v_mul_f32 v249, v249, v188
    v_mul_f32 v250, v250, v188
    v_mfma_f32_16x16x32_bf16 v[120:123], v[24:27], v[156:159], v[120:123]
    v_mul_f32 v251, v251, v188
    v_mul_f32 v252, v252, v188
    v_mul_f32 v253, v253, v188
    v_mul_f32 v254, v254, v188
    v_exp_f32 v174, v110
    v_mul_f32 v255, v255, v188
    v_cvt_pk_bf16_f32 v248, v248, v249
    v_mfma_f32_16x16x32_bf16 v[116:119], v[28:31], v[140:143], v[116:119]
    v_cvt_pk_bf16_f32 v46, v172, v173
    v_cvt_pk_bf16_f32 v249, v250, v251
    v_or3_b32 v186, v186, v45, v46
    v_cvt_pk_bf16_f32 v250, v252, v253
    v_exp_f32 v175, v111
    v_cvt_pk_bf16_f32 v251, v254, v255
    v_cvt_pk_bf16_f32 v47, v174, v175
    v_mfma_f32_16x16x32_bf16 v[124:127], v[28:31], v[156:159], v[124:127]
    ds_write_b128 v5, v[248:251] offset:7168
    v_bitop3_b32 v186, v186, v47, s77 bitop3:0xa8
    v_cmp_ne_u32 vcc, 0, v186
    s_cbranch_vccnz L_rs_a16
L_rr_a16:
    v_mfma_f32_16x16x32_bf16 v[8:11], a[252:255], v[40:43], 0
    s_waitcnt lgkmcnt(12)
    v_exp_f32 v160, v112
    v_mfma_f32_16x16x32_bf16 v[208:211], v[80:83], v[40:43], 0
    v_exp_f32 v161, v113
    v_mfma_f32_16x16x32_bf16 v[212:215], v[84:87], v[40:43], 0
    v_exp_f32 v162, v114
    v_mfma_f32_16x16x32_bf16 v[216:219], v[88:91], v[40:43], 0
    v_exp_f32 v163, v115
    v_mfma_f32_16x16x32_bf16 v[220:223], v[92:95], v[40:43], 0
    s_waitcnt lgkmcnt(3)
    v_exp_f32 v164, v116
    v_mfma_f32_16x16x32_bf16 v[192:195], v[64:67], v[40:43], 0
    v_exp_f32 v165, v117
    v_mfma_f32_16x16x32_bf16 v[196:199], v[68:71], v[40:43], 0
    v_exp_f32 v166, v118
    v_mfma_f32_16x16x32_bf16 v[200:203], v[72:75], v[40:43], 0
    v_exp_f32 v167, v119
    v_mfma_f32_16x16x32_bf16 v[204:207], v[76:79], v[40:43], 0
    s_waitcnt lgkmcnt(0)
L_r1:
    s_barrier
    v_mfma_f32_16x16x32_bf16 v[12:15], a[252:255], v[44:47], 0
    s_lshl_b32 s33, s3, 13
    ds_read_b128 v[48:51], v1 offset:33792
    ds_read_b128 v[52:55], v1 offset:34304
    v_cvt_pk_bf16_f32 v40, v160, v161
    v_mfma_f32_16x16x32_bf16 v[224:227], v[64:67], v[44:47], 0
    ds_read_b128 v[56:59], v1 offset:33856
    ds_read_b128 v[60:63], v1 offset:34368
    v_cvt_pk_bf16_f32 v41, v162, v163
    v_mfma_f32_16x16x32_bf16 v[228:231], v[68:71], v[44:47], 0
    ds_read_b128 v[16:19], v4 offset:0
    ds_read_b64_tr_b16 a[240:241], v3 offset:0
    v_cvt_pk_bf16_f32 v42, v164, v165
    v_mfma_f32_16x16x32_bf16 v[232:235], v[72:75], v[44:47], 0
    ds_read_b64_tr_b16 a[242:243], v3 offset:512
    ds_read_b128 v[20:23], v4 offset:4096
    v_or3_b32 v186, v40, v41, v42
    v_mfma_f32_16x16x32_bf16 v[236:239], v[76:79], v[44:47], 0
    ds_read_b128 v[24:27], v4 offset:8192
    ds_read_b128 v[28:31], v4 offset:12288
    v_cvt_pk_bf16_f32 v43, v166, v167
    v_mfma_f32_16x16x32_bf16 v[240:243], v[80:83], v[44:47], 0
    s_lshl_b32 s32, s4, 10
    ds_read_b128 v[32:35], v4 offset:16384
    ds_read_b128 v[36:39], v4 offset:20480
    v_mfma_f32_16x16x32_bf16 v[244:247], v[84:87], v[44:47], 0
    ds_read_b64_tr_b16 a[244:245], v3 offset:32
    ds_read_b64_tr_b16 a[246:247], v3 offset:544
    v_mfma_f32_16x16x32_bf16 v[248:251], v[88:91], v[44:47], 0
    ds_read_b128 v[64:67], v1 offset:33920
    ds_read_b128 v[68:71], v1 offset:34432
    v_mfma_f32_16x16x32_bf16 v[252:255], v[92:95], v[44:47], 0
    s_waitcnt lgkmcnt(14)
    ds_read_b128 v[72:75], v1 offset:33984
    ds_read_b128 v[76:79], v1 offset:34496
    v_mfma_f32_16x16x32_bf16 v[96:99], v[48:51], v[128:131], v[176:179]
    ds_read_b64_tr_b16 a[248:249], v3 offset:8448
    ds_read_b64_tr_b16 a[250:251], v3 offset:8960
    v_mfma_f32_16x16x32_bf16 v[104:107], v[48:51], v[144:147], v[180:183]
    s_add_u32 s16, s33, s32
    ds_read_b64_tr_b16 v[80:81], v2 offset:42368
    v_mfma_f32_16x16x32_bf16 v[100:103], v[52:55], v[128:131], v[176:179]
    ds_read_b64_tr_b16 v[82:83], v2 offset:42880
    v_mfma_f32_16x16x32_bf16 v[108:111], v[52:55], v[144:147], v[180:183]
    s_waitcnt lgkmcnt(15)
    ds_read_b64_tr_b16 v[84:85], v2 offset:42400
    v_mfma_f32_16x16x32_bf16 v[96:99], v[56:59], v[132:135], v[96:99]
    ds_read_b64_tr_b16 v[86:87], v2 offset:42912
    v_mfma_f32_16x16x32_bf16 v[104:107], v[56:59], v[148:151], v[104:107]
    ds_read_b64_tr_b16 v[88:89], v2 offset:42432
    v_mfma_f32_16x16x32_bf16 v[100:103], v[60:63], v[132:135], v[100:103]
    s_add_u32 s17, s16, 131072
    ds_read_b64_tr_b16 v[90:91], v2 offset:42944
    v_mfma_f32_16x16x32_bf16 v[108:111], v[60:63], v[148:151], v[108:111]
    s_waitcnt lgkmcnt(8)
    ds_read_b64_tr_b16 v[92:93], v2 offset:42464
    v_mfma_f32_16x16x32_bf16 v[96:99], v[64:67], v[136:139], v[96:99]
    ds_read_b64_tr_b16 v[94:95], v2 offset:42976
    v_mfma_f32_16x16x32_bf16 v[104:107], v[64:67], v[152:155], v[104:107]
    v_exp_f32 v168, v120
    v_mfma_f32_16x16x32_bf16 v[100:103], v[68:71], v[136:139], v[100:103]
    v_exp_f32 v169, v121
    v_mfma_f32_16x16x32_bf16 v[108:111], v[68:71], v[152:155], v[108:111]
    s_add_u32 s18, s16, 262144
    v_exp_f32 v170, v122
    v_mfma_f32_16x16x32_bf16 v[96:99], v[72:75], v[140:143], v[96:99]
    v_cvt_pk_bf16_f32 v44, v168, v169
    v_or3_b32 v186, v186, v43, v44
    v_mfma_f32_16x16x32_bf16 v[104:107], v[72:75], v[156:159], v[104:107]
    v_exp_f32 v171, v123
    v_mfma_f32_16x16x32_bf16 v[100:103], v[76:79], v[140:143], v[100:103]
    v_exp_f32 v172, v124
    v_mfma_f32_16x16x32_bf16 v[108:111], v[76:79], v[156:159], v[108:111]
    s_waitcnt lgkmcnt(8)
    v_cvt_pk_bf16_f32 v45, v170, v171
    v_mfma_f32_16x16x32_bf16 a[0:3], a[240:243], v[16:19], a[0:3]
    s_add_u32 s19, s16, 393216
    v_exp_f32 v173, v125
    v_mfma_f32_16x16x32_bf16 a[8:11], a[240:243], v[20:23], a[8:11]
    ds_read_b64_tr_b16 v[64:65], v2 offset:42240
    v_mfma_f32_16x16x32_bf16 a[16:19], a[240:243], v[24:27], a[16:19]
    ds_read_b64_tr_b16 v[66:67], v2 offset:42752
    v_mfma_f32_16x16x32_bf16 a[24:27], a[240:243], v[28:31], a[24:27]
    ds_read_b64_tr_b16 v[68:69], v2 offset:42272
    v_mfma_f32_16x16x32_bf16 a[32:35], a[240:243], v[32:35], a[32:35]
    ds_read_b64_tr_b16 v[70:71], v2 offset:42784
    v_mfma_f32_16x16x32_bf16 a[40:43], a[240:243], v[36:39], a[40:43]
    s_add_u32 s20, s16, 524288
    ds_read_b64_tr_b16 v[72:73], v2 offset:42304
    v_mfma_f32_16x16x32_bf16 a[4:7], a[244:247], v[16:19], a[4:7]
    ds_read_b64_tr_b16 v[74:75], v2 offset:42816
    v_mfma_f32_16x16x32_bf16 a[12:15], a[244:247], v[20:23], a[12:15]
    ds_read_b64_tr_b16 v[76:77], v2 offset:42336
    v_mfma_f32_16x16x32_bf16 a[20:23], a[244:247], v[24:27], a[20:23]
    ds_read_b64_tr_b16 v[78:79], v2 offset:42848
    v_mfma_f32_16x16x32_bf16 a[28:31], a[244:247], v[28:31], a[28:31]
    v_exp_f32 v174, v126
    v_mfma_f32_16x16x32_bf16 a[36:39], a[244:247], v[32:35], a[36:39]
    s_add_u32 s21, s16, 655360
    v_cvt_pk_bf16_f32 v46, v172, v173
    v_or3_b32 v186, v186, v45, v46
    v_mfma_f32_16x16x32_bf16 a[44:47], a[244:247], v[36:39], a[44:47]
    v_exp_f32 v175, v127
    v_mfma_f32_16x16x32_bf16 a[48:51], a[248:251], v[16:19], a[48:51]
    v_cvt_pk_bf16_f32 v47, v174, v175
    v_bitop3_b32 v186, v186, v47, s77 bitop3:0xa8
    v_mfma_f32_16x16x32_bf16 a[56:59], a[248:251], v[20:23], a[56:59]
    v_cmp_ne_u32 vcc, 0, v186
    v_mfma_f32_16x16x32_bf16 a[64:67], a[248:251], v[24:27], a[64:67]
    s_cbranch_vccnz L_rs_b1
L_rr_b1:
    v_mfma_f32_16x16x32_bf16 v[8:11], a[252:255], v[40:43], v[8:11]
    s_waitcnt lgkmcnt(8)
    v_exp_f32 v160, v96
    v_mfma_f32_16x16x32_bf16 v[208:211], v[80:83], v[40:43], v[208:211]
    v_exp_f32 v161, v97
    v_mfma_f32_16x16x32_bf16 v[212:215], v[84:87], v[40:43], v[212:215]
    v_exp_f32 v162, v98
    v_mfma_f32_16x16x32_bf16 v[216:219], v[88:91], v[40:43], v[216:219]
    v_exp_f32 v163, v99
    v_mfma_f32_16x16x32_bf16 v[220:223], v[92:95], v[40:43], v[220:223]
    s_waitcnt lgkmcnt(0)
    v_exp_f32 v164, v100
    v_mfma_f32_16x16x32_bf16 v[192:195], v[64:67], v[40:43], v[192:195]
    v_exp_f32 v165, v101
    v_mfma_f32_16x16x32_bf16 v[196:199], v[68:71], v[40:43], v[196:199]
    v_exp_f32 v166, v102
    v_mfma_f32_16x16x32_bf16 v[200:203], v[72:75], v[40:43], v[200:203]
    v_exp_f32 v167, v103
    v_mfma_f32_16x16x32_bf16 v[204:207], v[76:79], v[40:43], v[204:207]
    s_waitcnt lgkmcnt(0)
    s_barrier
    v_mfma_f32_16x16x32_bf16 v[12:15], a[252:255], v[44:47], v[12:15]
    s_add_u32 s22, s16, 786432
    ds_read_b128 v[48:51], v1 offset:50688
    ds_read_b128 v[52:55], v1 offset:51200
    v_cvt_pk_bf16_f32 v40, v160, v161
    v_mfma_f32_16x16x32_bf16 v[224:227], v[64:67], v[44:47], v[224:227]
    ds_read_b128 v[56:59], v1 offset:50752
    ds_read_b128 v[60:63], v1 offset:51264
    v_cvt_pk_bf16_f32 v41, v162, v163
    v_mfma_f32_16x16x32_bf16 v[228:231], v[68:71], v[44:47], v[228:231]
    ds_read_b64_tr_b16 a[240:241], v3 offset:8480
    ds_read_b64_tr_b16 a[242:243], v3 offset:8992
    v_cvt_pk_bf16_f32 v42, v164, v165
    v_mfma_f32_16x16x32_bf16 v[232:235], v[72:75], v[44:47], v[232:235]
    ds_read_b64_tr_b16 a[244:245], v3 offset:16896
    ds_read_b64_tr_b16 a[246:247], v3 offset:17408
    v_or3_b32 v186, v40, v41, v42
    v_mfma_f32_16x16x32_bf16 v[236:239], v[76:79], v[44:47], v[236:239]
    v_cvt_pk_bf16_f32 v43, v166, v167
    v_mfma_f32_16x16x32_bf16 v[240:243], v[80:83], v[44:47], v[240:243]
    s_add_u32 s23, s16, 917504
    v_exp_f32 v168, v104
    v_mfma_f32_16x16x32_bf16 v[244:247], v[84:87], v[44:47], v[244:247]
    v_exp_f32 v169, v105
    v_mfma_f32_16x16x32_bf16 v[248:251], v[88:91], v[44:47], v[248:251]
    ds_read_b128 v[64:67], v1 offset:50816
    ds_read_b128 v[68:71], v1 offset:51328
    v_mfma_f32_16x16x32_bf16 v[252:255], v[92:95], v[44:47], v[252:255]
    s_waitcnt lgkmcnt(8)
    ds_read_b128 v[72:75], v1 offset:50880
    ds_read_b128 v[76:79], v1 offset:51392
    v_mfma_f32_16x16x32_bf16 v[112:115], v[48:51], v[128:131], v[176:179]
    v_exp_f32 v170, v106
    v_mfma_f32_16x16x32_bf16 v[120:123], v[48:51], v[144:147], v[180:183]
    s_lshl_b32 s51, s3, 9
    ds_read_b64_tr_b16 v[80:81], v2 offset:59264
    v_cvt_pk_bf16_f32 v44, v168, v169
    v_mfma_f32_16x16x32_bf16 v[116:119], v[52:55], v[128:131], v[176:179]
    ds_read_b64_tr_b16 v[82:83], v2 offset:59776
    v_or3_b32 v186, v186, v43, v44
    v_mfma_f32_16x16x32_bf16 v[124:127], v[52:55], v[144:147], v[180:183]
    s_waitcnt lgkmcnt(10)
    ds_read_b64_tr_b16 v[84:85], v2 offset:59296
    v_mfma_f32_16x16x32_bf16 v[112:115], v[56:59], v[132:135], v[112:115]
    ds_read_b64_tr_b16 v[86:87], v2 offset:59808
    v_mfma_f32_16x16x32_bf16 v[120:123], v[56:59], v[148:151], v[120:123]
    ds_read_b64_tr_b16 v[88:89], v2 offset:59328
    v_mfma_f32_16x16x32_bf16 v[116:119], v[60:63], v[132:135], v[116:119]
    s_add_u32 s51, s51, 1048576
    ds_read_b64_tr_b16 v[90:91], v2 offset:59840
    v_mfma_f32_16x16x32_bf16 v[124:127], v[60:63], v[148:151], v[124:127]
    s_waitcnt lgkmcnt(6)
    ds_read_b64_tr_b16 v[92:93], v2 offset:59360
    v_mfma_f32_16x16x32_bf16 v[112:115], v[64:67], v[136:139], v[112:115]
    ds_read_b64_tr_b16 v[94:95], v2 offset:59872
    v_mfma_f32_16x16x32_bf16 v[120:123], v[64:67], v[152:155], v[120:123]
    v_exp_f32 v171, v107
    v_mfma_f32_16x16x32_bf16 v[116:119], v[68:71], v[136:139], v[116:119]
    v_exp_f32 v172, v108
    v_mfma_f32_16x16x32_bf16 v[124:127], v[68:71], v[152:155], v[124:127]
    s_lshl_b32 s50, s4, 3
    v_cvt_pk_bf16_f32 v45, v170, v171
    v_mfma_f32_16x16x32_bf16 v[112:115], v[72:75], v[140:143], v[112:115]
    v_exp_f32 v173, v109
    v_mfma_f32_16x16x32_bf16 v[120:123], v[72:75], v[156:159], v[120:123]
    v_exp_f32 v174, v110
    v_mfma_f32_16x16x32_bf16 v[116:119], v[76:79], v[140:143], v[116:119]
    v_cvt_pk_bf16_f32 v46, v172, v173
    v_or3_b32 v186, v186, v45, v46
    v_mfma_f32_16x16x32_bf16 v[124:127], v[76:79], v[156:159], v[124:127]
    v_exp_f32 v175, v111
    v_mfma_f32_16x16x32_bf16 a[72:75], a[248:251], v[28:31], a[72:75]
    s_add_u32 s50, s50, s51
    v_cvt_pk_bf16_f32 v47, v174, v175
    v_bitop3_b32 v186, v186, v47, s77 bitop3:0xa8
    v_mfma_f32_16x16x32_bf16 a[80:83], a[248:251], v[32:35], a[80:83]
    ds_read_b64_tr_b16 v[64:65], v2 offset:59136
    v_cmp_ne_u32 vcc, 0, v186
    v_mfma_f32_16x16x32_bf16 a[88:91], a[248:251], v[36:39], a[88:91]
    ds_read_b64_tr_b16 v[66:67], v2 offset:59648
    v_mfma_f32_16x16x32_bf16 a[52:55], a[240:243], v[16:19], a[52:55]
    ds_read_b64_tr_b16 v[68:69], v2 offset:59168
    v_mfma_f32_16x16x32_bf16 a[60:63], a[240:243], v[20:23], a[60:63]
    ds_read_b64_tr_b16 v[70:71], v2 offset:59680
    v_mfma_f32_16x16x32_bf16 a[68:71], a[240:243], v[24:27], a[68:71]
    s_mov_b32 s52, 0x01010101
    ds_read_b64_tr_b16 v[72:73], v2 offset:59200
    v_mfma_f32_16x16x32_bf16 a[76:79], a[240:243], v[28:31], a[76:79]
    ds_read_b64_tr_b16 v[74:75], v2 offset:59712
    v_mfma_f32_16x16x32_bf16 a[84:87], a[240:243], v[32:35], a[84:87]
    ds_read_b64_tr_b16 v[76:77], v2 offset:59232
    v_mfma_f32_16x16x32_bf16 a[92:95], a[240:243], v[36:39], a[92:95]
    ds_read_b64_tr_b16 v[78:79], v2 offset:59744
    v_mfma_f32_16x16x32_bf16 a[96:99], a[244:247], v[16:19], a[96:99]
    v_mfma_f32_16x16x32_bf16 a[104:107], a[244:247], v[20:23], a[104:107]
    s_lshl_b32 s52, s52, s4
    v_mfma_f32_16x16x32_bf16 a[112:115], a[244:247], v[24:27], a[112:115]
    v_mfma_f32_16x16x32_bf16 a[120:123], a[244:247], v[28:31], a[120:123]
    v_mfma_f32_16x16x32_bf16 a[128:131], a[244:247], v[32:35], a[128:131]
    v_mfma_f32_16x16x32_bf16 a[136:139], a[244:247], v[36:39], a[136:139]
    s_cbranch_vccnz L_rs_b2
L_rr_b2:
    v_mfma_f32_16x16x32_bf16 v[8:11], a[252:255], v[40:43], v[8:11]
    s_waitcnt lgkmcnt(8)
    v_exp_f32 v160, v112
    v_mfma_f32_16x16x32_bf16 v[208:211], v[80:83], v[40:43], v[208:211]
    v_exp_f32 v161, v113
    v_mfma_f32_16x16x32_bf16 v[212:215], v[84:87], v[40:43], v[212:215]
    v_exp_f32 v162, v114
    v_mfma_f32_16x16x32_bf16 v[216:219], v[88:91], v[40:43], v[216:219]
    v_exp_f32 v163, v115
    v_mfma_f32_16x16x32_bf16 v[220:223], v[92:95], v[40:43], v[220:223]
    s_waitcnt lgkmcnt(0)
    v_exp_f32 v164, v116
    v_mfma_f32_16x16x32_bf16 v[192:195], v[64:67], v[40:43], v[192:195]
    v_exp_f32 v165, v117
    v_mfma_f32_16x16x32_bf16 v[196:199], v[68:71], v[40:43], v[196:199]
    v_exp_f32 v166, v118
    v_mfma_f32_16x16x32_bf16 v[200:203], v[72:75], v[40:43], v[200:203]
    v_exp_f32 v167, v119
    v_mfma_f32_16x16x32_bf16 v[204:207], v[76:79], v[40:43], v[204:207]
    s_waitcnt lgkmcnt(0)
    s_barrier
    v_mfma_f32_16x16x32_bf16 v[12:15], a[252:255], v[44:47], v[12:15]
    s_mov_b32 s53, s52
    ds_read_b128 v[48:51], v1 offset:0
    ds_read_b128 v[52:55], v1 offset:512
    v_cvt_pk_bf16_f32 v40, v160, v161
    v_mfma_f32_16x16x32_bf16 v[224:227], v[64:67], v[44:47], v[224:227]
    ds_read_b128 v[56:59], v1 offset:64
    ds_read_b128 v[60:63], v1 offset:576
    v_cvt_pk_bf16_f32 v41, v162, v163
    v_mfma_f32_16x16x32_bf16 v[228:231], v[68:71], v[44:47], v[228:231]
    ds_read_b64_tr_b16 a[248:249], v3 offset:16928
    ds_read_b64_tr_b16 a[250:251], v3 offset:17440
    v_cvt_pk_bf16_f32 v42, v164, v165
    v_mfma_f32_16x16x32_bf16 v[232:235], v[72:75], v[44:47], v[232:235]
    ds_read_b64_tr_b16 a[240:241], v3 offset:25344
    ds_read_b64_tr_b16 a[242:243], v3 offset:25856
    v_or3_b32 v186, v40, v41, v42
    v_mfma_f32_16x16x32_bf16 v[236:239], v[76:79], v[44:47], v[236:239]
    ds_read_b64_tr_b16 a[244:245], v3 offset:25376
    ds_read_b64_tr_b16 a[246:247], v3 offset:25888
    v_cvt_pk_bf16_f32 v43, v166, v167
    v_mfma_f32_16x16x32_bf16 v[240:243], v[80:83], v[44:47], v[240:243]
    s_lshl_b32 s32, s4, 17
    v_exp_f32 v168, v120
    v_mfma_f32_16x16x32_bf16 v[244:247], v[84:87], v[44:47], v[244:247]
    v_exp_f32 v169, v121
    v_mfma_f32_16x16x32_bf16 v[248:251], v[88:91], v[44:47], v[248:251]
    ds_read_b128 v[64:67], v1 offset:128
    ds_read_b128 v[68:71], v1 offset:640
    v_mfma_f32_16x16x32_bf16 v[252:255], v[92:95], v[44:47], v[252:255]
    s_waitcnt lgkmcnt(10)
    ds_read_b128 v[72:75], v1 offset:192
    ds_read_b128 v[76:79], v1 offset:704
    v_mfma_f32_16x16x32_bf16 v[96:99], v[48:51], v[128:131], v[176:179]
    v_exp_f32 v170, v122
    v_mfma_f32_16x16x32_bf16 v[104:107], v[48:51], v[144:147], v[180:183]
    s_add_u32 s33, s33, s32
    ds_read_b64_tr_b16 v[80:81], v2 offset:8576
    v_cvt_pk_bf16_f32 v44, v168, v169
    v_mfma_f32_16x16x32_bf16 v[100:103], v[52:55], v[128:131], v[176:179]
    ds_read_b64_tr_b16 v[82:83], v2 offset:9088
    v_or3_b32 v186, v186, v43, v44
    v_mfma_f32_16x16x32_bf16 v[108:111], v[52:55], v[144:147], v[180:183]
    s_waitcnt lgkmcnt(12)
    ds_read_b64_tr_b16 v[84:85], v2 offset:8608
    v_mfma_f32_16x16x32_bf16 v[96:99], v[56:59], v[132:135], v[96:99]
    ds_read_b64_tr_b16 v[86:87], v2 offset:9120
    v_mfma_f32_16x16x32_bf16 v[104:107], v[56:59], v[148:151], v[104:107]
    ds_read_b64_tr_b16 v[88:89], v2 offset:8640
    v_mfma_f32_16x16x32_bf16 v[100:103], v[60:63], v[132:135], v[100:103]
    s_add_u32 s32, s4, 1
    ds_read_b64_tr_b16 v[90:91], v2 offset:9152
    v_mfma_f32_16x16x32_bf16 v[108:111], v[60:63], v[148:151], v[108:111]
    s_waitcnt lgkmcnt(6)
    ds_read_b64_tr_b16 v[92:93], v2 offset:8672
    v_mfma_f32_16x16x32_bf16 v[96:99], v[64:67], v[136:139], v[96:99]
    ds_read_b64_tr_b16 v[94:95], v2 offset:9184
    v_mfma_f32_16x16x32_bf16 v[104:107], v[64:67], v[152:155], v[104:107]
    v_exp_f32 v171, v123
    v_mfma_f32_16x16x32_bf16 v[100:103], v[68:71], v[136:139], v[100:103]
    v_exp_f32 v172, v124
    v_mfma_f32_16x16x32_bf16 v[108:111], v[68:71], v[152:155], v[108:111]
    s_and_b32 s32, s32, 7
    v_cvt_pk_bf16_f32 v45, v170, v171
    v_mfma_f32_16x16x32_bf16 v[96:99], v[72:75], v[140:143], v[96:99]
    v_exp_f32 v173, v125
    v_mfma_f32_16x16x32_bf16 v[104:107], v[72:75], v[156:159], v[104:107]
    v_exp_f32 v174, v126
    v_mfma_f32_16x16x32_bf16 v[100:103], v[76:79], v[140:143], v[100:103]
    v_cvt_pk_bf16_f32 v46, v172, v173
    v_or3_b32 v186, v186, v45, v46
    v_mfma_f32_16x16x32_bf16 v[108:111], v[76:79], v[156:159], v[108:111]
    v_exp_f32 v175, v127
    v_mfma_f32_16x16x32_bf16 a[100:103], a[248:251], v[16:19], a[100:103]
    s_lshl_b32 s32, s32, 10
    v_cvt_pk_bf16_f32 v47, v174, v175
    v_bitop3_b32 v186, v186, v47, s77 bitop3:0xa8
    v_mfma_f32_16x16x32_bf16 a[108:111], a[248:251], v[20:23], a[108:111]
    ds_read_b64_tr_b16 v[64:65], v2 offset:8448
    v_cmp_ne_u32 vcc, 0, v186
    v_mfma_f32_16x16x32_bf16 a[116:119], a[248:251], v[24:27], a[116:119]
    ds_read_b64_tr_b16 v[66:67], v2 offset:8960
    v_mfma_f32_16x16x32_bf16 a[124:127], a[248:251], v[28:31], a[124:127]
    ds_read_b64_tr_b16 v[68:69], v2 offset:8480
    v_mfma_f32_16x16x32_bf16 a[132:135], a[248:251], v[32:35], a[132:135]
    ds_read_b64_tr_b16 v[70:71], v2 offset:8992
    v_mfma_f32_16x16x32_bf16 a[140:143], a[248:251], v[36:39], a[140:143]
    s_add_u32 s66, s33, s32
    ds_read_b64_tr_b16 v[72:73], v2 offset:8512
    v_mfma_f32_16x16x32_bf16 a[144:147], a[240:243], v[16:19], a[144:147]
    ds_read_b64_tr_b16 v[74:75], v2 offset:9024
    v_mfma_f32_16x16x32_bf16 a[152:155], a[240:243], v[20:23], a[152:155]
    ds_read_b64_tr_b16 v[76:77], v2 offset:8544
    v_mfma_f32_16x16x32_bf16 a[160:163], a[240:243], v[24:27], a[160:163]
    ds_read_b64_tr_b16 v[78:79], v2 offset:9056
    v_mfma_f32_16x16x32_bf16 a[168:171], a[240:243], v[28:31], a[168:171]
    v_mfma_f32_16x16x32_bf16 a[176:179], a[240:243], v[32:35], a[176:179]
    s_add_u32 s32, s4, 2
    v_mfma_f32_16x16x32_bf16 a[184:187], a[240:243], v[36:39], a[184:187]
    v_mfma_f32_16x16x32_bf16 a[148:151], a[244:247], v[16:19], a[148:151]
    v_mfma_f32_16x16x32_bf16 a[156:159], a[244:247], v[20:23], a[156:159]
    v_mfma_f32_16x16x32_bf16 a[164:167], a[244:247], v[24:27], a[164:167]
    s_cbranch_vccnz L_rs_b3
L_rr_b3:
    v_mfma_f32_16x16x32_bf16 v[8:11], a[252:255], v[40:43], v[8:11]
    s_waitcnt lgkmcnt(8)
    v_exp_f32 v160, v96
    v_mfma_f32_16x16x32_bf16 v[208:211], v[80:83], v[40:43], v[208:211]
    v_exp_f32 v161, v97
    v_mfma_f32_16x16x32_bf16 v[212:215], v[84:87], v[40:43], v[212:215]
    v_exp_f32 v162, v98
    v_mfma_f32_16x16x32_bf16 v[216:219], v[88:91], v[40:43], v[216:219]
    v_exp_f32 v163, v99
    v_mfma_f32_16x16x32_bf16 v[220:223], v[92:95], v[40:43], v[220:223]
    s_waitcnt lgkmcnt(0)
    v_exp_f32 v164, v100
    v_mfma_f32_16x16x32_bf16 v[192:195], v[64:67], v[40:43], v[192:195]
    v_exp_f32 v165, v101
    v_mfma_f32_16x16x32_bf16 v[196:199], v[68:71], v[40:43], v[196:199]
    v_exp_f32 v166, v102
    v_mfma_f32_16x16x32_bf16 v[200:203], v[72:75], v[40:43], v[200:203]
    v_exp_f32 v167, v103
    v_mfma_f32_16x16x32_bf16 v[204:207], v[76:79], v[40:43], v[204:207]
    s_waitcnt lgkmcnt(0)
    s_barrier
    v_mfma_f32_16x16x32_bf16 v[12:15], a[252:255], v[44:47], v[12:15]
    s_and_b32 s32, s32, 7
    ds_read_b128 v[48:51], v1 offset:16896
    ds_read_b128 v[52:55], v1 offset:17408
    v_cvt_pk_bf16_f32 v40, v160, v161
    v_mfma_f32_16x16x32_bf16 v[224:227], v[64:67], v[44:47], v[224:227]
    ds_read_b128 v[56:59], v1 offset:16960
    ds_read_b128 v[60:63], v1 offset:17472
    v_cvt_pk_bf16_f32 v41, v162, v163
    v_mfma_f32_16x16x32_bf16 v[228:231], v[68:71], v[44:47], v[228:231]
    ds_read_b64_tr_b16 a[248:249], v3 offset:33792
    ds_read_b64_tr_b16 a[250:251], v3 offset:34304
    v_cvt_pk_bf16_f32 v42, v164, v165
    v_mfma_f32_16x16x32_bf16 v[232:235], v[72:75], v[44:47], v[232:235]
    ds_read_b64_tr_b16 a[240:241], v3 offset:33824
    ds_read_b64_tr_b16 a[242:243], v3 offset:34336
    v_or3_b32 v186, v40, v41, v42
    v_mfma_f32_16x16x32_bf16 v[236:239], v[76:79], v[44:47], v[236:239]
    v_cvt_pk_bf16_f32 v43, v166, v167
    v_mfma_f32_16x16x32_bf16 v[240:243], v[80:83], v[44:47], v[240:243]
    s_lshl_b32 s32, s32, 10
    v_exp_f32 v168, v104
    v_mfma_f32_16x16x32_bf16 v[244:247], v[84:87], v[44:47], v[244:247]
    v_exp_f32 v169, v105
    v_mfma_f32_16x16x32_bf16 v[248:251], v[88:91], v[44:47], v[248:251]
    ds_read_b128 v[64:67], v1 offset:17024
    ds_read_b128 v[68:71], v1 offset:17536
    v_mfma_f32_16x16x32_bf16 v[252:255], v[92:95], v[44:47], v[252:255]
    s_waitcnt lgkmcnt(8)
    ds_read_b128 v[72:75], v1 offset:17088
    ds_read_b128 v[76:79], v1 offset:17600
    v_mfma_f32_16x16x32_bf16 v[112:115], v[48:51], v[128:131], v[176:179]
    v_exp_f32 v170, v106
    v_mfma_f32_16x16x32_bf16 v[120:123], v[48:51], v[144:147], v[180:183]
    s_add_u32 s67, s33, s32
    ds_read_b64_tr_b16 v[80:81], v2 offset:25472
    v_cvt_pk_bf16_f32 v44, v168, v169
    v_mfma_f32_16x16x32_bf16 v[116:119], v[52:55], v[128:131], v[176:179]
    ds_read_b64_tr_b16 v[82:83], v2 offset:25984
    v_or3_b32 v186, v186, v43, v44
    v_mfma_f32_16x16x32_bf16 v[124:127], v[52:55], v[144:147], v[180:183]
    s_waitcnt lgkmcnt(10)
    ds_read_b64_tr_b16 v[84:85], v2 offset:25504
    v_mfma_f32_16x16x32_bf16 v[112:115], v[56:59], v[132:135], v[112:115]
    ds_read_b64_tr_b16 v[86:87], v2 offset:26016
    v_mfma_f32_16x16x32_bf16 v[120:123], v[56:59], v[148:151], v[120:123]
    ds_read_b64_tr_b16 v[88:89], v2 offset:25536
    v_mfma_f32_16x16x32_bf16 v[116:119], v[60:63], v[132:135], v[116:119]
    s_add_u32 s32, s4, 3
    ds_read_b64_tr_b16 v[90:91], v2 offset:26048
    v_mfma_f32_16x16x32_bf16 v[124:127], v[60:63], v[148:151], v[124:127]
    s_waitcnt lgkmcnt(6)
    ds_read_b64_tr_b16 v[92:93], v2 offset:25568
    v_mfma_f32_16x16x32_bf16 v[112:115], v[64:67], v[136:139], v[112:115]
    ds_read_b64_tr_b16 v[94:95], v2 offset:26080
    v_mfma_f32_16x16x32_bf16 v[120:123], v[64:67], v[152:155], v[120:123]
    v_exp_f32 v171, v107
    v_mfma_f32_16x16x32_bf16 v[116:119], v[68:71], v[136:139], v[116:119]
    v_exp_f32 v172, v108
    v_mfma_f32_16x16x32_bf16 v[124:127], v[68:71], v[152:155], v[124:127]
    s_and_b32 s32, s32, 7
    v_cvt_pk_bf16_f32 v45, v170, v171
    v_mfma_f32_16x16x32_bf16 v[112:115], v[72:75], v[140:143], v[112:115]
    v_exp_f32 v173, v109
    v_mfma_f32_16x16x32_bf16 v[120:123], v[72:75], v[156:159], v[120:123]
    v_exp_f32 v174, v110
    v_mfma_f32_16x16x32_bf16 v[116:119], v[76:79], v[140:143], v[116:119]
    v_cvt_pk_bf16_f32 v46, v172, v173
    v_or3_b32 v186, v186, v45, v46
    v_mfma_f32_16x16x32_bf16 v[124:127], v[76:79], v[156:159], v[124:127]
    v_exp_f32 v175, v111
    v_mfma_f32_16x16x32_bf16 a[172:175], a[244:247], v[28:31], a[172:175]
    s_lshl_b32 s32, s32, 10
    v_cvt_pk_bf16_f32 v47, v174, v175
    v_bitop3_b32 v186, v186, v47, s77 bitop3:0xa8
    v_mfma_f32_16x16x32_bf16 a[180:183], a[244:247], v[32:35], a[180:183]
    ds_read_b64_tr_b16 v[64:65], v2 offset:25344
    v_cmp_ne_u32 vcc, 0, v186
    v_mfma_f32_16x16x32_bf16 a[188:191], a[244:247], v[36:39], a[188:191]
    ds_read_b64_tr_b16 v[66:67], v2 offset:25856
    v_mfma_f32_16x16x32_bf16 a[192:195], a[248:251], v[16:19], a[192:195]
    ds_read_b64_tr_b16 v[68:69], v2 offset:25376
    v_mfma_f32_16x16x32_bf16 a[200:203], a[248:251], v[20:23], a[200:203]
    ds_read_b64_tr_b16 v[70:71], v2 offset:25888
    v_mfma_f32_16x16x32_bf16 a[208:211], a[248:251], v[24:27], a[208:211]
    s_add_u32 s68, s33, s32
    ds_read_b64_tr_b16 v[72:73], v2 offset:25408
    v_mfma_f32_16x16x32_bf16 a[216:219], a[248:251], v[28:31], a[216:219]
    ds_read_b64_tr_b16 v[74:75], v2 offset:25920
    v_mfma_f32_16x16x32_bf16 a[224:227], a[248:251], v[32:35], a[224:227]
    ds_read_b64_tr_b16 v[76:77], v2 offset:25440
    v_mfma_f32_16x16x32_bf16 a[232:235], a[248:251], v[36:39], a[232:235]
    ds_read_b64_tr_b16 v[78:79], v2 offset:25952
    v_mfma_f32_16x16x32_bf16 a[196:199], a[240:243], v[16:19], a[196:199]
    v_mfma_f32_16x16x32_bf16 a[204:207], a[240:243], v[20:23], a[204:207]
    s_add_u32 s32, s4, 4
    v_mfma_f32_16x16x32_bf16 a[212:215], a[240:243], v[24:27], a[212:215]
    v_mfma_f32_16x16x32_bf16 a[220:223], a[240:243], v[28:31], a[220:223]
    v_mfma_f32_16x16x32_bf16 a[228:231], a[240:243], v[32:35], a[228:231]
    v_mfma_f32_16x16x32_bf16 a[236:239], a[240:243], v[36:39], a[236:239]
    s_cbranch_vccnz L_rs_b4
L_rr_b4:
    v_mfma_f32_16x16x32_bf16 v[8:11], a[252:255], v[40:43], v[8:11]
    s_waitcnt lgkmcnt(8)
    v_exp_f32 v160, v112
    v_mfma_f32_16x16x32_bf16 v[208:211], v[80:83], v[40:43], v[208:211]
    v_exp_f32 v161, v113
    v_mfma_f32_16x16x32_bf16 v[212:215], v[84:87], v[40:43], v[212:215]
    v_exp_f32 v162, v114
    v_mfma_f32_16x16x32_bf16 v[216:219], v[88:91], v[40:43], v[216:219]
    v_exp_f32 v163, v115
    v_mfma_f32_16x16x32_bf16 v[220:223], v[92:95], v[40:43], v[220:223]
    s_waitcnt lgkmcnt(0)
    v_exp_f32 v164, v116
    v_mfma_f32_16x16x32_bf16 v[192:195], v[64:67], v[40:43], v[192:195]
    v_exp_f32 v165, v117
    v_mfma_f32_16x16x32_bf16 v[196:199], v[68:71], v[40:43], v[196:199]
    v_exp_f32 v166, v118
    v_mfma_f32_16x16x32_bf16 v[200:203], v[72:75], v[40:43], v[200:203]
    v_exp_f32 v167, v119
    v_mfma_f32_16x16x32_bf16 v[204:207], v[76:79], v[40:43], v[204:207]
    s_waitcnt lgkmcnt(0)
    s_barrier
    v_mfma_f32_16x16x32_bf16 v[12:15], a[252:255], v[44:47], v[12:15]
    s_and_b32 s32, s32, 7
    ds_read_b128 v[48:51], v1 offset:33792
    ds_read_b128 v[52:55], v1 offset:34304
    v_cvt_pk_bf16_f32 v40, v160, v161
    v_mfma_f32_16x16x32_bf16 v[224:227], v[64:67], v[44:47], v[224:227]
    ds_read_b128 v[56:59], v1 offset:33856
    ds_read_b128 v[60:63], v1 offset:34368
    v_cvt_pk_bf16_f32 v41, v162, v163
    v_mfma_f32_16x16x32_bf16 v[228:231], v[68:71], v[44:47], v[228:231]
    ds_read_b128 v[16:19], v4 offset:1024
    ds_read_b64_tr_b16 a[240:241], v3 offset:0
    v_cvt_pk_bf16_f32 v42, v164, v165
    v_mfma_f32_16x16x32_bf16 v[232:235], v[72:75], v[44:47], v[232:235]
    ds_read_b64_tr_b16 a[242:243], v3 offset:512
    ds_read_b128 v[20:23], v4 offset:5120
    v_or3_b32 v186, v40, v41, v42
    v_mfma_f32_16x16x32_bf16 v[236:239], v[76:79], v[44:47], v[236:239]
    ds_read_b128 v[24:27], v4 offset:9216
    ds_read_b128 v[28:31], v4 offset:13312
    v_cvt_pk_bf16_f32 v43, v166, v167
    v_mfma_f32_16x16x32_bf16 v[240:243], v[80:83], v[44:47], v[240:243]
    s_lshl_b32 s32, s32, 10
    ds_read_b128 v[32:35], v4 offset:17408
    ds_read_b128 v[36:39], v4 offset:21504
    v_mfma_f32_16x16x32_bf16 v[244:247], v[84:87], v[44:47], v[244:247]
    ds_read_b64_tr_b16 a[244:245], v3 offset:32
    ds_read_b64_tr_b16 a[246:247], v3 offset:544
    v_mfma_f32_16x16x32_bf16 v[248:251], v[88:91], v[44:47], v[248:251]
    ds_read_b128 v[64:67], v1 offset:33920
    ds_read_b128 v[68:71], v1 offset:34432
    v_mfma_f32_16x16x32_bf16 v[252:255], v[92:95], v[44:47], v[252:255]
    s_waitcnt lgkmcnt(14)
    ds_read_b128 v[72:75], v1 offset:33984
    ds_read_b128 v[76:79], v1 offset:34496
    v_mfma_f32_16x16x32_bf16 v[96:99], v[48:51], v[128:131], v[176:179]
    ds_read_b64_tr_b16 a[248:249], v3 offset:8448
    ds_read_b64_tr_b16 a[250:251], v3 offset:8960
    v_mfma_f32_16x16x32_bf16 v[104:107], v[48:51], v[144:147], v[180:183]
    s_add_u32 s69, s33, s32
    ds_read_b64_tr_b16 v[80:81], v2 offset:42368
    v_mfma_f32_16x16x32_bf16 v[100:103], v[52:55], v[128:131], v[176:179]
    ds_read_b64_tr_b16 v[82:83], v2 offset:42880
    v_mfma_f32_16x16x32_bf16 v[108:111], v[52:55], v[144:147], v[180:183]
    s_waitcnt lgkmcnt(15)
    ds_read_b64_tr_b16 v[84:85], v2 offset:42400
    v_mfma_f32_16x16x32_bf16 v[96:99], v[56:59], v[132:135], v[96:99]
    ds_read_b64_tr_b16 v[86:87], v2 offset:42912
    v_mfma_f32_16x16x32_bf16 v[104:107], v[56:59], v[148:151], v[104:107]
    ds_read_b64_tr_b16 v[88:89], v2 offset:42432
    v_mfma_f32_16x16x32_bf16 v[100:103], v[60:63], v[132:135], v[100:103]
    s_add_u32 s32, s4, 5
    ds_read_b64_tr_b16 v[90:91], v2 offset:42944
    v_mfma_f32_16x16x32_bf16 v[108:111], v[60:63], v[148:151], v[108:111]
    s_waitcnt lgkmcnt(8)
    ds_read_b64_tr_b16 v[92:93], v2 offset:42464
    v_mfma_f32_16x16x32_bf16 v[96:99], v[64:67], v[136:139], v[96:99]
    ds_read_b64_tr_b16 v[94:95], v2 offset:42976
    v_mfma_f32_16x16x32_bf16 v[104:107], v[64:67], v[152:155], v[104:107]
    v_exp_f32 v168, v120
    v_mfma_f32_16x16x32_bf16 v[100:103], v[68:71], v[136:139], v[100:103]
    v_exp_f32 v169, v121
    v_mfma_f32_16x16x32_bf16 v[108:111], v[68:71], v[152:155], v[108:111]
    s_and_b32 s32, s32, 7
    v_exp_f32 v170, v122
    v_mfma_f32_16x16x32_bf16 v[96:99], v[72:75], v[140:143], v[96:99]
    v_cvt_pk_bf16_f32 v44, v168, v169
    v_or3_b32 v186, v186, v43, v44
    v_mfma_f32_16x16x32_bf16 v[104:107], v[72:75], v[156:159], v[104:107]
    v_exp_f32 v171, v123
    v_mfma_f32_16x16x32_bf16 v[100:103], v[76:79], v[140:143], v[100:103]
    v_exp_f32 v172, v124
    v_mfma_f32_16x16x32_bf16 v[108:111], v[76:79], v[156:159], v[108:111]
    s_waitcnt lgkmcnt(8)
    v_cvt_pk_bf16_f32 v45, v170, v171
    v_mfma_f32_16x16x32_bf16 a[0:3], a[240:243], v[16:19], a[0:3]
    s_lshl_b32 s32, s32, 10
    v_exp_f32 v173, v125
    v_mfma_f32_16x16x32_bf16 a[8:11], a[240:243], v[20:23], a[8:11]
    ds_read_b64_tr_b16 v[64:65], v2 offset:42240
    v_mfma_f32_16x16x32_bf16 a[16:19], a[240:243], v[24:27], a[16:19]
    ds_read_b64_tr_b16 v[66:67], v2 offset:42752
    v_mfma_f32_16x16x32_bf16 a[24:27], a[240:243], v[28:31], a[24:27]
    ds_read_b64_tr_b16 v[68:69], v2 offset:42272
    v_mfma_f32_16x16x32_bf16 a[32:35], a[240:243], v[32:35], a[32:35]
    ds_read_b64_tr_b16 v[70:71], v2 offset:42784
    v_mfma_f32_16x16x32_bf16 a[40:43], a[240:243], v[36:39], a[40:43]
    s_add_u32 s70, s33, s32
    ds_read_b64_tr_b16 v[72:73], v2 offset:42304
    v_mfma_f32_16x16x32_bf16 a[4:7], a[244:247], v[16:19], a[4:7]
    ds_read_b64_tr_b16 v[74:75], v2 offset:42816
    v_mfma_f32_16x16x32_bf16 a[12:15], a[244:247], v[20:23], a[12:15]
    ds_read_b64_tr_b16 v[76:77], v2 offset:42336
    v_mfma_f32_16x16x32_bf16 a[20:23], a[244:247], v[24:27], a[20:23]
    ds_read_b64_tr_b16 v[78:79], v2 offset:42848
    v_mfma_f32_16x16x32_bf16 a[28:31], a[244:247], v[28:31], a[28:31]
    v_exp_f32 v174, v126
    v_mfma_f32_16x16x32_bf16 a[36:39], a[244:247], v[32:35], a[36:39]
    s_add_u32 s32, s4, 6
    v_cvt_pk_bf16_f32 v46, v172, v173
    v_or3_b32 v186, v186, v45, v46
    v_mfma_f32_16x16x32_bf16 a[44:47], a[244:247], v[36:39], a[44:47]
    v_exp_f32 v175, v127
    v_mfma_f32_16x16x32_bf16 a[48:51], a[248:251], v[16:19], a[48:51]
    v_cvt_pk_bf16_f32 v47, v174, v175
    v_bitop3_b32 v186, v186, v47, s77 bitop3:0xa8
    v_mfma_f32_16x16x32_bf16 a[56:59], a[248:251], v[20:23], a[56:59]
    v_cmp_ne_u32 vcc, 0, v186
    v_mfma_f32_16x16x32_bf16 a[64:67], a[248:251], v[24:27], a[64:67]
    s_cbranch_vccnz L_rs_b5
L_rr_b5:
    v_mfma_f32_16x16x32_bf16 v[8:11], a[252:255], v[40:43], v[8:11]
    s_waitcnt lgkmcnt(8)
    v_exp_f32 v160, v96
    v_mfma_f32_16x16x32_bf16 v[208:211], v[80:83], v[40:43], v[208:211]
    v_exp_f32 v161, v97
    v_mfma_f32_16x16x32_bf16 v[212:215], v[84:87], v[40:43], v[212:215]
    v_exp_f32 v162, v98
    v_mfma_f32_16x16x32_bf16 v[216:219], v[88:91], v[40:43], v[216:219]
    v_exp_f32 v163, v99
    v_mfma_f32_16x16x32_bf16 v[220:223], v[92:95], v[40:43], v[220:223]
    s_waitcnt lgkmcnt(0)
    v_exp_f32 v164, v100
    v_mfma_f32_16x16x32_bf16 v[192:195], v[64:67], v[40:43], v[192:195]
    v_exp_f32 v165, v101
    v_mfma_f32_16x16x32_bf16 v[196:199], v[68:71], v[40:43], v[196:199]
    v_exp_f32 v166, v102
    v_mfma_f32_16x16x32_bf16 v[200:203], v[72:75], v[40:43], v[200:203]
    v_exp_f32 v167, v103
    v_mfma_f32_16x16x32_bf16 v[204:207], v[76:79], v[40:43], v[204:207]
    s_waitcnt lgkmcnt(0)
    s_barrier
    v_mfma_f32_16x16x32_bf16 v[12:15], a[252:255], v[44:47], v[12:15]
    s_and_b32 s32, s32, 7
    ds_read_b128 v[48:51], v1 offset:50688
    ds_read_b128 v[52:55], v1 offset:51200
    v_cvt_pk_bf16_f32 v40, v160, v161
    v_mfma_f32_16x16x32_bf16 v[224:227], v[64:67], v[44:47], v[224:227]
    ds_read_b128 v[56:59], v1 offset:50752
    ds_read_b128 v[60:63], v1 offset:51264
    v_cvt_pk_bf16_f32 v41, v162, v163
    v_mfma_f32_16x16x32_bf16 v[228:231], v[68:71], v[44:47], v[228:231]
    ds_read_b64_tr_b16 a[240:241], v3 offset:8480
    ds_read_b64_tr_b16 a[242:243], v3 offset:8992
    v_cvt_pk_bf16_f32 v42, v164, v165
    v_mfma_f32_16x16x32_bf16 v[232:235], v[72:75], v[44:47], v[232:235]
    ds_read_b64_tr_b16 a[244:245], v3 offset:16896
    ds_read_b64_tr_b16 a[246:247], v3 offset:17408
    v_or3_b32 v186, v40, v41, v42
    v_mfma_f32_16x16x32_bf16 v[236:239], v[76:79], v[44:47], v[236:239]
    v_cvt_pk_bf16_f32 v43, v166, v167
    v_mfma_f32_16x16x32_bf16 v[240:243], v[80:83], v[44:47], v[240:243]
    s_lshl_b32 s32, s32, 10
    v_exp_f32 v168, v104
    v_mfma_f32_16x16x32_bf16 v[244:247], v[84:87], v[44:47], v[244:247]
    v_exp_f32 v169, v105
    v_mfma_f32_16x16x32_bf16 v[248:251], v[88:91], v[44:47], v[248:251]
    ds_read_b128 v[64:67], v1 offset:50816
    ds_read_b128 v[68:71], v1 offset:51328
    v_mfma_f32_16x16x32_bf16 v[252:255], v[92:95], v[44:47], v[252:255]
    s_waitcnt lgkmcnt(8)
    ds_read_b128 v[72:75], v1 offset:50880
    ds_read_b128 v[76:79], v1 offset:51392
    v_mfma_f32_16x16x32_bf16 v[112:115], v[48:51], v[128:131], v[176:179]
    v_exp_f32 v170, v106
    v_mfma_f32_16x16x32_bf16 v[120:123], v[48:51], v[144:147], v[180:183]
    s_add_u32 s71, s33, s32
    ds_read_b64_tr_b16 v[80:81], v2 offset:59264
    v_cvt_pk_bf16_f32 v44, v168, v169
    v_mfma_f32_16x16x32_bf16 v[116:119], v[52:55], v[128:131], v[176:179]
    ds_read_b64_tr_b16 v[82:83], v2 offset:59776
    v_or3_b32 v186, v186, v43, v44
    v_mfma_f32_16x16x32_bf16 v[124:127], v[52:55], v[144:147], v[180:183]
    s_waitcnt lgkmcnt(10)
    ds_read_b64_tr_b16 v[84:85], v2 offset:59296
    v_mfma_f32_16x16x32_bf16 v[112:115], v[56:59], v[132:135], v[112:115]
    ds_read_b64_tr_b16 v[86:87], v2 offset:59808
    v_mfma_f32_16x16x32_bf16 v[120:123], v[56:59], v[148:151], v[120:123]
    ds_read_b64_tr_b16 v[88:89], v2 offset:59328
    v_mfma_f32_16x16x32_bf16 v[116:119], v[60:63], v[132:135], v[116:119]
    s_add_u32 s32, s4, 7
    ds_read_b64_tr_b16 v[90:91], v2 offset:59840
    v_mfma_f32_16x16x32_bf16 v[124:127], v[60:63], v[148:151], v[124:127]
    s_waitcnt lgkmcnt(6)
    ds_read_b64_tr_b16 v[92:93], v2 offset:59360
    v_mfma_f32_16x16x32_bf16 v[112:115], v[64:67], v[136:139], v[112:115]
    ds_read_b64_tr_b16 v[94:95], v2 offset:59872
    v_mfma_f32_16x16x32_bf16 v[120:123], v[64:67], v[152:155], v[120:123]
    v_exp_f32 v171, v107
    v_mfma_f32_16x16x32_bf16 v[116:119], v[68:71], v[136:139], v[116:119]
    v_exp_f32 v172, v108
    v_mfma_f32_16x16x32_bf16 v[124:127], v[68:71], v[152:155], v[124:127]
    s_and_b32 s32, s32, 7
    v_cvt_pk_bf16_f32 v45, v170, v171
    v_mfma_f32_16x16x32_bf16 v[112:115], v[72:75], v[140:143], v[112:115]
    v_exp_f32 v173, v109
    v_mfma_f32_16x16x32_bf16 v[120:123], v[72:75], v[156:159], v[120:123]
    v_exp_f32 v174, v110
    v_mfma_f32_16x16x32_bf16 v[116:119], v[76:79], v[140:143], v[116:119]
    v_cvt_pk_bf16_f32 v46, v172, v173
    v_or3_b32 v186, v186, v45, v46
    v_mfma_f32_16x16x32_bf16 v[124:127], v[76:79], v[156:159], v[124:127]
    v_exp_f32 v175, v111
    v_mfma_f32_16x16x32_bf16 a[72:75], a[248:251], v[28:31], a[72:75]
    s_lshl_b32 s32, s32, 10
    v_cvt_pk_bf16_f32 v47, v174, v175
    v_bitop3_b32 v186, v186, v47, s77 bitop3:0xa8
    v_mfma_f32_16x16x32_bf16 a[80:83], a[248:251], v[32:35], a[80:83]
    ds_read_b64_tr_b16 v[64:65], v2 offset:59136
    v_cmp_ne_u32 vcc, 0, v186
    v_mfma_f32_16x16x32_bf16 a[88:91], a[248:251], v[36:39], a[88:91]
    ds_read_b64_tr_b16 v[66:67], v2 offset:59648
    v_mfma_f32_16x16x32_bf16 a[52:55], a[240:243], v[16:19], a[52:55]
    ds_read_b64_tr_b16 v[68:69], v2 offset:59168
    v_mfma_f32_16x16x32_bf16 a[60:63], a[240:243], v[20:23], a[60:63]
    ds_read_b64_tr_b16 v[70:71], v2 offset:59680
    v_mfma_f32_16x16x32_bf16 a[68:71], a[240:243], v[24:27], a[68:71]
    s_add_u32 s72, s33, s32
    ds_read_b64_tr_b16 v[72:73], v2 offset:59200
    v_mfma_f32_16x16x32_bf16 a[76:79], a[240:243], v[28:31], a[76:79]
    ds_read_b64_tr_b16 v[74:75], v2 offset:59712
    v_mfma_f32_16x16x32_bf16 a[84:87], a[240:243], v[32:35], a[84:87]
    ds_read_b64_tr_b16 v[76:77], v2 offset:59232
    v_mfma_f32_16x16x32_bf16 a[92:95], a[240:243], v[36:39], a[92:95]
    ds_read_b64_tr_b16 v[78:79], v2 offset:59744
    v_mfma_f32_16x16x32_bf16 a[96:99], a[244:247], v[16:19], a[96:99]
    v_mfma_f32_16x16x32_bf16 a[104:107], a[244:247], v[20:23], a[104:107]
    s_mul_i32 s35, s5, 245760
    v_mfma_f32_16x16x32_bf16 a[112:115], a[244:247], v[24:27], a[112:115]
    v_mfma_f32_16x16x32_bf16 a[120:123], a[244:247], v[28:31], a[120:123]
    v_mfma_f32_16x16x32_bf16 a[128:131], a[244:247], v[32:35], a[128:131]
    v_mfma_f32_16x16x32_bf16 a[136:139], a[244:247], v[36:39], a[136:139]
    s_cbranch_vccnz L_rs_b6
L_rr_b6:
    v_mfma_f32_16x16x32_bf16 v[8:11], a[252:255], v[40:43], v[8:11]
    s_waitcnt lgkmcnt(8)
    v_exp_f32 v160, v112
    v_mfma_f32_16x16x32_bf16 v[208:211], v[80:83], v[40:43], v[208:211]
    v_exp_f32 v161, v113
    v_mfma_f32_16x16x32_bf16 v[212:215], v[84:87], v[40:43], v[212:215]
    v_exp_f32 v162, v114
    v_mfma_f32_16x16x32_bf16 v[216:219], v[88:91], v[40:43], v[216:219]
    v_exp_f32 v163, v115
    v_mfma_f32_16x16x32_bf16 v[220:223], v[92:95], v[40:43], v[220:223]
    s_waitcnt lgkmcnt(0)
    v_exp_f32 v164, v116
    v_mfma_f32_16x16x32_bf16 v[192:195], v[64:67], v[40:43], v[192:195]
    v_exp_f32 v165, v117
    v_mfma_f32_16x16x32_bf16 v[196:199], v[68:71], v[40:43], v[196:199]
    v_exp_f32 v166, v118
    v_mfma_f32_16x16x32_bf16 v[200:203], v[72:75], v[40:43], v[200:203]
    v_exp_f32 v167, v119
    v_mfma_f32_16x16x32_bf16 v[204:207], v[76:79], v[40:43], v[204:207]
    s_waitcnt lgkmcnt(0)
    s_barrier
    v_mfma_f32_16x16x32_bf16 v[12:15], a[252:255], v[44:47], v[12:15]
    s_mul_i32 s32, s6, 1280
    ds_read_b128 v[48:51], v1 offset:0
    ds_read_b128 v[52:55], v1 offset:512
    v_cvt_pk_bf16_f32 v40, v160, v161
    v_mfma_f32_16x16x32_bf16 v[224:227], v[64:67], v[44:47], v[224:227]
    ds_read_b128 v[56:59], v1 offset:64
    ds_read_b128 v[60:63], v1 offset:576
    v_cvt_pk_bf16_f32 v41, v162, v163
    v_mfma_f32_16x16x32_bf16 v[228:231], v[68:71], v[44:47], v[228:231]
    ds_read_b64_tr_b16 a[248:249], v3 offset:16928
    ds_read_b64_tr_b16 a[250:251], v3 offset:17440
    v_cvt_pk_bf16_f32 v42, v164, v165
    v_mfma_f32_16x16x32_bf16 v[232:235], v[72:75], v[44:47], v[232:235]
    ds_read_b64_tr_b16 a[240:241], v3 offset:25344
    ds_read_b64_tr_b16 a[242:243], v3 offset:25856
    v_or3_b32 v186, v40, v41, v42
    v_mfma_f32_16x16x32_bf16 v[236:239], v[76:79], v[44:47], v[236:239]
    ds_read_b64_tr_b16 a[244:245], v3 offset:25376
    ds_read_b64_tr_b16 a[246:247], v3 offset:25888
    v_cvt_pk_bf16_f32 v43, v166, v167
    v_mfma_f32_16x16x32_bf16 v[240:243], v[80:83], v[44:47], v[240:243]
    s_add_u32 s35, s35, s32
    v_exp_f32 v168, v120
    v_mfma_f32_16x16x32_bf16 v[244:247], v[84:87], v[44:47], v[244:247]
    v_exp_f32 v169, v121
    v_mfma_f32_16x16x32_bf16 v[248:251], v[88:91], v[44:47], v[248:251]
    ds_read_b128 v[64:67], v1 offset:128
    ds_read_b128 v[68:71], v1 offset:640
    v_mfma_f32_16x16x32_bf16 v[252:255], v[92:95], v[44:47], v[252:255]
    s_waitcnt lgkmcnt(10)
    ds_read_b128 v[72:75], v1 offset:192
    ds_read_b128 v[76:79], v1 offset:704
    v_mfma_f32_16x16x32_bf16 v[96:99], v[48:51], v[128:131], v[176:179]
    v_exp_f32 v170, v122
    v_mfma_f32_16x16x32_bf16 v[104:107], v[48:51], v[144:147], v[180:183]
    s_lshl_b32 s32, s3, 6
    ds_read_b64_tr_b16 v[80:81], v2 offset:8576
    v_cvt_pk_bf16_f32 v44, v168, v169
    v_mfma_f32_16x16x32_bf16 v[100:103], v[52:55], v[128:131], v[176:179]
    ds_read_b64_tr_b16 v[82:83], v2 offset:9088
    v_or3_b32 v186, v186, v43, v44
    v_mfma_f32_16x16x32_bf16 v[108:111], v[52:55], v[144:147], v[180:183]
    s_waitcnt lgkmcnt(12)
    ds_read_b64_tr_b16 v[84:85], v2 offset:8608
    v_mfma_f32_16x16x32_bf16 v[96:99], v[56:59], v[132:135], v[96:99]
    ds_read_b64_tr_b16 v[86:87], v2 offset:9120
    v_mfma_f32_16x16x32_bf16 v[104:107], v[56:59], v[148:151], v[104:107]
    ds_read_b64_tr_b16 v[88:89], v2 offset:8640
    v_mfma_f32_16x16x32_bf16 v[100:103], v[60:63], v[132:135], v[100:103]
    s_add_u32 s35, s35, s32
    ds_read_b64_tr_b16 v[90:91], v2 offset:9152
    v_mfma_f32_16x16x32_bf16 v[108:111], v[60:63], v[148:151], v[108:111]
    s_waitcnt lgkmcnt(6)
    ds_read_b64_tr_b16 v[92:93], v2 offset:8672
    v_mfma_f32_16x16x32_bf16 v[96:99], v[64:67], v[136:139], v[96:99]
    ds_read_b64_tr_b16 v[94:95], v2 offset:9184
    v_mfma_f32_16x16x32_bf16 v[104:107], v[64:67], v[152:155], v[104:107]
    v_exp_f32 v171, v123
    v_mfma_f32_16x16x32_bf16 v[100:103], v[68:71], v[136:139], v[100:103]
    v_exp_f32 v172, v124
    v_mfma_f32_16x16x32_bf16 v[108:111], v[68:71], v[152:155], v[108:111]
    s_add_u32 s32, s4, 0
    v_cvt_pk_bf16_f32 v45, v170, v171
    v_mfma_f32_16x16x32_bf16 v[96:99], v[72:75], v[140:143], v[96:99]
    v_exp_f32 v173, v125
    v_mfma_f32_16x16x32_bf16 v[104:107], v[72:75], v[156:159], v[104:107]
    v_exp_f32 v174, v126
    v_mfma_f32_16x16x32_bf16 v[100:103], v[76:79], v[140:143], v[100:103]
    v_cvt_pk_bf16_f32 v46, v172, v173
    v_or3_b32 v186, v186, v45, v46
    v_mfma_f32_16x16x32_bf16 v[108:111], v[76:79], v[156:159], v[108:111]
    v_exp_f32 v175, v127
    v_mfma_f32_16x16x32_bf16 a[100:103], a[248:251], v[16:19], a[100:103]
    s_mul_i32 s33, s32, 43
    v_cvt_pk_bf16_f32 v47, v174, v175
    v_bitop3_b32 v186, v186, v47, s77 bitop3:0xa8
    v_mfma_f32_16x16x32_bf16 a[108:111], a[248:251], v[20:23], a[108:111]
    ds_read_b64_tr_b16 v[64:65], v2 offset:8448
    v_cmp_ne_u32 vcc, 0, v186
    v_mfma_f32_16x16x32_bf16 a[116:119], a[248:251], v[24:27], a[116:119]
    ds_read_b64_tr_b16 v[66:67], v2 offset:8960
    v_mfma_f32_16x16x32_bf16 a[124:127], a[248:251], v[28:31], a[124:127]
    ds_read_b64_tr_b16 v[68:69], v2 offset:8480
    v_mfma_f32_16x16x32_bf16 a[132:135], a[248:251], v[32:35], a[132:135]
    ds_read_b64_tr_b16 v[70:71], v2 offset:8992
    v_mfma_f32_16x16x32_bf16 a[140:143], a[248:251], v[36:39], a[140:143]
    s_lshr_b32 s33, s33, 8
    ds_read_b64_tr_b16 v[72:73], v2 offset:8512
    v_mfma_f32_16x16x32_bf16 a[144:147], a[240:243], v[16:19], a[144:147]
    ds_read_b64_tr_b16 v[74:75], v2 offset:9024
    v_mfma_f32_16x16x32_bf16 a[152:155], a[240:243], v[20:23], a[152:155]
    ds_read_b64_tr_b16 v[76:77], v2 offset:8544
    v_mfma_f32_16x16x32_bf16 a[160:163], a[240:243], v[24:27], a[160:163]
    ds_read_b64_tr_b16 v[78:79], v2 offset:9056
    v_mfma_f32_16x16x32_bf16 a[168:171], a[240:243], v[28:31], a[168:171]
    v_mfma_f32_16x16x32_bf16 a[176:179], a[240:243], v[32:35], a[176:179]
    s_lshl_b32 s73, s33, 8
    v_mfma_f32_16x16x32_bf16 a[184:187], a[240:243], v[36:39], a[184:187]
    v_mfma_f32_16x16x32_bf16 a[148:151], a[244:247], v[16:19], a[148:151]
    v_mfma_f32_16x16x32_bf16 a[156:159], a[244:247], v[20:23], a[156:159]
    v_mfma_f32_16x16x32_bf16 a[164:167], a[244:247], v[24:27], a[164:167]
    s_cbranch_vccnz L_rs_b7
L_rr_b7:
    v_mfma_f32_16x16x32_bf16 v[8:11], a[252:255], v[40:43], v[8:11]
    s_waitcnt lgkmcnt(8)
    v_exp_f32 v160, v96
    v_mfma_f32_16x16x32_bf16 v[208:211], v[80:83], v[40:43], v[208:211]
    v_exp_f32 v161, v97
    v_mfma_f32_16x16x32_bf16 v[212:215], v[84:87], v[40:43], v[212:215]
    v_exp_f32 v162, v98
    v_mfma_f32_16x16x32_bf16 v[216:219], v[88:91], v[40:43], v[216:219]
    v_exp_f32 v163, v99
    v_mfma_f32_16x16x32_bf16 v[220:223], v[92:95], v[40:43], v[220:223]
    s_waitcnt lgkmcnt(0)
    v_exp_f32 v164, v100
    v_mfma_f32_16x16x32_bf16 v[192:195], v[64:67], v[40:43], v[192:195]
    v_exp_f32 v165, v101
    v_mfma_f32_16x16x32_bf16 v[196:199], v[68:71], v[40:43], v[196:199]
    v_exp_f32 v166, v102
    v_mfma_f32_16x16x32_bf16 v[200:203], v[72:75], v[40:43], v[200:203]
    v_exp_f32 v167, v103
    v_mfma_f32_16x16x32_bf16 v[204:207], v[76:79], v[40:43], v[204:207]
    s_waitcnt lgkmcnt(0)
    s_barrier
    v_mfma_f32_16x16x32_bf16 v[12:15], a[252:255], v[44:47], v[12:15]
    s_mul_i32 s33, s33, 6
    ds_read_b128 v[48:51], v1 offset:16896
    ds_read_b128 v[52:55], v1 offset:17408
    v_cvt_pk_bf16_f32 v40, v160, v161
    v_mfma_f32_16x16x32_bf16 v[224:227], v[64:67], v[44:47], v[224:227]
    ds_read_b128 v[56:59], v1 offset:16960
    ds_read_b128 v[60:63], v1 offset:17472
    v_cvt_pk_bf16_f32 v41, v162, v163
    v_mfma_f32_16x16x32_bf16 v[228:231], v[68:71], v[44:47], v[228:231]
    ds_read_b64_tr_b16 a[248:249], v3 offset:33792
    ds_read_b64_tr_b16 a[250:251], v3 offset:34304
    v_cvt_pk_bf16_f32 v42, v164, v165
    v_mfma_f32_16x16x32_bf16 v[232:235], v[72:75], v[44:47], v[232:235]
    ds_read_b64_tr_b16 a[240:241], v3 offset:33824
    ds_read_b64_tr_b16 a[242:243], v3 offset:34336
    v_or3_b32 v186, v40, v41, v42
    v_mfma_f32_16x16x32_bf16 v[236:239], v[76:79], v[44:47], v[236:239]
    v_cvt_pk_bf16_f32 v43, v166, v167
    v_mfma_f32_16x16x32_bf16 v[240:243], v[80:83], v[44:47], v[240:243]
    s_sub_u32 s32, s32, s33
    v_exp_f32 v168, v104
    v_mfma_f32_16x16x32_bf16 v[244:247], v[84:87], v[44:47], v[244:247]
    v_exp_f32 v169, v105
    v_mfma_f32_16x16x32_bf16 v[248:251], v[88:91], v[44:47], v[248:251]
    ds_read_b128 v[64:67], v1 offset:17024
    ds_read_b128 v[68:71], v1 offset:17536
    v_mfma_f32_16x16x32_bf16 v[252:255], v[92:95], v[44:47], v[252:255]
    s_waitcnt lgkmcnt(8)
    ds_read_b128 v[72:75], v1 offset:17088
    ds_read_b128 v[76:79], v1 offset:17600
    v_mfma_f32_16x16x32_bf16 v[112:115], v[48:51], v[128:131], v[176:179]
    v_exp_f32 v170, v106
    v_mfma_f32_16x16x32_bf16 v[120:123], v[48:51], v[144:147], v[180:183]
    s_and_b32 s33, s32, 1
    ds_read_b64_tr_b16 v[80:81], v2 offset:25472
    v_cvt_pk_bf16_f32 v44, v168, v169
    v_mfma_f32_16x16x32_bf16 v[116:119], v[52:55], v[128:131], v[176:179]
    ds_read_b64_tr_b16 v[82:83], v2 offset:25984
    v_or3_b32 v186, v186, v43, v44
    v_mfma_f32_16x16x32_bf16 v[124:127], v[52:55], v[144:147], v[180:183]
    s_waitcnt lgkmcnt(10)
    ds_read_b64_tr_b16 v[84:85], v2 offset:25504
    v_mfma_f32_16x16x32_bf16 v[112:115], v[56:59], v[132:135], v[112:115]
    ds_read_b64_tr_b16 v[86:87], v2 offset:26016
    v_mfma_f32_16x16x32_bf16 v[120:123], v[56:59], v[148:151], v[120:123]
    ds_read_b64_tr_b16 v[88:89], v2 offset:25536
    v_mfma_f32_16x16x32_bf16 v[116:119], v[60:63], v[132:135], v[116:119]
    s_mul_i32 s33, s33, 5120
    ds_read_b64_tr_b16 v[90:91], v2 offset:26048
    v_mfma_f32_16x16x32_bf16 v[124:127], v[60:63], v[148:151], v[124:127]
    s_waitcnt lgkmcnt(6)
    ds_read_b64_tr_b16 v[92:93], v2 offset:25568
    v_mfma_f32_16x16x32_bf16 v[112:115], v[64:67], v[136:139], v[112:115]
    ds_read_b64_tr_b16 v[94:95], v2 offset:26080
    v_mfma_f32_16x16x32_bf16 v[120:123], v[64:67], v[152:155], v[120:123]
    v_exp_f32 v171, v107
    v_mfma_f32_16x16x32_bf16 v[116:119], v[68:71], v[136:139], v[116:119]
    v_exp_f32 v172, v108
    v_mfma_f32_16x16x32_bf16 v[124:127], v[68:71], v[152:155], v[124:127]
    s_add_u32 s73, s73, s33
    v_cvt_pk_bf16_f32 v45, v170, v171
    v_mfma_f32_16x16x32_bf16 v[112:115], v[72:75], v[140:143], v[112:115]
    v_exp_f32 v173, v109
    v_mfma_f32_16x16x32_bf16 v[120:123], v[72:75], v[156:159], v[120:123]
    v_exp_f32 v174, v110
    v_mfma_f32_16x16x32_bf16 v[116:119], v[76:79], v[140:143], v[116:119]
    v_cvt_pk_bf16_f32 v46, v172, v173
    v_or3_b32 v186, v186, v45, v46
    v_mfma_f32_16x16x32_bf16 v[124:127], v[76:79], v[156:159], v[124:127]
    v_exp_f32 v175, v111
    v_mfma_f32_16x16x32_bf16 a[172:175], a[244:247], v[28:31], a[172:175]
    s_lshr_b32 s32, s32, 1
    v_cvt_pk_bf16_f32 v47, v174, v175
    v_bitop3_b32 v186, v186, v47, s77 bitop3:0xa8
    v_mfma_f32_16x16x32_bf16 a[180:183], a[244:247], v[32:35], a[180:183]
    ds_read_b64_tr_b16 v[64:65], v2 offset:25344
    v_cmp_ne_u32 vcc, 0, v186
    v_mfma_f32_16x16x32_bf16 a[188:191], a[244:247], v[36:39], a[188:191]
    ds_read_b64_tr_b16 v[66:67], v2 offset:25856
    v_mfma_f32_16x16x32_bf16 a[192:195], a[248:251], v[16:19], a[192:195]
    ds_read_b64_tr_b16 v[68:69], v2 offset:25376
    v_mfma_f32_16x16x32_bf16 a[200:203], a[248:251], v[20:23], a[200:203]
    ds_read_b64_tr_b16 v[70:71], v2 offset:25888
    v_mfma_f32_16x16x32_bf16 a[208:211], a[248:251], v[24:27], a[208:211]
    s_mul_i32 s32, s32, 81920
    ds_read_b64_tr_b16 v[72:73], v2 offset:25408
    v_mfma_f32_16x16x32_bf16 a[216:219], a[248:251], v[28:31], a[216:219]
    ds_read_b64_tr_b16 v[74:75], v2 offset:25920
    v_mfma_f32_16x16x32_bf16 a[224:227], a[248:251], v[32:35], a[224:227]
    ds_read_b64_tr_b16 v[76:77], v2 offset:25440
    v_mfma_f32_16x16x32_bf16 a[232:235], a[248:251], v[36:39], a[232:235]
    ds_read_b64_tr_b16 v[78:79], v2 offset:25952
    v_mfma_f32_16x16x32_bf16 a[196:199], a[240:243], v[16:19], a[196:199]
    v_mfma_f32_16x16x32_bf16 a[204:207], a[240:243], v[20:23], a[204:207]
    s_add_u32 s73, s73, s32
    v_mfma_f32_16x16x32_bf16 a[212:215], a[240:243], v[24:27], a[212:215]
    v_mfma_f32_16x16x32_bf16 a[220:223], a[240:243], v[28:31], a[220:223]
    v_mfma_f32_16x16x32_bf16 a[228:231], a[240:243], v[32:35], a[228:231]
    v_mfma_f32_16x16x32_bf16 a[236:239], a[240:243], v[36:39], a[236:239]
    s_cbranch_vccnz L_rs_b8
L_rr_b8:
    v_mfma_f32_16x16x32_bf16 v[8:11], a[252:255], v[40:43], v[8:11]
    s_waitcnt lgkmcnt(8)
    v_exp_f32 v160, v112
    v_mfma_f32_16x16x32_bf16 v[208:211], v[80:83], v[40:43], v[208:211]
    v_exp_f32 v161, v113
    v_mfma_f32_16x16x32_bf16 v[212:215], v[84:87], v[40:43], v[212:215]
    v_exp_f32 v162, v114
    v_mfma_f32_16x16x32_bf16 v[216:219], v[88:91], v[40:43], v[216:219]
    v_exp_f32 v163, v115
    v_mfma_f32_16x16x32_bf16 v[220:223], v[92:95], v[40:43], v[220:223]
    s_waitcnt lgkmcnt(0)
    v_exp_f32 v164, v116
    v_mfma_f32_16x16x32_bf16 v[192:195], v[64:67], v[40:43], v[192:195]
    v_exp_f32 v165, v117
    v_mfma_f32_16x16x32_bf16 v[196:199], v[68:71], v[40:43], v[196:199]
    v_exp_f32 v166, v118
    v_mfma_f32_16x16x32_bf16 v[200:203], v[72:75], v[40:43], v[200:203]
    v_exp_f32 v167, v119
    v_mfma_f32_16x16x32_bf16 v[204:207], v[76:79], v[40:43], v[204:207]
    s_waitcnt lgkmcnt(0)
    s_barrier
    v_mfma_f32_16x16x32_bf16 v[12:15], a[252:255], v[44:47], v[12:15]
    s_add_u32 s73, s73, s35
    ds_read_b128 v[48:51], v1 offset:33792
    ds_read_b128 v[52:55], v1 offset:34304
    v_cvt_pk_bf16_f32 v40, v160, v161
    v_mfma_f32_16x16x32_bf16 v[224:227], v[64:67], v[44:47], v[224:227]
    ds_read_b128 v[56:59], v1 offset:33856
    ds_read_b128 v[60:63], v1 offset:34368
    v_cvt_pk_bf16_f32 v41, v162, v163
    v_mfma_f32_16x16x32_bf16 v[228:231], v[68:71], v[44:47], v[228:231]
    ds_read_b128 v[16:19], v4 offset:2048
    ds_read_b64_tr_b16 a[240:241], v3 offset:0
    v_cvt_pk_bf16_f32 v42, v164, v165
    v_mfma_f32_16x16x32_bf16 v[232:235], v[72:75], v[44:47], v[232:235]
    ds_read_b64_tr_b16 a[242:243], v3 offset:512
    ds_read_b128 v[20:23], v4 offset:6144
    v_or3_b32 v186, v40, v41, v42
    v_mfma_f32_16x16x32_bf16 v[236:239], v[76:79], v[44:47], v[236:239]
    ds_read_b128 v[24:27], v4 offset:10240
    ds_read_b128 v[28:31], v4 offset:14336
    v_cvt_pk_bf16_f32 v43, v166, v167
    v_mfma_f32_16x16x32_bf16 v[240:243], v[80:83], v[44:47], v[240:243]
    s_add_u32 s32, s4, 8
    ds_read_b128 v[32:35], v4 offset:18432
    ds_read_b128 v[36:39], v4 offset:22528
    v_mfma_f32_16x16x32_bf16 v[244:247], v[84:87], v[44:47], v[244:247]
    ds_read_b64_tr_b16 a[244:245], v3 offset:32
    ds_read_b64_tr_b16 a[246:247], v3 offset:544
    v_mfma_f32_16x16x32_bf16 v[248:251], v[88:91], v[44:47], v[248:251]
    ds_read_b128 v[64:67], v1 offset:33920
    ds_read_b128 v[68:71], v1 offset:34432
    v_mfma_f32_16x16x32_bf16 v[252:255], v[92:95], v[44:47], v[252:255]
    s_waitcnt lgkmcnt(14)
    ds_read_b128 v[72:75], v1 offset:33984
    ds_read_b128 v[76:79], v1 offset:34496
    v_mfma_f32_16x16x32_bf16 v[96:99], v[48:51], v[128:131], v[176:179]
    ds_read_b64_tr_b16 a[248:249], v3 offset:8448
    ds_read_b64_tr_b16 a[250:251], v3 offset:8960
    v_mfma_f32_16x16x32_bf16 v[104:107], v[48:51], v[144:147], v[180:183]
    s_mul_i32 s33, s32, 43
    ds_read_b64_tr_b16 v[80:81], v2 offset:42368
    v_mfma_f32_16x16x32_bf16 v[100:103], v[52:55], v[128:131], v[176:179]
    ds_read_b64_tr_b16 v[82:83], v2 offset:42880
    v_mfma_f32_16x16x32_bf16 v[108:111], v[52:55], v[144:147], v[180:183]
    s_waitcnt lgkmcnt(15)
    ds_read_b64_tr_b16 v[84:85], v2 offset:42400
    v_mfma_f32_16x16x32_bf16 v[96:99], v[56:59], v[132:135], v[96:99]
    ds_read_b64_tr_b16 v[86:87], v2 offset:42912
    v_mfma_f32_16x16x32_bf16 v[104:107], v[56:59], v[148:151], v[104:107]
    ds_read_b64_tr_b16 v[88:89], v2 offset:42432
    v_mfma_f32_16x16x32_bf16 v[100:103], v[60:63], v[132:135], v[100:103]
    s_lshr_b32 s33, s33, 8
    ds_read_b64_tr_b16 v[90:91], v2 offset:42944
    v_mfma_f32_16x16x32_bf16 v[108:111], v[60:63], v[148:151], v[108:111]
    s_waitcnt lgkmcnt(8)
    ds_read_b64_tr_b16 v[92:93], v2 offset:42464
    v_mfma_f32_16x16x32_bf16 v[96:99], v[64:67], v[136:139], v[96:99]
    ds_read_b64_tr_b16 v[94:95], v2 offset:42976
    v_mfma_f32_16x16x32_bf16 v[104:107], v[64:67], v[152:155], v[104:107]
    v_exp_f32 v168, v120
    v_mfma_f32_16x16x32_bf16 v[100:103], v[68:71], v[136:139], v[100:103]
    v_exp_f32 v169, v121
    v_mfma_f32_16x16x32_bf16 v[108:111], v[68:71], v[152:155], v[108:111]
    s_lshl_b32 s74, s33, 8
    v_exp_f32 v170, v122
    v_mfma_f32_16x16x32_bf16 v[96:99], v[72:75], v[140:143], v[96:99]
    v_cvt_pk_bf16_f32 v44, v168, v169
    v_or3_b32 v186, v186, v43, v44
    v_mfma_f32_16x16x32_bf16 v[104:107], v[72:75], v[156:159], v[104:107]
    v_exp_f32 v171, v123
    v_mfma_f32_16x16x32_bf16 v[100:103], v[76:79], v[140:143], v[100:103]
    v_exp_f32 v172, v124
    v_mfma_f32_16x16x32_bf16 v[108:111], v[76:79], v[156:159], v[108:111]
    s_waitcnt lgkmcnt(8)
    v_cvt_pk_bf16_f32 v45, v170, v171
    v_mfma_f32_16x16x32_bf16 a[0:3], a[240:243], v[16:19], a[0:3]
    s_mul_i32 s33, s33, 6
    v_exp_f32 v173, v125
    v_mfma_f32_16x16x32_bf16 a[8:11], a[240:243], v[20:23], a[8:11]
    ds_read_b64_tr_b16 v[64:65], v2 offset:42240
    v_mfma_f32_16x16x32_bf16 a[16:19], a[240:243], v[24:27], a[16:19]
    ds_read_b64_tr_b16 v[66:67], v2 offset:42752
    v_mfma_f32_16x16x32_bf16 a[24:27], a[240:243], v[28:31], a[24:27]
    ds_read_b64_tr_b16 v[68:69], v2 offset:42272
    v_mfma_f32_16x16x32_bf16 a[32:35], a[240:243], v[32:35], a[32:35]
    ds_read_b64_tr_b16 v[70:71], v2 offset:42784
    v_mfma_f32_16x16x32_bf16 a[40:43], a[240:243], v[36:39], a[40:43]
    s_sub_u32 s32, s32, s33
    ds_read_b64_tr_b16 v[72:73], v2 offset:42304
    v_mfma_f32_16x16x32_bf16 a[4:7], a[244:247], v[16:19], a[4:7]
    ds_read_b64_tr_b16 v[74:75], v2 offset:42816
    v_mfma_f32_16x16x32_bf16 a[12:15], a[244:247], v[20:23], a[12:15]
    ds_read_b64_tr_b16 v[76:77], v2 offset:42336
    v_mfma_f32_16x16x32_bf16 a[20:23], a[244:247], v[24:27], a[20:23]
    ds_read_b64_tr_b16 v[78:79], v2 offset:42848
    v_mfma_f32_16x16x32_bf16 a[28:31], a[244:247], v[28:31], a[28:31]
    v_exp_f32 v174, v126
    v_mfma_f32_16x16x32_bf16 a[36:39], a[244:247], v[32:35], a[36:39]
    s_and_b32 s33, s32, 1
    v_cvt_pk_bf16_f32 v46, v172, v173
    v_or3_b32 v186, v186, v45, v46
    v_mfma_f32_16x16x32_bf16 a[44:47], a[244:247], v[36:39], a[44:47]
    v_exp_f32 v175, v127
    v_mfma_f32_16x16x32_bf16 a[48:51], a[248:251], v[16:19], a[48:51]
    v_cvt_pk_bf16_f32 v47, v174, v175
    v_bitop3_b32 v186, v186, v47, s77 bitop3:0xa8
    v_mfma_f32_16x16x32_bf16 a[56:59], a[248:251], v[20:23], a[56:59]
    v_cmp_ne_u32 vcc, 0, v186
    v_mfma_f32_16x16x32_bf16 a[64:67], a[248:251], v[24:27], a[64:67]
    s_cbranch_vccnz L_rs_b9
L_rr_b9:
    v_mfma_f32_16x16x32_bf16 v[8:11], a[252:255], v[40:43], v[8:11]
    s_waitcnt lgkmcnt(8)
    v_exp_f32 v160, v96
    v_mfma_f32_16x16x32_bf16 v[208:211], v[80:83], v[40:43], v[208:211]
    v_exp_f32 v161, v97
    v_mfma_f32_16x16x32_bf16 v[212:215], v[84:87], v[40:43], v[212:215]
    v_exp_f32 v162, v98
    v_mfma_f32_16x16x32_bf16 v[216:219], v[88:91], v[40:43], v[216:219]
    v_exp_f32 v163, v99
    v_mfma_f32_16x16x32_bf16 v[220:223], v[92:95], v[40:43], v[220:223]
    s_waitcnt lgkmcnt(0)
    v_exp_f32 v164, v100
    v_mfma_f32_16x16x32_bf16 v[192:195], v[64:67], v[40:43], v[192:195]
    v_exp_f32 v165, v101
    v_mfma_f32_16x16x32_bf16 v[196:199], v[68:71], v[40:43], v[196:199]
    v_exp_f32 v166, v102
    v_mfma_f32_16x16x32_bf16 v[200:203], v[72:75], v[40:43], v[200:203]
    v_exp_f32 v167, v103
    v_mfma_f32_16x16x32_bf16 v[204:207], v[76:79], v[40:43], v[204:207]
    s_waitcnt lgkmcnt(0)
    s_barrier
    v_mfma_f32_16x16x32_bf16 v[12:15], a[252:255], v[44:47], v[12:15]
    s_mul_i32 s33, s33, 5120
    ds_read_b128 v[48:51], v1 offset:50688
    ds_read_b128 v[52:55], v1 offset:51200
    v_cvt_pk_bf16_f32 v40, v160, v161
    v_mfma_f32_16x16x32_bf16 v[224:227], v[64:67], v[44:47], v[224:227]
    ds_read_b128 v[56:59], v1 offset:50752
    ds_read_b128 v[60:63], v1 offset:51264
    v_cvt_pk_bf16_f32 v41, v162, v163
    v_mfma_f32_16x16x32_bf16 v[228:231], v[68:71], v[44:47], v[228:231]
    ds_read_b64_tr_b16 a[240:241], v3 offset:8480
    ds_read_b64_tr_b16 a[242:243], v3 offset:8992
    v_cvt_pk_bf16_f32 v42, v164, v165
    v_mfma_f32_16x16x32_bf16 v[232:235], v[72:75], v[44:47], v[232:235]
    ds_read_b64_tr_b16 a[244:245], v3 offset:16896
    ds_read_b64_tr_b16 a[246:247], v3 offset:17408
    v_or3_b32 v186, v40, v41, v42
    v_mfma_f32_16x16x32_bf16 v[236:239], v[76:79], v[44:47], v[236:239]
    v_cvt_pk_bf16_f32 v43, v166, v167
    v_mfma_f32_16x16x32_bf16 v[240:243], v[80:83], v[44:47], v[240:243]
    s_add_u32 s74, s74, s33
    v_exp_f32 v168, v104
    v_mfma_f32_16x16x32_bf16 v[244:247], v[84:87], v[44:47], v[244:247]
    v_exp_f32 v169, v105
    v_mfma_f32_16x16x32_bf16 v[248:251], v[88:91], v[44:47], v[248:251]
    ds_read_b128 v[64:67], v1 offset:50816
    ds_read_b128 v[68:71], v1 offset:51328
    v_mfma_f32_16x16x32_bf16 v[252:255], v[92:95], v[44:47], v[252:255]
    s_waitcnt lgkmcnt(8)
    ds_read_b128 v[72:75], v1 offset:50880
    ds_read_b128 v[76:79], v1 offset:51392
    v_mfma_f32_16x16x32_bf16 v[112:115], v[48:51], v[128:131], v[176:179]
    v_exp_f32 v170, v106
    v_mfma_f32_16x16x32_bf16 v[120:123], v[48:51], v[144:147], v[180:183]
    s_lshr_b32 s32, s32, 1
    ds_read_b64_tr_b16 v[80:81], v2 offset:59264
    v_cvt_pk_bf16_f32 v44, v168, v169
    v_mfma_f32_16x16x32_bf16 v[116:119], v[52:55], v[128:131], v[176:179]
    ds_read_b64_tr_b16 v[82:83], v2 offset:59776
    v_or3_b32 v186, v186, v43, v44
    v_mfma_f32_16x16x32_bf16 v[124:127], v[52:55], v[144:147], v[180:183]
    s_waitcnt lgkmcnt(10)
    ds_read_b64_tr_b16 v[84:85], v2 offset:59296
    v_mfma_f32_16x16x32_bf16 v[112:115], v[56:59], v[132:135], v[112:115]
    ds_read_b64_tr_b16 v[86:87], v2 offset:59808
    v_mfma_f32_16x16x32_bf16 v[120:123], v[56:59], v[148:151], v[120:123]
    ds_read_b64_tr_b16 v[88:89], v2 offset:59328
    v_mfma_f32_16x16x32_bf16 v[116:119], v[60:63], v[132:135], v[116:119]
    s_mul_i32 s32, s32, 81920
    ds_read_b64_tr_b16 v[90:91], v2 offset:59840
    v_mfma_f32_16x16x32_bf16 v[124:127], v[60:63], v[148:151], v[124:127]
    s_waitcnt lgkmcnt(6)
    ds_read_b64_tr_b16 v[92:93], v2 offset:59360
    v_mfma_f32_16x16x32_bf16 v[112:115], v[64:67], v[136:139], v[112:115]
    ds_read_b64_tr_b16 v[94:95], v2 offset:59872
    v_mfma_f32_16x16x32_bf16 v[120:123], v[64:67], v[152:155], v[120:123]
    v_exp_f32 v171, v107
    v_mfma_f32_16x16x32_bf16 v[116:119], v[68:71], v[136:139], v[116:119]
    v_exp_f32 v172, v108
    v_mfma_f32_16x16x32_bf16 v[124:127], v[68:71], v[152:155], v[124:127]
    s_add_u32 s74, s74, s32
    v_cvt_pk_bf16_f32 v45, v170, v171
    v_mfma_f32_16x16x32_bf16 v[112:115], v[72:75], v[140:143], v[112:115]
    v_exp_f32 v173, v109
    v_mfma_f32_16x16x32_bf16 v[120:123], v[72:75], v[156:159], v[120:123]
    v_exp_f32 v174, v110
    v_mfma_f32_16x16x32_bf16 v[116:119], v[76:79], v[140:143], v[116:119]
    v_cvt_pk_bf16_f32 v46, v172, v173
    v_or3_b32 v186, v186, v45, v46
    v_mfma_f32_16x16x32_bf16 v[124:127], v[76:79], v[156:159], v[124:127]
    v_exp_f32 v175, v111
    v_mfma_f32_16x16x32_bf16 a[72:75], a[248:251], v[28:31], a[72:75]
    s_add_u32 s74, s74, s35
    v_cvt_pk_bf16_f32 v47, v174, v175
    v_bitop3_b32 v186, v186, v47, s77 bitop3:0xa8
    v_mfma_f32_16x16x32_bf16 a[80:83], a[248:251], v[32:35], a[80:83]
    ds_read_b64_tr_b16 v[64:65], v2 offset:59136
    v_cmp_ne_u32 vcc, 0, v186
    v_mfma_f32_16x16x32_bf16 a[88:91], a[248:251], v[36:39], a[88:91]
    ds_read_b64_tr_b16 v[66:67], v2 offset:59648
    v_mfma_f32_16x16x32_bf16 a[52:55], a[240:243], v[16:19], a[52:55]
    ds_read_b64_tr_b16 v[68:69], v2 offset:59168
    v_mfma_f32_16x16x32_bf16 a[60:63], a[240:243], v[20:23], a[60:63]
    ds_read_b64_tr_b16 v[70:71], v2 offset:59680
    v_mfma_f32_16x16x32_bf16 a[68:71], a[240:243], v[24:27], a[68:71]
    s_add_u32 s32, s4, 16
    ds_read_b64_tr_b16 v[72:73], v2 offset:59200
    v_mfma_f32_16x16x32_bf16 a[76:79], a[240:243], v[28:31], a[76:79]
    ds_read_b64_tr_b16 v[74:75], v2 offset:59712
    v_mfma_f32_16x16x32_bf16 a[84:87], a[240:243], v[32:35], a[84:87]
    ds_read_b64_tr_b16 v[76:77], v2 offset:59232
    v_mfma_f32_16x16x32_bf16 a[92:95], a[240:243], v[36:39], a[92:95]
    ds_read_b64_tr_b16 v[78:79], v2 offset:59744
    v_mfma_f32_16x16x32_bf16 a[96:99], a[244:247], v[16:19], a[96:99]
    v_mfma_f32_16x16x32_bf16 a[104:107], a[244:247], v[20:23], a[104:107]
    s_mul_i32 s33, s32, 43
    v_mfma_f32_16x16x32_bf16 a[112:115], a[244:247], v[24:27], a[112:115]
    v_mfma_f32_16x16x32_bf16 a[120:123], a[244:247], v[28:31], a[120:123]
    v_mfma_f32_16x16x32_bf16 a[128:131], a[244:247], v[32:35], a[128:131]
    v_mfma_f32_16x16x32_bf16 a[136:139], a[244:247], v[36:39], a[136:139]
    s_cbranch_vccnz L_rs_b10
L_rr_b10:
    v_mfma_f32_16x16x32_bf16 v[8:11], a[252:255], v[40:43], v[8:11]
    s_waitcnt lgkmcnt(8)
    v_exp_f32 v160, v112
    v_mfma_f32_16x16x32_bf16 v[208:211], v[80:83], v[40:43], v[208:211]
    v_exp_f32 v161, v113
    v_mfma_f32_16x16x32_bf16 v[212:215], v[84:87], v[40:43], v[212:215]
    v_exp_f32 v162, v114
    v_mfma_f32_16x16x32_bf16 v[216:219], v[88:91], v[40:43], v[216:219]
    v_exp_f32 v163, v115
    v_mfma_f32_16x16x32_bf16 v[220:223], v[92:95], v[40:43], v[220:223]
    s_waitcnt lgkmcnt(0)
    v_exp_f32 v164, v116
    v_mfma_f32_16x16x32_bf16 v[192:195], v[64:67], v[40:43], v[192:195]
    v_exp_f32 v165, v117
    v_mfma_f32_16x16x32_bf16 v[196:199], v[68:71], v[40:43], v[196:199]
    v_exp_f32 v166, v118
    v_mfma_f32_16x16x32_bf16 v[200:203], v[72:75], v[40:43], v[200:203]
    v_exp_f32 v167, v119
    v_mfma_f32_16x16x32_bf16 v[204:207], v[76:79], v[40:43], v[204:207]
    s_waitcnt lgkmcnt(0)
    s_barrier
    v_mfma_f32_16x16x32_bf16 v[12:15], a[252:255], v[44:47], v[12:15]
    s_lshr_b32 s33, s33, 8
    ds_read_b128 v[48:51], v1 offset:0
    ds_read_b128 v[52:55], v1 offset:512
    v_cvt_pk_bf16_f32 v40, v160, v161
    v_mfma_f32_16x16x32_bf16 v[224:227], v[64:67], v[44:47], v[224:227]
    ds_read_b128 v[56:59], v1 offset:64
    ds_read_b128 v[60:63], v1 offset:576
    v_cvt_pk_bf16_f32 v41, v162, v163
    v_mfma_f32_16x16x32_bf16 v[228:231], v[68:71], v[44:47], v[228:231]
    ds_read_b64_tr_b16 a[248:249], v3 offset:16928
    ds_read_b64_tr_b16 a[250:251], v3 offset:17440
    v_cvt_pk_bf16_f32 v42, v164, v165
    v_mfma_f32_16x16x32_bf16 v[232:235], v[72:75], v[44:47], v[232:235]
    ds_read_b64_tr_b16 a[240:241], v3 offset:25344
    ds_read_b64_tr_b16 a[242:243], v3 offset:25856
    v_or3_b32 v186, v40, v41, v42
    v_mfma_f32_16x16x32_bf16 v[236:239], v[76:79], v[44:47], v[236:239]
    ds_read_b64_tr_b16 a[244:245], v3 offset:25376
    ds_read_b64_tr_b16 a[246:247], v3 offset:25888
    v_cvt_pk_bf16_f32 v43, v166, v167
    v_mfma_f32_16x16x32_bf16 v[240:243], v[80:83], v[44:47], v[240:243]
    s_lshl_b32 s7, s33, 8
    v_exp_f32 v168, v120
    v_mfma_f32_16x16x32_bf16 v[244:247], v[84:87], v[44:47], v[244:247]
    v_exp_f32 v169, v121
    v_mfma_f32_16x16x32_bf16 v[248:251], v[88:91], v[44:47], v[248:251]
    ds_read_b128 v[64:67], v1 offset:128
    ds_read_b128 v[68:71], v1 offset:640
    v_mfma_f32_16x16x32_bf16 v[252:255], v[92:95], v[44:47], v[252:255]
    s_waitcnt lgkmcnt(10)
    ds_read_b128 v[72:75], v1 offset:192
    ds_read_b128 v[76:79], v1 offset:704
    v_mfma_f32_16x16x32_bf16 v[96:99], v[48:51], v[128:131], v[176:179]
    v_exp_f32 v170, v122
    v_mfma_f32_16x16x32_bf16 v[104:107], v[48:51], v[144:147], v[180:183]
    s_mul_i32 s33, s33, 6
    ds_read_b64_tr_b16 v[80:81], v2 offset:8576
    v_cvt_pk_bf16_f32 v44, v168, v169
    v_mfma_f32_16x16x32_bf16 v[100:103], v[52:55], v[128:131], v[176:179]
    ds_read_b64_tr_b16 v[82:83], v2 offset:9088
    v_or3_b32 v186, v186, v43, v44
    v_mfma_f32_16x16x32_bf16 v[108:111], v[52:55], v[144:147], v[180:183]
    s_waitcnt lgkmcnt(12)
    ds_read_b64_tr_b16 v[84:85], v2 offset:8608
    v_mfma_f32_16x16x32_bf16 v[96:99], v[56:59], v[132:135], v[96:99]
    ds_read_b64_tr_b16 v[86:87], v2 offset:9120
    v_mfma_f32_16x16x32_bf16 v[104:107], v[56:59], v[148:151], v[104:107]
    ds_read_b64_tr_b16 v[88:89], v2 offset:8640
    v_mfma_f32_16x16x32_bf16 v[100:103], v[60:63], v[132:135], v[100:103]
    s_sub_u32 s32, s32, s33
    ds_read_b64_tr_b16 v[90:91], v2 offset:9152
    v_mfma_f32_16x16x32_bf16 v[108:111], v[60:63], v[148:151], v[108:111]
    s_waitcnt lgkmcnt(6)
    ds_read_b64_tr_b16 v[92:93], v2 offset:8672
    v_mfma_f32_16x16x32_bf16 v[96:99], v[64:67], v[136:139], v[96:99]
    ds_read_b64_tr_b16 v[94:95], v2 offset:9184
    v_mfma_f32_16x16x32_bf16 v[104:107], v[64:67], v[152:155], v[104:107]
    v_exp_f32 v171, v123
    v_mfma_f32_16x16x32_bf16 v[100:103], v[68:71], v[136:139], v[100:103]
    v_exp_f32 v172, v124
    v_mfma_f32_16x16x32_bf16 v[108:111], v[68:71], v[152:155], v[108:111]
    s_and_b32 s33, s32, 1
    v_cvt_pk_bf16_f32 v45, v170, v171
    v_mfma_f32_16x16x32_bf16 v[96:99], v[72:75], v[140:143], v[96:99]
    v_exp_f32 v173, v125
    v_mfma_f32_16x16x32_bf16 v[104:107], v[72:75], v[156:159], v[104:107]
    v_exp_f32 v174, v126
    v_mfma_f32_16x16x32_bf16 v[100:103], v[76:79], v[140:143], v[100:103]
    v_cvt_pk_bf16_f32 v46, v172, v173
    v_or3_b32 v186, v186, v45, v46
    v_mfma_f32_16x16x32_bf16 v[108:111], v[76:79], v[156:159], v[108:111]
    v_exp_f32 v175, v127
    v_mfma_f32_16x16x32_bf16 a[100:103], a[248:251], v[16:19], a[100:103]
    s_mul_i32 s33, s33, 5120
    v_cvt_pk_bf16_f32 v47, v174, v175
    v_bitop3_b32 v186, v186, v47, s77 bitop3:0xa8
    v_mfma_f32_16x16x32_bf16 a[108:111], a[248:251], v[20:23], a[108:111]
    ds_read_b64_tr_b16 v[64:65], v2 offset:8448
    v_cmp_ne_u32 vcc, 0, v186
    v_mfma_f32_16x16x32_bf16 a[116:119], a[248:251], v[24:27], a[116:119]
    ds_read_b64_tr_b16 v[66:67], v2 offset:8960
    v_mfma_f32_16x16x32_bf16 a[124:127], a[248:251], v[28:31], a[124:127]
    ds_read_b64_tr_b16 v[68:69], v2 offset:8480
    v_mfma_f32_16x16x32_bf16 a[132:135], a[248:251], v[32:35], a[132:135]
    ds_read_b64_tr_b16 v[70:71], v2 offset:8992
    v_mfma_f32_16x16x32_bf16 a[140:143], a[248:251], v[36:39], a[140:143]
    s_add_u32 s7, s7, s33
    ds_read_b64_tr_b16 v[72:73], v2 offset:8512
    v_mfma_f32_16x16x32_bf16 a[144:147], a[240:243], v[16:19], a[144:147]
    ds_read_b64_tr_b16 v[74:75], v2 offset:9024
    v_mfma_f32_16x16x32_bf16 a[152:155], a[240:243], v[20:23], a[152:155]
    ds_read_b64_tr_b16 v[76:77], v2 offset:8544
    v_mfma_f32_16x16x32_bf16 a[160:163], a[240:243], v[24:27], a[160:163]
    ds_read_b64_tr_b16 v[78:79], v2 offset:9056
    v_mfma_f32_16x16x32_bf16 a[168:171], a[240:243], v[28:31], a[168:171]
    v_mfma_f32_16x16x32_bf16 a[176:179], a[240:243], v[32:35], a[176:179]
    s_lshr_b32 s32, s32, 1
    v_mfma_f32_16x16x32_bf16 a[184:187], a[240:243], v[36:39], a[184:187]
    v_mfma_f32_16x16x32_bf16 a[148:151], a[244:247], v[16:19], a[148:151]
    v_mfma_f32_16x16x32_bf16 a[156:159], a[244:247], v[20:23], a[156:159]
    v_mfma_f32_16x16x32_bf16 a[164:167], a[244:247], v[24:27], a[164:167]
    s_cbranch_vccnz L_rs_b11
L_rr_b11:
    v_mfma_f32_16x16x32_bf16 v[8:11], a[252:255], v[40:43], v[8:11]
    s_waitcnt lgkmcnt(8)
    v_exp_f32 v160, v96
    v_mfma_f32_16x16x32_bf16 v[208:211], v[80:83], v[40:43], v[208:211]
    v_exp_f32 v161, v97
    v_mfma_f32_16x16x32_bf16 v[212:215], v[84:87], v[40:43], v[212:215]
    v_exp_f32 v162, v98
    v_mfma_f32_16x16x32_bf16 v[216:219], v[88:91], v[40:43], v[216:219]
    v_exp_f32 v163, v99
    v_mfma_f32_16x16x32_bf16 v[220:223], v[92:95], v[40:43], v[220:223]
    s_waitcnt lgkmcnt(0)
    v_exp_f32 v164, v100
    v_mfma_f32_16x16x32_bf16 v[192:195], v[64:67], v[40:43], v[192:195]
    v_exp_f32 v165, v101
    v_mfma_f32_16x16x32_bf16 v[196:199], v[68:71], v[40:43], v[196:199]
    v_exp_f32 v166, v102
    v_mfma_f32_16x16x32_bf16 v[200:203], v[72:75], v[40:43], v[200:203]
    v_exp_f32 v167, v103
    v_mfma_f32_16x16x32_bf16 v[204:207], v[76:79], v[40:43], v[204:207]
    s_waitcnt lgkmcnt(0)
    s_barrier
    v_mfma_f32_16x16x32_bf16 v[12:15], a[252:255], v[44:47], v[12:15]
    s_mul_i32 s32, s32, 81920
    ds_read_b128 v[48:51], v1 offset:16896
    ds_read_b128 v[52:55], v1 offset:17408
    v_cvt_pk_bf16_f32 v40, v160, v161
    v_mfma_f32_16x16x32_bf16 v[224:227], v[64:67], v[44:47], v[224:227]
    ds_read_b128 v[56:59], v1 offset:16960
    ds_read_b128 v[60:63], v1 offset:17472
    v_cvt_pk_bf16_f32 v41, v162, v163
    v_mfma_f32_16x16x32_bf16 v[228:231], v[68:71], v[44:47], v[228:231]
    ds_read_b64_tr_b16 a[248:249], v3 offset:33792
    ds_read_b64_tr_b16 a[250:251], v3 offset:34304
    v_cvt_pk_bf16_f32 v42, v164, v165
    v_mfma_f32_16x16x32_bf16 v[232:235], v[72:75], v[44:47], v[232:235]
    ds_read_b64_tr_b16 a[240:241], v3 offset:33824
    ds_read_b64_tr_b16 a[242:243], v3 offset:34336
    v_or3_b32 v186, v40, v41, v42
    v_mfma_f32_16x16x32_bf16 v[236:239], v[76:79], v[44:47], v[236:239]
    v_cvt_pk_bf16_f32 v43, v166, v167
    v_mfma_f32_16x16x32_bf16 v[240:243], v[80:83], v[44:47], v[240:243]
    s_add_u32 s7, s7, s32
    v_exp_f32 v168, v104
    v_mfma_f32_16x16x32_bf16 v[244:247], v[84:87], v[44:47], v[244:247]
    v_exp_f32 v169, v105
    v_mfma_f32_16x16x32_bf16 v[248:251], v[88:91], v[44:47], v[248:251]
    ds_read_b128 v[64:67], v1 offset:17024
    ds_read_b128 v[68:71], v1 offset:17536
    v_mfma_f32_16x16x32_bf16 v[252:255], v[92:95], v[44:47], v[252:255]
    s_waitcnt lgkmcnt(8)
    ds_read_b128 v[72:75], v1 offset:17088
    ds_read_b128 v[76:79], v1 offset:17600
    v_mfma_f32_16x16x32_bf16 v[112:115], v[48:51], v[128:131], v[176:179]
    v_exp_f32 v170, v106
    v_mfma_f32_16x16x32_bf16 v[120:123], v[48:51], v[144:147], v[180:183]
    s_add_u32 s7, s7, s35
    ds_read_b64_tr_b16 v[80:81], v2 offset:25472
    v_cvt_pk_bf16_f32 v44, v168, v169
    v_mfma_f32_16x16x32_bf16 v[116:119], v[52:55], v[128:131], v[176:179]
    ds_read_b64_tr_b16 v[82:83], v2 offset:25984
    v_or3_b32 v186, v186, v43, v44
    v_mfma_f32_16x16x32_bf16 v[124:127], v[52:55], v[144:147], v[180:183]
    s_waitcnt lgkmcnt(10)
    ds_read_b64_tr_b16 v[84:85], v2 offset:25504
    v_mfma_f32_16x16x32_bf16 v[112:115], v[56:59], v[132:135], v[112:115]
    ds_read_b64_tr_b16 v[86:87], v2 offset:26016
    v_mfma_f32_16x16x32_bf16 v[120:123], v[56:59], v[148:151], v[120:123]
    ds_read_b64_tr_b16 v[88:89], v2 offset:25536
    v_mfma_f32_16x16x32_bf16 v[116:119], v[60:63], v[132:135], v[116:119]
    s_add_u32 s32, s4, 24
    ds_read_b64_tr_b16 v[90:91], v2 offset:26048
    v_mfma_f32_16x16x32_bf16 v[124:127], v[60:63], v[148:151], v[124:127]
    s_waitcnt lgkmcnt(6)
    ds_read_b64_tr_b16 v[92:93], v2 offset:25568
    v_mfma_f32_16x16x32_bf16 v[112:115], v[64:67], v[136:139], v[112:115]
    ds_read_b64_tr_b16 v[94:95], v2 offset:26080
    v_mfma_f32_16x16x32_bf16 v[120:123], v[64:67], v[152:155], v[120:123]
    v_exp_f32 v171, v107
    v_mfma_f32_16x16x32_bf16 v[116:119], v[68:71], v[136:139], v[116:119]
    v_exp_f32 v172, v108
    v_mfma_f32_16x16x32_bf16 v[124:127], v[68:71], v[152:155], v[124:127]
    s_mul_i32 s33, s32, 43
    v_cvt_pk_bf16_f32 v45, v170, v171
    v_mfma_f32_16x16x32_bf16 v[112:115], v[72:75], v[140:143], v[112:115]
    v_exp_f32 v173, v109
    v_mfma_f32_16x16x32_bf16 v[120:123], v[72:75], v[156:159], v[120:123]
    v_exp_f32 v174, v110
    v_mfma_f32_16x16x32_bf16 v[116:119], v[76:79], v[140:143], v[116:119]
    v_cvt_pk_bf16_f32 v46, v172, v173
    v_or3_b32 v186, v186, v45, v46
    v_mfma_f32_16x16x32_bf16 v[124:127], v[76:79], v[156:159], v[124:127]
    v_exp_f32 v175, v111
    v_mfma_f32_16x16x32_bf16 a[172:175], a[244:247], v[28:31], a[172:175]
    s_lshr_b32 s33, s33, 8
    v_cvt_pk_bf16_f32 v47, v174, v175
    v_bitop3_b32 v186, v186, v47, s77 bitop3:0xa8
    v_mfma_f32_16x16x32_bf16 a[180:183], a[244:247], v[32:35], a[180:183]
    ds_read_b64_tr_b16 v[64:65], v2 offset:25344
    v_cmp_ne_u32 vcc, 0, v186
    v_mfma_f32_16x16x32_bf16 a[188:191], a[244:247], v[36:39], a[188:191]
    ds_read_b64_tr_b16 v[66:67], v2 offset:25856
    v_mfma_f32_16x16x32_bf16 a[192:195], a[248:251], v[16:19], a[192:195]
    ds_read_b64_tr_b16 v[68:69], v2 offset:25376
    v_mfma_f32_16x16x32_bf16 a[200:203], a[248:251], v[20:23], a[200:203]
    ds_read_b64_tr_b16 v[70:71], v2 offset:25888
    v_mfma_f32_16x16x32_bf16 a[208:211], a[248:251], v[24:27], a[208:211]
    s_lshl_b32 s55, s33, 8
    ds_read_b64_tr_b16 v[72:73], v2 offset:25408
    v_mfma_f32_16x16x32_bf16 a[216:219], a[248:251], v[28:31], a[216:219]
    ds_read_b64_tr_b16 v[74:75], v2 offset:25920
    v_mfma_f32_16x16x32_bf16 a[224:227], a[248:251], v[32:35], a[224:227]
    ds_read_b64_tr_b16 v[76:77], v2 offset:25440
    v_mfma_f32_16x16x32_bf16 a[232:235], a[248:251], v[36:39], a[232:235]
    ds_read_b64_tr_b16 v[78:79], v2 offset:25952
    v_mfma_f32_16x16x32_bf16 a[196:199], a[240:243], v[16:19], a[196:199]
    v_mfma_f32_16x16x32_bf16 a[204:207], a[240:243], v[20:23], a[204:207]
    s_mul_i32 s33, s33, 6
    v_mfma_f32_16x16x32_bf16 a[212:215], a[240:243], v[24:27], a[212:215]
    v_mfma_f32_16x16x32_bf16 a[220:223], a[240:243], v[28:31], a[220:223]
    v_mfma_f32_16x16x32_bf16 a[228:231], a[240:243], v[32:35], a[228:231]
    v_mfma_f32_16x16x32_bf16 a[236:239], a[240:243], v[36:39], a[236:239]
    s_cbranch_vccnz L_rs_b12
L_rr_b12:
    v_mfma_f32_16x16x32_bf16 v[8:11], a[252:255], v[40:43], v[8:11]
    s_waitcnt lgkmcnt(8)
    v_exp_f32 v160, v112
    v_mfma_f32_16x16x32_bf16 v[208:211], v[80:83], v[40:43], v[208:211]
    v_exp_f32 v161, v113
    v_mfma_f32_16x16x32_bf16 v[212:215], v[84:87], v[40:43], v[212:215]
    v_exp_f32 v162, v114
    v_mfma_f32_16x16x32_bf16 v[216:219], v[88:91], v[40:43], v[216:219]
    v_exp_f32 v163, v115
    v_mfma_f32_16x16x32_bf16 v[220:223], v[92:95], v[40:43], v[220:223]
    s_waitcnt lgkmcnt(0)
    v_exp_f32 v164, v116
    v_mfma_f32_16x16x32_bf16 v[192:195], v[64:67], v[40:43], v[192:195]
    v_exp_f32 v165, v117
    v_mfma_f32_16x16x32_bf16 v[196:199], v[68:71], v[40:43], v[196:199]
    v_exp_f32 v166, v118
    v_mfma_f32_16x16x32_bf16 v[200:203], v[72:75], v[40:43], v[200:203]
    v_exp_f32 v167, v119
    v_mfma_f32_16x16x32_bf16 v[204:207], v[76:79], v[40:43], v[204:207]
    s_waitcnt lgkmcnt(0)
    s_barrier
    v_mfma_f32_16x16x32_bf16 v[12:15], a[252:255], v[44:47], v[12:15]
    s_sub_u32 s32, s32, s33
    ds_read_b128 v[48:51], v1 offset:33792
    ds_read_b128 v[52:55], v1 offset:34304
    v_cvt_pk_bf16_f32 v40, v160, v161
    v_mfma_f32_16x16x32_bf16 v[224:227], v[64:67], v[44:47], v[224:227]
    ds_read_b128 v[56:59], v1 offset:33856
    ds_read_b128 v[60:63], v1 offset:34368
    v_cvt_pk_bf16_f32 v41, v162, v163
    v_mfma_f32_16x16x32_bf16 v[228:231], v[68:71], v[44:47], v[228:231]
    ds_read_b128 v[16:19], v4 offset:3072
    ds_read_b64_tr_b16 a[240:241], v3 offset:0
    v_cvt_pk_bf16_f32 v42, v164, v165
    v_mfma_f32_16x16x32_bf16 v[232:235], v[72:75], v[44:47], v[232:235]
    ds_read_b64_tr_b16 a[242:243], v3 offset:512
    ds_read_b128 v[20:23], v4 offset:7168
    v_or3_b32 v186, v40, v41, v42
    v_mfma_f32_16x16x32_bf16 v[236:239], v[76:79], v[44:47], v[236:239]
    ds_read_b128 v[24:27], v4 offset:11264
    ds_read_b128 v[28:31], v4 offset:15360
    v_cvt_pk_bf16_f32 v43, v166, v167
    v_mfma_f32_16x16x32_bf16 v[240:243], v[80:83], v[44:47], v[240:243]
    s_and_b32 s33, s32, 1
    ds_read_b128 v[32:35], v4 offset:19456
    ds_read_b128 v[36:39], v4 offset:23552
    v_mfma_f32_16x16x32_bf16 v[244:247], v[84:87], v[44:47], v[244:247]
    ds_read_b64_tr_b16 a[244:245], v3 offset:32
    ds_read_b64_tr_b16 a[246:247], v3 offset:544
    v_mfma_f32_16x16x32_bf16 v[248:251], v[88:91], v[44:47], v[248:251]
    ds_read_b128 v[64:67], v1 offset:33920
    ds_read_b128 v[68:71], v1 offset:34432
    v_mfma_f32_16x16x32_bf16 v[252:255], v[92:95], v[44:47], v[252:255]
    s_waitcnt lgkmcnt(14)
    ds_read_b128 v[72:75], v1 offset:33984
    ds_read_b128 v[76:79], v1 offset:34496
    v_mfma_f32_16x16x32_bf16 v[96:99], v[48:51], v[128:131], v[176:179]
    ds_read_b64_tr_b16 a[248:249], v3 offset:8448
    ds_read_b64_tr_b16 a[250:251], v3 offset:8960
    v_mfma_f32_16x16x32_bf16 v[104:107], v[48:51], v[144:147], v[180:183]
    s_mul_i32 s33, s33, 5120
    ds_read_b64_tr_b16 v[80:81], v2 offset:42368
    v_mfma_f32_16x16x32_bf16 v[100:103], v[52:55], v[128:131], v[176:179]
    ds_read_b64_tr_b16 v[82:83], v2 offset:42880
    v_mfma_f32_16x16x32_bf16 v[108:111], v[52:55], v[144:147], v[180:183]
    s_waitcnt lgkmcnt(15)
    ds_read_b64_tr_b16 v[84:85], v2 offset:42400
    v_mfma_f32_16x16x32_bf16 v[96:99], v[56:59], v[132:135], v[96:99]
    ds_read_b64_tr_b16 v[86:87], v2 offset:42912
    v_mfma_f32_16x16x32_bf16 v[104:107], v[56:59], v[148:151], v[104:107]
    ds_read_b64_tr_b16 v[88:89], v2 offset:42432
    v_mfma_f32_16x16x32_bf16 v[100:103], v[60:63], v[132:135], v[100:103]
    s_add_u32 s55, s55, s33
    ds_read_b64_tr_b16 v[90:91], v2 offset:42944
    v_mfma_f32_16x16x32_bf16 v[108:111], v[60:63], v[148:151], v[108:111]
    s_waitcnt lgkmcnt(8)
    ds_read_b64_tr_b16 v[92:93], v2 offset:42464
    v_mfma_f32_16x16x32_bf16 v[96:99], v[64:67], v[136:139], v[96:99]
    ds_read_b64_tr_b16 v[94:95], v2 offset:42976
    v_mfma_f32_16x16x32_bf16 v[104:107], v[64:67], v[152:155], v[104:107]
    v_exp_f32 v168, v120
    v_mfma_f32_16x16x32_bf16 v[100:103], v[68:71], v[136:139], v[100:103]
    v_exp_f32 v169, v121
    v_mfma_f32_16x16x32_bf16 v[108:111], v[68:71], v[152:155], v[108:111]
    s_lshr_b32 s32, s32, 1
    v_exp_f32 v170, v122
    v_mfma_f32_16x16x32_bf16 v[96:99], v[72:75], v[140:143], v[96:99]
    v_cvt_pk_bf16_f32 v44, v168, v169
    v_or3_b32 v186, v186, v43, v44
    v_mfma_f32_16x16x32_bf16 v[104:107], v[72:75], v[156:159], v[104:107]
    v_exp_f32 v171, v123
    v_mfma_f32_16x16x32_bf16 v[100:103], v[76:79], v[140:143], v[100:103]
    v_exp_f32 v172, v124
    v_mfma_f32_16x16x32_bf16 v[108:111], v[76:79], v[156:159], v[108:111]
    s_waitcnt lgkmcnt(8)
    v_cvt_pk_bf16_f32 v45, v170, v171
    v_mfma_f32_16x16x32_bf16 a[0:3], a[240:243], v[16:19], a[0:3]
    s_mul_i32 s32, s32, 81920
    v_exp_f32 v173, v125
    v_mfma_f32_16x16x32_bf16 a[8:11], a[240:243], v[20:23], a[8:11]
    ds_read_b64_tr_b16 v[64:65], v2 offset:42240
    v_mfma_f32_16x16x32_bf16 a[16:19], a[240:243], v[24:27], a[16:19]
    ds_read_b64_tr_b16 v[66:67], v2 offset:42752
    v_mfma_f32_16x16x32_bf16 a[24:27], a[240:243], v[28:31], a[24:27]
    ds_read_b64_tr_b16 v[68:69], v2 offset:42272
    v_mfma_f32_16x16x32_bf16 a[32:35], a[240:243], v[32:35], a[32:35]
    ds_read_b64_tr_b16 v[70:71], v2 offset:42784
    v_mfma_f32_16x16x32_bf16 a[40:43], a[240:243], v[36:39], a[40:43]
    s_add_u32 s55, s55, s32
    ds_read_b64_tr_b16 v[72:73], v2 offset:42304
    v_mfma_f32_16x16x32_bf16 a[4:7], a[244:247], v[16:19], a[4:7]
    ds_read_b64_tr_b16 v[74:75], v2 offset:42816
    v_mfma_f32_16x16x32_bf16 a[12:15], a[244:247], v[20:23], a[12:15]
    ds_read_b64_tr_b16 v[76:77], v2 offset:42336
    v_mfma_f32_16x16x32_bf16 a[20:23], a[244:247], v[24:27], a[20:23]
    ds_read_b64_tr_b16 v[78:79], v2 offset:42848
    v_mfma_f32_16x16x32_bf16 a[28:31], a[244:247], v[28:31], a[28:31]
    v_exp_f32 v174, v126
    v_mfma_f32_16x16x32_bf16 a[36:39], a[244:247], v[32:35], a[36:39]
    s_add_u32 s55, s55, s35
    v_cvt_pk_bf16_f32 v46, v172, v173
    v_or3_b32 v186, v186, v45, v46
    v_mfma_f32_16x16x32_bf16 a[44:47], a[244:247], v[36:39], a[44:47]
    v_exp_f32 v175, v127
    v_mfma_f32_16x16x32_bf16 a[48:51], a[248:251], v[16:19], a[48:51]
    v_cvt_pk_bf16_f32 v47, v174, v175
    v_bitop3_b32 v186, v186, v47, s77 bitop3:0xa8
    v_mfma_f32_16x16x32_bf16 a[56:59], a[248:251], v[20:23], a[56:59]
    v_cmp_ne_u32 vcc, 0, v186
    v_mfma_f32_16x16x32_bf16 a[64:67], a[248:251], v[24:27], a[64:67]
    s_cbranch_vccnz L_rs_b13
L_rr_b13:
    v_mfma_f32_16x16x32_bf16 v[8:11], a[252:255], v[40:43], v[8:11]
    s_waitcnt lgkmcnt(8)
    v_exp_f32 v160, v96
    v_mfma_f32_16x16x32_bf16 v[208:211], v[80:83], v[40:43], v[208:211]
    v_exp_f32 v161, v97
    v_mfma_f32_16x16x32_bf16 v[212:215], v[84:87], v[40:43], v[212:215]
    v_exp_f32 v162, v98
    v_mfma_f32_16x16x32_bf16 v[216:219], v[88:91], v[40:43], v[216:219]
    v_exp_f32 v163, v99
    v_mfma_f32_16x16x32_bf16 v[220:223], v[92:95], v[40:43], v[220:223]
    s_waitcnt lgkmcnt(0)
    v_exp_f32 v164, v100
    v_mfma_f32_16x16x32_bf16 v[192:195], v[64:67], v[40:43], v[192:195]
    v_exp_f32 v165, v101
    v_mfma_f32_16x16x32_bf16 v[196:199], v[68:71], v[40:43], v[196:199]
    v_exp_f32 v166, v102
    v_mfma_f32_16x16x32_bf16 v[200:203], v[72:75], v[40:43], v[200:203]
    v_exp_f32 v167, v103
    v_mfma_f32_16x16x32_bf16 v[204:207], v[76:79], v[40:43], v[204:207]
    s_waitcnt lgkmcnt(0)
    s_barrier
    v_mfma_f32_16x16x32_bf16 v[12:15], a[252:255], v[44:47], v[12:15]
    ds_read_b128 v[48:51], v1 offset:50688
    ds_read_b128 v[52:55], v1 offset:51200
    v_cvt_pk_bf16_f32 v40, v160, v161
    v_mfma_f32_16x16x32_bf16 v[224:227], v[64:67], v[44:47], v[224:227]
    ds_read_b128 v[56:59], v1 offset:50752
    ds_read_b128 v[60:63], v1 offset:51264
    v_cvt_pk_bf16_f32 v41, v162, v163
    v_mfma_f32_16x16x32_bf16 v[228:231], v[68:71], v[44:47], v[228:231]
    ds_read_b64_tr_b16 a[240:241], v3 offset:8480
    ds_read_b64_tr_b16 a[242:243], v3 offset:8992
    v_cvt_pk_bf16_f32 v42, v164, v165
    v_mfma_f32_16x16x32_bf16 v[232:235], v[72:75], v[44:47], v[232:235]
    ds_read_b64_tr_b16 a[244:245], v3 offset:16896
    ds_read_b64_tr_b16 a[246:247], v3 offset:17408
    v_or3_b32 v186, v40, v41, v42
    v_mfma_f32_16x16x32_bf16 v[236:239], v[76:79], v[44:47], v[236:239]
    v_cvt_pk_bf16_f32 v43, v166, v167
    v_mfma_f32_16x16x32_bf16 v[240:243], v[80:83], v[44:47], v[240:243]
    v_exp_f32 v168, v104
    v_mfma_f32_16x16x32_bf16 v[244:247], v[84:87], v[44:47], v[244:247]
    v_exp_f32 v169, v105
    v_mfma_f32_16x16x32_bf16 v[248:251], v[88:91], v[44:47], v[248:251]
    ds_read_b128 v[64:67], v1 offset:50816
    ds_read_b128 v[68:71], v1 offset:51328
    v_mfma_f32_16x16x32_bf16 v[252:255], v[92:95], v[44:47], v[252:255]
    s_waitcnt lgkmcnt(8)
    ds_read_b128 v[72:75], v1 offset:50880
    ds_read_b128 v[76:79], v1 offset:51392
    v_mfma_f32_16x16x32_bf16 v[112:115], v[48:51], v[128:131], v[176:179]
    v_exp_f32 v170, v106
    v_mfma_f32_16x16x32_bf16 v[120:123], v[48:51], v[144:147], v[180:183]
    ds_read_b64_tr_b16 v[80:81], v2 offset:59264
    v_cvt_pk_bf16_f32 v44, v168, v169
    v_mfma_f32_16x16x32_bf16 v[116:119], v[52:55], v[128:131], v[176:179]
    ds_read_b64_tr_b16 v[82:83], v2 offset:59776
    v_or3_b32 v186, v186, v43, v44
    v_mfma_f32_16x16x32_bf16 v[124:127], v[52:55], v[144:147], v[180:183]
    s_waitcnt lgkmcnt(10)
    ds_read_b64_tr_b16 v[84:85], v2 offset:59296
    v_mfma_f32_16x16x32_bf16 v[112:115], v[56:59], v[132:135], v[112:115]
    ds_read_b64_tr_b16 v[86:87], v2 offset:59808
    v_mfma_f32_16x16x32_bf16 v[120:123], v[56:59], v[148:151], v[120:123]
    ds_read_b64_tr_b16 v[88:89], v2 offset:59328
    v_mfma_f32_16x16x32_bf16 v[116:119], v[60:63], v[132:135], v[116:119]
    ds_read_b64_tr_b16 v[90:91], v2 offset:59840
    v_mfma_f32_16x16x32_bf16 v[124:127], v[60:63], v[148:151], v[124:127]
    s_waitcnt lgkmcnt(6)
    ds_read_b64_tr_b16 v[92:93], v2 offset:59360
    v_mfma_f32_16x16x32_bf16 v[112:115], v[64:67], v[136:139], v[112:115]
    ds_read_b64_tr_b16 v[94:95], v2 offset:59872
    v_mfma_f32_16x16x32_bf16 v[120:123], v[64:67], v[152:155], v[120:123]
    v_exp_f32 v171, v107
    v_mfma_f32_16x16x32_bf16 v[116:119], v[68:71], v[136:139], v[116:119]
    v_exp_f32 v172, v108
    v_mfma_f32_16x16x32_bf16 v[124:127], v[68:71], v[152:155], v[124:127]
    v_cvt_pk_bf16_f32 v45, v170, v171
    v_mfma_f32_16x16x32_bf16 v[112:115], v[72:75], v[140:143], v[112:115]
    v_exp_f32 v173, v109
    v_mfma_f32_16x16x32_bf16 v[120:123], v[72:75], v[156:159], v[120:123]
    v_exp_f32 v174, v110
    v_mfma_f32_16x16x32_bf16 v[116:119], v[76:79], v[140:143], v[116:119]
    v_cvt_pk_bf16_f32 v46, v172, v173
    v_or3_b32 v186, v186, v45, v46
    v_mfma_f32_16x16x32_bf16 v[124:127], v[76:79], v[156:159], v[124:127]
    v_exp_f32 v175, v111
    v_mfma_f32_16x16x32_bf16 a[72:75], a[248:251], v[28:31], a[72:75]
    v_cvt_pk_bf16_f32 v47, v174, v175
    v_bitop3_b32 v186, v186, v47, s77 bitop3:0xa8
    v_mfma_f32_16x16x32_bf16 a[80:83], a[248:251], v[32:35], a[80:83]
    ds_read_b64_tr_b16 v[64:65], v2 offset:59136
    v_cmp_ne_u32 vcc, 0, v186
    v_mfma_f32_16x16x32_bf16 a[88:91], a[248:251], v[36:39], a[88:91]
    ds_read_b64_tr_b16 v[66:67], v2 offset:59648
    v_mfma_f32_16x16x32_bf16 a[52:55], a[240:243], v[16:19], a[52:55]
    ds_read_b64_tr_b16 v[68:69], v2 offset:59168
    v_mfma_f32_16x16x32_bf16 a[60:63], a[240:243], v[20:23], a[60:63]
    ds_read_b64_tr_b16 v[70:71], v2 offset:59680
    v_mfma_f32_16x16x32_bf16 a[68:71], a[240:243], v[24:27], a[68:71]
    ds_read_b64_tr_b16 v[72:73], v2 offset:59200
    v_mfma_f32_16x16x32_bf16 a[76:79], a[240:243], v[28:31], a[76:79]
    ds_read_b64_tr_b16 v[74:75], v2 offset:59712
    v_mfma_f32_16x16x32_bf16 a[84:87], a[240:243], v[32:35], a[84:87]
    ds_read_b64_tr_b16 v[76:77], v2 offset:59232
    v_mfma_f32_16x16x32_bf16 a[92:95], a[240:243], v[36:39], a[92:95]
    ds_read_b64_tr_b16 v[78:79], v2 offset:59744
    v_mfma_f32_16x16x32_bf16 a[96:99], a[244:247], v[16:19], a[96:99]
    ds_read_b128 v[128:131], v6 offset:0
    ds_read_b128 v[132:135], v6 offset:1024
    v_mfma_f32_16x16x32_bf16 a[104:107], a[244:247], v[20:23], a[104:107]
    ds_read_b128 v[136:139], v6 offset:2048
    ds_read_b128 v[140:143], v6 offset:3072
    v_mfma_f32_16x16x32_bf16 a[112:115], a[244:247], v[24:27], a[112:115]
    ds_read_b128 v[144:147], v6 offset:4096
    ds_read_b128 v[148:151], v6 offset:5120
    v_mfma_f32_16x16x32_bf16 a[120:123], a[244:247], v[28:31], a[120:123]
    ds_read_b128 v[152:155], v6 offset:6144
    ds_read_b128 v[156:159], v6 offset:7168
    v_mfma_f32_16x16x32_bf16 a[128:131], a[244:247], v[32:35], a[128:131]
    v_mfma_f32_16x16x32_bf16 a[136:139], a[244:247], v[36:39], a[136:139]
    s_cbranch_vccnz L_rs_b14
L_rr_b14:
    v_mfma_f32_16x16x32_bf16 v[8:11], a[252:255], v[40:43], v[8:11]
    s_waitcnt lgkmcnt(15)
    v_exp_f32 v160, v112
    v_mfma_f32_16x16x32_bf16 v[208:211], v[80:83], v[40:43], v[208:211]
    v_exp_f32 v161, v113
    v_mfma_f32_16x16x32_bf16 v[212:215], v[84:87], v[40:43], v[212:215]
    v_exp_f32 v162, v114
    v_mfma_f32_16x16x32_bf16 v[216:219], v[88:91], v[40:43], v[216:219]
    v_exp_f32 v163, v115
    v_mfma_f32_16x16x32_bf16 v[220:223], v[92:95], v[40:43], v[220:223]
    s_waitcnt lgkmcnt(8)
    v_exp_f32 v164, v116
    v_mfma_f32_16x16x32_bf16 v[192:195], v[64:67], v[40:43], v[192:195]
    v_exp_f32 v165, v117
    v_mfma_f32_16x16x32_bf16 v[196:199], v[68:71], v[40:43], v[196:199]
    v_exp_f32 v166, v118
    v_mfma_f32_16x16x32_bf16 v[200:203], v[72:75], v[40:43], v[200:203]
    v_exp_f32 v167, v119
    v_mfma_f32_16x16x32_bf16 v[204:207], v[76:79], v[40:43], v[204:207]
    s_waitcnt lgkmcnt(0)
    s_cmp_eq_u32 s80, 3
    s_cbranch_scc1 L_final
    s_barrier
    v_mfma_f32_16x16x32_bf16 v[12:15], a[252:255], v[44:47], v[12:15]
    ds_read_b128 v[48:51], v1 offset:0
    ds_read_b128 v[52:55], v1 offset:512
    v_cvt_pk_bf16_f32 v40, v160, v161
    v_mfma_f32_16x16x32_bf16 v[224:227], v[64:67], v[44:47], v[224:227]
    ds_read_b128 v[56:59], v1 offset:64
    ds_read_b128 v[60:63], v1 offset:576
    v_cvt_pk_bf16_f32 v41, v162, v163
    v_mfma_f32_16x16x32_bf16 v[228:231], v[68:71], v[44:47], v[228:231]
    ds_read_b64_tr_b16 a[248:249], v3 offset:16928
    ds_read_b64_tr_b16 a[250:251], v3 offset:17440
    v_cvt_pk_bf16_f32 v42, v164, v165
    v_mfma_f32_16x16x32_bf16 v[232:235], v[72:75], v[44:47], v[232:235]
    ds_read_b64_tr_b16 a[240:241], v3 offset:25344
    ds_read_b64_tr_b16 a[242:243], v3 offset:25856
    v_or3_b32 v186, v40, v41, v42
    v_mfma_f32_16x16x32_bf16 v[236:239], v[76:79], v[44:47], v[236:239]
    ds_read_b64_tr_b16 a[244:245], v3 offset:25376
    ds_read_b64_tr_b16 a[246:247], v3 offset:25888
    v_cvt_pk_bf16_f32 v43, v166, v167
    v_mfma_f32_16x16x32_bf16 v[240:243], v[80:83], v[44:47], v[240:243]
    v_exp_f32 v168, v120
    v_mfma_f32_16x16x32_bf16 v[244:247], v[84:87], v[44:47], v[244:247]
    v_exp_f32 v169, v121
    v_mfma_f32_16x16x32_bf16 v[248:251], v[88:91], v[44:47], v[248:251]
    ds_read_b128 v[64:67], v1 offset:128
    ds_read_b128 v[68:71], v1 offset:640
    v_mfma_f32_16x16x32_bf16 v[252:255], v[92:95], v[44:47], v[252:255]
    s_waitcnt lgkmcnt(10)
    ds_read_b128 v[72:75], v1 offset:192
    ds_read_b128 v[76:79], v1 offset:704
    v_mfma_f32_16x16x32_bf16 v[96:99], v[48:51], v[128:131], 0
    v_exp_f32 v170, v122
    v_cvt_pk_bf16_f32 v44, v168, v169
    v_mfma_f32_16x16x32_bf16 v[104:107], v[48:51], v[144:147], 0
    ds_read_b64_tr_b16 v[80:81], v2 offset:8576
    v_or3_b32 v186, v186, v43, v44
    v_mfma_f32_16x16x32_bf16 v[100:103], v[52:55], v[128:131], 0
    ds_read_b64_tr_b16 v[82:83], v2 offset:9088
    v_exp_f32 v171, v123
    v_mfma_f32_16x16x32_bf16 v[108:111], v[52:55], v[144:147], 0
    s_waitcnt lgkmcnt(12)
    ds_read_b64_tr_b16 v[84:85], v2 offset:8608
    v_exp_f32 v172, v124
    v_cvt_pk_bf16_f32 v45, v170, v171
    v_mfma_f32_16x16x32_bf16 v[96:99], v[56:59], v[132:135], v[96:99]
    ds_read_b64_tr_b16 v[86:87], v2 offset:9120
    v_exp_f32 v173, v125
    v_mfma_f32_16x16x32_bf16 v[104:107], v[56:59], v[148:151], v[104:107]
    ds_read_b64_tr_b16 v[88:89], v2 offset:8640
    v_exp_f32 v174, v126
    v_mfma_f32_16x16x32_bf16 v[100:103], v[60:63], v[132:135], v[100:103]
    ds_read_b64_tr_b16 v[90:91], v2 offset:9152
    v_cvt_pk_bf16_f32 v46, v172, v173
    v_or3_b32 v186, v186, v45, v46
    v_mfma_f32_16x16x32_bf16 v[108:111], v[60:63], v[148:151], v[108:111]
    s_waitcnt lgkmcnt(6)
    ds_read_b64_tr_b16 v[92:93], v2 offset:8672
    v_mfma_f32_16x16x32_bf16 v[96:99], v[64:67], v[136:139], v[96:99]
    ds_read_b64_tr_b16 v[94:95], v2 offset:9184
    v_exp_f32 v175, v127
    v_mfma_f32_16x16x32_bf16 v[104:107], v[64:67], v[152:155], v[104:107]
    v_cvt_pk_bf16_f32 v47, v174, v175
    v_bitop3_b32 v186, v186, v47, s77 bitop3:0xa8
    v_cmp_ne_u32 vcc, 0, v186
    v_mfma_f32_16x16x32_bf16 v[100:103], v[68:71], v[136:139], v[100:103]
    v_mfma_f32_16x16x32_bf16 v[108:111], v[68:71], v[152:155], v[108:111]
    v_mfma_f32_16x16x32_bf16 v[96:99], v[72:75], v[140:143], v[96:99]
    v_mfma_f32_16x16x32_bf16 v[104:107], v[72:75], v[156:159], v[104:107]
    v_mfma_f32_16x16x32_bf16 v[100:103], v[76:79], v[140:143], v[100:103]
    v_mfma_f32_16x16x32_bf16 v[108:111], v[76:79], v[156:159], v[108:111]
    v_mfma_f32_16x16x32_bf16 a[100:103], a[248:251], v[16:19], a[100:103]
    v_mfma_f32_16x16x32_bf16 a[108:111], a[248:251], v[20:23], a[108:111]
    ds_read_b64_tr_b16 v[64:65], v2 offset:8448
    v_mfma_f32_16x16x32_bf16 a[116:119], a[248:251], v[24:27], a[116:119]
    ds_read_b64_tr_b16 v[66:67], v2 offset:8960
    v_max3_f32 v188, v96, v97, v98
    v_max3_f32 v189, v104, v105, v106
    v_max3_f32 v188, v188, v99, v100
    v_max3_f32 v189, v189, v107, v108
    v_max3_f32 v188, v188, v101, v102
    v_max3_f32 v189, v189, v109, v110
    v_max_f32 v188, v188, v103
    v_max_f32 v189, v189, v111
    s_nop 1
    v_permlane32_swap_b32 v188, v189
    v_mfma_f32_16x16x32_bf16 a[124:127], a[248:251], v[28:31], a[124:127]
    ds_read_b64_tr_b16 v[68:69], v2 offset:8480
    v_max_f32 v189, v188, v189
    v_mov_b32 v190, v189
    v_mfma_f32_16x16x32_bf16 a[132:135], a[248:251], v[32:35], a[132:135]
    ds_read_b64_tr_b16 v[70:71], v2 offset:8992
    v_permlane16_swap_b32 v190, v189
    v_max_f32 v189, v190, v189
    v_mfma_f32_16x16x32_bf16 a[140:143], a[248:251], v[36:39], a[140:143]
    ds_read_b64_tr_b16 v[72:73], v2 offset:8512
    v_sub_f32 v176, 0xc1800000, v189
    v_sub_f32 v180, 0xc1800000, v189
    v_mfma_f32_16x16x32_bf16 a[144:147], a[240:243], v[16:19], a[144:147]
    ds_read_b64_tr_b16 v[74:75], v2 offset:9024
    v_permlane32_swap_b32 v176, v180
    v_mov_b32 v177, v176
    v_mfma_f32_16x16x32_bf16 a[152:155], a[240:243], v[20:23], a[152:155]
    ds_read_b64_tr_b16 v[76:77], v2 offset:8544
    v_mov_b32 v181, v180
    v_mfma_f32_16x16x32_bf16 a[160:163], a[240:243], v[24:27], a[160:163]
    ds_read_b64_tr_b16 v[78:79], v2 offset:9056
    v_mov_b32 v178, v176
    v_mov_b32 v182, v180
    v_mfma_f32_16x16x32_bf16 a[168:171], a[240:243], v[28:31], a[168:171]
    v_mov_b32 v179, v176
    v_mov_b32 v183, v180
    v_add_f32 v96, v96, v176
    v_mfma_f32_16x16x32_bf16 a[176:179], a[240:243], v[32:35], a[176:179]
    v_add_f32 v97, v97, v176
    v_add_f32 v98, v98, v176
    v_add_f32 v99, v99, v176
    v_mfma_f32_16x16x32_bf16 a[184:187], a[240:243], v[36:39], a[184:187]
    v_add_f32 v100, v100, v176
    v_add_f32 v101, v101, v176
    v_add_f32 v102, v102, v176
    v_mfma_f32_16x16x32_bf16 a[148:151], a[244:247], v[16:19], a[148:151]
    v_add_f32 v103, v103, v176
    v_add_f32 v104, v104, v180
    v_add_f32 v105, v105, v180
    v_mfma_f32_16x16x32_bf16 a[156:159], a[244:247], v[20:23], a[156:159]
    v_add_f32 v106, v106, v180
    v_add_f32 v107, v107, v180
    v_add_f32 v108, v108, v180
    v_mfma_f32_16x16x32_bf16 a[164:167], a[244:247], v[24:27], a[164:167]
    v_add_f32 v109, v109, v180
    v_add_f32 v110, v110, v180
    v_add_f32 v111, v111, v180
    s_cbranch_vccnz L_rs_b15
L_rr_b15:
    v_mfma_f32_16x16x32_bf16 v[8:11], a[252:255], v[40:43], v[8:11]
    s_waitcnt lgkmcnt(8)
    v_exp_f32 v160, v96
    v_mfma_f32_16x16x32_bf16 v[208:211], v[80:83], v[40:43], v[208:211]
    v_exp_f32 v161, v97
    v_mfma_f32_16x16x32_bf16 v[212:215], v[84:87], v[40:43], v[212:215]
    v_exp_f32 v162, v98
    v_mfma_f32_16x16x32_bf16 v[216:219], v[88:91], v[40:43], v[216:219]
    v_exp_f32 v163, v99
    v_mfma_f32_16x16x32_bf16 v[220:223], v[92:95], v[40:43], v[220:223]
    s_waitcnt lgkmcnt(0)
    v_exp_f32 v164, v100
    v_mfma_f32_16x16x32_bf16 v[192:195], v[64:67], v[40:43], v[192:195]
    v_exp_f32 v165, v101
    v_mfma_f32_16x16x32_bf16 v[196:199], v[68:71], v[40:43], v[196:199]
    v_exp_f32 v166, v102
    v_mfma_f32_16x16x32_bf16 v[200:203], v[72:75], v[40:43], v[200:203]
    v_exp_f32 v167, v103
    v_mfma_f32_16x16x32_bf16 v[204:207], v[76:79], v[40:43], v[204:207]
    s_waitcnt lgkmcnt(0)
    s_barrier
    v_mfma_f32_16x16x32_bf16 v[12:15], a[252:255], v[44:47], v[12:15]
    ds_read_b128 v[48:51], v1 offset:16896
    ds_read_b128 v[52:55], v1 offset:17408
    v_cvt_pk_bf16_f32 v40, v160, v161
    v_cvt_pk_bf16_f32 v41, v162, v163
    v_mfma_f32_16x16x32_bf16 v[224:227], v[64:67], v[44:47], v[224:227]
    ds_read_b128 v[56:59], v1 offset:16960
    ds_read_b128 v[60:63], v1 offset:17472
    v_rcp_f32 v184, v8
    v_mfma_f32_16x16x32_bf16 v[228:231], v[68:71], v[44:47], v[228:231]
    ds_read_b64_tr_b16 a[248:249], v3 offset:33792
    ds_read_b64_tr_b16 a[250:251], v3 offset:34304
    v_mul_f32 v192, v192, v184
    v_mul_f32 v193, v193, v184
    v_mul_f32 v194, v194, v184
    v_mfma_f32_16x16x32_bf16 v[232:235], v[72:75], v[44:47], v[232:235]
    ds_read_b64_tr_b16 a[240:241], v3 offset:33824
    ds_read_b64_tr_b16 a[242:243], v3 offset:34336
    v_mul_f32 v195, v195, v184
    v_mul_f32 v196, v196, v184
    v_mul_f32 v197, v197, v184
    v_mfma_f32_16x16x32_bf16 v[236:239], v[76:79], v[44:47], v[236:239]
    v_mul_f32 v198, v198, v184
    v_mul_f32 v199, v199, v184
    v_cvt_pk_bf16_f32 v192, v192, v193
    v_cvt_pk_bf16_f32 v193, v194, v195
    v_cvt_pk_bf16_f32 v194, v196, v197
    v_mfma_f32_16x16x32_bf16 v[240:243], v[80:83], v[44:47], v[240:243]
    v_cvt_pk_bf16_f32 v195, v198, v199
    v_cvt_pk_bf16_f32 v42, v164, v165
    v_or3_b32 v186, v40, v41, v42
    v_cvt_pk_bf16_f32 v43, v166, v167
    v_mfma_f32_16x16x32_bf16 v[244:247], v[84:87], v[44:47], v[244:247]
    ds_write_b128 v5, v[192:195] offset:0
    v_mul_f32 v200, v200, v184
    v_mfma_f32_16x16x32_bf16 v[248:251], v[88:91], v[44:47], v[248:251]
    ds_read_b128 v[64:67], v1 offset:17024
    ds_read_b128 v[68:71], v1 offset:17536
    v_mul_f32 v201, v201, v184
    v_mul_f32 v202, v202, v184
    v_mul_f32 v203, v203, v184
    v_mfma_f32_16x16x32_bf16 v[252:255], v[92:95], v[44:47], v[252:255]
    s_waitcnt lgkmcnt(9)
    ds_read_b128 v[72:75], v1 offset:17088
    ds_read_b128 v[76:79], v1 offset:17600
    v_mul_f32 v204, v204, v184
    v_mul_f32 v205, v205, v184
    v_mul_f32 v206, v206, v184
    v_mfma_f32_16x16x32_bf16 v[112:115], v[48:51], v[128:131], v[176:179]
    v_mul_f32 v207, v207, v184
    v_cvt_pk_bf16_f32 v200, v200, v201
    v_cvt_pk_bf16_f32 v201, v202, v203
    v_cvt_pk_bf16_f32 v202, v204, v205
    v_cvt_pk_bf16_f32 v203, v206, v207
    v_mfma_f32_16x16x32_bf16 v[120:123], v[48:51], v[144:147], v[180:183]
    ds_write_b128 v5, v[200:203] offset:1024
    ds_read_b64_tr_b16 v[80:81], v2 offset:25472
    v_mul_f32 v208, v208, v184
    v_mfma_f32_16x16x32_bf16 v[116:119], v[52:55], v[128:131], v[176:179]
    ds_read_b64_tr_b16 v[82:83], v2 offset:25984
    v_mul_f32 v209, v209, v184
    v_mul_f32 v210, v210, v184
    v_mfma_f32_16x16x32_bf16 v[124:127], v[52:55], v[144:147], v[180:183]
    s_waitcnt lgkmcnt(12)
    ds_read_b64_tr_b16 v[84:85], v2 offset:25504
    v_mul_f32 v211, v211, v184
    v_mul_f32 v212, v212, v184
    v_mul_f32 v213, v213, v184
    v_mul_f32 v214, v214, v184
    v_mfma_f32_16x16x32_bf16 v[112:115], v[56:59], v[132:135], v[112:115]
    ds_read_b64_tr_b16 v[86:87], v2 offset:26016
    v_mul_f32 v215, v215, v184
    v_cvt_pk_bf16_f32 v208, v208, v209
    v_cvt_pk_bf16_f32 v209, v210, v211
    v_cvt_pk_bf16_f32 v210, v212, v213
    v_mfma_f32_16x16x32_bf16 v[120:123], v[56:59], v[148:151], v[120:123]
    ds_read_b64_tr_b16 v[88:89], v2 offset:25536
    v_cvt_pk_bf16_f32 v211, v214, v215
    v_exp_f32 v168, v104
    v_mfma_f32_16x16x32_bf16 v[116:119], v[60:63], v[132:135], v[116:119]
    ds_write_b128 v5, v[208:211] offset:2048
    ds_read_b64_tr_b16 v[90:91], v2 offset:26048
    v_mul_f32 v216, v216, v184
    v_mfma_f32_16x16x32_bf16 v[124:127], v[60:63], v[148:151], v[124:127]
    s_waitcnt lgkmcnt(8)
    ds_read_b64_tr_b16 v[92:93], v2 offset:25568
    v_mul_f32 v217, v217, v184
    v_mul_f32 v218, v218, v184
    v_mul_f32 v219, v219, v184
    v_mfma_f32_16x16x32_bf16 v[112:115], v[64:67], v[136:139], v[112:115]
    ds_read_b64_tr_b16 v[94:95], v2 offset:26080
    v_mul_f32 v220, v220, v184
    v_mul_f32 v221, v221, v184
    v_mul_f32 v222, v222, v184
    v_mul_f32 v223, v223, v184
    v_mfma_f32_16x16x32_bf16 v[120:123], v[64:67], v[152:155], v[120:123]
    v_cvt_pk_bf16_f32 v216, v216, v217
    v_cvt_pk_bf16_f32 v217, v218, v219
    v_cvt_pk_bf16_f32 v218, v220, v221
    v_cvt_pk_bf16_f32 v219, v222, v223
    v_mfma_f32_16x16x32_bf16 v[116:119], v[68:71], v[136:139], v[116:119]
    ds_write_b128 v5, v[216:219] offset:3072
    v_mfma_f32_16x16x32_bf16 v[124:127], v[68:71], v[152:155], v[124:127]
    v_rcp_f32 v188, v12
    s_nop 0
    v_mul_f32 v224, v224, v188
    v_mul_f32 v225, v225, v188
    v_mul_f32 v226, v226, v188
    v_mfma_f32_16x16x32_bf16 v[112:115], v[72:75], v[140:143], v[112:115]
    v_mul_f32 v227, v227, v188
    v_mul_f32 v228, v228, v188
    v_mul_f32 v229, v229, v188
    v_mul_f32 v230, v230, v188
    v_mul_f32 v231, v231, v188
    v_mfma_f32_16x16x32_bf16 v[120:123], v[72:75], v[156:159], v[120:123]
    v_cvt_pk_bf16_f32 v224, v224, v225
    v_cvt_pk_bf16_f32 v225, v226, v227
    v_cvt_pk_bf16_f32 v226, v228, v229
    v_cvt_pk_bf16_f32 v227, v230, v231
    v_mfma_f32_16x16x32_bf16 v[116:119], v[76:79], v[140:143], v[116:119]
    ds_write_b128 v5, v[224:227] offset:4096
    v_mul_f32 v232, v232, v188
    v_mfma_f32_16x16x32_bf16 v[124:127], v[76:79], v[156:159], v[124:127]
    v_mul_f32 v233, v233, v188
    v_mul_f32 v234, v234, v188
    v_mul_f32 v235, v235, v188
    v_mul_f32 v236, v236, v188
    v_mul_f32 v237, v237, v188
    v_mfma_f32_16x16x32_bf16 a[172:175], a[244:247], v[28:31], a[172:175]
    v_mul_f32 v238, v238, v188
    v_mul_f32 v239, v239, v188
    v_cvt_pk_bf16_f32 v232, v232, v233
    v_cvt_pk_bf16_f32 v233, v234, v235
    v_cvt_pk_bf16_f32 v234, v236, v237
    v_mfma_f32_16x16x32_bf16 a[180:183], a[244:247], v[32:35], a[180:183]
    ds_read_b64_tr_b16 v[64:65], v2 offset:25344
    v_cvt_pk_bf16_f32 v235, v238, v239
    v_exp_f32 v169, v105
    v_mfma_f32_16x16x32_bf16 a[188:191], a[244:247], v[36:39], a[188:191]
    ds_write_b128 v5, v[232:235] offset:5120
    ds_read_b64_tr_b16 v[66:67], v2 offset:25856
    v_mul_f32 v240, v240, v188
    v_mfma_f32_16x16x32_bf16 a[192:195], a[248:251], v[16:19], a[192:195]
    ds_read_b64_tr_b16 v[68:69], v2 offset:25376
    v_mul_f32 v241, v241, v188
    v_mul_f32 v242, v242, v188
    v_mul_f32 v243, v243, v188
    v_mfma_f32_16x16x32_bf16 a[200:203], a[248:251], v[20:23], a[200:203]
    ds_read_b64_tr_b16 v[70:71], v2 offset:25888
    v_mul_f32 v244, v244, v188
    v_mul_f32 v245, v245, v188
    v_mul_f32 v246, v246, v188
    v_mul_f32 v247, v247, v188
    v_mfma_f32_16x16x32_bf16 a[208:211], a[248:251], v[24:27], a[208:211]
    ds_read_b64_tr_b16 v[72:73], v2 offset:25408
    v_cvt_pk_bf16_f32 v240, v240, v241
    v_exp_f32 v170, v106
    v_cvt_pk_bf16_f32 v241, v242, v243
    v_mfma_f32_16x16x32_bf16 a[216:219], a[248:251], v[28:31], a[216:219]
    ds_read_b64_tr_b16 v[74:75], v2 offset:25920
    v_cvt_pk_bf16_f32 v242, v244, v245
    v_cvt_pk_bf16_f32 v44, v168, v169
    v_cvt_pk_bf16_f32 v243, v246, v247
    v_or3_b32 v186, v186, v43, v44
    v_mfma_f32_16x16x32_bf16 a[224:227], a[248:251], v[32:35], a[224:227]
    ds_write_b128 v5, v[240:243] offset:6144
    ds_read_b64_tr_b16 v[76:77], v2 offset:25440
    v_mul_f32 v248, v248, v188
    v_mfma_f32_16x16x32_bf16 a[232:235], a[248:251], v[36:39], a[232:235]
    ds_read_b64_tr_b16 v[78:79], v2 offset:25952
    v_exp_f32 v171, v107
    v_mfma_f32_16x16x32_bf16 a[196:199], a[240:243], v[16:19], a[196:199]
    v_mul_f32 v249, v249, v188
    v_exp_f32 v172, v108
    v_mul_f32 v250, v250, v188
    v_mul_f32 v251, v251, v188
    v_mfma_f32_16x16x32_bf16 a[204:207], a[240:243], v[20:23], a[204:207]
    v_cvt_pk_bf16_f32 v45, v170, v171
    v_mul_f32 v252, v252, v188
    v_exp_f32 v173, v109
    v_mul_f32 v253, v253, v188
    v_mfma_f32_16x16x32_bf16 a[212:215], a[240:243], v[24:27], a[212:215]
    v_mul_f32 v254, v254, v188
    v_exp_f32 v174, v110
    v_mul_f32 v255, v255, v188
    v_cvt_pk_bf16_f32 v248, v248, v249
    v_mfma_f32_16x16x32_bf16 a[220:223], a[240:243], v[28:31], a[220:223]
    v_cvt_pk_bf16_f32 v46, v172, v173
    v_cvt_pk_bf16_f32 v249, v250, v251
    v_or3_b32 v186, v186, v45, v46
    v_cvt_pk_bf16_f32 v250, v252, v253
    v_cvt_pk_bf16_f32 v251, v254, v255
    v_mfma_f32_16x16x32_bf16 a[228:231], a[240:243], v[32:35], a[228:231]
    ds_write_b128 v5, v[248:251] offset:7168
    v_mfma_f32_16x16x32_bf16 a[236:239], a[240:243], v[36:39], a[236:239]
    v_exp_f32 v175, v111
    s_nop 0
    v_cvt_pk_bf16_f32 v47, v174, v175
    v_bitop3_b32 v186, v186, v47, s77 bitop3:0xa8
    v_cmp_ne_u32 vcc, 0, v186
    s_cbranch_vccnz L_rs_b16
L_rr_b16:
    v_mfma_f32_16x16x32_bf16 v[8:11], a[252:255], v[40:43], 0
    s_waitcnt lgkmcnt(13)
    v_exp_f32 v160, v112
    v_mfma_f32_16x16x32_bf16 v[208:211], v[80:83], v[40:43], 0
    v_exp_f32 v161, v113
    v_mfma_f32_16x16x32_bf16 v[212:215], v[84:87], v[40:43], 0
    v_exp_f32 v162, v114
    v_mfma_f32_16x16x32_bf16 v[216:219], v[88:91], v[40:43], 0
    v_exp_f32 v163, v115
    v_mfma_f32_16x16x32_bf16 v[220:223], v[92:95], v[40:43], 0
    s_waitcnt lgkmcnt(1)
    v_exp_f32 v164, v116
    v_mfma_f32_16x16x32_bf16 v[192:195], v[64:67], v[40:43], 0
    v_exp_f32 v165, v117
    v_mfma_f32_16x16x32_bf16 v[196:199], v[68:71], v[40:43], 0
    v_exp_f32 v166, v118
    v_mfma_f32_16x16x32_bf16 v[200:203], v[72:75], v[40:43], 0
    v_exp_f32 v167, v119
    v_mfma_f32_16x16x32_bf16 v[204:207], v[76:79], v[40:43], 0
    s_waitcnt lgkmcnt(0)
    s_add_u32 s80, s80, 1
    s_branch L_r1
L_final:
    s_nop 7
    s_barrier
    v_mfma_f32_16x16x32_bf16 v[12:15], a[252:255], v[44:47], v[12:15]
    ds_read_b64_tr_b16 a[248:249], v3 offset:16928
    ds_read_b64_tr_b16 a[250:251], v3 offset:17440
    v_cvt_pk_bf16_f32 v40, v160, v161
    v_mfma_f32_16x16x32_bf16 v[224:227], v[64:67], v[44:47], v[224:227]
    ds_read_b64_tr_b16 a[240:241], v3 offset:25344
    ds_read_b64_tr_b16 a[242:243], v3 offset:25856
    v_cvt_pk_bf16_f32 v41, v162, v163
    v_mfma_f32_16x16x32_bf16 v[228:231], v[68:71], v[44:47], v[228:231]
    ds_read_b64_tr_b16 a[244:245], v3 offset:25376
    ds_read_b64_tr_b16 a[246:247], v3 offset:25888
    v_cvt_pk_bf16_f32 v42, v164, v165
    v_mfma_f32_16x16x32_bf16 v[232:235], v[72:75], v[44:47], v[232:235]
    v_or3_b32 v186, v40, v41, v42
    v_cvt_pk_bf16_f32 v43, v166, v167
    v_mfma_f32_16x16x32_bf16 v[236:239], v[76:79], v[44:47], v[236:239]
    v_exp_f32 v168, v120
    v_mfma_f32_16x16x32_bf16 v[240:243], v[80:83], v[44:47], v[240:243]
    v_exp_f32 v169, v121
    v_mfma_f32_16x16x32_bf16 v[244:247], v[84:87], v[44:47], v[244:247]
    v_exp_f32 v170, v122
    v_mfma_f32_16x16x32_bf16 v[248:251], v[88:91], v[44:47], v[248:251]
    v_exp_f32 v171, v123
    v_mfma_f32_16x16x32_bf16 v[252:255], v[92:95], v[44:47], v[252:255]
    s_waitcnt lgkmcnt(0)
    v_exp_f32 v172, v124
    v_mfma_f32_16x16x32_bf16 a[100:103], a[248:251], v[16:19], a[100:103]
    v_cvt_pk_bf16_f32 v44, v168, v169
    v_or3_b32 v186, v186, v43, v44
    v_mfma_f32_16x16x32_bf16 a[108:111], a[248:251], v[20:23], a[108:111]
    ds_read_b64_tr_b16 v[80:81], v2 offset:8576
    v_cvt_pk_bf16_f32 v45, v170, v171
    v_mfma_f32_16x16x32_bf16 a[116:119], a[248:251], v[24:27], a[116:119]
    ds_read_b64_tr_b16 v[82:83], v2 offset:9088
    v_mfma_f32_16x16x32_bf16 a[124:127], a[248:251], v[28:31], a[124:127]
    ds_read_b64_tr_b16 v[84:85], v2 offset:8608
    v_mfma_f32_16x16x32_bf16 a[132:135], a[248:251], v[32:35], a[132:135]
    ds_read_b64_tr_b16 v[86:87], v2 offset:9120
    v_exp_f32 v173, v125
    v_mfma_f32_16x16x32_bf16 a[140:143], a[248:251], v[36:39], a[140:143]
    ds_read_b64_tr_b16 v[88:89], v2 offset:8640
    v_mfma_f32_16x16x32_bf16 a[144:147], a[240:243], v[16:19], a[144:147]
    ds_read_b64_tr_b16 v[90:91], v2 offset:9152
    v_mfma_f32_16x16x32_bf16 a[152:155], a[240:243], v[20:23], a[152:155]
    ds_read_b64_tr_b16 v[92:93], v2 offset:8672
    v_mfma_f32_16x16x32_bf16 a[160:163], a[240:243], v[24:27], a[160:163]
    ds_read_b64_tr_b16 v[94:95], v2 offset:9184
    v_exp_f32 v174, v126
    v_mfma_f32_16x16x32_bf16 a[168:171], a[240:243], v[28:31], a[168:171]
    ds_read_b64_tr_b16 v[64:65], v2 offset:8448
    v_cvt_pk_bf16_f32 v46, v172, v173
    v_mfma_f32_16x16x32_bf16 a[176:179], a[240:243], v[32:35], a[176:179]
    ds_read_b64_tr_b16 v[66:67], v2 offset:8960
    v_or3_b32 v186, v186, v45, v46
    v_mfma_f32_16x16x32_bf16 a[184:187], a[240:243], v[36:39], a[184:187]
    ds_read_b64_tr_b16 v[68:69], v2 offset:8480
    v_exp_f32 v175, v127
    v_mfma_f32_16x16x32_bf16 a[148:151], a[244:247], v[16:19], a[148:151]
    ds_read_b64_tr_b16 v[70:71], v2 offset:8992
    v_cvt_pk_bf16_f32 v47, v174, v175
    v_mfma_f32_16x16x32_bf16 a[156:159], a[244:247], v[20:23], a[156:159]
    ds_read_b64_tr_b16 v[72:73], v2 offset:8512
    v_bitop3_b32 v186, v186, v47, s77 bitop3:0xa8
    v_mfma_f32_16x16x32_bf16 a[164:167], a[244:247], v[24:27], a[164:167]
    ds_read_b64_tr_b16 v[74:75], v2 offset:9024
    ds_read_b64_tr_b16 v[76:77], v2 offset:8544
    ds_read_b64_tr_b16 v[78:79], v2 offset:9056
    v_cmp_ne_u32 vcc, 0, v186
    s_cbranch_vccnz L_rs_f15
L_rr_f15:
    v_mfma_f32_16x16x32_bf16 v[8:11], a[252:255], v[40:43], v[8:11]
    s_waitcnt lgkmcnt(8)
    v_mfma_f32_16x16x32_bf16 v[208:211], v[80:83], v[40:43], v[208:211]
    v_mfma_f32_16x16x32_bf16 v[212:215], v[84:87], v[40:43], v[212:215]
    v_mfma_f32_16x16x32_bf16 v[216:219], v[88:91], v[40:43], v[216:219]
    v_mfma_f32_16x16x32_bf16 v[220:223], v[92:95], v[40:43], v[220:223]
    s_waitcnt lgkmcnt(0)
    v_mfma_f32_16x16x32_bf16 v[192:195], v[64:67], v[40:43], v[192:195]
    v_mfma_f32_16x16x32_bf16 v[196:199], v[68:71], v[40:43], v[196:199]
    v_mfma_f32_16x16x32_bf16 v[200:203], v[72:75], v[40:43], v[200:203]
    v_mfma_f32_16x16x32_bf16 v[204:207], v[76:79], v[40:43], v[204:207]
    s_waitcnt lgkmcnt(0)
    s_barrier
    v_mfma_f32_16x16x32_bf16 v[12:15], a[252:255], v[44:47], v[12:15]
    ds_read_b64_tr_b16 a[248:249], v3 offset:33792
    ds_read_b64_tr_b16 a[250:251], v3 offset:34304
    v_rcp_f32 v184, v8
    s_nop 0
    v_mul_f32 v192, v192, v184
    v_mfma_f32_16x16x32_bf16 v[224:227], v[64:67], v[44:47], v[224:227]
    ds_read_b64_tr_b16 a[240:241], v3 offset:33824
    ds_read_b64_tr_b16 a[242:243], v3 offset:34336
    v_mul_f32 v193, v193, v184
    v_mul_f32 v194, v194, v184
    v_mul_f32 v195, v195, v184
    v_mul_f32 v196, v196, v184
    v_mfma_f32_16x16x32_bf16 v[228:231], v[68:71], v[44:47], v[228:231]
    v_mul_f32 v197, v197, v184
    v_mul_f32 v198, v198, v184
    v_mul_f32 v199, v199, v184
    v_cvt_pk_bf16_f32 v192, v192, v193
    v_cvt_pk_bf16_f32 v193, v194, v195
    v_cvt_pk_bf16_f32 v194, v196, v197
    v_mfma_f32_16x16x32_bf16 v[232:235], v[72:75], v[44:47], v[232:235]
    v_cvt_pk_bf16_f32 v195, v198, v199
    v_mfma_f32_16x16x32_bf16 v[236:239], v[76:79], v[44:47], v[236:239]
    ds_write_b128 v5, v[192:195] offset:0
    v_mul_f32 v200, v200, v184
    v_mul_f32 v201, v201, v184
    v_mul_f32 v202, v202, v184
    v_mul_f32 v203, v203, v184
    v_mul_f32 v204, v204, v184
    v_mfma_f32_16x16x32_bf16 v[240:243], v[80:83], v[44:47], v[240:243]
    v_mul_f32 v205, v205, v184
    v_mul_f32 v206, v206, v184
    v_mul_f32 v207, v207, v184
    v_cvt_pk_bf16_f32 v200, v200, v201
    v_cvt_pk_bf16_f32 v201, v202, v203
    v_cvt_pk_bf16_f32 v202, v204, v205
    v_cvt_pk_bf16_f32 v203, v206, v207
    v_mfma_f32_16x16x32_bf16 v[244:247], v[84:87], v[44:47], v[244:247]
    ds_write_b128 v5, v[200:203] offset:1024
    v_mul_f32 v208, v208, v184
    v_mfma_f32_16x16x32_bf16 v[248:251], v[88:91], v[44:47], v[248:251]
    v_mul_f32 v209, v209, v184
    v_mul_f32 v210, v210, v184
    v_mul_f32 v211, v211, v184
    v_mul_f32 v212, v212, v184
    v_mul_f32 v213, v213, v184
    v_mul_f32 v214, v214, v184
    v_mfma_f32_16x16x32_bf16 v[252:255], v[92:95], v[44:47], v[252:255]
    s_waitcnt lgkmcnt(2)
    v_mul_f32 v215, v215, v184
    v_cvt_pk_bf16_f32 v208, v208, v209
    v_cvt_pk_bf16_f32 v209, v210, v211
    v_cvt_pk_bf16_f32 v210, v212, v213
    v_cvt_pk_bf16_f32 v211, v214, v215
    v_mfma_f32_16x16x32_bf16 a[172:175], a[244:247], v[28:31], a[172:175]
    ds_write_b128 v5, v[208:211] offset:2048
    v_mul_f32 v216, v216, v184
    v_mul_f32 v217, v217, v184
    v_mfma_f32_16x16x32_bf16 a[180:183], a[244:247], v[32:35], a[180:183]
    v_mul_f32 v218, v218, v184
    v_mul_f32 v219, v219, v184
    v_mul_f32 v220, v220, v184
    v_mul_f32 v221, v221, v184
    v_mul_f32 v222, v222, v184
    v_mul_f32 v223, v223, v184
    v_mfma_f32_16x16x32_bf16 a[188:191], a[244:247], v[36:39], a[188:191]
    v_cvt_pk_bf16_f32 v216, v216, v217
    v_cvt_pk_bf16_f32 v217, v218, v219
    v_cvt_pk_bf16_f32 v218, v220, v221
    v_cvt_pk_bf16_f32 v219, v222, v223
    v_mfma_f32_16x16x32_bf16 a[192:195], a[248:251], v[16:19], a[192:195]
    ds_write_b128 v5, v[216:219] offset:3072
    v_rcp_f32 v188, v12
    s_nop 0
    v_mul_f32 v224, v224, v188
    v_mul_f32 v225, v225, v188
    v_mfma_f32_16x16x32_bf16 a[200:203], a[248:251], v[20:23], a[200:203]
    v_mul_f32 v226, v226, v188
    v_mul_f32 v227, v227, v188
    v_mul_f32 v228, v228, v188
    v_mul_f32 v229, v229, v188
    v_mul_f32 v230, v230, v188
    v_mul_f32 v231, v231, v188
    v_mfma_f32_16x16x32_bf16 a[208:211], a[248:251], v[24:27], a[208:211]
    v_cvt_pk_bf16_f32 v224, v224, v225
    v_cvt_pk_bf16_f32 v225, v226, v227
    v_cvt_pk_bf16_f32 v226, v228, v229
    v_cvt_pk_bf16_f32 v227, v230, v231
    v_mfma_f32_16x16x32_bf16 a[216:219], a[248:251], v[28:31], a[216:219]
    ds_write_b128 v5, v[224:227] offset:4096
    v_mul_f32 v232, v232, v188
    v_mul_f32 v233, v233, v188
    v_mul_f32 v234, v234, v188
    v_mfma_f32_16x16x32_bf16 a[224:227], a[248:251], v[32:35], a[224:227]
    v_mul_f32 v235, v235, v188
    v_mul_f32 v236, v236, v188
    v_mul_f32 v237, v237, v188
    v_mul_f32 v238, v238, v188
    v_mul_f32 v239, v239, v188
    v_cvt_pk_bf16_f32 v232, v232, v233
    v_mfma_f32_16x16x32_bf16 a[232:235], a[248:251], v[36:39], a[232:235]
    v_cvt_pk_bf16_f32 v233, v234, v235
    v_cvt_pk_bf16_f32 v234, v236, v237
    v_cvt_pk_bf16_f32 v235, v238, v239
    v_mfma_f32_16x16x32_bf16 a[196:199], a[240:243], v[16:19], a[196:199]
    ds_write_b128 v5, v[232:235] offset:5120
    v_mul_f32 v240, v240, v188
    v_mul_f32 v241, v241, v188
    v_mul_f32 v242, v242, v188
    v_mul_f32 v243, v243, v188
    v_mul_f32 v244, v244, v188
    v_mfma_f32_16x16x32_bf16 a[204:207], a[240:243], v[20:23], a[204:207]
    v_mul_f32 v245, v245, v188
    v_mul_f32 v246, v246, v188
    v_mul_f32 v247, v247, v188
    v_cvt_pk_bf16_f32 v240, v240, v241
    v_cvt_pk_bf16_f32 v241, v242, v243
    v_cvt_pk_bf16_f32 v242, v244, v245
    v_mfma_f32_16x16x32_bf16 a[212:215], a[240:243], v[24:27], a[212:215]
    v_cvt_pk_bf16_f32 v243, v246, v247
    v_mfma_f32_16x16x32_bf16 a[220:223], a[240:243], v[28:31], a[220:223]
    ds_write_b128 v5, v[240:243] offset:6144
    v_mul_f32 v248, v248, v188
    v_mul_f32 v249, v249, v188
    v_mul_f32 v250, v250, v188
    v_mul_f32 v251, v251, v188
    v_mul_f32 v252, v252, v188
    v_mfma_f32_16x16x32_bf16 a[228:231], a[240:243], v[32:35], a[228:231]
    v_mul_f32 v253, v253, v188
    v_mul_f32 v254, v254, v188
    v_mul_f32 v255, v255, v188
    v_cvt_pk_bf16_f32 v248, v248, v249
    v_cvt_pk_bf16_f32 v249, v250, v251
    v_cvt_pk_bf16_f32 v250, v252, v253
    v_mfma_f32_16x16x32_bf16 a[236:239], a[240:243], v[36:39], a[236:239]
    v_cvt_pk_bf16_f32 v251, v254, v255
    ds_write_b128 v5, v[248:251] offset:7168
    s_waitcnt lgkmcnt(0)
    s_branch L_tail
L_loader:
    s_nop 7
    s_nop 7
    s_mov_b32 s78, 139264
    s_mov_b32 s79, 143360
    s_mov_b32 s81, 147456
    s_mov_b32 s82, 151552
    s_mov_b32 s83, 0
    v_add_u32 v10, 109824, v2
    v_add_u32 v9, 109824, v0
    v_bfe_u32 v14, v7, 2, 3
    v_mul_u32_u24 v2, 1056, v14
    v_lshrrev_b32 v14, 5, v7
    v_lshl_add_u32 v2, v14, 8, v2
    v_and_b32 v14, 3, v7
    v_lshl_add_u32 v2, v14, 3, v2
    s_lshl_b32 s32, s3, 6
    s_add_u32 s32, s32, 67584
    v_add_u32 v3, s32, v2
    v_add_u32 v4, 139264, v0
    v_and_b32 v13, 0x300, v0
    v_mul_u32_u24 v8, 40, v13
    v_and_b32 v13, 0xf0, v0
    v_add_u32 v8, v8, v13
    s_waitcnt lgkmcnt(0)
    s_barrier
    ds_write_b128 v32, a[48:51] offset:25344
    ds_write_b128 v32, a[52:55] offset:26400
    ds_write_b128 v32, a[56:59] offset:33792
    ds_write_b128 v32, a[60:63] offset:34848
    ds_write_b128 v32, a[64:67] offset:42240
    ds_write_b128 v32, a[68:71] offset:43296
    ds_read_b128 v[160:163], v4 offset:0
    ds_read_b128 v[164:167], v4 offset:1024
    ds_read_b128 v[168:171], v4 offset:2048
    ds_read_b128 v[172:175], v4 offset:3072
    ds_read_b128 v[176:179], v4 offset:4096
    ds_read_b128 v[180:183], v4 offset:5120
    ds_read_b128 v[184:187], v4 offset:6144
    ds_read_b128 v[188:191], v4 offset:7168
    ds_read_b128 v[192:195], v4 offset:8192
    ds_read_b128 v[196:199], v4 offset:9216
    ds_read_b128 v[200:203], v4 offset:10240
    ds_read_b128 v[204:207], v4 offset:11264
    ds_read_b128 v[208:211], v4 offset:12288
    ds_read_b128 v[212:215], v4 offset:13312
    ds_read_b128 v[216:219], v4 offset:14336
    ds_read_b128 v[220:223], v4 offset:15360
    ds_read_b128 v[224:227], v4 offset:16384
    ds_read_b128 v[228:231], v4 offset:17408
    ds_read_b128 v[232:235], v4 offset:18432
    ds_read_b128 v[236:239], v4 offset:19456
    ds_read_b128 v[240:243], v4 offset:20480
    ds_read_b128 v[244:247], v4 offset:21504
    ds_read_b128 v[248:251], v4 offset:22528
    ds_read_b128 v[252:255], v4 offset:23552
    s_waitcnt lgkmcnt(0)
    s_barrier
    ds_write_b128 v32, a[72:75] offset:50688
    ds_write_b128 v32, a[76:79] offset:51744
    ds_write_b128 v32, a[80:83] offset:59136
    ds_write_b128 v32, a[84:87] offset:60192
    s_waitcnt lgkmcnt(0)
    s_barrier
    s_add_u32 s75, s34, 114688
    buffer_load_dwordx4 a[0:3], v0, s[8:11], s75 offen offset:0 nt
    buffer_load_dwordx4 a[4:7], v0, s[8:11], s75 offen offset:1024 nt
    s_add_u32 s75, s34, 106496
    buffer_load_dwordx4 a[8:11], v0, s[12:15], s75 offen offset:0 nt
    buffer_load_dwordx4 a[12:15], v0, s[12:15], s75 offen offset:1024 nt
    v_mfma_f32_32x32x16_bf16 a[64:79], v[36:39], v[36:39], 0
    s_lshl_b32 s33, s3, 13
    s_lshl_b32 s32, s4, 10
    s_add_u32 s16, s33, s32
    s_add_u32 s17, s16, 131072
    s_add_u32 s18, s16, 262144
    s_add_u32 s19, s16, 393216
    s_add_u32 s20, s16, 524288
    s_add_u32 s21, s16, 655360
    ds_write_b128 v32, a[88:91] offset:0
    ds_write_b128 v32, a[92:95] offset:1056
    ds_write_b128 v32, a[96:99] offset:8448
    ds_write_b128 v32, a[100:103] offset:9504
    s_waitcnt lgkmcnt(0)
    s_barrier
    s_add_u32 s75, s76, 0
    buffer_load_dwordx4 a[248:251], v0, s[24:27], s75 offen
    s_add_u32 s75, s76, 1024
    buffer_load_dwordx4 a[248:251], v0, s[24:27], s75 offen
    v_mfma_f32_32x32x16_bf16 a[80:95], v[36:39], v[36:39], 0
    s_add_u32 s22, s16, 786432
    s_add_u32 s23, s16, 917504
    s_lshl_b32 s51, s3, 9
    s_add_u32 s51, s51, 1048576
    s_lshl_b32 s50, s4, 3
    s_add_u32 s50, s50, s51
    s_mov_b32 s52, 0x01010101
    s_lshl_b32 s52, s52, s4
    ds_write_b128 v32, a[104:107] offset:16896
    ds_write_b128 v32, a[108:111] offset:17952
    ds_write_b128 v32, a[112:115] offset:25344
    ds_write_b128 v32, a[116:119] offset:26400
    s_waitcnt lgkmcnt(0)
    s_barrier
    s_add_u32 s75, s34, 122880
    buffer_load_dwordx4 a[16:19], v0, s[8:11], s75 offen offset:0 nt
    buffer_load_dwordx4 a[20:23], v0, s[8:11], s75 offen offset:1024 nt
    s_add_u32 s75, s34, 114688
    buffer_load_dwordx4 a[24:27], v0, s[12:15], s75 offen offset:0 nt
    buffer_load_dwordx4 a[28:31], v0, s[12:15], s75 offen offset:1024 nt
    v_mfma_f32_32x32x16_bf16 a[96:111], v[36:39], v[36:39], 0
    s_mov_b32 s53, s52
    s_lshl_b32 s32, s4, 17
    s_add_u32 s33, s33, s32
    s_add_u32 s32, s4, 1
    s_and_b32 s32, s32, 7
    s_lshl_b32 s32, s32, 10
    s_add_u32 s66, s33, s32
    s_add_u32 s32, s4, 2
    ds_write_b128 v32, a[120:123] offset:33792
    ds_write_b128 v32, a[124:127] offset:34848
    ds_write_b128 v32, a[128:131] offset:42240
    ds_write_b128 v32, a[132:135] offset:43296
    s_waitcnt lgkmcnt(0)
    s_barrier
    s_add_u32 s75, s76, 2048
    buffer_load_dwordx4 a[248:251], v0, s[24:27], s75 offen
    s_add_u32 s75, s76, 3072
    buffer_load_dwordx4 a[248:251], v0, s[24:27], s75 offen
    v_mfma_f32_32x32x16_bf16 a[112:127], v[36:39], v[36:39], 0
    s_and_b32 s32, s32, 7
    s_lshl_b32 s32, s32, 10
    s_add_u32 s67, s33, s32
    s_add_u32 s32, s4, 3
    s_and_b32 s32, s32, 7
    s_lshl_b32 s32, s32, 10
    s_add_u32 s68, s33, s32
    s_add_u32 s32, s4, 4
    ds_write_b128 v32, a[136:139] offset:50688
    ds_write_b128 v32, a[140:143] offset:51744
    ds_write_b128 v32, a[144:147] offset:59136
    ds_write_b128 v32, a[148:151] offset:60192
    s_waitcnt lgkmcnt(0)
    s_barrier
    s_add_u32 s75, s34, 131072
    buffer_load_dwordx4 a[32:35], v0, s[8:11], s75 offen offset:0 nt
    buffer_load_dwordx4 a[36:39], v0, s[8:11], s75 offen offset:1024 nt
    s_add_u32 s75, s34, 122880
    buffer_load_dwordx4 a[40:43], v0, s[12:15], s75 offen offset:0 nt
    buffer_load_dwordx4 a[44:47], v0, s[12:15], s75 offen offset:1024 nt
    v_mfma_f32_32x32x16_bf16 a[128:143], v[36:39], v[36:39], 0
    s_and_b32 s32, s32, 7
    s_lshl_b32 s32, s32, 10
    s_add_u32 s69, s33, s32
    s_add_u32 s32, s4, 5
    s_and_b32 s32, s32, 7
    s_lshl_b32 s32, s32, 10
    s_add_u32 s70, s33, s32
    s_add_u32 s32, s4, 6
    ds_write_b128 v32, a[152:155] offset:0
    ds_write_b128 v32, a[156:159] offset:1056
    ds_write_b128 v32, a[160:163] offset:8448
    ds_write_b128 v32, a[164:167] offset:9504
    s_waitcnt lgkmcnt(0)
    s_barrier
    s_add_u32 s75, s76, 4096
    buffer_load_dwordx4 a[248:251], v0, s[24:27], s75 offen
    s_add_u32 s75, s76, 5120
    buffer_load_dwordx4 a[248:251], v0, s[24:27], s75 offen
    v_mfma_f32_32x32x16_bf16 a[144:159], v[36:39], v[36:39], 0
    s_and_b32 s32, s32, 7
    s_lshl_b32 s32, s32, 10
    s_add_u32 s71, s33, s32
    s_add_u32 s32, s4, 7
    s_and_b32 s32, s32, 7
    s_lshl_b32 s32, s32, 10
    s_add_u32 s72, s33, s32
    s_mul_i32 s35, s5, 245760
    s_waitcnt vmcnt(34)
    ds_write_b128 v32, a[168:171] offset:16896
    ds_write_b128 v32, a[172:175] offset:17952
    ds_write_b128 v32, a[176:179] offset:25344
    ds_write_b128 v32, a[180:183] offset:26400
    s_waitcnt lgkmcnt(0)
    s_barrier
    s_add_u32 s75, s76, 6144
    buffer_load_dwordx4 a[248:251], v0, s[24:27], s75 offen
    s_add_u32 s75, s76, 7168
    buffer_load_dwordx4 a[248:251], v0, s[24:27], s75 offen
    v_mfma_f32_32x32x16_bf16 a[160:175], v[36:39], v[36:39], 0
    s_mul_i32 s32, s6, 1280
    s_add_u32 s35, s35, s32
    s_lshl_b32 s32, s3, 6
    s_add_u32 s35, s35, s32
    s_add_u32 s32, s4, 0
    s_mul_i32 s33, s32, 43
    s_lshr_b32 s33, s33, 8
    s_lshl_b32 s73, s33, 8
    s_waitcnt vmcnt(32)
    ds_write_b128 v32, a[184:187] offset:33792
    ds_write_b128 v32, a[188:191] offset:34848
    ds_write_b128 v32, a[192:195] offset:42240
    ds_write_b128 v32, a[196:199] offset:43296
    s_waitcnt lgkmcnt(0)
    s_barrier
    s_add_u32 s75, s76, 8192
    buffer_load_dwordx4 a[248:251], v0, s[24:27], s75 offen
    s_add_u32 s75, s76, 9216
    buffer_load_dwordx4 a[248:251], v0, s[24:27], s75 offen
    v_mfma_f32_32x32x16_bf16 a[176:191], v[36:39], v[36:39], 0
    s_mul_i32 s33, s33, 6
    s_sub_u32 s32, s32, s33
    s_and_b32 s33, s32, 1
    s_mul_i32 s33, s33, 5120
    s_add_u32 s73, s73, s33
    s_lshr_b32 s32, s32, 1
    s_mul_i32 s32, s32, 81920
    s_add_u32 s73, s73, s32
    s_waitcnt vmcnt(30)
    ds_write_b128 v32, a[200:203] offset:50688
    ds_write_b128 v32, a[204:207] offset:51744
    ds_write_b128 v32, a[208:211] offset:59136
    ds_write_b128 v32, a[212:215] offset:60192
    s_waitcnt lgkmcnt(0)
    s_barrier
    s_add_u32 s75, s34, 139264
    buffer_load_dwordx4 a[48:51], v0, s[8:11], s75 offen offset:0 nt
    buffer_load_dwordx4 a[52:55], v0, s[8:11], s75 offen offset:1024 nt
    s_add_u32 s75, s34, 131072
    buffer_load_dwordx4 a[56:59], v0, s[12:15], s75 offen offset:0 nt
    buffer_load_dwordx4 a[60:63], v0, s[12:15], s75 offen offset:1024 nt
    v_mfma_f32_32x32x16_bf16 a[192:207], v[36:39], v[36:39], 0
    s_add_u32 s73, s73, s35
    s_add_u32 s32, s4, 8
    s_mul_i32 s33, s32, 43
    s_lshr_b32 s33, s33, 8
    s_lshl_b32 s74, s33, 8
    s_mul_i32 s33, s33, 6
    s_sub_u32 s32, s32, s33
    s_and_b32 s33, s32, 1
    s_waitcnt vmcnt(30)
    ds_write_b128 v32, a[216:219] offset:0
    ds_write_b128 v32, a[220:223] offset:1056
    ds_write_b128 v32, a[224:227] offset:8448
    ds_write_b128 v32, a[228:231] offset:9504
    s_waitcnt lgkmcnt(0)
    s_barrier
    v_mfma_f32_32x32x16_bf16 a[208:223], v[36:39], v[36:39], 0
    s_mul_i32 s33, s33, 5120
    s_add_u32 s74, s74, s33
    s_lshr_b32 s32, s32, 1
    s_mul_i32 s32, s32, 81920
    s_add_u32 s74, s74, s32
    s_add_u32 s74, s74, s35
    s_add_u32 s32, s4, 16
    s_mul_i32 s33, s32, 43
    s_waitcnt vmcnt(26)
    ds_write_b128 v32, a[232:235] offset:16896
    ds_write_b128 v32, a[236:239] offset:17952
    ds_write_b128 v32, a[240:243] offset:25344
    ds_write_b128 v32, a[244:247] offset:26400
    s_waitcnt lgkmcnt(0)
    s_barrier
    v_mfma_f32_32x32x16_bf16 a[224:239], v[36:39], v[36:39], 0
    s_lshr_b32 s33, s33, 8
    s_lshl_b32 s7, s33, 8
    s_mul_i32 s33, s33, 6
    s_sub_u32 s32, s32, s33
    s_and_b32 s33, s32, 1
    s_mul_i32 s33, s33, 5120
    s_add_u32 s7, s7, s33
    s_lshr_b32 s32, s32, 1
    s_waitcnt vmcnt(22)
    ds_write_b128 v32, a[0:3] offset:33792
    ds_write_b128 v32, a[4:7] offset:34848
    ds_write_b128 v32, a[8:11] offset:42240
    ds_write_b128 v32, a[12:15] offset:43296
    s_waitcnt lgkmcnt(0)
    s_barrier
    v_mfma_f32_32x32x16_bf16 a[0:15], v[36:39], v[36:39], 0
    s_mul_i32 s32, s32, 81920
    s_add_u32 s7, s7, s32
    s_add_u32 s7, s7, s35
    s_add_u32 s32, s4, 24
    s_mul_i32 s33, s32, 43
    s_lshr_b32 s33, s33, 8
    s_lshl_b32 s55, s33, 8
    s_mul_i32 s33, s33, 6
    s_waitcnt vmcnt(16)
    ds_write_b128 v32, a[16:19] offset:50688
    ds_write_b128 v32, a[20:23] offset:51744
    ds_write_b128 v32, a[24:27] offset:59136
    ds_write_b128 v32, a[28:31] offset:60192
    s_waitcnt lgkmcnt(0)
    s_barrier
    v_mfma_f32_32x32x16_bf16 a[16:31], v[36:39], v[36:39], 0
    s_sub_u32 s32, s32, s33
    s_and_b32 s33, s32, 1
    s_mul_i32 s33, s33, 5120
    s_add_u32 s55, s55, s33
    s_lshr_b32 s32, s32, 1
    s_mul_i32 s32, s32, 81920
    s_add_u32 s55, s55, s32
    s_add_u32 s55, s55, s35
    s_waitcnt vmcnt(10)
    ds_write_b128 v32, a[32:35] offset:0
    ds_write_b128 v32, a[36:39] offset:1056
    ds_write_b128 v32, a[40:43] offset:8448
    ds_write_b128 v32, a[44:47] offset:9504
    s_waitcnt lgkmcnt(0)
    s_barrier
    s_waitcnt vmcnt(0)
    ds_write_b128 v32, a[48:51] offset:16896
    ds_write_b128 v32, a[52:55] offset:17952
    ds_write_b128 v32, a[56:59] offset:25344
    ds_write_b128 v32, a[60:63] offset:26400
    s_mov_b32 m0, 67584
    s_add_u32 s75, s83, 0
    buffer_load_dwordx4 v8, s[24:27], s75 offen offset:0 lds
    s_mov_b32 m0, 67360
    s_nop 0
    buffer_load_dwordx4 v8, s[24:27], s75 offen offset:1280 lds
    s_mov_b32 m0, 67136
    s_nop 0
    buffer_load_dwordx4 v8, s[24:27], s75 offen offset:2560 lds
    s_mov_b32 m0, 66912
    s_nop 0
    buffer_load_dwordx4 v8, s[24:27], s75 offen offset:3840 lds
    s_mov_b32 m0, 71808
    s_add_u32 s75, s83, 5120
    buffer_load_dwordx4 v8, s[24:27], s75 offen offset:0 lds
    s_mov_b32 m0, 71584
    s_nop 0
    buffer_load_dwordx4 v8, s[24:27], s75 offen offset:1280 lds
    s_mov_b32 m0, 71360
    s_nop 0
    buffer_load_dwordx4 v8, s[24:27], s75 offen offset:2560 lds
    s_mov_b32 m0, 71136
    s_nop 0
    buffer_load_dwordx4 v8, s[24:27], s75 offen offset:3840 lds
    s_mov_b32 m0, 33792
    s_nop 0
    buffer_load_dwordx4 v0, s[8:11], s81 offen offset:0 nt lds
    s_mov_b32 m0, 33824
    s_nop 0
    buffer_load_dwordx4 v0, s[8:11], s81 offen offset:1024 nt lds
    s_mov_b32 m0, 33856
    s_nop 0
    buffer_load_dwordx4 v0, s[8:11], s81 offen offset:2048 nt lds
    s_mov_b32 m0, 33888
    s_nop 0
    buffer_load_dwordx4 v0, s[8:11], s81 offen offset:3072 nt lds
    s_mov_b32 m0, 38016
    s_nop 0
    buffer_load_dwordx4 v0, s[8:11], s82 offen offset:0 nt lds
    s_mov_b32 m0, 38048
    s_nop 0
    buffer_load_dwordx4 v0, s[8:11], s82 offen offset:1024 nt lds
    s_mov_b32 m0, 38080
    s_nop 0
    buffer_load_dwordx4 v0, s[8:11], s82 offen offset:2048 nt lds
    s_mov_b32 m0, 38112
    s_nop 0
    buffer_load_dwordx4 v0, s[8:11], s82 offen offset:3072 nt lds
    s_mov_b32 m0, 42240
    s_nop 0
    buffer_load_dwordx4 v0, s[12:15], s78 offen offset:0 nt lds
    s_mov_b32 m0, 42272
    s_nop 0
    buffer_load_dwordx4 v0, s[12:15], s78 offen offset:1024 nt lds
    s_mov_b32 m0, 42304
    s_nop 0
    buffer_load_dwordx4 v0, s[12:15], s78 offen offset:2048 nt lds
    s_mov_b32 m0, 42336
    s_nop 0
    buffer_load_dwordx4 v0, s[12:15], s78 offen offset:3072 nt lds
    s_mov_b32 m0, 46464
    s_nop 0
    buffer_load_dwordx4 v0, s[12:15], s79 offen offset:0 nt lds
    s_mov_b32 m0, 46496
    s_nop 0
    buffer_load_dwordx4 v0, s[12:15], s79 offen offset:1024 nt lds
    s_mov_b32 m0, 46528
    s_nop 0
    buffer_load_dwordx4 v0, s[12:15], s79 offen offset:2048 nt lds
    s_mov_b32 m0, 46560
    s_nop 0
    buffer_load_dwordx4 v0, s[12:15], s79 offen offset:3072 nt lds
    s_mov_b32 s78, s81
    s_mov_b32 s79, s82
    s_add_u32 s81, s81, 8192
    s_add_u32 s82, s82, 8192
    v_mfma_f32_32x32x16_bf16 a[32:47], v[36:39], v[36:39], 0
    s_waitcnt lgkmcnt(0)
    s_barrier
    s_mov_b32 m0, 76032
    s_add_u32 s75, s83, 256
    buffer_load_dwordx4 v8, s[24:27], s75 offen offset:0 lds
    s_mov_b32 m0, 75808
    s_nop 0
    buffer_load_dwordx4 v8, s[24:27], s75 offen offset:1280 lds
    s_mov_b32 m0, 75584
    s_nop 0
    buffer_load_dwordx4 v8, s[24:27], s75 offen offset:2560 lds
    s_mov_b32 m0, 75360
    s_nop 0
    buffer_load_dwordx4 v8, s[24:27], s75 offen offset:3840 lds
    s_mov_b32 m0, 80256
    s_add_u32 s75, s83, 5376
    buffer_load_dwordx4 v8, s[24:27], s75 offen offset:0 lds
    s_mov_b32 m0, 80032
    s_nop 0
    buffer_load_dwordx4 v8, s[24:27], s75 offen offset:1280 lds
    s_mov_b32 m0, 79808
    s_nop 0
    buffer_load_dwordx4 v8, s[24:27], s75 offen offset:2560 lds
    s_mov_b32 m0, 79584
    s_nop 0
    buffer_load_dwordx4 v8, s[24:27], s75 offen offset:3840 lds
    s_mov_b32 m0, 50688
    s_nop 0
    buffer_load_dwordx4 v0, s[8:11], s81 offen offset:0 nt lds
    s_mov_b32 m0, 50720
    s_nop 0
    buffer_load_dwordx4 v0, s[8:11], s81 offen offset:1024 nt lds
    s_mov_b32 m0, 50752
    s_nop 0
    buffer_load_dwordx4 v0, s[8:11], s81 offen offset:2048 nt lds
    s_mov_b32 m0, 50784
    s_nop 0
    buffer_load_dwordx4 v0, s[8:11], s81 offen offset:3072 nt lds
    s_mov_b32 m0, 54912
    s_nop 0
    buffer_load_dwordx4 v0, s[8:11], s82 offen offset:0 nt lds
    s_mov_b32 m0, 54944
    s_nop 0
    buffer_load_dwordx4 v0, s[8:11], s82 offen offset:1024 nt lds
    s_mov_b32 m0, 54976
    s_nop 0
    buffer_load_dwordx4 v0, s[8:11], s82 offen offset:2048 nt lds
    s_mov_b32 m0, 55008
    s_nop 0
    buffer_load_dwordx4 v0, s[8:11], s82 offen offset:3072 nt lds
    s_mov_b32 m0, 59136
    s_nop 0
    buffer_load_dwordx4 v0, s[12:15], s78 offen offset:0 nt lds
    s_mov_b32 m0, 59168
    s_nop 0
    buffer_load_dwordx4 v0, s[12:15], s78 offen offset:1024 nt lds
    s_mov_b32 m0, 59200
    s_nop 0
    buffer_load_dwordx4 v0, s[12:15], s78 offen offset:2048 nt lds
    s_mov_b32 m0, 59232
    s_nop 0
    buffer_load_dwordx4 v0, s[12:15], s78 offen offset:3072 nt lds
    s_mov_b32 m0, 63360
    s_nop 0
    buffer_load_dwordx4 v0, s[12:15], s79 offen offset:0 nt lds
    s_mov_b32 m0, 63392
    s_nop 0
    buffer_load_dwordx4 v0, s[12:15], s79 offen offset:1024 nt lds
    s_mov_b32 m0, 63424
    s_nop 0
    buffer_load_dwordx4 v0, s[12:15], s79 offen offset:2048 nt lds
    s_mov_b32 m0, 63456
    s_nop 0
    buffer_load_dwordx4 v0, s[12:15], s79 offen offset:3072 nt lds
    s_mov_b32 s78, s81
    s_mov_b32 s79, s82
    s_add_u32 s81, s81, 8192
    s_add_u32 s82, s82, 8192
    v_mfma_f32_32x32x16_bf16 a[48:63], v[36:39], v[36:39], 0
    s_waitcnt lgkmcnt(0)
    s_barrier
    s_mov_b32 m0, 84480
    s_add_u32 s75, s83, 512
    buffer_load_dwordx4 v8, s[24:27], s75 offen offset:0 lds
    s_mov_b32 m0, 84256
    s_nop 0
    buffer_load_dwordx4 v8, s[24:27], s75 offen offset:1280 lds
    s_mov_b32 m0, 84032
    s_nop 0
    buffer_load_dwordx4 v8, s[24:27], s75 offen offset:2560 lds
    s_mov_b32 m0, 83808
    s_nop 0
    buffer_load_dwordx4 v8, s[24:27], s75 offen offset:3840 lds
    s_mov_b32 m0, 88704
    s_add_u32 s75, s83, 5632
    buffer_load_dwordx4 v8, s[24:27], s75 offen offset:0 lds
    s_mov_b32 m0, 88480
    s_nop 0
    buffer_load_dwordx4 v8, s[24:27], s75 offen offset:1280 lds
    s_mov_b32 m0, 88256
    s_nop 0
    buffer_load_dwordx4 v8, s[24:27], s75 offen offset:2560 lds
    s_mov_b32 m0, 88032
    s_nop 0
    buffer_load_dwordx4 v8, s[24:27], s75 offen offset:3840 lds
    s_mov_b32 m0, 92928
    s_add_u32 s75, s83, 768
    buffer_load_dwordx4 v8, s[24:27], s75 offen offset:0 lds
    s_mov_b32 m0, 92704
    s_nop 0
    buffer_load_dwordx4 v8, s[24:27], s75 offen offset:1280 lds
    s_mov_b32 m0, 92480
    s_nop 0
    buffer_load_dwordx4 v8, s[24:27], s75 offen offset:2560 lds
    s_mov_b32 m0, 92256
    s_nop 0
    buffer_load_dwordx4 v8, s[24:27], s75 offen offset:3840 lds
    s_mov_b32 m0, 0
    s_nop 0
    buffer_load_dwordx4 v0, s[8:11], s81 offen offset:0 nt lds
    s_mov_b32 m0, 32
    s_nop 0
    buffer_load_dwordx4 v0, s[8:11], s81 offen offset:1024 nt lds
    s_waitcnt vmcnt(61)
    s_mov_b32 m0, 64
    s_nop 0
    buffer_load_dwordx4 v0, s[8:11], s81 offen offset:2048 nt lds
    s_waitcnt vmcnt(61)
    s_mov_b32 m0, 96
    s_nop 0
    buffer_load_dwordx4 v0, s[8:11], s81 offen offset:3072 nt lds
    s_waitcnt vmcnt(61)
    s_mov_b32 m0, 4224
    s_nop 0
    buffer_load_dwordx4 v0, s[8:11], s82 offen offset:0 nt lds
    s_waitcnt vmcnt(61)
    s_mov_b32 m0, 4256
    s_nop 0
    buffer_load_dwordx4 v0, s[8:11], s82 offen offset:1024 nt lds
    s_waitcnt vmcnt(61)
    s_mov_b32 m0, 4288
    s_nop 0
    buffer_load_dwordx4 v0, s[8:11], s82 offen offset:2048 nt lds
    s_waitcnt vmcnt(61)
    s_mov_b32 m0, 4320
    s_nop 0
    buffer_load_dwordx4 v0, s[8:11], s82 offen offset:3072 nt lds
    s_waitcnt vmcnt(61)
    s_mov_b32 m0, 8448
    s_nop 0
    buffer_load_dwordx4 v0, s[12:15], s78 offen offset:0 nt lds
    s_waitcnt vmcnt(61)
    s_mov_b32 m0, 8480
    s_nop 0
    buffer_load_dwordx4 v0, s[12:15], s78 offen offset:1024 nt lds
    s_waitcnt vmcnt(61)
    s_mov_b32 m0, 8512
    s_nop 0
    buffer_load_dwordx4 v0, s[12:15], s78 offen offset:2048 nt lds
    s_waitcnt vmcnt(61)
    s_mov_b32 m0, 8544
    s_nop 0
    buffer_load_dwordx4 v0, s[12:15], s78 offen offset:3072 nt lds
    s_waitcnt vmcnt(61)
    s_mov_b32 m0, 12672
    s_nop 0
    buffer_load_dwordx4 v0, s[12:15], s79 offen offset:0 nt lds
    s_waitcnt vmcnt(61)
    s_mov_b32 m0, 12704
    s_nop 0
    buffer_load_dwordx4 v0, s[12:15], s79 offen offset:1024 nt lds
    s_waitcnt vmcnt(61)
    s_mov_b32 m0, 12736
    s_nop 0
    buffer_load_dwordx4 v0, s[12:15], s79 offen offset:2048 nt lds
    s_waitcnt vmcnt(61)
    s_mov_b32 m0, 12768
    s_nop 0
    buffer_load_dwordx4 v0, s[12:15], s79 offen offset:3072 nt lds
    s_mov_b32 s78, s81
    s_mov_b32 s79, s82
    s_add_u32 s81, s81, 8192
    s_add_u32 s82, s82, 8192
    s_waitcnt lgkmcnt(0)
    s_mov_b32 s80, 1
L_ld:
    s_waitcnt vmcnt(34)
    s_barrier
    ds_read_b128 v[16:19], v4 offset:0
    ds_read_b64_tr_b16 a[240:241], v3 offset:0
    ds_read_b64_tr_b16 a[242:243], v3 offset:512
    ds_read_b128 v[20:23], v4 offset:4096
    ds_read_b128 v[24:27], v4 offset:8192
    ds_read_b128 v[28:31], v4 offset:12288
    ds_read_b128 v[32:35], v4 offset:16384
    ds_read_b128 v[36:39], v4 offset:20480
    ds_read_b64_tr_b16 a[244:245], v3 offset:32
    ds_read_b64_tr_b16 a[246:247], v3 offset:544
    ds_read_b64_tr_b16 a[248:249], v3 offset:8448
    ds_read_b64_tr_b16 a[250:251], v3 offset:8960
    s_mov_b32 m0, 97152
    s_add_u32 s75, s83, 5888
    buffer_load_dwordx4 v8, s[24:27], s75 offen offset:0 lds
    s_mov_b32 m0, 96928
    s_nop 0
    buffer_load_dwordx4 v8, s[24:27], s75 offen offset:1280 lds
    s_mov_b32 m0, 96704
    s_nop 0
    buffer_load_dwordx4 v8, s[24:27], s75 offen offset:2560 lds
    s_mov_b32 m0, 96480
    s_nop 0
    buffer_load_dwordx4 v8, s[24:27], s75 offen offset:3840 lds
    s_mov_b32 m0, 101376
    s_add_u32 s75, s83, 1024
    buffer_load_dwordx4 v8, s[24:27], s75 offen offset:0 lds
    s_mov_b32 m0, 101152
    s_nop 0
    buffer_load_dwordx4 v8, s[24:27], s75 offen offset:1280 lds
    s_mov_b32 m0, 100928
    s_nop 0
    buffer_load_dwordx4 v8, s[24:27], s75 offen offset:2560 lds
    s_mov_b32 m0, 100704
    s_nop 0
    buffer_load_dwordx4 v8, s[24:27], s75 offen offset:3840 lds
    s_waitcnt lgkmcnt(9)
    v_mfma_f32_16x16x32_bf16 a[0:3], a[240:243], v[16:19], a[0:3]
    s_mov_b32 m0, 105600
    s_add_u32 s75, s83, 6144
    buffer_load_dwordx4 v8, s[24:27], s75 offen offset:0 lds
    s_waitcnt lgkmcnt(8)
    v_mfma_f32_16x16x32_bf16 a[8:11], a[240:243], v[20:23], a[8:11]
    s_mov_b32 m0, 105376
    s_nop 0
    buffer_load_dwordx4 v8, s[24:27], s75 offen offset:1280 lds
    s_mov_b32 m0, 105152
    s_nop 0
    buffer_load_dwordx4 v8, s[24:27], s75 offen offset:2560 lds
    s_waitcnt lgkmcnt(7)
    v_mfma_f32_16x16x32_bf16 a[16:19], a[240:243], v[24:27], a[16:19]
    s_mov_b32 m0, 104928
    s_nop 0
    buffer_load_dwordx4 v8, s[24:27], s75 offen offset:3840 lds
    s_add_u32 s83, s83, 40960
    s_waitcnt lgkmcnt(6)
    v_mfma_f32_16x16x32_bf16 a[24:27], a[240:243], v[28:31], a[24:27]
    s_mov_b32 m0, 16896
    s_nop 0
    buffer_load_dwordx4 v0, s[8:11], s81 offen offset:0 nt lds
    s_mov_b32 m0, 16928
    s_nop 0
    buffer_load_dwordx4 v0, s[8:11], s81 offen offset:1024 nt lds
    s_waitcnt lgkmcnt(5)
    v_mfma_f32_16x16x32_bf16 a[32:35], a[240:243], v[32:35], a[32:35]
    s_mov_b32 m0, 16960
    s_nop 0
    buffer_load_dwordx4 v0, s[8:11], s81 offen offset:2048 nt lds
    s_waitcnt lgkmcnt(4)
    v_mfma_f32_16x16x32_bf16 a[40:43], a[240:243], v[36:39], a[40:43]
    s_mov_b32 m0, 16992
    s_nop 0
    buffer_load_dwordx4 v0, s[8:11], s81 offen offset:3072 nt lds
    s_mov_b32 m0, 21120
    s_nop 0
    buffer_load_dwordx4 v0, s[8:11], s82 offen offset:0 nt lds
    s_waitcnt lgkmcnt(2)
    v_mfma_f32_16x16x32_bf16 a[4:7], a[244:247], v[16:19], a[4:7]
    s_mov_b32 m0, 21152
    s_nop 0
    buffer_load_dwordx4 v0, s[8:11], s82 offen offset:1024 nt lds
    v_mfma_f32_16x16x32_bf16 a[12:15], a[244:247], v[20:23], a[12:15]
    s_mov_b32 m0, 21184
    s_nop 0
    buffer_load_dwordx4 v0, s[8:11], s82 offen offset:2048 nt lds
    s_mov_b32 m0, 21216
    s_nop 0
    buffer_load_dwordx4 v0, s[8:11], s82 offen offset:3072 nt lds
    v_mfma_f32_16x16x32_bf16 a[20:23], a[244:247], v[24:27], a[20:23]
    s_mov_b32 m0, 25344
    s_nop 0
    buffer_load_dwordx4 v0, s[12:15], s78 offen offset:0 nt lds
    v_mfma_f32_16x16x32_bf16 a[28:31], a[244:247], v[28:31], a[28:31]
    s_mov_b32 m0, 25376
    s_nop 0
    buffer_load_dwordx4 v0, s[12:15], s78 offen offset:1024 nt lds
    s_mov_b32 m0, 25408
    s_nop 0
    buffer_load_dwordx4 v0, s[12:15], s78 offen offset:2048 nt lds
    v_mfma_f32_16x16x32_bf16 a[36:39], a[244:247], v[32:35], a[36:39]
    s_mov_b32 m0, 25440
    s_nop 0
    buffer_load_dwordx4 v0, s[12:15], s78 offen offset:3072 nt lds
    v_mfma_f32_16x16x32_bf16 a[44:47], a[244:247], v[36:39], a[44:47]
    s_mov_b32 m0, 29568
    s_nop 0
    buffer_load_dwordx4 v0, s[12:15], s79 offen offset:0 nt lds
    s_mov_b32 m0, 29600
    s_nop 0
    buffer_load_dwordx4 v0, s[12:15], s79 offen offset:1024 nt lds
    s_waitcnt lgkmcnt(0)
    v_mfma_f32_16x16x32_bf16 a[48:51], a[248:251], v[16:19], a[48:51]
    s_mov_b32 m0, 29632
    s_nop 0
    buffer_load_dwordx4 v0, s[12:15], s79 offen offset:2048 nt lds
    v_mfma_f32_16x16x32_bf16 a[56:59], a[248:251], v[20:23], a[56:59]
    s_mov_b32 m0, 29664
    s_nop 0
    buffer_load_dwordx4 v0, s[12:15], s79 offen offset:3072 nt lds
    s_mov_b32 s78, s81
    s_mov_b32 s79, s82
    s_add_u32 s81, s81, 8192
    s_add_u32 s82, s82, 8192
    v_mfma_f32_16x16x32_bf16 a[64:67], a[248:251], v[24:27], a[64:67]
    s_cmp_eq_u32 s80, 1
    s_cbranch_scc1 L_qa1
    ds_write_b64 v10, v[64:65] offset:0
    ds_write_b64 v10, v[76:77] offset:512
    ds_write_b64 v10, v[88:89] offset:1024
    ds_write_b64 v10, v[100:101] offset:1536
    ds_write_b64 v10, v[112:113] offset:2048
    ds_write_b64 v10, v[124:125] offset:2560
    s_branch L_qb1
L_qa1:
    ds_write_b128 v9, v[160:163] offset:0
    ds_write_b128 v9, v[164:167] offset:1024
    ds_write_b128 v9, v[168:171] offset:2048
L_qb1:
    s_waitcnt lgkmcnt(0)
    s_waitcnt vmcnt(38)
    s_barrier
    ds_read_b64_tr_b16 a[240:241], v3 offset:8480
    ds_read_b64_tr_b16 a[242:243], v3 offset:8992
    ds_read_b64_tr_b16 a[244:245], v3 offset:16896
    ds_read_b64_tr_b16 a[246:247], v3 offset:17408
    s_mov_b32 m0, 67584
    s_add_u32 s75, s83, 0
    buffer_load_dwordx4 v8, s[24:27], s75 offen offset:0 lds
    s_mov_b32 m0, 67360
    s_nop 0
    buffer_load_dwordx4 v8, s[24:27], s75 offen offset:1280 lds
    s_mov_b32 m0, 67136
    s_nop 0
    buffer_load_dwordx4 v8, s[24:27], s75 offen offset:2560 lds
    s_mov_b32 m0, 66912
    s_nop 0
    buffer_load_dwordx4 v8, s[24:27], s75 offen offset:3840 lds
    s_mov_b32 m0, 71808
    s_add_u32 s75, s83, 5120
    buffer_load_dwordx4 v8, s[24:27], s75 offen offset:0 lds
    s_mov_b32 m0, 71584
    s_nop 0
    buffer_load_dwordx4 v8, s[24:27], s75 offen offset:1280 lds
    s_mov_b32 m0, 71360
    s_nop 0
    buffer_load_dwordx4 v8, s[24:27], s75 offen offset:2560 lds
    v_mfma_f32_16x16x32_bf16 a[72:75], a[248:251], v[28:31], a[72:75]
    s_mov_b32 m0, 71136
    s_nop 0
    buffer_load_dwordx4 v8, s[24:27], s75 offen offset:3840 lds
    v_mfma_f32_16x16x32_bf16 a[80:83], a[248:251], v[32:35], a[80:83]
    s_mov_b32 m0, 33792
    s_nop 0
    buffer_load_dwordx4 v0, s[8:11], s81 offen offset:0 nt lds
    v_mfma_f32_16x16x32_bf16 a[88:91], a[248:251], v[36:39], a[88:91]
    s_mov_b32 m0, 33824
    s_nop 0
    buffer_load_dwordx4 v0, s[8:11], s81 offen offset:1024 nt lds
    s_mov_b32 m0, 33856
    s_nop 0
    buffer_load_dwordx4 v0, s[8:11], s81 offen offset:2048 nt lds
    s_waitcnt lgkmcnt(2)
    v_mfma_f32_16x16x32_bf16 a[52:55], a[240:243], v[16:19], a[52:55]
    s_mov_b32 m0, 33888
    s_nop 0
    buffer_load_dwordx4 v0, s[8:11], s81 offen offset:3072 nt lds
    v_mfma_f32_16x16x32_bf16 a[60:63], a[240:243], v[20:23], a[60:63]
    s_mov_b32 m0, 38016
    s_nop 0
    buffer_load_dwordx4 v0, s[8:11], s82 offen offset:0 nt lds
    v_mfma_f32_16x16x32_bf16 a[68:71], a[240:243], v[24:27], a[68:71]
    s_mov_b32 m0, 38048
    s_nop 0
    buffer_load_dwordx4 v0, s[8:11], s82 offen offset:1024 nt lds
    v_mfma_f32_16x16x32_bf16 a[76:79], a[240:243], v[28:31], a[76:79]
    s_mov_b32 m0, 38080
    s_nop 0
    buffer_load_dwordx4 v0, s[8:11], s82 offen offset:2048 nt lds
    s_mov_b32 m0, 38112
    s_nop 0
    buffer_load_dwordx4 v0, s[8:11], s82 offen offset:3072 nt lds
    v_mfma_f32_16x16x32_bf16 a[84:87], a[240:243], v[32:35], a[84:87]
    s_mov_b32 m0, 42240
    s_nop 0
    buffer_load_dwordx4 v0, s[12:15], s78 offen offset:0 nt lds
    v_mfma_f32_16x16x32_bf16 a[92:95], a[240:243], v[36:39], a[92:95]
    s_mov_b32 m0, 42272
    s_nop 0
    buffer_load_dwordx4 v0, s[12:15], s78 offen offset:1024 nt lds
    s_waitcnt lgkmcnt(0)
    v_mfma_f32_16x16x32_bf16 a[96:99], a[244:247], v[16:19], a[96:99]
    s_mov_b32 m0, 42304
    s_nop 0
    buffer_load_dwordx4 v0, s[12:15], s78 offen offset:2048 nt lds
    v_mfma_f32_16x16x32_bf16 a[104:107], a[244:247], v[20:23], a[104:107]
    s_mov_b32 m0, 42336
    s_nop 0
    buffer_load_dwordx4 v0, s[12:15], s78 offen offset:3072 nt lds
    s_mov_b32 m0, 46464
    s_nop 0
    buffer_load_dwordx4 v0, s[12:15], s79 offen offset:0 nt lds
    v_mfma_f32_16x16x32_bf16 a[112:115], a[244:247], v[24:27], a[112:115]
    s_mov_b32 m0, 46496
    s_nop 0
    buffer_load_dwordx4 v0, s[12:15], s79 offen offset:1024 nt lds
    v_mfma_f32_16x16x32_bf16 a[120:123], a[244:247], v[28:31], a[120:123]
    s_mov_b32 m0, 46528
    s_nop 0
    buffer_load_dwordx4 v0, s[12:15], s79 offen offset:2048 nt lds
    v_mfma_f32_16x16x32_bf16 a[128:131], a[244:247], v[32:35], a[128:131]
    s_mov_b32 m0, 46560
    s_nop 0
    buffer_load_dwordx4 v0, s[12:15], s79 offen offset:3072 nt lds
    s_mov_b32 s78, s81
    s_mov_b32 s79, s82
    s_add_u32 s81, s81, 8192
    s_add_u32 s82, s82, 8192
    v_mfma_f32_16x16x32_bf16 a[136:139], a[244:247], v[36:39], a[136:139]
    s_cmp_eq_u32 s80, 1
    s_cbranch_scc1 L_qa2
    ds_write_b64 v10, v[136:137] offset:3072
    ds_write_b64 v10, v[148:149] offset:3584
    ds_write_b64 v10, v[66:67] offset:4096
    ds_write_b64 v10, v[78:79] offset:4608
    ds_write_b64 v10, v[90:91] offset:5120
    ds_write_b64 v10, v[102:103] offset:5632
    s_branch L_qb2
L_qa2:
    ds_write_b128 v9, v[172:175] offset:3072
    ds_write_b128 v9, v[176:179] offset:4096
    ds_write_b128 v9, v[180:183] offset:5120
L_qb2:
    s_waitcnt lgkmcnt(0)
    s_waitcnt vmcnt(38)
    s_barrier
    ds_read_b64_tr_b16 a[248:249], v3 offset:16928
    ds_read_b64_tr_b16 a[250:251], v3 offset:17440
    ds_read_b64_tr_b16 a[240:241], v3 offset:25344
    ds_read_b64_tr_b16 a[242:243], v3 offset:25856
    ds_read_b64_tr_b16 a[244:245], v3 offset:25376
    ds_read_b64_tr_b16 a[246:247], v3 offset:25888
    s_mov_b32 m0, 76032
    s_add_u32 s75, s83, 256
    buffer_load_dwordx4 v8, s[24:27], s75 offen offset:0 lds
    s_mov_b32 m0, 75808
    s_nop 0
    buffer_load_dwordx4 v8, s[24:27], s75 offen offset:1280 lds
    s_mov_b32 m0, 75584
    s_nop 0
    buffer_load_dwordx4 v8, s[24:27], s75 offen offset:2560 lds
    s_mov_b32 m0, 75360
    s_nop 0
    buffer_load_dwordx4 v8, s[24:27], s75 offen offset:3840 lds
    s_mov_b32 m0, 80256
    s_add_u32 s75, s83, 5376
    buffer_load_dwordx4 v8, s[24:27], s75 offen offset:0 lds
    s_mov_b32 m0, 80032
    s_nop 0
    buffer_load_dwordx4 v8, s[24:27], s75 offen offset:1280 lds
    s_mov_b32 m0, 79808
    s_nop 0
    buffer_load_dwordx4 v8, s[24:27], s75 offen offset:2560 lds
    s_waitcnt lgkmcnt(4)
    v_mfma_f32_16x16x32_bf16 a[100:103], a[248:251], v[16:19], a[100:103]
    s_mov_b32 m0, 79584
    s_nop 0
    buffer_load_dwordx4 v8, s[24:27], s75 offen offset:3840 lds
    v_mfma_f32_16x16x32_bf16 a[108:111], a[248:251], v[20:23], a[108:111]
    s_mov_b32 m0, 50688
    s_nop 0
    buffer_load_dwordx4 v0, s[8:11], s81 offen offset:0 nt lds
    v_mfma_f32_16x16x32_bf16 a[116:119], a[248:251], v[24:27], a[116:119]
    s_mov_b32 m0, 50720
    s_nop 0
    buffer_load_dwordx4 v0, s[8:11], s81 offen offset:1024 nt lds
    s_mov_b32 m0, 50752
    s_nop 0
    buffer_load_dwordx4 v0, s[8:11], s81 offen offset:2048 nt lds
    v_mfma_f32_16x16x32_bf16 a[124:127], a[248:251], v[28:31], a[124:127]
    s_mov_b32 m0, 50784
    s_nop 0
    buffer_load_dwordx4 v0, s[8:11], s81 offen offset:3072 nt lds
    v_mfma_f32_16x16x32_bf16 a[132:135], a[248:251], v[32:35], a[132:135]
    s_mov_b32 m0, 54912
    s_nop 0
    buffer_load_dwordx4 v0, s[8:11], s82 offen offset:0 nt lds
    v_mfma_f32_16x16x32_bf16 a[140:143], a[248:251], v[36:39], a[140:143]
    s_mov_b32 m0, 54944
    s_nop 0
    buffer_load_dwordx4 v0, s[8:11], s82 offen offset:1024 nt lds
    s_waitcnt lgkmcnt(2)
    v_mfma_f32_16x16x32_bf16 a[144:147], a[240:243], v[16:19], a[144:147]
    s_mov_b32 m0, 54976
    s_nop 0
    buffer_load_dwordx4 v0, s[8:11], s82 offen offset:2048 nt lds
    s_mov_b32 m0, 55008
    s_nop 0
    buffer_load_dwordx4 v0, s[8:11], s82 offen offset:3072 nt lds
    v_mfma_f32_16x16x32_bf16 a[152:155], a[240:243], v[20:23], a[152:155]
    s_mov_b32 m0, 59136
    s_nop 0
    buffer_load_dwordx4 v0, s[12:15], s78 offen offset:0 nt lds
    v_mfma_f32_16x16x32_bf16 a[160:163], a[240:243], v[24:27], a[160:163]
    s_mov_b32 m0, 59168
    s_nop 0
    buffer_load_dwordx4 v0, s[12:15], s78 offen offset:1024 nt lds
    v_mfma_f32_16x16x32_bf16 a[168:171], a[240:243], v[28:31], a[168:171]
    s_mov_b32 m0, 59200
    s_nop 0
    buffer_load_dwordx4 v0, s[12:15], s78 offen offset:2048 nt lds
    v_mfma_f32_16x16x32_bf16 a[176:179], a[240:243], v[32:35], a[176:179]
    s_mov_b32 m0, 59232
    s_nop 0
    buffer_load_dwordx4 v0, s[12:15], s78 offen offset:3072 nt lds
    s_mov_b32 m0, 63360
    s_nop 0
    buffer_load_dwordx4 v0, s[12:15], s79 offen offset:0 nt lds
    v_mfma_f32_16x16x32_bf16 a[184:187], a[240:243], v[36:39], a[184:187]
    s_mov_b32 m0, 63392
    s_nop 0
    buffer_load_dwordx4 v0, s[12:15], s79 offen offset:1024 nt lds
    s_waitcnt lgkmcnt(0)
    v_mfma_f32_16x16x32_bf16 a[148:151], a[244:247], v[16:19], a[148:151]
    s_mov_b32 m0, 63424
    s_nop 0
    buffer_load_dwordx4 v0, s[12:15], s79 offen offset:2048 nt lds
    v_mfma_f32_16x16x32_bf16 a[156:159], a[244:247], v[20:23], a[156:159]
    s_mov_b32 m0, 63456
    s_nop 0
    buffer_load_dwordx4 v0, s[12:15], s79 offen offset:3072 nt lds
    s_mov_b32 s78, s81
    s_mov_b32 s79, s82
    s_add_u32 s81, s81, 8192
    s_add_u32 s82, s82, 8192
    v_mfma_f32_16x16x32_bf16 a[164:167], a[244:247], v[24:27], a[164:167]
    s_cmp_eq_u32 s80, 1
    s_cbranch_scc1 L_qa3
    ds_write_b64 v10, v[114:115] offset:6144
    ds_write_b64 v10, v[126:127] offset:6656
    ds_write_b64 v10, v[138:139] offset:7168
    ds_write_b64 v10, v[150:151] offset:7680
    ds_write_b64 v10, v[68:69] offset:8192
    ds_write_b64 v10, v[80:81] offset:8704
    s_branch L_qb3
L_qa3:
    ds_write_b128 v9, v[184:187] offset:6144
    ds_write_b128 v9, v[188:191] offset:7168
    ds_write_b128 v9, v[192:195] offset:8192
L_qb3:
    s_waitcnt lgkmcnt(0)
    s_waitcnt vmcnt(34)
    s_barrier
    ds_read_b64_tr_b16 a[248:249], v3 offset:33792
    ds_read_b64_tr_b16 a[250:251], v3 offset:34304
    ds_read_b64_tr_b16 a[240:241], v3 offset:33824
    ds_read_b64_tr_b16 a[242:243], v3 offset:34336
    s_mov_b32 m0, 84480
    s_add_u32 s75, s83, 512
    buffer_load_dwordx4 v8, s[24:27], s75 offen offset:0 lds
    s_mov_b32 m0, 84256
    s_nop 0
    buffer_load_dwordx4 v8, s[24:27], s75 offen offset:1280 lds
    s_mov_b32 m0, 84032
    s_nop 0
    buffer_load_dwordx4 v8, s[24:27], s75 offen offset:2560 lds
    s_mov_b32 m0, 83808
    s_nop 0
    buffer_load_dwordx4 v8, s[24:27], s75 offen offset:3840 lds
    s_mov_b32 m0, 88704
    s_add_u32 s75, s83, 5632
    buffer_load_dwordx4 v8, s[24:27], s75 offen offset:0 lds
    s_mov_b32 m0, 88480
    s_nop 0
    buffer_load_dwordx4 v8, s[24:27], s75 offen offset:1280 lds
    s_mov_b32 m0, 88256
    s_nop 0
    buffer_load_dwordx4 v8, s[24:27], s75 offen offset:2560 lds
    s_mov_b32 m0, 88032
    s_nop 0
    buffer_load_dwordx4 v8, s[24:27], s75 offen offset:3840 lds
    v_mfma_f32_16x16x32_bf16 a[172:175], a[244:247], v[28:31], a[172:175]
    s_mov_b32 m0, 92928
    s_add_u32 s75, s83, 768
    buffer_load_dwordx4 v8, s[24:27], s75 offen offset:0 lds
    v_mfma_f32_16x16x32_bf16 a[180:183], a[244:247], v[32:35], a[180:183]
    s_mov_b32 m0, 92704
    s_nop 0
    buffer_load_dwordx4 v8, s[24:27], s75 offen offset:1280 lds
    s_mov_b32 m0, 92480
    s_nop 0
    buffer_load_dwordx4 v8, s[24:27], s75 offen offset:2560 lds
    v_mfma_f32_16x16x32_bf16 a[188:191], a[244:247], v[36:39], a[188:191]
    s_mov_b32 m0, 92256
    s_nop 0
    buffer_load_dwordx4 v8, s[24:27], s75 offen offset:3840 lds
    s_waitcnt lgkmcnt(2)
    v_mfma_f32_16x16x32_bf16 a[192:195], a[248:251], v[16:19], a[192:195]
    s_mov_b32 m0, 0
    s_nop 0
    buffer_load_dwordx4 v0, s[8:11], s81 offen offset:0 nt lds
    s_mov_b32 m0, 32
    s_nop 0
    buffer_load_dwordx4 v0, s[8:11], s81 offen offset:1024 nt lds
    v_mfma_f32_16x16x32_bf16 a[200:203], a[248:251], v[20:23], a[200:203]
    s_mov_b32 m0, 64
    s_nop 0
    buffer_load_dwordx4 v0, s[8:11], s81 offen offset:2048 nt lds
    v_mfma_f32_16x16x32_bf16 a[208:211], a[248:251], v[24:27], a[208:211]
    s_mov_b32 m0, 96
    s_nop 0
    buffer_load_dwordx4 v0, s[8:11], s81 offen offset:3072 nt lds
    s_mov_b32 m0, 4224
    s_nop 0
    buffer_load_dwordx4 v0, s[8:11], s82 offen offset:0 nt lds
    v_mfma_f32_16x16x32_bf16 a[216:219], a[248:251], v[28:31], a[216:219]
    s_mov_b32 m0, 4256
    s_nop 0
    buffer_load_dwordx4 v0, s[8:11], s82 offen offset:1024 nt lds
    v_mfma_f32_16x16x32_bf16 a[224:227], a[248:251], v[32:35], a[224:227]
    s_mov_b32 m0, 4288
    s_nop 0
    buffer_load_dwordx4 v0, s[8:11], s82 offen offset:2048 nt lds
    s_mov_b32 m0, 4320
    s_nop 0
    buffer_load_dwordx4 v0, s[8:11], s82 offen offset:3072 nt lds
    v_mfma_f32_16x16x32_bf16 a[232:235], a[248:251], v[36:39], a[232:235]
    s_mov_b32 m0, 8448
    s_nop 0
    buffer_load_dwordx4 v0, s[12:15], s78 offen offset:0 nt lds
    s_waitcnt lgkmcnt(0)
    v_mfma_f32_16x16x32_bf16 a[196:199], a[240:243], v[16:19], a[196:199]
    s_mov_b32 m0, 8480
    s_nop 0
    buffer_load_dwordx4 v0, s[12:15], s78 offen offset:1024 nt lds
    s_mov_b32 m0, 8512
    s_nop 0
    buffer_load_dwordx4 v0, s[12:15], s78 offen offset:2048 nt lds
    v_mfma_f32_16x16x32_bf16 a[204:207], a[240:243], v[20:23], a[204:207]
    s_mov_b32 m0, 8544
    s_nop 0
    buffer_load_dwordx4 v0, s[12:15], s78 offen offset:3072 nt lds
    v_mfma_f32_16x16x32_bf16 a[212:215], a[240:243], v[24:27], a[212:215]
    s_mov_b32 m0, 12672
    s_nop 0
    buffer_load_dwordx4 v0, s[12:15], s79 offen offset:0 nt lds
    s_mov_b32 m0, 12704
    s_nop 0
    buffer_load_dwordx4 v0, s[12:15], s79 offen offset:1024 nt lds
    v_mfma_f32_16x16x32_bf16 a[220:223], a[240:243], v[28:31], a[220:223]
    s_mov_b32 m0, 12736
    s_nop 0
    buffer_load_dwordx4 v0, s[12:15], s79 offen offset:2048 nt lds
    v_mfma_f32_16x16x32_bf16 a[228:231], a[240:243], v[32:35], a[228:231]
    s_mov_b32 m0, 12768
    s_nop 0
    buffer_load_dwordx4 v0, s[12:15], s79 offen offset:3072 nt lds
    s_mov_b32 s78, s81
    s_mov_b32 s79, s82
    s_add_u32 s81, s81, 8192
    s_add_u32 s82, s82, 8192
    v_mfma_f32_16x16x32_bf16 a[236:239], a[240:243], v[36:39], a[236:239]
    s_cmp_eq_u32 s80, 1
    s_cbranch_scc1 L_qa4
    ds_write_b64 v10, v[92:93] offset:9216
    ds_write_b64 v10, v[104:105] offset:9728
    ds_write_b64 v10, v[116:117] offset:10240
    ds_write_b64 v10, v[128:129] offset:10752
    ds_write_b64 v10, v[140:141] offset:11264
    ds_write_b64 v10, v[152:153] offset:11776
    s_branch L_qb4
L_qa4:
    ds_write_b128 v9, v[196:199] offset:9216
    ds_write_b128 v9, v[200:203] offset:10240
    ds_write_b128 v9, v[204:207] offset:11264
L_qb4:
    s_waitcnt lgkmcnt(0)
    s_waitcnt vmcnt(34)
    s_barrier
    ds_read_b128 v[16:19], v4 offset:1024
    ds_read_b64_tr_b16 a[240:241], v3 offset:0
    ds_read_b64_tr_b16 a[242:243], v3 offset:512
    ds_read_b128 v[20:23], v4 offset:5120
    ds_read_b128 v[24:27], v4 offset:9216
    ds_read_b128 v[28:31], v4 offset:13312
    ds_read_b128 v[32:35], v4 offset:17408
    ds_read_b128 v[36:39], v4 offset:21504
    ds_read_b64_tr_b16 a[244:245], v3 offset:32
    ds_read_b64_tr_b16 a[246:247], v3 offset:544
    ds_read_b64_tr_b16 a[248:249], v3 offset:8448
    ds_read_b64_tr_b16 a[250:251], v3 offset:8960
    s_mov_b32 m0, 97152
    s_add_u32 s75, s83, 5888
    buffer_load_dwordx4 v8, s[24:27], s75 offen offset:0 lds
    s_mov_b32 m0, 96928
    s_nop 0
    buffer_load_dwordx4 v8, s[24:27], s75 offen offset:1280 lds
    s_mov_b32 m0, 96704
    s_nop 0
    buffer_load_dwordx4 v8, s[24:27], s75 offen offset:2560 lds
    s_mov_b32 m0, 96480
    s_nop 0
    buffer_load_dwordx4 v8, s[24:27], s75 offen offset:3840 lds
    s_mov_b32 m0, 101376
    s_add_u32 s75, s83, 1024
    buffer_load_dwordx4 v8, s[24:27], s75 offen offset:0 lds
    s_mov_b32 m0, 101152
    s_nop 0
    buffer_load_dwordx4 v8, s[24:27], s75 offen offset:1280 lds
    s_mov_b32 m0, 100928
    s_nop 0
    buffer_load_dwordx4 v8, s[24:27], s75 offen offset:2560 lds
    s_mov_b32 m0, 100704
    s_nop 0
    buffer_load_dwordx4 v8, s[24:27], s75 offen offset:3840 lds
    s_waitcnt lgkmcnt(9)
    v_mfma_f32_16x16x32_bf16 a[0:3], a[240:243], v[16:19], a[0:3]
    s_mov_b32 m0, 105600
    s_add_u32 s75, s83, 6144
    buffer_load_dwordx4 v8, s[24:27], s75 offen offset:0 lds
    s_waitcnt lgkmcnt(8)
    v_mfma_f32_16x16x32_bf16 a[8:11], a[240:243], v[20:23], a[8:11]
    s_mov_b32 m0, 105376
    s_nop 0
    buffer_load_dwordx4 v8, s[24:27], s75 offen offset:1280 lds
    s_mov_b32 m0, 105152
    s_nop 0
    buffer_load_dwordx4 v8, s[24:27], s75 offen offset:2560 lds
    s_waitcnt lgkmcnt(7)
    v_mfma_f32_16x16x32_bf16 a[16:19], a[240:243], v[24:27], a[16:19]
    s_mov_b32 m0, 104928
    s_nop 0
    buffer_load_dwordx4 v8, s[24:27], s75 offen offset:3840 lds
    s_add_u32 s83, s83, 40960
    s_waitcnt lgkmcnt(6)
    v_mfma_f32_16x16x32_bf16 a[24:27], a[240:243], v[28:31], a[24:27]
    s_mov_b32 m0, 16896
    s_nop 0
    buffer_load_dwordx4 v0, s[8:11], s81 offen offset:0 nt lds
    s_mov_b32 m0, 16928
    s_nop 0
    buffer_load_dwordx4 v0, s[8:11], s81 offen offset:1024 nt lds
    s_waitcnt lgkmcnt(5)
    v_mfma_f32_16x16x32_bf16 a[32:35], a[240:243], v[32:35], a[32:35]
    s_mov_b32 m0, 16960
    s_nop 0
    buffer_load_dwordx4 v0, s[8:11], s81 offen offset:2048 nt lds
    s_waitcnt lgkmcnt(4)
    v_mfma_f32_16x16x32_bf16 a[40:43], a[240:243], v[36:39], a[40:43]
    s_mov_b32 m0, 16992
    s_nop 0
    buffer_load_dwordx4 v0, s[8:11], s81 offen offset:3072 nt lds
    s_mov_b32 m0, 21120
    s_nop 0
    buffer_load_dwordx4 v0, s[8:11], s82 offen offset:0 nt lds
    s_waitcnt lgkmcnt(2)
    v_mfma_f32_16x16x32_bf16 a[4:7], a[244:247], v[16:19], a[4:7]
    s_mov_b32 m0, 21152
    s_nop 0
    buffer_load_dwordx4 v0, s[8:11], s82 offen offset:1024 nt lds
    v_mfma_f32_16x16x32_bf16 a[12:15], a[244:247], v[20:23], a[12:15]
    s_mov_b32 m0, 21184
    s_nop 0
    buffer_load_dwordx4 v0, s[8:11], s82 offen offset:2048 nt lds
    s_mov_b32 m0, 21216
    s_nop 0
    buffer_load_dwordx4 v0, s[8:11], s82 offen offset:3072 nt lds
    v_mfma_f32_16x16x32_bf16 a[20:23], a[244:247], v[24:27], a[20:23]
    s_mov_b32 m0, 25344
    s_nop 0
    buffer_load_dwordx4 v0, s[12:15], s78 offen offset:0 nt lds
    v_mfma_f32_16x16x32_bf16 a[28:31], a[244:247], v[28:31], a[28:31]
    s_mov_b32 m0, 25376
    s_nop 0
    buffer_load_dwordx4 v0, s[12:15], s78 offen offset:1024 nt lds
    s_mov_b32 m0, 25408
    s_nop 0
    buffer_load_dwordx4 v0, s[12:15], s78 offen offset:2048 nt lds
    v_mfma_f32_16x16x32_bf16 a[36:39], a[244:247], v[32:35], a[36:39]
    s_mov_b32 m0, 25440
    s_nop 0
    buffer_load_dwordx4 v0, s[12:15], s78 offen offset:3072 nt lds
    v_mfma_f32_16x16x32_bf16 a[44:47], a[244:247], v[36:39], a[44:47]
    s_mov_b32 m0, 29568
    s_nop 0
    buffer_load_dwordx4 v0, s[12:15], s79 offen offset:0 nt lds
    s_mov_b32 m0, 29600
    s_nop 0
    buffer_load_dwordx4 v0, s[12:15], s79 offen offset:1024 nt lds
    s_waitcnt lgkmcnt(0)
    v_mfma_f32_16x16x32_bf16 a[48:51], a[248:251], v[16:19], a[48:51]
    s_mov_b32 m0, 29632
    s_nop 0
    buffer_load_dwordx4 v0, s[12:15], s79 offen offset:2048 nt lds
    v_mfma_f32_16x16x32_bf16 a[56:59], a[248:251], v[20:23], a[56:59]
    s_mov_b32 m0, 29664
    s_nop 0
    buffer_load_dwordx4 v0, s[12:15], s79 offen offset:3072 nt lds
    s_mov_b32 s78, s81
    s_mov_b32 s79, s82
    s_add_u32 s81, s81, 8192
    s_add_u32 s82, s82, 8192
    v_mfma_f32_16x16x32_bf16 a[64:67], a[248:251], v[24:27], a[64:67]
    s_cmp_eq_u32 s80, 1
    s_cbranch_scc1 L_qa5
    ds_write_b64 v10, v[70:71] offset:12288
    ds_write_b64 v10, v[82:83] offset:12800
    ds_write_b64 v10, v[94:95] offset:13312
    ds_write_b64 v10, v[106:107] offset:13824
    ds_write_b64 v10, v[118:119] offset:14336
    ds_write_b64 v10, v[130:131] offset:14848
    s_branch L_qb5
L_qa5:
    ds_write_b128 v9, v[208:211] offset:12288
    ds_write_b128 v9, v[212:215] offset:13312
    ds_write_b128 v9, v[216:219] offset:14336
L_qb5:
    s_waitcnt lgkmcnt(0)
    s_waitcnt vmcnt(38)
    s_barrier
    ds_read_b64_tr_b16 a[240:241], v3 offset:8480
    ds_read_b64_tr_b16 a[242:243], v3 offset:8992
    ds_read_b64_tr_b16 a[244:245], v3 offset:16896
    ds_read_b64_tr_b16 a[246:247], v3 offset:17408
    s_mov_b32 m0, 67584
    s_add_u32 s75, s83, 0
    buffer_load_dwordx4 v8, s[24:27], s75 offen offset:0 lds
    s_mov_b32 m0, 67360
    s_nop 0
    buffer_load_dwordx4 v8, s[24:27], s75 offen offset:1280 lds
    s_mov_b32 m0, 67136
    s_nop 0
    buffer_load_dwordx4 v8, s[24:27], s75 offen offset:2560 lds
    s_mov_b32 m0, 66912
    s_nop 0
    buffer_load_dwordx4 v8, s[24:27], s75 offen offset:3840 lds
    s_mov_b32 m0, 71808
    s_add_u32 s75, s83, 5120
    buffer_load_dwordx4 v8, s[24:27], s75 offen offset:0 lds
    s_mov_b32 m0, 71584
    s_nop 0
    buffer_load_dwordx4 v8, s[24:27], s75 offen offset:1280 lds
    s_mov_b32 m0, 71360
    s_nop 0
    buffer_load_dwordx4 v8, s[24:27], s75 offen offset:2560 lds
    v_mfma_f32_16x16x32_bf16 a[72:75], a[248:251], v[28:31], a[72:75]
    s_mov_b32 m0, 71136
    s_nop 0
    buffer_load_dwordx4 v8, s[24:27], s75 offen offset:3840 lds
    v_mfma_f32_16x16x32_bf16 a[80:83], a[248:251], v[32:35], a[80:83]
    s_mov_b32 m0, 33792
    s_nop 0
    buffer_load_dwordx4 v0, s[8:11], s81 offen offset:0 nt lds
    v_mfma_f32_16x16x32_bf16 a[88:91], a[248:251], v[36:39], a[88:91]
    s_mov_b32 m0, 33824
    s_nop 0
    buffer_load_dwordx4 v0, s[8:11], s81 offen offset:1024 nt lds
    s_mov_b32 m0, 33856
    s_nop 0
    buffer_load_dwordx4 v0, s[8:11], s81 offen offset:2048 nt lds
    s_waitcnt lgkmcnt(2)
    v_mfma_f32_16x16x32_bf16 a[52:55], a[240:243], v[16:19], a[52:55]
    s_mov_b32 m0, 33888
    s_nop 0
    buffer_load_dwordx4 v0, s[8:11], s81 offen offset:3072 nt lds
    v_mfma_f32_16x16x32_bf16 a[60:63], a[240:243], v[20:23], a[60:63]
    s_mov_b32 m0, 38016
    s_nop 0
    buffer_load_dwordx4 v0, s[8:11], s82 offen offset:0 nt lds
    v_mfma_f32_16x16x32_bf16 a[68:71], a[240:243], v[24:27], a[68:71]
    s_mov_b32 m0, 38048
    s_nop 0
    buffer_load_dwordx4 v0, s[8:11], s82 offen offset:1024 nt lds
    v_mfma_f32_16x16x32_bf16 a[76:79], a[240:243], v[28:31], a[76:79]
    s_mov_b32 m0, 38080
    s_nop 0
    buffer_load_dwordx4 v0, s[8:11], s82 offen offset:2048 nt lds
    s_mov_b32 m0, 38112
    s_nop 0
    buffer_load_dwordx4 v0, s[8:11], s82 offen offset:3072 nt lds
    v_mfma_f32_16x16x32_bf16 a[84:87], a[240:243], v[32:35], a[84:87]
    s_mov_b32 m0, 42240
    s_nop 0
    buffer_load_dwordx4 v0, s[12:15], s78 offen offset:0 nt lds
    v_mfma_f32_16x16x32_bf16 a[92:95], a[240:243], v[36:39], a[92:95]
    s_mov_b32 m0, 42272
    s_nop 0
    buffer_load_dwordx4 v0, s[12:15], s78 offen offset:1024 nt lds
    s_waitcnt lgkmcnt(0)
    v_mfma_f32_16x16x32_bf16 a[96:99], a[244:247], v[16:19], a[96:99]
    s_mov_b32 m0, 42304
    s_nop 0
    buffer_load_dwordx4 v0, s[12:15], s78 offen offset:2048 nt lds
    v_mfma_f32_16x16x32_bf16 a[104:107], a[244:247], v[20:23], a[104:107]
    s_mov_b32 m0, 42336
    s_nop 0
    buffer_load_dwordx4 v0, s[12:15], s78 offen offset:3072 nt lds
    s_mov_b32 m0, 46464
    s_nop 0
    buffer_load_dwordx4 v0, s[12:15], s79 offen offset:0 nt lds
    v_mfma_f32_16x16x32_bf16 a[112:115], a[244:247], v[24:27], a[112:115]
    s_mov_b32 m0, 46496
    s_nop 0
    buffer_load_dwordx4 v0, s[12:15], s79 offen offset:1024 nt lds
    v_mfma_f32_16x16x32_bf16 a[120:123], a[244:247], v[28:31], a[120:123]
    s_mov_b32 m0, 46528
    s_nop 0
    buffer_load_dwordx4 v0, s[12:15], s79 offen offset:2048 nt lds
    v_mfma_f32_16x16x32_bf16 a[128:131], a[244:247], v[32:35], a[128:131]
    s_mov_b32 m0, 46560
    s_nop 0
    buffer_load_dwordx4 v0, s[12:15], s79 offen offset:3072 nt lds
    s_mov_b32 s78, s81
    s_mov_b32 s79, s82
    s_add_u32 s81, s81, 8192
    s_add_u32 s82, s82, 8192
    v_mfma_f32_16x16x32_bf16 a[136:139], a[244:247], v[36:39], a[136:139]
    s_cmp_eq_u32 s80, 1
    s_cbranch_scc1 L_qa6
    ds_write_b64 v10, v[142:143] offset:15360
    ds_write_b64 v10, v[154:155] offset:15872
    ds_write_b64 v10, v[72:73] offset:16384
    ds_write_b64 v10, v[84:85] offset:16896
    ds_write_b64 v10, v[96:97] offset:17408
    ds_write_b64 v10, v[108:109] offset:17920
    s_branch L_qb6
L_qa6:
    ds_write_b128 v9, v[220:223] offset:15360
    ds_write_b128 v9, v[224:227] offset:16384
    ds_write_b128 v9, v[228:231] offset:17408
L_qb6:
    s_waitcnt lgkmcnt(0)
    s_waitcnt vmcnt(38)
    s_barrier
    ds_read_b64_tr_b16 a[248:249], v3 offset:16928
    ds_read_b64_tr_b16 a[250:251], v3 offset:17440
    ds_read_b64_tr_b16 a[240:241], v3 offset:25344
    ds_read_b64_tr_b16 a[242:243], v3 offset:25856
    ds_read_b64_tr_b16 a[244:245], v3 offset:25376
    ds_read_b64_tr_b16 a[246:247], v3 offset:25888
    s_mov_b32 m0, 76032
    s_add_u32 s75, s83, 256
    buffer_load_dwordx4 v8, s[24:27], s75 offen offset:0 lds
    s_mov_b32 m0, 75808
    s_nop 0
    buffer_load_dwordx4 v8, s[24:27], s75 offen offset:1280 lds
    s_mov_b32 m0, 75584
    s_nop 0
    buffer_load_dwordx4 v8, s[24:27], s75 offen offset:2560 lds
    s_mov_b32 m0, 75360
    s_nop 0
    buffer_load_dwordx4 v8, s[24:27], s75 offen offset:3840 lds
    s_mov_b32 m0, 80256
    s_add_u32 s75, s83, 5376
    buffer_load_dwordx4 v8, s[24:27], s75 offen offset:0 lds
    s_mov_b32 m0, 80032
    s_nop 0
    buffer_load_dwordx4 v8, s[24:27], s75 offen offset:1280 lds
    s_mov_b32 m0, 79808
    s_nop 0
    buffer_load_dwordx4 v8, s[24:27], s75 offen offset:2560 lds
    s_waitcnt lgkmcnt(4)
    v_mfma_f32_16x16x32_bf16 a[100:103], a[248:251], v[16:19], a[100:103]
    s_mov_b32 m0, 79584
    s_nop 0
    buffer_load_dwordx4 v8, s[24:27], s75 offen offset:3840 lds
    v_mfma_f32_16x16x32_bf16 a[108:111], a[248:251], v[20:23], a[108:111]
    s_mov_b32 m0, 50688
    s_nop 0
    buffer_load_dwordx4 v0, s[8:11], s81 offen offset:0 nt lds
    v_mfma_f32_16x16x32_bf16 a[116:119], a[248:251], v[24:27], a[116:119]
    s_mov_b32 m0, 50720
    s_nop 0
    buffer_load_dwordx4 v0, s[8:11], s81 offen offset:1024 nt lds
    s_mov_b32 m0, 50752
    s_nop 0
    buffer_load_dwordx4 v0, s[8:11], s81 offen offset:2048 nt lds
    v_mfma_f32_16x16x32_bf16 a[124:127], a[248:251], v[28:31], a[124:127]
    s_mov_b32 m0, 50784
    s_nop 0
    buffer_load_dwordx4 v0, s[8:11], s81 offen offset:3072 nt lds
    v_mfma_f32_16x16x32_bf16 a[132:135], a[248:251], v[32:35], a[132:135]
    s_mov_b32 m0, 54912
    s_nop 0
    buffer_load_dwordx4 v0, s[8:11], s82 offen offset:0 nt lds
    v_mfma_f32_16x16x32_bf16 a[140:143], a[248:251], v[36:39], a[140:143]
    s_mov_b32 m0, 54944
    s_nop 0
    buffer_load_dwordx4 v0, s[8:11], s82 offen offset:1024 nt lds
    s_waitcnt lgkmcnt(2)
    v_mfma_f32_16x16x32_bf16 a[144:147], a[240:243], v[16:19], a[144:147]
    s_mov_b32 m0, 54976
    s_nop 0
    buffer_load_dwordx4 v0, s[8:11], s82 offen offset:2048 nt lds
    s_mov_b32 m0, 55008
    s_nop 0
    buffer_load_dwordx4 v0, s[8:11], s82 offen offset:3072 nt lds
    v_mfma_f32_16x16x32_bf16 a[152:155], a[240:243], v[20:23], a[152:155]
    s_mov_b32 m0, 59136
    s_nop 0
    buffer_load_dwordx4 v0, s[12:15], s78 offen offset:0 nt lds
    v_mfma_f32_16x16x32_bf16 a[160:163], a[240:243], v[24:27], a[160:163]
    s_mov_b32 m0, 59168
    s_nop 0
    buffer_load_dwordx4 v0, s[12:15], s78 offen offset:1024 nt lds
    v_mfma_f32_16x16x32_bf16 a[168:171], a[240:243], v[28:31], a[168:171]
    s_mov_b32 m0, 59200
    s_nop 0
    buffer_load_dwordx4 v0, s[12:15], s78 offen offset:2048 nt lds
    v_mfma_f32_16x16x32_bf16 a[176:179], a[240:243], v[32:35], a[176:179]
    s_mov_b32 m0, 59232
    s_nop 0
    buffer_load_dwordx4 v0, s[12:15], s78 offen offset:3072 nt lds
    s_mov_b32 m0, 63360
    s_nop 0
    buffer_load_dwordx4 v0, s[12:15], s79 offen offset:0 nt lds
    v_mfma_f32_16x16x32_bf16 a[184:187], a[240:243], v[36:39], a[184:187]
    s_mov_b32 m0, 63392
    s_nop 0
    buffer_load_dwordx4 v0, s[12:15], s79 offen offset:1024 nt lds
    s_waitcnt lgkmcnt(0)
    v_mfma_f32_16x16x32_bf16 a[148:151], a[244:247], v[16:19], a[148:151]
    s_mov_b32 m0, 63424
    s_nop 0
    buffer_load_dwordx4 v0, s[12:15], s79 offen offset:2048 nt lds
    v_mfma_f32_16x16x32_bf16 a[156:159], a[244:247], v[20:23], a[156:159]
    s_mov_b32 m0, 63456
    s_nop 0
    buffer_load_dwordx4 v0, s[12:15], s79 offen offset:3072 nt lds
    s_mov_b32 s78, s81
    s_mov_b32 s79, s82
    s_add_u32 s81, s81, 8192
    s_add_u32 s82, s82, 8192
    v_mfma_f32_16x16x32_bf16 a[164:167], a[244:247], v[24:27], a[164:167]
    s_cmp_eq_u32 s80, 1
    s_cbranch_scc1 L_qa7
    ds_write_b64 v10, v[120:121] offset:18432
    ds_write_b64 v10, v[132:133] offset:18944
    ds_write_b64 v10, v[144:145] offset:19456
    ds_write_b64 v10, v[156:157] offset:19968
    ds_write_b64 v10, v[74:75] offset:20480
    ds_write_b64 v10, v[86:87] offset:20992
    s_branch L_qb7
L_qa7:
    ds_write_b128 v9, v[232:235] offset:18432
    ds_write_b128 v9, v[236:239] offset:19456
    ds_write_b128 v9, v[240:243] offset:20480
L_qb7:
    s_waitcnt lgkmcnt(0)
    s_waitcnt vmcnt(34)
    s_barrier
    ds_read_b64_tr_b16 a[248:249], v3 offset:33792
    ds_read_b64_tr_b16 a[250:251], v3 offset:34304
    ds_read_b64_tr_b16 a[240:241], v3 offset:33824
    ds_read_b64_tr_b16 a[242:243], v3 offset:34336
    s_mov_b32 m0, 84480
    s_add_u32 s75, s83, 512
    buffer_load_dwordx4 v8, s[24:27], s75 offen offset:0 lds
    s_mov_b32 m0, 84256
    s_nop 0
    buffer_load_dwordx4 v8, s[24:27], s75 offen offset:1280 lds
    s_mov_b32 m0, 84032
    s_nop 0
    buffer_load_dwordx4 v8, s[24:27], s75 offen offset:2560 lds
    s_mov_b32 m0, 83808
    s_nop 0
    buffer_load_dwordx4 v8, s[24:27], s75 offen offset:3840 lds
    s_mov_b32 m0, 88704
    s_add_u32 s75, s83, 5632
    buffer_load_dwordx4 v8, s[24:27], s75 offen offset:0 lds
    s_mov_b32 m0, 88480
    s_nop 0
    buffer_load_dwordx4 v8, s[24:27], s75 offen offset:1280 lds
    s_mov_b32 m0, 88256
    s_nop 0
    buffer_load_dwordx4 v8, s[24:27], s75 offen offset:2560 lds
    s_mov_b32 m0, 88032
    s_nop 0
    buffer_load_dwordx4 v8, s[24:27], s75 offen offset:3840 lds
    v_mfma_f32_16x16x32_bf16 a[172:175], a[244:247], v[28:31], a[172:175]
    s_mov_b32 m0, 92928
    s_add_u32 s75, s83, 768
    buffer_load_dwordx4 v8, s[24:27], s75 offen offset:0 lds
    v_mfma_f32_16x16x32_bf16 a[180:183], a[244:247], v[32:35], a[180:183]
    s_mov_b32 m0, 92704
    s_nop 0
    buffer_load_dwordx4 v8, s[24:27], s75 offen offset:1280 lds
    s_mov_b32 m0, 92480
    s_nop 0
    buffer_load_dwordx4 v8, s[24:27], s75 offen offset:2560 lds
    v_mfma_f32_16x16x32_bf16 a[188:191], a[244:247], v[36:39], a[188:191]
    s_mov_b32 m0, 92256
    s_nop 0
    buffer_load_dwordx4 v8, s[24:27], s75 offen offset:3840 lds
    s_waitcnt lgkmcnt(2)
    v_mfma_f32_16x16x32_bf16 a[192:195], a[248:251], v[16:19], a[192:195]
    s_mov_b32 m0, 0
    s_nop 0
    buffer_load_dwordx4 v0, s[8:11], s81 offen offset:0 nt lds
    s_mov_b32 m0, 32
    s_nop 0
    buffer_load_dwordx4 v0, s[8:11], s81 offen offset:1024 nt lds
    v_mfma_f32_16x16x32_bf16 a[200:203], a[248:251], v[20:23], a[200:203]
    s_mov_b32 m0, 64
    s_nop 0
    buffer_load_dwordx4 v0, s[8:11], s81 offen offset:2048 nt lds
    v_mfma_f32_16x16x32_bf16 a[208:211], a[248:251], v[24:27], a[208:211]
    s_mov_b32 m0, 96
    s_nop 0
    buffer_load_dwordx4 v0, s[8:11], s81 offen offset:3072 nt lds
    s_mov_b32 m0, 4224
    s_nop 0
    buffer_load_dwordx4 v0, s[8:11], s82 offen offset:0 nt lds
    v_mfma_f32_16x16x32_bf16 a[216:219], a[248:251], v[28:31], a[216:219]
    s_mov_b32 m0, 4256
    s_nop 0
    buffer_load_dwordx4 v0, s[8:11], s82 offen offset:1024 nt lds
    v_mfma_f32_16x16x32_bf16 a[224:227], a[248:251], v[32:35], a[224:227]
    s_mov_b32 m0, 4288
    s_nop 0
    buffer_load_dwordx4 v0, s[8:11], s82 offen offset:2048 nt lds
    s_mov_b32 m0, 4320
    s_nop 0
    buffer_load_dwordx4 v0, s[8:11], s82 offen offset:3072 nt lds
    v_mfma_f32_16x16x32_bf16 a[232:235], a[248:251], v[36:39], a[232:235]
    s_mov_b32 m0, 8448
    s_nop 0
    buffer_load_dwordx4 v0, s[12:15], s78 offen offset:0 nt lds
    s_waitcnt lgkmcnt(0)
    v_mfma_f32_16x16x32_bf16 a[196:199], a[240:243], v[16:19], a[196:199]
    s_mov_b32 m0, 8480
    s_nop 0
    buffer_load_dwordx4 v0, s[12:15], s78 offen offset:1024 nt lds
    s_mov_b32 m0, 8512
    s_nop 0
    buffer_load_dwordx4 v0, s[12:15], s78 offen offset:2048 nt lds
    v_mfma_f32_16x16x32_bf16 a[204:207], a[240:243], v[20:23], a[204:207]
    s_mov_b32 m0, 8544
    s_nop 0
    buffer_load_dwordx4 v0, s[12:15], s78 offen offset:3072 nt lds
    v_mfma_f32_16x16x32_bf16 a[212:215], a[240:243], v[24:27], a[212:215]
    s_mov_b32 m0, 12672
    s_nop 0
    buffer_load_dwordx4 v0, s[12:15], s79 offen offset:0 nt lds
    s_mov_b32 m0, 12704
    s_nop 0
    buffer_load_dwordx4 v0, s[12:15], s79 offen offset:1024 nt lds
    v_mfma_f32_16x16x32_bf16 a[220:223], a[240:243], v[28:31], a[220:223]
    s_mov_b32 m0, 12736
    s_nop 0
    buffer_load_dwordx4 v0, s[12:15], s79 offen offset:2048 nt lds
    v_mfma_f32_16x16x32_bf16 a[228:231], a[240:243], v[32:35], a[228:231]
    s_mov_b32 m0, 12768
    s_nop 0
    buffer_load_dwordx4 v0, s[12:15], s79 offen offset:3072 nt lds
    s_mov_b32 s78, s81
    s_mov_b32 s79, s82
    s_add_u32 s81, s81, 8192
    s_add_u32 s82, s82, 8192
    v_mfma_f32_16x16x32_bf16 a[236:239], a[240:243], v[36:39], a[236:239]
    s_cmp_eq_u32 s80, 1
    s_cbranch_scc1 L_qa8
    ds_write_b64 v10, v[98:99] offset:21504
    ds_write_b64 v10, v[110:111] offset:22016
    ds_write_b64 v10, v[122:123] offset:22528
    ds_write_b64 v10, v[134:135] offset:23040
    ds_write_b64 v10, v[146:147] offset:23552
    ds_write_b64 v10, v[158:159] offset:24064
    s_branch L_qb8
L_qa8:
    ds_write_b128 v9, v[244:247] offset:21504
    ds_write_b128 v9, v[248:251] offset:22528
    ds_write_b128 v9, v[252:255] offset:23552
L_qb8:
    s_waitcnt lgkmcnt(0)
    s_waitcnt vmcnt(34)
    s_barrier
    ds_read_b128 v[16:19], v4 offset:2048
    ds_read_b64_tr_b16 a[240:241], v3 offset:0
    ds_read_b64_tr_b16 a[242:243], v3 offset:512
    ds_read_b128 v[20:23], v4 offset:6144
    ds_read_b128 v[24:27], v4 offset:10240
    ds_read_b128 v[28:31], v4 offset:14336
    ds_read_b128 v[32:35], v4 offset:18432
    ds_read_b128 v[36:39], v4 offset:22528
    ds_read_b64_tr_b16 a[244:245], v3 offset:32
    ds_read_b64_tr_b16 a[246:247], v3 offset:544
    ds_read_b64_tr_b16 a[248:249], v3 offset:8448
    ds_read_b64_tr_b16 a[250:251], v3 offset:8960
    s_mov_b32 m0, 97152
    s_add_u32 s75, s83, 5888
    buffer_load_dwordx4 v8, s[24:27], s75 offen offset:0 lds
    s_mov_b32 m0, 96928
    s_nop 0
    buffer_load_dwordx4 v8, s[24:27], s75 offen offset:1280 lds
    s_mov_b32 m0, 96704
    s_nop 0
    buffer_load_dwordx4 v8, s[24:27], s75 offen offset:2560 lds
    s_mov_b32 m0, 96480
    s_nop 0
    buffer_load_dwordx4 v8, s[24:27], s75 offen offset:3840 lds
    s_mov_b32 m0, 101376
    s_add_u32 s75, s83, 1024
    buffer_load_dwordx4 v8, s[24:27], s75 offen offset:0 lds
    s_mov_b32 m0, 101152
    s_nop 0
    buffer_load_dwordx4 v8, s[24:27], s75 offen offset:1280 lds
    s_mov_b32 m0, 100928
    s_nop 0
    buffer_load_dwordx4 v8, s[24:27], s75 offen offset:2560 lds
    s_mov_b32 m0, 100704
    s_nop 0
    buffer_load_dwordx4 v8, s[24:27], s75 offen offset:3840 lds
    s_waitcnt lgkmcnt(9)
    v_mfma_f32_16x16x32_bf16 a[0:3], a[240:243], v[16:19], a[0:3]
    s_mov_b32 m0, 105600
    s_add_u32 s75, s83, 6144
    buffer_load_dwordx4 v8, s[24:27], s75 offen offset:0 lds
    s_waitcnt lgkmcnt(8)
    v_mfma_f32_16x16x32_bf16 a[8:11], a[240:243], v[20:23], a[8:11]
    s_mov_b32 m0, 105376
    s_nop 0
    buffer_load_dwordx4 v8, s[24:27], s75 offen offset:1280 lds
    s_mov_b32 m0, 105152
    s_nop 0
    buffer_load_dwordx4 v8, s[24:27], s75 offen offset:2560 lds
    s_waitcnt lgkmcnt(7)
    v_mfma_f32_16x16x32_bf16 a[16:19], a[240:243], v[24:27], a[16:19]
    s_mov_b32 m0, 104928
    s_nop 0
    buffer_load_dwordx4 v8, s[24:27], s75 offen offset:3840 lds
    s_add_u32 s83, s83, 40960
    s_waitcnt lgkmcnt(6)
    v_mfma_f32_16x16x32_bf16 a[24:27], a[240:243], v[28:31], a[24:27]
    s_mov_b32 m0, 16896
    s_nop 0
    buffer_load_dwordx4 v0, s[8:11], s81 offen offset:0 nt lds
    s_mov_b32 m0, 16928
    s_nop 0
    buffer_load_dwordx4 v0, s[8:11], s81 offen offset:1024 nt lds
    s_waitcnt lgkmcnt(5)
    v_mfma_f32_16x16x32_bf16 a[32:35], a[240:243], v[32:35], a[32:35]
    s_mov_b32 m0, 16960
    s_nop 0
    buffer_load_dwordx4 v0, s[8:11], s81 offen offset:2048 nt lds
    s_waitcnt lgkmcnt(4)
    v_mfma_f32_16x16x32_bf16 a[40:43], a[240:243], v[36:39], a[40:43]
    s_mov_b32 m0, 16992
    s_nop 0
    buffer_load_dwordx4 v0, s[8:11], s81 offen offset:3072 nt lds
    s_mov_b32 m0, 21120
    s_nop 0
    buffer_load_dwordx4 v0, s[8:11], s82 offen offset:0 nt lds
    s_waitcnt lgkmcnt(2)
    v_mfma_f32_16x16x32_bf16 a[4:7], a[244:247], v[16:19], a[4:7]
    s_mov_b32 m0, 21152
    s_nop 0
    buffer_load_dwordx4 v0, s[8:11], s82 offen offset:1024 nt lds
    v_mfma_f32_16x16x32_bf16 a[12:15], a[244:247], v[20:23], a[12:15]
    s_mov_b32 m0, 21184
    s_nop 0
    buffer_load_dwordx4 v0, s[8:11], s82 offen offset:2048 nt lds
    s_mov_b32 m0, 21216
    s_nop 0
    buffer_load_dwordx4 v0, s[8:11], s82 offen offset:3072 nt lds
    v_mfma_f32_16x16x32_bf16 a[20:23], a[244:247], v[24:27], a[20:23]
    s_mov_b32 m0, 25344
    s_nop 0
    buffer_load_dwordx4 v0, s[12:15], s78 offen offset:0 nt lds
    v_mfma_f32_16x16x32_bf16 a[28:31], a[244:247], v[28:31], a[28:31]
    s_mov_b32 m0, 25376
    s_nop 0
    buffer_load_dwordx4 v0, s[12:15], s78 offen offset:1024 nt lds
    s_mov_b32 m0, 25408
    s_nop 0
    buffer_load_dwordx4 v0, s[12:15], s78 offen offset:2048 nt lds
    v_mfma_f32_16x16x32_bf16 a[36:39], a[244:247], v[32:35], a[36:39]
    s_mov_b32 m0, 25440
    s_nop 0
    buffer_load_dwordx4 v0, s[12:15], s78 offen offset:3072 nt lds
    v_mfma_f32_16x16x32_bf16 a[44:47], a[244:247], v[36:39], a[44:47]
    s_mov_b32 m0, 29568
    s_nop 0
    buffer_load_dwordx4 v0, s[12:15], s79 offen offset:0 nt lds
    s_mov_b32 m0, 29600
    s_nop 0
    buffer_load_dwordx4 v0, s[12:15], s79 offen offset:1024 nt lds
    s_waitcnt lgkmcnt(0)
    v_mfma_f32_16x16x32_bf16 a[48:51], a[248:251], v[16:19], a[48:51]
    s_mov_b32 m0, 29632
    s_nop 0
    buffer_load_dwordx4 v0, s[12:15], s79 offen offset:2048 nt lds
    v_mfma_f32_16x16x32_bf16 a[56:59], a[248:251], v[20:23], a[56:59]
    s_mov_b32 m0, 29664
    s_nop 0
    buffer_load_dwordx4 v0, s[12:15], s79 offen offset:3072 nt lds
    s_mov_b32 s78, s81
    s_mov_b32 s79, s82
    s_add_u32 s81, s81, 8192
    s_add_u32 s82, s82, 8192
    v_mfma_f32_16x16x32_bf16 a[64:67], a[248:251], v[24:27], a[64:67]
    s_waitcnt vmcnt(38)
    s_barrier
    ds_read_b64_tr_b16 a[240:241], v3 offset:8480
    ds_read_b64_tr_b16 a[242:243], v3 offset:8992
    ds_read_b64_tr_b16 a[244:245], v3 offset:16896
    ds_read_b64_tr_b16 a[246:247], v3 offset:17408
    s_mov_b32 m0, 67584
    s_add_u32 s75, s83, 0
    buffer_load_dwordx4 v8, s[24:27], s75 offen offset:0 lds
    s_mov_b32 m0, 67360
    s_nop 0
    buffer_load_dwordx4 v8, s[24:27], s75 offen offset:1280 lds
    s_mov_b32 m0, 67136
    s_nop 0
    buffer_load_dwordx4 v8, s[24:27], s75 offen offset:2560 lds
    s_mov_b32 m0, 66912
    s_nop 0
    buffer_load_dwordx4 v8, s[24:27], s75 offen offset:3840 lds
    s_mov_b32 m0, 71808
    s_add_u32 s75, s83, 5120
    buffer_load_dwordx4 v8, s[24:27], s75 offen offset:0 lds
    s_mov_b32 m0, 71584
    s_nop 0
    buffer_load_dwordx4 v8, s[24:27], s75 offen offset:1280 lds
    s_mov_b32 m0, 71360
    s_nop 0
    buffer_load_dwordx4 v8, s[24:27], s75 offen offset:2560 lds
    v_mfma_f32_16x16x32_bf16 a[72:75], a[248:251], v[28:31], a[72:75]
    s_mov_b32 m0, 71136
    s_nop 0
    buffer_load_dwordx4 v8, s[24:27], s75 offen offset:3840 lds
    v_mfma_f32_16x16x32_bf16 a[80:83], a[248:251], v[32:35], a[80:83]
    s_mov_b32 m0, 33792
    s_nop 0
    buffer_load_dwordx4 v0, s[8:11], s81 offen offset:0 nt lds
    v_mfma_f32_16x16x32_bf16 a[88:91], a[248:251], v[36:39], a[88:91]
    s_mov_b32 m0, 33824
    s_nop 0
    buffer_load_dwordx4 v0, s[8:11], s81 offen offset:1024 nt lds
    s_mov_b32 m0, 33856
    s_nop 0
    buffer_load_dwordx4 v0, s[8:11], s81 offen offset:2048 nt lds
    s_waitcnt lgkmcnt(2)
    v_mfma_f32_16x16x32_bf16 a[52:55], a[240:243], v[16:19], a[52:55]
    s_mov_b32 m0, 33888
    s_nop 0
    buffer_load_dwordx4 v0, s[8:11], s81 offen offset:3072 nt lds
    v_mfma_f32_16x16x32_bf16 a[60:63], a[240:243], v[20:23], a[60:63]
    s_mov_b32 m0, 38016
    s_nop 0
    buffer_load_dwordx4 v0, s[8:11], s82 offen offset:0 nt lds
    v_mfma_f32_16x16x32_bf16 a[68:71], a[240:243], v[24:27], a[68:71]
    s_mov_b32 m0, 38048
    s_nop 0
    buffer_load_dwordx4 v0, s[8:11], s82 offen offset:1024 nt lds
    v_mfma_f32_16x16x32_bf16 a[76:79], a[240:243], v[28:31], a[76:79]
    s_mov_b32 m0, 38080
    s_nop 0
    buffer_load_dwordx4 v0, s[8:11], s82 offen offset:2048 nt lds
    s_mov_b32 m0, 38112
    s_nop 0
    buffer_load_dwordx4 v0, s[8:11], s82 offen offset:3072 nt lds
    v_mfma_f32_16x16x32_bf16 a[84:87], a[240:243], v[32:35], a[84:87]
    s_mov_b32 m0, 42240
    s_nop 0
    buffer_load_dwordx4 v0, s[12:15], s78 offen offset:0 nt lds
    v_mfma_f32_16x16x32_bf16 a[92:95], a[240:243], v[36:39], a[92:95]
    s_mov_b32 m0, 42272
    s_nop 0
    buffer_load_dwordx4 v0, s[12:15], s78 offen offset:1024 nt lds
    s_waitcnt lgkmcnt(0)
    v_mfma_f32_16x16x32_bf16 a[96:99], a[244:247], v[16:19], a[96:99]
    s_mov_b32 m0, 42304
    s_nop 0
    buffer_load_dwordx4 v0, s[12:15], s78 offen offset:2048 nt lds
    v_mfma_f32_16x16x32_bf16 a[104:107], a[244:247], v[20:23], a[104:107]
    s_mov_b32 m0, 42336
    s_nop 0
    buffer_load_dwordx4 v0, s[12:15], s78 offen offset:3072 nt lds
    s_mov_b32 m0, 46464
    s_nop 0
    buffer_load_dwordx4 v0, s[12:15], s79 offen offset:0 nt lds
    v_mfma_f32_16x16x32_bf16 a[112:115], a[244:247], v[24:27], a[112:115]
    s_mov_b32 m0, 46496
    s_nop 0
    buffer_load_dwordx4 v0, s[12:15], s79 offen offset:1024 nt lds
    v_mfma_f32_16x16x32_bf16 a[120:123], a[244:247], v[28:31], a[120:123]
    s_mov_b32 m0, 46528
    s_nop 0
    buffer_load_dwordx4 v0, s[12:15], s79 offen offset:2048 nt lds
    v_mfma_f32_16x16x32_bf16 a[128:131], a[244:247], v[32:35], a[128:131]
    s_mov_b32 m0, 46560
    s_nop 0
    buffer_load_dwordx4 v0, s[12:15], s79 offen offset:3072 nt lds
    s_mov_b32 s78, s81
    s_mov_b32 s79, s82
    s_add_u32 s81, s81, 8192
    s_add_u32 s82, s82, 8192
    v_mfma_f32_16x16x32_bf16 a[136:139], a[244:247], v[36:39], a[136:139]
    s_waitcnt vmcnt(38)
    s_barrier
    ds_read_b64_tr_b16 a[248:249], v3 offset:16928
    ds_read_b64_tr_b16 a[250:251], v3 offset:17440
    ds_read_b64_tr_b16 a[240:241], v3 offset:25344
    ds_read_b64_tr_b16 a[242:243], v3 offset:25856
    ds_read_b64_tr_b16 a[244:245], v3 offset:25376
    ds_read_b64_tr_b16 a[246:247], v3 offset:25888
    s_mov_b32 m0, 76032
    s_add_u32 s75, s83, 256
    buffer_load_dwordx4 v8, s[24:27], s75 offen offset:0 lds
    s_mov_b32 m0, 75808
    s_nop 0
    buffer_load_dwordx4 v8, s[24:27], s75 offen offset:1280 lds
    s_mov_b32 m0, 75584
    s_nop 0
    buffer_load_dwordx4 v8, s[24:27], s75 offen offset:2560 lds
    s_mov_b32 m0, 75360
    s_nop 0
    buffer_load_dwordx4 v8, s[24:27], s75 offen offset:3840 lds
    s_mov_b32 m0, 80256
    s_add_u32 s75, s83, 5376
    buffer_load_dwordx4 v8, s[24:27], s75 offen offset:0 lds
    s_mov_b32 m0, 80032
    s_nop 0
    buffer_load_dwordx4 v8, s[24:27], s75 offen offset:1280 lds
    s_mov_b32 m0, 79808
    s_nop 0
    buffer_load_dwordx4 v8, s[24:27], s75 offen offset:2560 lds
    s_waitcnt lgkmcnt(4)
    v_mfma_f32_16x16x32_bf16 a[100:103], a[248:251], v[16:19], a[100:103]
    s_mov_b32 m0, 79584
    s_nop 0
    buffer_load_dwordx4 v8, s[24:27], s75 offen offset:3840 lds
    v_mfma_f32_16x16x32_bf16 a[108:111], a[248:251], v[20:23], a[108:111]
    s_mov_b32 m0, 50688
    s_nop 0
    buffer_load_dwordx4 v0, s[8:11], s81 offen offset:0 nt lds
    v_mfma_f32_16x16x32_bf16 a[116:119], a[248:251], v[24:27], a[116:119]
    s_mov_b32 m0, 50720
    s_nop 0
    buffer_load_dwordx4 v0, s[8:11], s81 offen offset:1024 nt lds
    s_mov_b32 m0, 50752
    s_nop 0
    buffer_load_dwordx4 v0, s[8:11], s81 offen offset:2048 nt lds
    v_mfma_f32_16x16x32_bf16 a[124:127], a[248:251], v[28:31], a[124:127]
    s_mov_b32 m0, 50784
    s_nop 0
    buffer_load_dwordx4 v0, s[8:11], s81 offen offset:3072 nt lds
    v_mfma_f32_16x16x32_bf16 a[132:135], a[248:251], v[32:35], a[132:135]
    s_mov_b32 m0, 54912
    s_nop 0
    buffer_load_dwordx4 v0, s[8:11], s82 offen offset:0 nt lds
    v_mfma_f32_16x16x32_bf16 a[140:143], a[248:251], v[36:39], a[140:143]
    s_mov_b32 m0, 54944
    s_nop 0
    buffer_load_dwordx4 v0, s[8:11], s82 offen offset:1024 nt lds
    s_waitcnt lgkmcnt(2)
    v_mfma_f32_16x16x32_bf16 a[144:147], a[240:243], v[16:19], a[144:147]
    s_mov_b32 m0, 54976
    s_nop 0
    buffer_load_dwordx4 v0, s[8:11], s82 offen offset:2048 nt lds
    s_mov_b32 m0, 55008
    s_nop 0
    buffer_load_dwordx4 v0, s[8:11], s82 offen offset:3072 nt lds
    v_mfma_f32_16x16x32_bf16 a[152:155], a[240:243], v[20:23], a[152:155]
    s_mov_b32 m0, 59136
    s_nop 0
    buffer_load_dwordx4 v0, s[12:15], s78 offen offset:0 nt lds
    v_mfma_f32_16x16x32_bf16 a[160:163], a[240:243], v[24:27], a[160:163]
    s_mov_b32 m0, 59168
    s_nop 0
    buffer_load_dwordx4 v0, s[12:15], s78 offen offset:1024 nt lds
    v_mfma_f32_16x16x32_bf16 a[168:171], a[240:243], v[28:31], a[168:171]
    s_mov_b32 m0, 59200
    s_nop 0
    buffer_load_dwordx4 v0, s[12:15], s78 offen offset:2048 nt lds
    v_mfma_f32_16x16x32_bf16 a[176:179], a[240:243], v[32:35], a[176:179]
    s_mov_b32 m0, 59232
    s_nop 0
    buffer_load_dwordx4 v0, s[12:15], s78 offen offset:3072 nt lds
    s_mov_b32 m0, 63360
    s_nop 0
    buffer_load_dwordx4 v0, s[12:15], s79 offen offset:0 nt lds
    v_mfma_f32_16x16x32_bf16 a[184:187], a[240:243], v[36:39], a[184:187]
    s_mov_b32 m0, 63392
    s_nop 0
    buffer_load_dwordx4 v0, s[12:15], s79 offen offset:1024 nt lds
    s_waitcnt lgkmcnt(0)
    v_mfma_f32_16x16x32_bf16 a[148:151], a[244:247], v[16:19], a[148:151]
    s_mov_b32 m0, 63424
    s_nop 0
    buffer_load_dwordx4 v0, s[12:15], s79 offen offset:2048 nt lds
    v_mfma_f32_16x16x32_bf16 a[156:159], a[244:247], v[20:23], a[156:159]
    s_mov_b32 m0, 63456
    s_nop 0
    buffer_load_dwordx4 v0, s[12:15], s79 offen offset:3072 nt lds
    s_mov_b32 s78, s81
    s_mov_b32 s79, s82
    s_add_u32 s81, s81, 8192
    s_add_u32 s82, s82, 8192
    v_mfma_f32_16x16x32_bf16 a[164:167], a[244:247], v[24:27], a[164:167]
    s_waitcnt vmcnt(34)
    s_barrier
    ds_read_b64_tr_b16 a[248:249], v3 offset:33792
    ds_read_b64_tr_b16 a[250:251], v3 offset:34304
    ds_read_b64_tr_b16 a[240:241], v3 offset:33824
    ds_read_b64_tr_b16 a[242:243], v3 offset:34336
    s_mov_b32 m0, 84480
    s_add_u32 s75, s83, 512
    buffer_load_dwordx4 v8, s[24:27], s75 offen offset:0 lds
    s_mov_b32 m0, 84256
    s_nop 0
    buffer_load_dwordx4 v8, s[24:27], s75 offen offset:1280 lds
    s_mov_b32 m0, 84032
    s_nop 0
    buffer_load_dwordx4 v8, s[24:27], s75 offen offset:2560 lds
    s_mov_b32 m0, 83808
    s_nop 0
    buffer_load_dwordx4 v8, s[24:27], s75 offen offset:3840 lds
    s_mov_b32 m0, 88704
    s_add_u32 s75, s83, 5632
    buffer_load_dwordx4 v8, s[24:27], s75 offen offset:0 lds
    s_mov_b32 m0, 88480
    s_nop 0
    buffer_load_dwordx4 v8, s[24:27], s75 offen offset:1280 lds
    s_mov_b32 m0, 88256
    s_nop 0
    buffer_load_dwordx4 v8, s[24:27], s75 offen offset:2560 lds
    s_mov_b32 m0, 88032
    s_nop 0
    buffer_load_dwordx4 v8, s[24:27], s75 offen offset:3840 lds
    v_mfma_f32_16x16x32_bf16 a[172:175], a[244:247], v[28:31], a[172:175]
    s_mov_b32 m0, 92928
    s_add_u32 s75, s83, 768
    buffer_load_dwordx4 v8, s[24:27], s75 offen offset:0 lds
    v_mfma_f32_16x16x32_bf16 a[180:183], a[244:247], v[32:35], a[180:183]
    s_mov_b32 m0, 92704
    s_nop 0
    buffer_load_dwordx4 v8, s[24:27], s75 offen offset:1280 lds
    s_mov_b32 m0, 92480
    s_nop 0
    buffer_load_dwordx4 v8, s[24:27], s75 offen offset:2560 lds
    v_mfma_f32_16x16x32_bf16 a[188:191], a[244:247], v[36:39], a[188:191]
    s_mov_b32 m0, 92256
    s_nop 0
    buffer_load_dwordx4 v8, s[24:27], s75 offen offset:3840 lds
    s_waitcnt lgkmcnt(2)
    v_mfma_f32_16x16x32_bf16 a[192:195], a[248:251], v[16:19], a[192:195]
    s_mov_b32 m0, 0
    s_nop 0
    buffer_load_dwordx4 v0, s[8:11], s81 offen offset:0 nt lds
    s_mov_b32 m0, 32
    s_nop 0
    buffer_load_dwordx4 v0, s[8:11], s81 offen offset:1024 nt lds
    v_mfma_f32_16x16x32_bf16 a[200:203], a[248:251], v[20:23], a[200:203]
    s_mov_b32 m0, 64
    s_nop 0
    buffer_load_dwordx4 v0, s[8:11], s81 offen offset:2048 nt lds
    v_mfma_f32_16x16x32_bf16 a[208:211], a[248:251], v[24:27], a[208:211]
    s_mov_b32 m0, 96
    s_nop 0
    buffer_load_dwordx4 v0, s[8:11], s81 offen offset:3072 nt lds
    s_mov_b32 m0, 4224
    s_nop 0
    buffer_load_dwordx4 v0, s[8:11], s82 offen offset:0 nt lds
    v_mfma_f32_16x16x32_bf16 a[216:219], a[248:251], v[28:31], a[216:219]
    s_mov_b32 m0, 4256
    s_nop 0
    buffer_load_dwordx4 v0, s[8:11], s82 offen offset:1024 nt lds
    v_mfma_f32_16x16x32_bf16 a[224:227], a[248:251], v[32:35], a[224:227]
    s_mov_b32 m0, 4288
    s_nop 0
    buffer_load_dwordx4 v0, s[8:11], s82 offen offset:2048 nt lds
    s_mov_b32 m0, 4320
    s_nop 0
    buffer_load_dwordx4 v0, s[8:11], s82 offen offset:3072 nt lds
    v_mfma_f32_16x16x32_bf16 a[232:235], a[248:251], v[36:39], a[232:235]
    s_mov_b32 m0, 8448
    s_nop 0
    buffer_load_dwordx4 v0, s[12:15], s78 offen offset:0 nt lds
    s_waitcnt lgkmcnt(0)
    v_mfma_f32_16x16x32_bf16 a[196:199], a[240:243], v[16:19], a[196:199]
    s_mov_b32 m0, 8480
    s_nop 0
    buffer_load_dwordx4 v0, s[12:15], s78 offen offset:1024 nt lds
    s_mov_b32 m0, 8512
    s_nop 0
    buffer_load_dwordx4 v0, s[12:15], s78 offen offset:2048 nt lds
    v_mfma_f32_16x16x32_bf16 a[204:207], a[240:243], v[20:23], a[204:207]
    s_mov_b32 m0, 8544
    s_nop 0
    buffer_load_dwordx4 v0, s[12:15], s78 offen offset:3072 nt lds
    v_mfma_f32_16x16x32_bf16 a[212:215], a[240:243], v[24:27], a[212:215]
    s_mov_b32 m0, 12672
    s_nop 0
    buffer_load_dwordx4 v0, s[12:15], s79 offen offset:0 nt lds
    s_mov_b32 m0, 12704
    s_nop 0
    buffer_load_dwordx4 v0, s[12:15], s79 offen offset:1024 nt lds
    v_mfma_f32_16x16x32_bf16 a[220:223], a[240:243], v[28:31], a[220:223]
    s_mov_b32 m0, 12736
    s_nop 0
    buffer_load_dwordx4 v0, s[12:15], s79 offen offset:2048 nt lds
    v_mfma_f32_16x16x32_bf16 a[228:231], a[240:243], v[32:35], a[228:231]
    s_mov_b32 m0, 12768
    s_nop 0
    buffer_load_dwordx4 v0, s[12:15], s79 offen offset:3072 nt lds
    s_mov_b32 s78, s81
    s_mov_b32 s79, s82
    s_add_u32 s81, s81, 8192
    s_add_u32 s82, s82, 8192
    v_mfma_f32_16x16x32_bf16 a[236:239], a[240:243], v[36:39], a[236:239]
    s_waitcnt vmcnt(34)
    s_barrier
    ds_read_b128 v[16:19], v4 offset:3072
    ds_read_b64_tr_b16 a[240:241], v3 offset:0
    ds_read_b64_tr_b16 a[242:243], v3 offset:512
    ds_read_b128 v[20:23], v4 offset:7168
    ds_read_b128 v[24:27], v4 offset:11264
    ds_read_b128 v[28:31], v4 offset:15360
    ds_read_b128 v[32:35], v4 offset:19456
    ds_read_b128 v[36:39], v4 offset:23552
    ds_read_b64_tr_b16 a[244:245], v3 offset:32
    ds_read_b64_tr_b16 a[246:247], v3 offset:544
    ds_read_b64_tr_b16 a[248:249], v3 offset:8448
    ds_read_b64_tr_b16 a[250:251], v3 offset:8960
    s_mov_b32 m0, 97152
    s_add_u32 s75, s83, 5888
    buffer_load_dwordx4 v8, s[24:27], s75 offen offset:0 lds
    s_mov_b32 m0, 96928
    s_nop 0
    buffer_load_dwordx4 v8, s[24:27], s75 offen offset:1280 lds
    s_mov_b32 m0, 96704
    s_nop 0
    buffer_load_dwordx4 v8, s[24:27], s75 offen offset:2560 lds
    s_mov_b32 m0, 96480
    s_nop 0
    buffer_load_dwordx4 v8, s[24:27], s75 offen offset:3840 lds
    s_mov_b32 m0, 101376
    s_add_u32 s75, s83, 1024
    buffer_load_dwordx4 v8, s[24:27], s75 offen offset:0 lds
    s_mov_b32 m0, 101152
    s_nop 0
    buffer_load_dwordx4 v8, s[24:27], s75 offen offset:1280 lds
    s_mov_b32 m0, 100928
    s_nop 0
    buffer_load_dwordx4 v8, s[24:27], s75 offen offset:2560 lds
    s_mov_b32 m0, 100704
    s_nop 0
    buffer_load_dwordx4 v8, s[24:27], s75 offen offset:3840 lds
    s_waitcnt lgkmcnt(9)
    v_mfma_f32_16x16x32_bf16 a[0:3], a[240:243], v[16:19], a[0:3]
    s_mov_b32 m0, 105600
    s_add_u32 s75, s83, 6144
    buffer_load_dwordx4 v8, s[24:27], s75 offen offset:0 lds
    s_waitcnt lgkmcnt(8)
    v_mfma_f32_16x16x32_bf16 a[8:11], a[240:243], v[20:23], a[8:11]
    s_mov_b32 m0, 105376
    s_nop 0
    buffer_load_dwordx4 v8, s[24:27], s75 offen offset:1280 lds
    s_mov_b32 m0, 105152
    s_nop 0
    buffer_load_dwordx4 v8, s[24:27], s75 offen offset:2560 lds
    s_waitcnt lgkmcnt(7)
    v_mfma_f32_16x16x32_bf16 a[16:19], a[240:243], v[24:27], a[16:19]
    s_mov_b32 m0, 104928
    s_nop 0
    buffer_load_dwordx4 v8, s[24:27], s75 offen offset:3840 lds
    s_add_u32 s83, s83, 40960
    s_waitcnt lgkmcnt(6)
    v_mfma_f32_16x16x32_bf16 a[24:27], a[240:243], v[28:31], a[24:27]
    s_mov_b32 m0, 16896
    s_nop 0
    buffer_load_dwordx4 v0, s[8:11], s81 offen offset:0 nt lds
    s_mov_b32 m0, 16928
    s_nop 0
    buffer_load_dwordx4 v0, s[8:11], s81 offen offset:1024 nt lds
    s_waitcnt lgkmcnt(5)
    v_mfma_f32_16x16x32_bf16 a[32:35], a[240:243], v[32:35], a[32:35]
    s_mov_b32 m0, 16960
    s_nop 0
    buffer_load_dwordx4 v0, s[8:11], s81 offen offset:2048 nt lds
    s_waitcnt lgkmcnt(4)
    v_mfma_f32_16x16x32_bf16 a[40:43], a[240:243], v[36:39], a[40:43]
    s_mov_b32 m0, 16992
    s_nop 0
    buffer_load_dwordx4 v0, s[8:11], s81 offen offset:3072 nt lds
    s_mov_b32 m0, 21120
    s_nop 0
    buffer_load_dwordx4 v0, s[8:11], s82 offen offset:0 nt lds
    s_waitcnt lgkmcnt(2)
    v_mfma_f32_16x16x32_bf16 a[4:7], a[244:247], v[16:19], a[4:7]
    s_mov_b32 m0, 21152
    s_nop 0
    buffer_load_dwordx4 v0, s[8:11], s82 offen offset:1024 nt lds
    v_mfma_f32_16x16x32_bf16 a[12:15], a[244:247], v[20:23], a[12:15]
    s_mov_b32 m0, 21184
    s_nop 0
    buffer_load_dwordx4 v0, s[8:11], s82 offen offset:2048 nt lds
    s_mov_b32 m0, 21216
    s_nop 0
    buffer_load_dwordx4 v0, s[8:11], s82 offen offset:3072 nt lds
    v_mfma_f32_16x16x32_bf16 a[20:23], a[244:247], v[24:27], a[20:23]
    s_mov_b32 m0, 25344
    s_nop 0
    buffer_load_dwordx4 v0, s[12:15], s78 offen offset:0 nt lds
    v_mfma_f32_16x16x32_bf16 a[28:31], a[244:247], v[28:31], a[28:31]
    s_mov_b32 m0, 25376
    s_nop 0
    buffer_load_dwordx4 v0, s[12:15], s78 offen offset:1024 nt lds
    s_mov_b32 m0, 25408
    s_nop 0
    buffer_load_dwordx4 v0, s[12:15], s78 offen offset:2048 nt lds
    v_mfma_f32_16x16x32_bf16 a[36:39], a[244:247], v[32:35], a[36:39]
    s_mov_b32 m0, 25440
    s_nop 0
    buffer_load_dwordx4 v0, s[12:15], s78 offen offset:3072 nt lds
    v_mfma_f32_16x16x32_bf16 a[44:47], a[244:247], v[36:39], a[44:47]
    s_mov_b32 m0, 29568
    s_nop 0
    buffer_load_dwordx4 v0, s[12:15], s79 offen offset:0 nt lds
    s_mov_b32 m0, 29600
    s_nop 0
    buffer_load_dwordx4 v0, s[12:15], s79 offen offset:1024 nt lds
    s_waitcnt lgkmcnt(0)
    v_mfma_f32_16x16x32_bf16 a[48:51], a[248:251], v[16:19], a[48:51]
    s_mov_b32 m0, 29632
    s_nop 0
    buffer_load_dwordx4 v0, s[12:15], s79 offen offset:2048 nt lds
    v_mfma_f32_16x16x32_bf16 a[56:59], a[248:251], v[20:23], a[56:59]
    s_mov_b32 m0, 29664
    s_nop 0
    buffer_load_dwordx4 v0, s[12:15], s79 offen offset:3072 nt lds
    s_mov_b32 s78, s81
    s_mov_b32 s79, s82
    s_add_u32 s81, s81, 8192
    s_add_u32 s82, s82, 8192
    v_mfma_f32_16x16x32_bf16 a[64:67], a[248:251], v[24:27], a[64:67]
    s_waitcnt vmcnt(38)
    s_barrier
    ds_read_b64_tr_b16 a[240:241], v3 offset:8480
    ds_read_b64_tr_b16 a[242:243], v3 offset:8992
    ds_read_b64_tr_b16 a[244:245], v3 offset:16896
    ds_read_b64_tr_b16 a[246:247], v3 offset:17408
    s_mov_b32 m0, 67584
    s_add_u32 s75, s83, 0
    buffer_load_dwordx4 v8, s[24:27], s75 offen offset:0 lds
    s_mov_b32 m0, 67360
    s_nop 0
    buffer_load_dwordx4 v8, s[24:27], s75 offen offset:1280 lds
    s_mov_b32 m0, 67136
    s_nop 0
    buffer_load_dwordx4 v8, s[24:27], s75 offen offset:2560 lds
    s_mov_b32 m0, 66912
    s_nop 0
    buffer_load_dwordx4 v8, s[24:27], s75 offen offset:3840 lds
    s_mov_b32 m0, 71808
    s_add_u32 s75, s83, 5120
    buffer_load_dwordx4 v8, s[24:27], s75 offen offset:0 lds
    s_mov_b32 m0, 71584
    s_nop 0
    buffer_load_dwordx4 v8, s[24:27], s75 offen offset:1280 lds
    s_mov_b32 m0, 71360
    s_nop 0
    buffer_load_dwordx4 v8, s[24:27], s75 offen offset:2560 lds
    v_mfma_f32_16x16x32_bf16 a[72:75], a[248:251], v[28:31], a[72:75]
    s_mov_b32 m0, 71136
    s_nop 0
    buffer_load_dwordx4 v8, s[24:27], s75 offen offset:3840 lds
    v_mfma_f32_16x16x32_bf16 a[80:83], a[248:251], v[32:35], a[80:83]
    s_mov_b32 m0, 33792
    s_nop 0
    buffer_load_dwordx4 v0, s[8:11], s81 offen offset:0 nt lds
    v_mfma_f32_16x16x32_bf16 a[88:91], a[248:251], v[36:39], a[88:91]
    s_mov_b32 m0, 33824
    s_nop 0
    buffer_load_dwordx4 v0, s[8:11], s81 offen offset:1024 nt lds
    s_mov_b32 m0, 33856
    s_nop 0
    buffer_load_dwordx4 v0, s[8:11], s81 offen offset:2048 nt lds
    s_waitcnt lgkmcnt(2)
    v_mfma_f32_16x16x32_bf16 a[52:55], a[240:243], v[16:19], a[52:55]
    s_mov_b32 m0, 33888
    s_nop 0
    buffer_load_dwordx4 v0, s[8:11], s81 offen offset:3072 nt lds
    v_mfma_f32_16x16x32_bf16 a[60:63], a[240:243], v[20:23], a[60:63]
    s_mov_b32 m0, 38016
    s_nop 0
    buffer_load_dwordx4 v0, s[8:11], s82 offen offset:0 nt lds
    v_mfma_f32_16x16x32_bf16 a[68:71], a[240:243], v[24:27], a[68:71]
    s_mov_b32 m0, 38048
    s_nop 0
    buffer_load_dwordx4 v0, s[8:11], s82 offen offset:1024 nt lds
    v_mfma_f32_16x16x32_bf16 a[76:79], a[240:243], v[28:31], a[76:79]
    s_mov_b32 m0, 38080
    s_nop 0
    buffer_load_dwordx4 v0, s[8:11], s82 offen offset:2048 nt lds
    s_mov_b32 m0, 38112
    s_nop 0
    buffer_load_dwordx4 v0, s[8:11], s82 offen offset:3072 nt lds
    v_mfma_f32_16x16x32_bf16 a[84:87], a[240:243], v[32:35], a[84:87]
    s_mov_b32 m0, 42240
    s_nop 0
    buffer_load_dwordx4 v0, s[12:15], s78 offen offset:0 nt lds
    v_mfma_f32_16x16x32_bf16 a[92:95], a[240:243], v[36:39], a[92:95]
    s_mov_b32 m0, 42272
    s_nop 0
    buffer_load_dwordx4 v0, s[12:15], s78 offen offset:1024 nt lds
    s_waitcnt lgkmcnt(0)
    v_mfma_f32_16x16x32_bf16 a[96:99], a[244:247], v[16:19], a[96:99]
    s_mov_b32 m0, 42304
    s_nop 0
    buffer_load_dwordx4 v0, s[12:15], s78 offen offset:2048 nt lds
    v_mfma_f32_16x16x32_bf16 a[104:107], a[244:247], v[20:23], a[104:107]
    s_mov_b32 m0, 42336
    s_nop 0
    buffer_load_dwordx4 v0, s[12:15], s78 offen offset:3072 nt lds
    s_mov_b32 m0, 46464
    s_nop 0
    buffer_load_dwordx4 v0, s[12:15], s79 offen offset:0 nt lds
    v_mfma_f32_16x16x32_bf16 a[112:115], a[244:247], v[24:27], a[112:115]
    s_mov_b32 m0, 46496
    s_nop 0
    buffer_load_dwordx4 v0, s[12:15], s79 offen offset:1024 nt lds
    v_mfma_f32_16x16x32_bf16 a[120:123], a[244:247], v[28:31], a[120:123]
    s_mov_b32 m0, 46528
    s_nop 0
    buffer_load_dwordx4 v0, s[12:15], s79 offen offset:2048 nt lds
    v_mfma_f32_16x16x32_bf16 a[128:131], a[244:247], v[32:35], a[128:131]
    s_mov_b32 m0, 46560
    s_nop 0
    buffer_load_dwordx4 v0, s[12:15], s79 offen offset:3072 nt lds
    s_mov_b32 s78, s81
    s_mov_b32 s79, s82
    s_add_u32 s81, s81, 8192
    s_add_u32 s82, s82, 8192
    v_mfma_f32_16x16x32_bf16 a[136:139], a[244:247], v[36:39], a[136:139]
    s_waitcnt vmcnt(38)
    s_barrier
    ds_read_b64_tr_b16 a[248:249], v3 offset:16928
    ds_read_b64_tr_b16 a[250:251], v3 offset:17440
    ds_read_b64_tr_b16 a[240:241], v3 offset:25344
    ds_read_b64_tr_b16 a[242:243], v3 offset:25856
    ds_read_b64_tr_b16 a[244:245], v3 offset:25376
    ds_read_b64_tr_b16 a[246:247], v3 offset:25888
    s_mov_b32 m0, 76032
    s_add_u32 s75, s83, 256
    buffer_load_dwordx4 v8, s[24:27], s75 offen offset:0 lds
    s_mov_b32 m0, 75808
    s_nop 0
    buffer_load_dwordx4 v8, s[24:27], s75 offen offset:1280 lds
    s_mov_b32 m0, 75584
    s_nop 0
    buffer_load_dwordx4 v8, s[24:27], s75 offen offset:2560 lds
    s_mov_b32 m0, 75360
    s_nop 0
    buffer_load_dwordx4 v8, s[24:27], s75 offen offset:3840 lds
    s_mov_b32 m0, 80256
    s_add_u32 s75, s83, 5376
    buffer_load_dwordx4 v8, s[24:27], s75 offen offset:0 lds
    s_mov_b32 m0, 80032
    s_nop 0
    buffer_load_dwordx4 v8, s[24:27], s75 offen offset:1280 lds
    s_mov_b32 m0, 79808
    s_nop 0
    buffer_load_dwordx4 v8, s[24:27], s75 offen offset:2560 lds
    s_waitcnt lgkmcnt(4)
    v_mfma_f32_16x16x32_bf16 a[100:103], a[248:251], v[16:19], a[100:103]
    s_mov_b32 m0, 79584
    s_nop 0
    buffer_load_dwordx4 v8, s[24:27], s75 offen offset:3840 lds
    v_mfma_f32_16x16x32_bf16 a[108:111], a[248:251], v[20:23], a[108:111]
    s_mov_b32 m0, 50688
    s_nop 0
    buffer_load_dwordx4 v0, s[8:11], s81 offen offset:0 nt lds
    v_mfma_f32_16x16x32_bf16 a[116:119], a[248:251], v[24:27], a[116:119]
    s_mov_b32 m0, 50720
    s_nop 0
    buffer_load_dwordx4 v0, s[8:11], s81 offen offset:1024 nt lds
    s_mov_b32 m0, 50752
    s_nop 0
    buffer_load_dwordx4 v0, s[8:11], s81 offen offset:2048 nt lds
    v_mfma_f32_16x16x32_bf16 a[124:127], a[248:251], v[28:31], a[124:127]
    s_mov_b32 m0, 50784
    s_nop 0
    buffer_load_dwordx4 v0, s[8:11], s81 offen offset:3072 nt lds
    v_mfma_f32_16x16x32_bf16 a[132:135], a[248:251], v[32:35], a[132:135]
    s_mov_b32 m0, 54912
    s_nop 0
    buffer_load_dwordx4 v0, s[8:11], s82 offen offset:0 nt lds
    v_mfma_f32_16x16x32_bf16 a[140:143], a[248:251], v[36:39], a[140:143]
    s_mov_b32 m0, 54944
    s_nop 0
    buffer_load_dwordx4 v0, s[8:11], s82 offen offset:1024 nt lds
    s_waitcnt lgkmcnt(2)
    v_mfma_f32_16x16x32_bf16 a[144:147], a[240:243], v[16:19], a[144:147]
    s_mov_b32 m0, 54976
    s_nop 0
    buffer_load_dwordx4 v0, s[8:11], s82 offen offset:2048 nt lds
    s_mov_b32 m0, 55008
    s_nop 0
    buffer_load_dwordx4 v0, s[8:11], s82 offen offset:3072 nt lds
    v_mfma_f32_16x16x32_bf16 a[152:155], a[240:243], v[20:23], a[152:155]
    s_mov_b32 m0, 59136
    s_nop 0
    buffer_load_dwordx4 v0, s[12:15], s78 offen offset:0 nt lds
    v_mfma_f32_16x16x32_bf16 a[160:163], a[240:243], v[24:27], a[160:163]
    s_mov_b32 m0, 59168
    s_nop 0
    buffer_load_dwordx4 v0, s[12:15], s78 offen offset:1024 nt lds
    v_mfma_f32_16x16x32_bf16 a[168:171], a[240:243], v[28:31], a[168:171]
    s_mov_b32 m0, 59200
    s_nop 0
    buffer_load_dwordx4 v0, s[12:15], s78 offen offset:2048 nt lds
    v_mfma_f32_16x16x32_bf16 a[176:179], a[240:243], v[32:35], a[176:179]
    s_mov_b32 m0, 59232
    s_nop 0
    buffer_load_dwordx4 v0, s[12:15], s78 offen offset:3072 nt lds
    s_mov_b32 m0, 63360
    s_nop 0
    buffer_load_dwordx4 v0, s[12:15], s79 offen offset:0 nt lds
    v_mfma_f32_16x16x32_bf16 a[184:187], a[240:243], v[36:39], a[184:187]
    s_mov_b32 m0, 63392
    s_nop 0
    buffer_load_dwordx4 v0, s[12:15], s79 offen offset:1024 nt lds
    s_waitcnt lgkmcnt(0)
    v_mfma_f32_16x16x32_bf16 a[148:151], a[244:247], v[16:19], a[148:151]
    s_mov_b32 m0, 63424
    s_nop 0
    buffer_load_dwordx4 v0, s[12:15], s79 offen offset:2048 nt lds
    v_mfma_f32_16x16x32_bf16 a[156:159], a[244:247], v[20:23], a[156:159]
    s_mov_b32 m0, 63456
    s_nop 0
    buffer_load_dwordx4 v0, s[12:15], s79 offen offset:3072 nt lds
    s_mov_b32 s78, s81
    s_mov_b32 s79, s82
    s_add_u32 s81, s81, 8192
    s_add_u32 s82, s82, 8192
    v_mfma_f32_16x16x32_bf16 a[164:167], a[244:247], v[24:27], a[164:167]
    s_waitcnt vmcnt(34)
    s_barrier
    ds_read_b64_tr_b16 a[248:249], v3 offset:33792
    ds_read_b64_tr_b16 a[250:251], v3 offset:34304
    ds_read_b64_tr_b16 a[240:241], v3 offset:33824
    ds_read_b64_tr_b16 a[242:243], v3 offset:34336
    s_mov_b32 m0, 84480
    s_add_u32 s75, s83, 512
    buffer_load_dwordx4 v8, s[24:27], s75 offen offset:0 lds
    s_mov_b32 m0, 84256
    s_nop 0
    buffer_load_dwordx4 v8, s[24:27], s75 offen offset:1280 lds
    s_mov_b32 m0, 84032
    s_nop 0
    buffer_load_dwordx4 v8, s[24:27], s75 offen offset:2560 lds
    s_mov_b32 m0, 83808
    s_nop 0
    buffer_load_dwordx4 v8, s[24:27], s75 offen offset:3840 lds
    s_mov_b32 m0, 88704
    s_add_u32 s75, s83, 5632
    buffer_load_dwordx4 v8, s[24:27], s75 offen offset:0 lds
    s_mov_b32 m0, 88480
    s_nop 0
    buffer_load_dwordx4 v8, s[24:27], s75 offen offset:1280 lds
    s_mov_b32 m0, 88256
    s_nop 0
    buffer_load_dwordx4 v8, s[24:27], s75 offen offset:2560 lds
    s_mov_b32 m0, 88032
    s_nop 0
    buffer_load_dwordx4 v8, s[24:27], s75 offen offset:3840 lds
    v_mfma_f32_16x16x32_bf16 a[172:175], a[244:247], v[28:31], a[172:175]
    s_mov_b32 m0, 92928
    s_add_u32 s75, s83, 768
    buffer_load_dwordx4 v8, s[24:27], s75 offen offset:0 lds
    v_mfma_f32_16x16x32_bf16 a[180:183], a[244:247], v[32:35], a[180:183]
    s_mov_b32 m0, 92704
    s_nop 0
    buffer_load_dwordx4 v8, s[24:27], s75 offen offset:1280 lds
    s_mov_b32 m0, 92480
    s_nop 0
    buffer_load_dwordx4 v8, s[24:27], s75 offen offset:2560 lds
    v_mfma_f32_16x16x32_bf16 a[188:191], a[244:247], v[36:39], a[188:191]
    s_mov_b32 m0, 92256
    s_nop 0
    buffer_load_dwordx4 v8, s[24:27], s75 offen offset:3840 lds
    s_waitcnt lgkmcnt(2)
    v_mfma_f32_16x16x32_bf16 a[192:195], a[248:251], v[16:19], a[192:195]
    s_mov_b32 m0, 0
    s_nop 0
    buffer_load_dwordx4 v0, s[8:11], s81 offen offset:0 nt lds
    s_mov_b32 m0, 32
    s_nop 0
    buffer_load_dwordx4 v0, s[8:11], s81 offen offset:1024 nt lds
    v_mfma_f32_16x16x32_bf16 a[200:203], a[248:251], v[20:23], a[200:203]
    s_mov_b32 m0, 64
    s_nop 0
    buffer_load_dwordx4 v0, s[8:11], s81 offen offset:2048 nt lds
    v_mfma_f32_16x16x32_bf16 a[208:211], a[248:251], v[24:27], a[208:211]
    s_mov_b32 m0, 96
    s_nop 0
    buffer_load_dwordx4 v0, s[8:11], s81 offen offset:3072 nt lds
    s_mov_b32 m0, 4224
    s_nop 0
    buffer_load_dwordx4 v0, s[8:11], s82 offen offset:0 nt lds
    v_mfma_f32_16x16x32_bf16 a[216:219], a[248:251], v[28:31], a[216:219]
    s_mov_b32 m0, 4256
    s_nop 0
    buffer_load_dwordx4 v0, s[8:11], s82 offen offset:1024 nt lds
    v_mfma_f32_16x16x32_bf16 a[224:227], a[248:251], v[32:35], a[224:227]
    s_mov_b32 m0, 4288
    s_nop 0
    buffer_load_dwordx4 v0, s[8:11], s82 offen offset:2048 nt lds
    s_mov_b32 m0, 4320
    s_nop 0
    buffer_load_dwordx4 v0, s[8:11], s82 offen offset:3072 nt lds
    v_mfma_f32_16x16x32_bf16 a[232:235], a[248:251], v[36:39], a[232:235]
    s_mov_b32 m0, 8448
    s_nop 0
    buffer_load_dwordx4 v0, s[12:15], s78 offen offset:0 nt lds
    s_waitcnt lgkmcnt(0)
    v_mfma_f32_16x16x32_bf16 a[196:199], a[240:243], v[16:19], a[196:199]
    s_mov_b32 m0, 8480
    s_nop 0
    buffer_load_dwordx4 v0, s[12:15], s78 offen offset:1024 nt lds
    s_mov_b32 m0, 8512
    s_nop 0
    buffer_load_dwordx4 v0, s[12:15], s78 offen offset:2048 nt lds
    v_mfma_f32_16x16x32_bf16 a[204:207], a[240:243], v[20:23], a[204:207]
    s_mov_b32 m0, 8544
    s_nop 0
    buffer_load_dwordx4 v0, s[12:15], s78 offen offset:3072 nt lds
    v_mfma_f32_16x16x32_bf16 a[212:215], a[240:243], v[24:27], a[212:215]
    s_mov_b32 m0, 12672
    s_nop 0
    buffer_load_dwordx4 v0, s[12:15], s79 offen offset:0 nt lds
    s_mov_b32 m0, 12704
    s_nop 0
    buffer_load_dwordx4 v0, s[12:15], s79 offen offset:1024 nt lds
    v_mfma_f32_16x16x32_bf16 a[220:223], a[240:243], v[28:31], a[220:223]
    s_mov_b32 m0, 12736
    s_nop 0
    buffer_load_dwordx4 v0, s[12:15], s79 offen offset:2048 nt lds
    v_mfma_f32_16x16x32_bf16 a[228:231], a[240:243], v[32:35], a[228:231]
    s_mov_b32 m0, 12768
    s_nop 0
    buffer_load_dwordx4 v0, s[12:15], s79 offen offset:3072 nt lds
    s_mov_b32 s78, s81
    s_mov_b32 s79, s82
    s_add_u32 s81, s81, 8192
    s_add_u32 s82, s82, 8192
    v_mfma_f32_16x16x32_bf16 a[236:239], a[240:243], v[36:39], a[236:239]
    s_add_u32 s80, s80, 1
    s_cmp_lt_u32 s80, 3
    s_cbranch_scc1 L_ld
L_ld3:
    s_waitcnt vmcnt(44)
    s_barrier
    ds_read_b128 v[16:19], v4 offset:0
    ds_read_b64_tr_b16 a[240:241], v3 offset:0
    ds_read_b64_tr_b16 a[242:243], v3 offset:512
    ds_read_b128 v[20:23], v4 offset:4096
    ds_read_b128 v[24:27], v4 offset:8192
    ds_read_b128 v[28:31], v4 offset:12288
    ds_read_b128 v[32:35], v4 offset:16384
    ds_read_b128 v[36:39], v4 offset:20480
    ds_read_b64_tr_b16 a[244:245], v3 offset:32
    ds_read_b64_tr_b16 a[246:247], v3 offset:544
    ds_read_b64_tr_b16 a[248:249], v3 offset:8448
    ds_read_b64_tr_b16 a[250:251], v3 offset:8960
    s_mov_b32 m0, 97152
    s_add_u32 s75, s83, 5888
    buffer_load_dwordx4 v8, s[24:27], s75 offen offset:0 lds
    s_mov_b32 m0, 96928
    s_nop 0
    buffer_load_dwordx4 v8, s[24:27], s75 offen offset:1280 lds
    s_mov_b32 m0, 96704
    s_nop 0
    buffer_load_dwordx4 v8, s[24:27], s75 offen offset:2560 lds
    s_mov_b32 m0, 96480
    s_nop 0
    buffer_load_dwordx4 v8, s[24:27], s75 offen offset:3840 lds
    s_mov_b32 m0, 101376
    s_add_u32 s75, s83, 1024
    buffer_load_dwordx4 v8, s[24:27], s75 offen offset:0 lds
    s_mov_b32 m0, 101152
    s_nop 0
    buffer_load_dwordx4 v8, s[24:27], s75 offen offset:1280 lds
    s_mov_b32 m0, 100928
    s_nop 0
    buffer_load_dwordx4 v8, s[24:27], s75 offen offset:2560 lds
    s_mov_b32 m0, 100704
    s_nop 0
    buffer_load_dwordx4 v8, s[24:27], s75 offen offset:3840 lds
    s_waitcnt lgkmcnt(9)
    v_mfma_f32_16x16x32_bf16 a[0:3], a[240:243], v[16:19], a[0:3]
    s_mov_b32 m0, 105600
    s_add_u32 s75, s83, 6144
    buffer_load_dwordx4 v8, s[24:27], s75 offen offset:0 lds
    s_waitcnt lgkmcnt(8)
    v_mfma_f32_16x16x32_bf16 a[8:11], a[240:243], v[20:23], a[8:11]
    s_mov_b32 m0, 105376
    s_nop 0
    buffer_load_dwordx4 v8, s[24:27], s75 offen offset:1280 lds
    s_mov_b32 m0, 105152
    s_nop 0
    buffer_load_dwordx4 v8, s[24:27], s75 offen offset:2560 lds
    s_waitcnt lgkmcnt(7)
    v_mfma_f32_16x16x32_bf16 a[16:19], a[240:243], v[24:27], a[16:19]
    s_mov_b32 m0, 104928
    s_nop 0
    buffer_load_dwordx4 v8, s[24:27], s75 offen offset:3840 lds
    s_add_u32 s83, s83, 40960
    s_waitcnt lgkmcnt(6)
    v_mfma_f32_16x16x32_bf16 a[24:27], a[240:243], v[28:31], a[24:27]
    s_mov_b32 m0, 16896
    s_nop 0
    buffer_load_dwordx4 v0, s[8:11], s81 offen offset:0 nt lds
    s_mov_b32 m0, 16928
    s_nop 0
    buffer_load_dwordx4 v0, s[8:11], s81 offen offset:1024 nt lds
    s_waitcnt lgkmcnt(5)
    v_mfma_f32_16x16x32_bf16 a[32:35], a[240:243], v[32:35], a[32:35]
    s_mov_b32 m0, 16960
    s_nop 0
    buffer_load_dwordx4 v0, s[8:11], s81 offen offset:2048 nt lds
    s_waitcnt lgkmcnt(4)
    v_mfma_f32_16x16x32_bf16 a[40:43], a[240:243], v[36:39], a[40:43]
    s_mov_b32 m0, 16992
    s_nop 0
    buffer_load_dwordx4 v0, s[8:11], s81 offen offset:3072 nt lds
    s_mov_b32 m0, 21120
    s_nop 0
    buffer_load_dwordx4 v0, s[8:11], s82 offen offset:0 nt lds
    s_waitcnt lgkmcnt(2)
    v_mfma_f32_16x16x32_bf16 a[4:7], a[244:247], v[16:19], a[4:7]
    s_mov_b32 m0, 21152
    s_nop 0
    buffer_load_dwordx4 v0, s[8:11], s82 offen offset:1024 nt lds
    v_mfma_f32_16x16x32_bf16 a[12:15], a[244:247], v[20:23], a[12:15]
    s_waitcnt vmcnt(61)
    s_mov_b32 m0, 21184
    s_nop 0
    buffer_load_dwordx4 v0, s[8:11], s82 offen offset:2048 nt lds
    s_waitcnt vmcnt(61)
    s_mov_b32 m0, 21216
    s_nop 0
    buffer_load_dwordx4 v0, s[8:11], s82 offen offset:3072 nt lds
    v_mfma_f32_16x16x32_bf16 a[20:23], a[244:247], v[24:27], a[20:23]
    s_waitcnt vmcnt(61)
    s_mov_b32 m0, 25344
    s_nop 0
    buffer_load_dwordx4 v0, s[12:15], s78 offen offset:0 nt lds
    v_mfma_f32_16x16x32_bf16 a[28:31], a[244:247], v[28:31], a[28:31]
    s_waitcnt vmcnt(61)
    s_mov_b32 m0, 25376
    s_nop 0
    buffer_load_dwordx4 v0, s[12:15], s78 offen offset:1024 nt lds
    s_waitcnt vmcnt(61)
    s_mov_b32 m0, 25408
    s_nop 0
    buffer_load_dwordx4 v0, s[12:15], s78 offen offset:2048 nt lds
    v_mfma_f32_16x16x32_bf16 a[36:39], a[244:247], v[32:35], a[36:39]
    s_waitcnt vmcnt(61)
    s_mov_b32 m0, 25440
    s_nop 0
    buffer_load_dwordx4 v0, s[12:15], s78 offen offset:3072 nt lds
    v_mfma_f32_16x16x32_bf16 a[44:47], a[244:247], v[36:39], a[44:47]
    s_waitcnt vmcnt(61)
    s_mov_b32 m0, 29568
    s_nop 0
    buffer_load_dwordx4 v0, s[12:15], s79 offen offset:0 nt lds
    s_waitcnt vmcnt(61)
    s_mov_b32 m0, 29600
    s_nop 0
    buffer_load_dwordx4 v0, s[12:15], s79 offen offset:1024 nt lds
    s_waitcnt lgkmcnt(0)
    v_mfma_f32_16x16x32_bf16 a[48:51], a[248:251], v[16:19], a[48:51]
    s_waitcnt vmcnt(61)
    s_mov_b32 m0, 29632
    s_nop 0
    buffer_load_dwordx4 v0, s[12:15], s79 offen offset:2048 nt lds
    v_mfma_f32_16x16x32_bf16 a[56:59], a[248:251], v[20:23], a[56:59]
    s_waitcnt vmcnt(61)
    s_mov_b32 m0, 29664
    s_nop 0
    buffer_load_dwordx4 v0, s[12:15], s79 offen offset:3072 nt lds
    s_mov_b32 s78, s81
    s_mov_b32 s79, s82
    s_add_u32 s81, s81, 8192
    s_add_u32 s82, s82, 8192
    v_mfma_f32_16x16x32_bf16 a[64:67], a[248:251], v[24:27], a[64:67]
    s_waitcnt vmcnt(44)
    s_barrier
    ds_read_b64_tr_b16 a[240:241], v3 offset:8480
    ds_read_b64_tr_b16 a[242:243], v3 offset:8992
    ds_read_b64_tr_b16 a[244:245], v3 offset:16896
    ds_read_b64_tr_b16 a[246:247], v3 offset:17408
    s_mov_b32 m0, 67584
    s_add_u32 s75, s83, 0
    buffer_load_dwordx4 v8, s[24:27], s75 offen offset:0 lds
    s_mov_b32 m0, 67360
    s_nop 0
    buffer_load_dwordx4 v8, s[24:27], s75 offen offset:1280 lds
    s_mov_b32 m0, 67136
    s_nop 0
    buffer_load_dwordx4 v8, s[24:27], s75 offen offset:2560 lds
    s_mov_b32 m0, 66912
    s_nop 0
    buffer_load_dwordx4 v8, s[24:27], s75 offen offset:3840 lds
    s_mov_b32 m0, 71808
    s_add_u32 s75, s83, 5120
    buffer_load_dwordx4 v8, s[24:27], s75 offen offset:0 lds
    s_mov_b32 m0, 71584
    s_nop 0
    buffer_load_dwordx4 v8, s[24:27], s75 offen offset:1280 lds
    s_mov_b32 m0, 71360
    s_nop 0
    buffer_load_dwordx4 v8, s[24:27], s75 offen offset:2560 lds
    v_mfma_f32_16x16x32_bf16 a[72:75], a[248:251], v[28:31], a[72:75]
    s_mov_b32 m0, 71136
    s_nop 0
    buffer_load_dwordx4 v8, s[24:27], s75 offen offset:3840 lds
    v_mfma_f32_16x16x32_bf16 a[80:83], a[248:251], v[32:35], a[80:83]
    s_mov_b32 m0, 33792
    s_nop 0
    buffer_load_dwordx4 v0, s[8:11], s81 offen offset:0 nt lds
    v_mfma_f32_16x16x32_bf16 a[88:91], a[248:251], v[36:39], a[88:91]
    s_mov_b32 m0, 33824
    s_nop 0
    buffer_load_dwordx4 v0, s[8:11], s81 offen offset:1024 nt lds
    s_mov_b32 m0, 33856
    s_nop 0
    buffer_load_dwordx4 v0, s[8:11], s81 offen offset:2048 nt lds
    s_waitcnt lgkmcnt(2)
    v_mfma_f32_16x16x32_bf16 a[52:55], a[240:243], v[16:19], a[52:55]
    s_mov_b32 m0, 33888
    s_nop 0
    buffer_load_dwordx4 v0, s[8:11], s81 offen offset:3072 nt lds
    v_mfma_f32_16x16x32_bf16 a[60:63], a[240:243], v[20:23], a[60:63]
    s_mov_b32 m0, 38016
    s_nop 0
    buffer_load_dwordx4 v0, s[8:11], s82 offen offset:0 nt lds
    v_mfma_f32_16x16x32_bf16 a[68:71], a[240:243], v[24:27], a[68:71]
    s_mov_b32 m0, 38048
    s_nop 0
    buffer_load_dwordx4 v0, s[8:11], s82 offen offset:1024 nt lds
    v_mfma_f32_16x16x32_bf16 a[76:79], a[240:243], v[28:31], a[76:79]
    s_mov_b32 m0, 38080
    s_nop 0
    buffer_load_dwordx4 v0, s[8:11], s82 offen offset:2048 nt lds
    s_mov_b32 m0, 38112
    s_nop 0
    buffer_load_dwordx4 v0, s[8:11], s82 offen offset:3072 nt lds
    v_mfma_f32_16x16x32_bf16 a[84:87], a[240:243], v[32:35], a[84:87]
    s_mov_b32 m0, 42240
    s_nop 0
    buffer_load_dwordx4 v0, s[12:15], s78 offen offset:0 nt lds
    v_mfma_f32_16x16x32_bf16 a[92:95], a[240:243], v[36:39], a[92:95]
    s_mov_b32 m0, 42272
    s_nop 0
    buffer_load_dwordx4 v0, s[12:15], s78 offen offset:1024 nt lds
    s_waitcnt lgkmcnt(0)
    v_mfma_f32_16x16x32_bf16 a[96:99], a[244:247], v[16:19], a[96:99]
    s_waitcnt vmcnt(61)
    s_mov_b32 m0, 42304
    s_nop 0
    buffer_load_dwordx4 v0, s[12:15], s78 offen offset:2048 nt lds
    v_mfma_f32_16x16x32_bf16 a[104:107], a[244:247], v[20:23], a[104:107]
    s_waitcnt vmcnt(61)
    s_mov_b32 m0, 42336
    s_nop 0
    buffer_load_dwordx4 v0, s[12:15], s78 offen offset:3072 nt lds
    s_waitcnt vmcnt(61)
    s_mov_b32 m0, 46464
    s_nop 0
    buffer_load_dwordx4 v0, s[12:15], s79 offen offset:0 nt lds
    v_mfma_f32_16x16x32_bf16 a[112:115], a[244:247], v[24:27], a[112:115]
    s_waitcnt vmcnt(61)
    s_mov_b32 m0, 46496
    s_nop 0
    buffer_load_dwordx4 v0, s[12:15], s79 offen offset:1024 nt lds
    v_mfma_f32_16x16x32_bf16 a[120:123], a[244:247], v[28:31], a[120:123]
    s_waitcnt vmcnt(61)
    s_mov_b32 m0, 46528
    s_nop 0
    buffer_load_dwordx4 v0, s[12:15], s79 offen offset:2048 nt lds
    v_mfma_f32_16x16x32_bf16 a[128:131], a[244:247], v[32:35], a[128:131]
    s_waitcnt vmcnt(61)
    s_mov_b32 m0, 46560
    s_nop 0
    buffer_load_dwordx4 v0, s[12:15], s79 offen offset:3072 nt lds
    s_mov_b32 s78, s81
    s_mov_b32 s79, s82
    s_add_u32 s81, s81, 8192
    s_add_u32 s82, s82, 8192
    v_mfma_f32_16x16x32_bf16 a[136:139], a[244:247], v[36:39], a[136:139]
    s_waitcnt vmcnt(40)
    s_barrier
    ds_read_b64_tr_b16 a[248:249], v3 offset:16928
    ds_read_b64_tr_b16 a[250:251], v3 offset:17440
    ds_read_b64_tr_b16 a[240:241], v3 offset:25344
    ds_read_b64_tr_b16 a[242:243], v3 offset:25856
    ds_read_b64_tr_b16 a[244:245], v3 offset:25376
    ds_read_b64_tr_b16 a[246:247], v3 offset:25888
    s_mov_b32 m0, 76032
    s_add_u32 s75, s83, 256
    buffer_load_dwordx4 v8, s[24:27], s75 offen offset:0 lds
    s_mov_b32 m0, 75808
    s_nop 0
    buffer_load_dwordx4 v8, s[24:27], s75 offen offset:1280 lds
    s_mov_b32 m0, 75584
    s_nop 0
    buffer_load_dwordx4 v8, s[24:27], s75 offen offset:2560 lds
    s_mov_b32 m0, 75360
    s_nop 0
    buffer_load_dwordx4 v8, s[24:27], s75 offen offset:3840 lds
    s_mov_b32 m0, 80256
    s_add_u32 s75, s83, 5376
    buffer_load_dwordx4 v8, s[24:27], s75 offen offset:0 lds
    s_mov_b32 m0, 80032
    s_nop 0
    buffer_load_dwordx4 v8, s[24:27], s75 offen offset:1280 lds
    s_mov_b32 m0, 79808
    s_nop 0
    buffer_load_dwordx4 v8, s[24:27], s75 offen offset:2560 lds
    s_waitcnt lgkmcnt(4)
    v_mfma_f32_16x16x32_bf16 a[100:103], a[248:251], v[16:19], a[100:103]
    s_mov_b32 m0, 79584
    s_nop 0
    buffer_load_dwordx4 v8, s[24:27], s75 offen offset:3840 lds
    v_mfma_f32_16x16x32_bf16 a[108:111], a[248:251], v[20:23], a[108:111]
    s_mov_b32 m0, 50688
    s_nop 0
    buffer_load_dwordx4 v0, s[8:11], s81 offen offset:0 nt lds
    v_mfma_f32_16x16x32_bf16 a[116:119], a[248:251], v[24:27], a[116:119]
    s_mov_b32 m0, 50720
    s_nop 0
    buffer_load_dwordx4 v0, s[8:11], s81 offen offset:1024 nt lds
    s_mov_b32 m0, 50752
    s_nop 0
    buffer_load_dwordx4 v0, s[8:11], s81 offen offset:2048 nt lds
    v_mfma_f32_16x16x32_bf16 a[124:127], a[248:251], v[28:31], a[124:127]
    s_mov_b32 m0, 50784
    s_nop 0
    buffer_load_dwordx4 v0, s[8:11], s81 offen offset:3072 nt lds
    v_mfma_f32_16x16x32_bf16 a[132:135], a[248:251], v[32:35], a[132:135]
    s_mov_b32 m0, 54912
    s_nop 0
    buffer_load_dwordx4 v0, s[8:11], s82 offen offset:0 nt lds
    v_mfma_f32_16x16x32_bf16 a[140:143], a[248:251], v[36:39], a[140:143]
    s_mov_b32 m0, 54944
    s_nop 0
    buffer_load_dwordx4 v0, s[8:11], s82 offen offset:1024 nt lds
    s_waitcnt lgkmcnt(2)
    v_mfma_f32_16x16x32_bf16 a[144:147], a[240:243], v[16:19], a[144:147]
    s_mov_b32 m0, 54976
    s_nop 0
    buffer_load_dwordx4 v0, s[8:11], s82 offen offset:2048 nt lds
    s_mov_b32 m0, 55008
    s_nop 0
    buffer_load_dwordx4 v0, s[8:11], s82 offen offset:3072 nt lds
    v_mfma_f32_16x16x32_bf16 a[152:155], a[240:243], v[20:23], a[152:155]
    s_mov_b32 m0, 59136
    s_nop 0
    buffer_load_dwordx4 v0, s[12:15], s78 offen offset:0 nt lds
    v_mfma_f32_16x16x32_bf16 a[160:163], a[240:243], v[24:27], a[160:163]
    s_mov_b32 m0, 59168
    s_nop 0
    buffer_load_dwordx4 v0, s[12:15], s78 offen offset:1024 nt lds
    v_mfma_f32_16x16x32_bf16 a[168:171], a[240:243], v[28:31], a[168:171]
    s_mov_b32 m0, 59200
    s_nop 0
    buffer_load_dwordx4 v0, s[12:15], s78 offen offset:2048 nt lds
    v_mfma_f32_16x16x32_bf16 a[176:179], a[240:243], v[32:35], a[176:179]
    s_mov_b32 m0, 59232
    s_nop 0
    buffer_load_dwordx4 v0, s[12:15], s78 offen offset:3072 nt lds
    s_mov_b32 m0, 63360
    s_nop 0
    buffer_load_dwordx4 v0, s[12:15], s79 offen offset:0 nt lds
    v_mfma_f32_16x16x32_bf16 a[184:187], a[240:243], v[36:39], a[184:187]
    s_mov_b32 m0, 63392
    s_nop 0
    buffer_load_dwordx4 v0, s[12:15], s79 offen offset:1024 nt lds
    s_waitcnt lgkmcnt(0)
    v_mfma_f32_16x16x32_bf16 a[148:151], a[244:247], v[16:19], a[148:151]
    s_waitcnt vmcnt(61)
    s_mov_b32 m0, 63424
    s_nop 0
    buffer_load_dwordx4 v0, s[12:15], s79 offen offset:2048 nt lds
    v_mfma_f32_16x16x32_bf16 a[156:159], a[244:247], v[20:23], a[156:159]
    s_waitcnt vmcnt(61)
    s_mov_b32 m0, 63456
    s_nop 0
    buffer_load_dwordx4 v0, s[12:15], s79 offen offset:3072 nt lds
    s_mov_b32 s78, s81
    s_mov_b32 s79, s82
    s_add_u32 s81, s81, 8192
    s_add_u32 s82, s82, 8192
    v_mfma_f32_16x16x32_bf16 a[164:167], a[244:247], v[24:27], a[164:167]
    s_waitcnt vmcnt(40)
    s_barrier
    ds_read_b64_tr_b16 a[248:249], v3 offset:33792
    ds_read_b64_tr_b16 a[250:251], v3 offset:34304
    ds_read_b64_tr_b16 a[240:241], v3 offset:33824
    ds_read_b64_tr_b16 a[242:243], v3 offset:34336
    s_mov_b32 m0, 84480
    s_add_u32 s75, s83, 512
    buffer_load_dwordx4 v8, s[24:27], s75 offen offset:0 lds
    s_mov_b32 m0, 84256
    s_nop 0
    buffer_load_dwordx4 v8, s[24:27], s75 offen offset:1280 lds
    s_mov_b32 m0, 84032
    s_nop 0
    buffer_load_dwordx4 v8, s[24:27], s75 offen offset:2560 lds
    s_mov_b32 m0, 83808
    s_nop 0
    buffer_load_dwordx4 v8, s[24:27], s75 offen offset:3840 lds
    s_mov_b32 m0, 88704
    s_add_u32 s75, s83, 5632
    buffer_load_dwordx4 v8, s[24:27], s75 offen offset:0 lds
    s_mov_b32 m0, 88480
    s_nop 0
    buffer_load_dwordx4 v8, s[24:27], s75 offen offset:1280 lds
    s_mov_b32 m0, 88256
    s_nop 0
    buffer_load_dwordx4 v8, s[24:27], s75 offen offset:2560 lds
    s_mov_b32 m0, 88032
    s_nop 0
    buffer_load_dwordx4 v8, s[24:27], s75 offen offset:3840 lds
    v_mfma_f32_16x16x32_bf16 a[172:175], a[244:247], v[28:31], a[172:175]
    s_mov_b32 m0, 92928
    s_add_u32 s75, s83, 768
    buffer_load_dwordx4 v8, s[24:27], s75 offen offset:0 lds
    v_mfma_f32_16x16x32_bf16 a[180:183], a[244:247], v[32:35], a[180:183]
    s_mov_b32 m0, 92704
    s_nop 0
    buffer_load_dwordx4 v8, s[24:27], s75 offen offset:1280 lds
    s_mov_b32 m0, 92480
    s_nop 0
    buffer_load_dwordx4 v8, s[24:27], s75 offen offset:2560 lds
    v_mfma_f32_16x16x32_bf16 a[188:191], a[244:247], v[36:39], a[188:191]
    s_mov_b32 m0, 92256
    s_nop 0
    buffer_load_dwordx4 v8, s[24:27], s75 offen offset:3840 lds
    s_waitcnt lgkmcnt(2)
    v_mfma_f32_16x16x32_bf16 a[192:195], a[248:251], v[16:19], a[192:195]
    s_mov_b32 m0, 0
    s_nop 0
    buffer_load_dwordx4 v0, s[8:11], s81 offen offset:0 nt lds
    s_mov_b32 m0, 32
    s_nop 0
    buffer_load_dwordx4 v0, s[8:11], s81 offen offset:1024 nt lds
    v_mfma_f32_16x16x32_bf16 a[200:203], a[248:251], v[20:23], a[200:203]
    s_mov_b32 m0, 64
    s_nop 0
    buffer_load_dwordx4 v0, s[8:11], s81 offen offset:2048 nt lds
    v_mfma_f32_16x16x32_bf16 a[208:211], a[248:251], v[24:27], a[208:211]
    s_mov_b32 m0, 96
    s_nop 0
    buffer_load_dwordx4 v0, s[8:11], s81 offen offset:3072 nt lds
    s_mov_b32 m0, 4224
    s_nop 0
    buffer_load_dwordx4 v0, s[8:11], s82 offen offset:0 nt lds
    v_mfma_f32_16x16x32_bf16 a[216:219], a[248:251], v[28:31], a[216:219]
    s_mov_b32 m0, 4256
    s_nop 0
    buffer_load_dwordx4 v0, s[8:11], s82 offen offset:1024 nt lds
    v_mfma_f32_16x16x32_bf16 a[224:227], a[248:251], v[32:35], a[224:227]
    s_mov_b32 m0, 4288
    s_nop 0
    buffer_load_dwordx4 v0, s[8:11], s82 offen offset:2048 nt lds
    s_mov_b32 m0, 4320
    s_nop 0
    buffer_load_dwordx4 v0, s[8:11], s82 offen offset:3072 nt lds
    v_mfma_f32_16x16x32_bf16 a[232:235], a[248:251], v[36:39], a[232:235]
    s_mov_b32 m0, 8448
    s_nop 0
    buffer_load_dwordx4 v0, s[12:15], s78 offen offset:0 nt lds
    s_waitcnt lgkmcnt(0)
    v_mfma_f32_16x16x32_bf16 a[196:199], a[240:243], v[16:19], a[196:199]
    s_mov_b32 m0, 8480
    s_nop 0
    buffer_load_dwordx4 v0, s[12:15], s78 offen offset:1024 nt lds
    s_waitcnt vmcnt(61)
    s_mov_b32 m0, 8512
    s_nop 0
    buffer_load_dwordx4 v0, s[12:15], s78 offen offset:2048 nt lds
    v_mfma_f32_16x16x32_bf16 a[204:207], a[240:243], v[20:23], a[204:207]
    s_waitcnt vmcnt(61)
    s_mov_b32 m0, 8544
    s_nop 0
    buffer_load_dwordx4 v0, s[12:15], s78 offen offset:3072 nt lds
    v_mfma_f32_16x16x32_bf16 a[212:215], a[240:243], v[24:27], a[212:215]
    s_waitcnt vmcnt(61)
    s_mov_b32 m0, 12672
    s_nop 0
    buffer_load_dwordx4 v0, s[12:15], s79 offen offset:0 nt lds
    s_waitcnt vmcnt(61)
    s_mov_b32 m0, 12704
    s_nop 0
    buffer_load_dwordx4 v0, s[12:15], s79 offen offset:1024 nt lds
    v_mfma_f32_16x16x32_bf16 a[220:223], a[240:243], v[28:31], a[220:223]
    s_waitcnt vmcnt(61)
    s_mov_b32 m0, 12736
    s_nop 0
    buffer_load_dwordx4 v0, s[12:15], s79 offen offset:2048 nt lds
    v_mfma_f32_16x16x32_bf16 a[228:231], a[240:243], v[32:35], a[228:231]
    s_waitcnt vmcnt(61)
    s_mov_b32 m0, 12768
    s_nop 0
    buffer_load_dwordx4 v0, s[12:15], s79 offen offset:3072 nt lds
    s_mov_b32 s78, s81
    s_mov_b32 s79, s82
    s_add_u32 s81, s81, 8192
    s_add_u32 s82, s82, 8192
    v_mfma_f32_16x16x32_bf16 a[236:239], a[240:243], v[36:39], a[236:239]
    s_waitcnt vmcnt(44)
    s_barrier
    ds_read_b128 v[16:19], v4 offset:1024
    ds_read_b64_tr_b16 a[240:241], v3 offset:0
    ds_read_b64_tr_b16 a[242:243], v3 offset:512
    ds_read_b128 v[20:23], v4 offset:5120
    ds_read_b128 v[24:27], v4 offset:9216
    ds_read_b128 v[28:31], v4 offset:13312
    ds_read_b128 v[32:35], v4 offset:17408
    ds_read_b128 v[36:39], v4 offset:21504
    ds_read_b64_tr_b16 a[244:245], v3 offset:32
    ds_read_b64_tr_b16 a[246:247], v3 offset:544
    ds_read_b64_tr_b16 a[248:249], v3 offset:8448
    ds_read_b64_tr_b16 a[250:251], v3 offset:8960
    s_mov_b32 m0, 97152
    s_add_u32 s75, s83, 5888
    buffer_load_dwordx4 v8, s[24:27], s75 offen offset:0 lds
    s_mov_b32 m0, 96928
    s_nop 0
    buffer_load_dwordx4 v8, s[24:27], s75 offen offset:1280 lds
    s_mov_b32 m0, 96704
    s_nop 0
    buffer_load_dwordx4 v8, s[24:27], s75 offen offset:2560 lds
    s_mov_b32 m0, 96480
    s_nop 0
    buffer_load_dwordx4 v8, s[24:27], s75 offen offset:3840 lds
    s_mov_b32 m0, 101376
    s_add_u32 s75, s83, 1024
    buffer_load_dwordx4 v8, s[24:27], s75 offen offset:0 lds
    s_mov_b32 m0, 101152
    s_nop 0
    buffer_load_dwordx4 v8, s[24:27], s75 offen offset:1280 lds
    s_mov_b32 m0, 100928
    s_nop 0
    buffer_load_dwordx4 v8, s[24:27], s75 offen offset:2560 lds
    s_mov_b32 m0, 100704
    s_nop 0
    buffer_load_dwordx4 v8, s[24:27], s75 offen offset:3840 lds
    s_waitcnt lgkmcnt(9)
    v_mfma_f32_16x16x32_bf16 a[0:3], a[240:243], v[16:19], a[0:3]
    s_mov_b32 m0, 105600
    s_add_u32 s75, s83, 6144
    buffer_load_dwordx4 v8, s[24:27], s75 offen offset:0 lds
    s_waitcnt lgkmcnt(8)
    v_mfma_f32_16x16x32_bf16 a[8:11], a[240:243], v[20:23], a[8:11]
    s_mov_b32 m0, 105376
    s_nop 0
    buffer_load_dwordx4 v8, s[24:27], s75 offen offset:1280 lds
    s_mov_b32 m0, 105152
    s_nop 0
    buffer_load_dwordx4 v8, s[24:27], s75 offen offset:2560 lds
    s_waitcnt lgkmcnt(7)
    v_mfma_f32_16x16x32_bf16 a[16:19], a[240:243], v[24:27], a[16:19]
    s_mov_b32 m0, 104928
    s_nop 0
    buffer_load_dwordx4 v8, s[24:27], s75 offen offset:3840 lds
    s_add_u32 s83, s83, 40960
    s_waitcnt lgkmcnt(6)
    v_mfma_f32_16x16x32_bf16 a[24:27], a[240:243], v[28:31], a[24:27]
    s_mov_b32 m0, 16896
    s_nop 0
    buffer_load_dwordx4 v0, s[8:11], s81 offen offset:0 nt lds
    s_mov_b32 m0, 16928
    s_nop 0
    buffer_load_dwordx4 v0, s[8:11], s81 offen offset:1024 nt lds
    s_waitcnt lgkmcnt(5)
    v_mfma_f32_16x16x32_bf16 a[32:35], a[240:243], v[32:35], a[32:35]
    s_mov_b32 m0, 16960
    s_nop 0
    buffer_load_dwordx4 v0, s[8:11], s81 offen offset:2048 nt lds
    s_waitcnt lgkmcnt(4)
    v_mfma_f32_16x16x32_bf16 a[40:43], a[240:243], v[36:39], a[40:43]
    s_mov_b32 m0, 16992
    s_nop 0
    buffer_load_dwordx4 v0, s[8:11], s81 offen offset:3072 nt lds
    s_mov_b32 m0, 21120
    s_nop 0
    buffer_load_dwordx4 v0, s[8:11], s82 offen offset:0 nt lds
    s_waitcnt lgkmcnt(2)
    v_mfma_f32_16x16x32_bf16 a[4:7], a[244:247], v[16:19], a[4:7]
    s_mov_b32 m0, 21152
    s_nop 0
    buffer_load_dwordx4 v0, s[8:11], s82 offen offset:1024 nt lds
    v_mfma_f32_16x16x32_bf16 a[12:15], a[244:247], v[20:23], a[12:15]
    s_waitcnt vmcnt(61)
    s_mov_b32 m0, 21184
    s_nop 0
    buffer_load_dwordx4 v0, s[8:11], s82 offen offset:2048 nt lds
    s_waitcnt vmcnt(61)
    s_mov_b32 m0, 21216
    s_nop 0
    buffer_load_dwordx4 v0, s[8:11], s82 offen offset:3072 nt lds
    v_mfma_f32_16x16x32_bf16 a[20:23], a[244:247], v[24:27], a[20:23]
    s_waitcnt vmcnt(61)
    s_mov_b32 m0, 25344
    s_nop 0
    buffer_load_dwordx4 v0, s[12:15], s78 offen offset:0 nt lds
    v_mfma_f32_16x16x32_bf16 a[28:31], a[244:247], v[28:31], a[28:31]
    s_waitcnt vmcnt(61)
    s_mov_b32 m0, 25376
    s_nop 0
    buffer_load_dwordx4 v0, s[12:15], s78 offen offset:1024 nt lds
    s_waitcnt vmcnt(61)
    s_mov_b32 m0, 25408
    s_nop 0
    buffer_load_dwordx4 v0, s[12:15], s78 offen offset:2048 nt lds
    v_mfma_f32_16x16x32_bf16 a[36:39], a[244:247], v[32:35], a[36:39]
    s_waitcnt vmcnt(61)
    s_mov_b32 m0, 25440
    s_nop 0
    buffer_load_dwordx4 v0, s[12:15], s78 offen offset:3072 nt lds
    v_mfma_f32_16x16x32_bf16 a[44:47], a[244:247], v[36:39], a[44:47]
    s_waitcnt vmcnt(61)
    s_mov_b32 m0, 29568
    s_nop 0
    buffer_load_dwordx4 v0, s[12:15], s79 offen offset:0 nt lds
    s_waitcnt vmcnt(61)
    s_mov_b32 m0, 29600
    s_nop 0
    buffer_load_dwordx4 v0, s[12:15], s79 offen offset:1024 nt lds
    s_waitcnt lgkmcnt(0)
    v_mfma_f32_16x16x32_bf16 a[48:51], a[248:251], v[16:19], a[48:51]
    s_waitcnt vmcnt(61)
    s_mov_b32 m0, 29632
    s_nop 0
    buffer_load_dwordx4 v0, s[12:15], s79 offen offset:2048 nt lds
    v_mfma_f32_16x16x32_bf16 a[56:59], a[248:251], v[20:23], a[56:59]
    s_waitcnt vmcnt(61)
    s_mov_b32 m0, 29664
    s_nop 0
    buffer_load_dwordx4 v0, s[12:15], s79 offen offset:3072 nt lds
    s_mov_b32 s78, s81
    s_mov_b32 s79, s82
    s_add_u32 s81, s81, 8192
    s_add_u32 s82, s82, 8192
    v_mfma_f32_16x16x32_bf16 a[64:67], a[248:251], v[24:27], a[64:67]
    s_waitcnt vmcnt(44)
    s_barrier
    ds_read_b64_tr_b16 a[240:241], v3 offset:8480
    ds_read_b64_tr_b16 a[242:243], v3 offset:8992
    ds_read_b64_tr_b16 a[244:245], v3 offset:16896
    ds_read_b64_tr_b16 a[246:247], v3 offset:17408
    s_mov_b32 m0, 67584
    s_add_u32 s75, s83, 0
    buffer_load_dwordx4 v8, s[24:27], s75 offen offset:0 lds
    s_mov_b32 m0, 67360
    s_nop 0
    buffer_load_dwordx4 v8, s[24:27], s75 offen offset:1280 lds
    s_mov_b32 m0, 67136
    s_nop 0
    buffer_load_dwordx4 v8, s[24:27], s75 offen offset:2560 lds
    s_mov_b32 m0, 66912
    s_nop 0
    buffer_load_dwordx4 v8, s[24:27], s75 offen offset:3840 lds
    s_mov_b32 m0, 71808
    s_add_u32 s75, s83, 5120
    buffer_load_dwordx4 v8, s[24:27], s75 offen offset:0 lds
    s_mov_b32 m0, 71584
    s_nop 0
    buffer_load_dwordx4 v8, s[24:27], s75 offen offset:1280 lds
    s_mov_b32 m0, 71360
    s_nop 0
    buffer_load_dwordx4 v8, s[24:27], s75 offen offset:2560 lds
    v_mfma_f32_16x16x32_bf16 a[72:75], a[248:251], v[28:31], a[72:75]
    s_mov_b32 m0, 71136
    s_nop 0
    buffer_load_dwordx4 v8, s[24:27], s75 offen offset:3840 lds
    v_mfma_f32_16x16x32_bf16 a[80:83], a[248:251], v[32:35], a[80:83]
    s_mov_b32 m0, 33792
    s_nop 0
    buffer_load_dwordx4 v0, s[8:11], s81 offen offset:0 nt lds
    v_mfma_f32_16x16x32_bf16 a[88:91], a[248:251], v[36:39], a[88:91]
    s_mov_b32 m0, 33824
    s_nop 0
    buffer_load_dwordx4 v0, s[8:11], s81 offen offset:1024 nt lds
    s_mov_b32 m0, 33856
    s_nop 0
    buffer_load_dwordx4 v0, s[8:11], s81 offen offset:2048 nt lds
    s_waitcnt lgkmcnt(2)
    v_mfma_f32_16x16x32_bf16 a[52:55], a[240:243], v[16:19], a[52:55]
    s_mov_b32 m0, 33888
    s_nop 0
    buffer_load_dwordx4 v0, s[8:11], s81 offen offset:3072 nt lds
    v_mfma_f32_16x16x32_bf16 a[60:63], a[240:243], v[20:23], a[60:63]
    s_mov_b32 m0, 38016
    s_nop 0
    buffer_load_dwordx4 v0, s[8:11], s82 offen offset:0 nt lds
    v_mfma_f32_16x16x32_bf16 a[68:71], a[240:243], v[24:27], a[68:71]
    s_mov_b32 m0, 38048
    s_nop 0
    buffer_load_dwordx4 v0, s[8:11], s82 offen offset:1024 nt lds
    v_mfma_f32_16x16x32_bf16 a[76:79], a[240:243], v[28:31], a[76:79]
    s_mov_b32 m0, 38080
    s_nop 0
    buffer_load_dwordx4 v0, s[8:11], s82 offen offset:2048 nt lds
    s_mov_b32 m0, 38112
    s_nop 0
    buffer_load_dwordx4 v0, s[8:11], s82 offen offset:3072 nt lds
    v_mfma_f32_16x16x32_bf16 a[84:87], a[240:243], v[32:35], a[84:87]
    s_mov_b32 m0, 42240
    s_nop 0
    buffer_load_dwordx4 v0, s[12:15], s78 offen offset:0 nt lds
    v_mfma_f32_16x16x32_bf16 a[92:95], a[240:243], v[36:39], a[92:95]
    s_mov_b32 m0, 42272
    s_nop 0
    buffer_load_dwordx4 v0, s[12:15], s78 offen offset:1024 nt lds
    s_waitcnt lgkmcnt(0)
    v_mfma_f32_16x16x32_bf16 a[96:99], a[244:247], v[16:19], a[96:99]
    s_waitcnt vmcnt(61)
    s_mov_b32 m0, 42304
    s_nop 0
    buffer_load_dwordx4 v0, s[12:15], s78 offen offset:2048 nt lds
    v_mfma_f32_16x16x32_bf16 a[104:107], a[244:247], v[20:23], a[104:107]
    s_waitcnt vmcnt(61)
    s_mov_b32 m0, 42336
    s_nop 0
    buffer_load_dwordx4 v0, s[12:15], s78 offen offset:3072 nt lds
    s_waitcnt vmcnt(61)
    s_mov_b32 m0, 46464
    s_nop 0
    buffer_load_dwordx4 v0, s[12:15], s79 offen offset:0 nt lds
    v_mfma_f32_16x16x32_bf16 a[112:115], a[244:247], v[24:27], a[112:115]
    s_waitcnt vmcnt(61)
    s_mov_b32 m0, 46496
    s_nop 0
    buffer_load_dwordx4 v0, s[12:15], s79 offen offset:1024 nt lds
    v_mfma_f32_16x16x32_bf16 a[120:123], a[244:247], v[28:31], a[120:123]
    s_waitcnt vmcnt(61)
    s_mov_b32 m0, 46528
    s_nop 0
    buffer_load_dwordx4 v0, s[12:15], s79 offen offset:2048 nt lds
    v_mfma_f32_16x16x32_bf16 a[128:131], a[244:247], v[32:35], a[128:131]
    s_waitcnt vmcnt(61)
    s_mov_b32 m0, 46560
    s_nop 0
    buffer_load_dwordx4 v0, s[12:15], s79 offen offset:3072 nt lds
    s_mov_b32 s78, s81
    s_mov_b32 s79, s82
    s_add_u32 s81, s81, 8192
    s_add_u32 s82, s82, 8192
    v_mfma_f32_16x16x32_bf16 a[136:139], a[244:247], v[36:39], a[136:139]
    s_waitcnt vmcnt(40)
    s_barrier
    ds_read_b64_tr_b16 a[248:249], v3 offset:16928
    ds_read_b64_tr_b16 a[250:251], v3 offset:17440
    ds_read_b64_tr_b16 a[240:241], v3 offset:25344
    ds_read_b64_tr_b16 a[242:243], v3 offset:25856
    ds_read_b64_tr_b16 a[244:245], v3 offset:25376
    ds_read_b64_tr_b16 a[246:247], v3 offset:25888
    s_mov_b32 m0, 76032
    s_add_u32 s75, s83, 256
    buffer_load_dwordx4 v8, s[24:27], s75 offen offset:0 lds
    s_mov_b32 m0, 75808
    s_nop 0
    buffer_load_dwordx4 v8, s[24:27], s75 offen offset:1280 lds
    s_mov_b32 m0, 75584
    s_nop 0
    buffer_load_dwordx4 v8, s[24:27], s75 offen offset:2560 lds
    s_mov_b32 m0, 75360
    s_nop 0
    buffer_load_dwordx4 v8, s[24:27], s75 offen offset:3840 lds
    s_mov_b32 m0, 80256
    s_add_u32 s75, s83, 5376
    buffer_load_dwordx4 v8, s[24:27], s75 offen offset:0 lds
    s_mov_b32 m0, 80032
    s_nop 0
    buffer_load_dwordx4 v8, s[24:27], s75 offen offset:1280 lds
    s_mov_b32 m0, 79808
    s_nop 0
    buffer_load_dwordx4 v8, s[24:27], s75 offen offset:2560 lds
    s_waitcnt lgkmcnt(4)
    v_mfma_f32_16x16x32_bf16 a[100:103], a[248:251], v[16:19], a[100:103]
    s_mov_b32 m0, 79584
    s_nop 0
    buffer_load_dwordx4 v8, s[24:27], s75 offen offset:3840 lds
    v_mfma_f32_16x16x32_bf16 a[108:111], a[248:251], v[20:23], a[108:111]
    s_mov_b32 m0, 50688
    s_nop 0
    buffer_load_dwordx4 v0, s[8:11], s81 offen offset:0 nt lds
    v_mfma_f32_16x16x32_bf16 a[116:119], a[248:251], v[24:27], a[116:119]
    s_mov_b32 m0, 50720
    s_nop 0
    buffer_load_dwordx4 v0, s[8:11], s81 offen offset:1024 nt lds
    s_mov_b32 m0, 50752
    s_nop 0
    buffer_load_dwordx4 v0, s[8:11], s81 offen offset:2048 nt lds
    v_mfma_f32_16x16x32_bf16 a[124:127], a[248:251], v[28:31], a[124:127]
    s_mov_b32 m0, 50784
    s_nop 0
    buffer_load_dwordx4 v0, s[8:11], s81 offen offset:3072 nt lds
    v_mfma_f32_16x16x32_bf16 a[132:135], a[248:251], v[32:35], a[132:135]
    s_mov_b32 m0, 54912
    s_nop 0
    buffer_load_dwordx4 v0, s[8:11], s82 offen offset:0 nt lds
    v_mfma_f32_16x16x32_bf16 a[140:143], a[248:251], v[36:39], a[140:143]
    s_mov_b32 m0, 54944
    s_nop 0
    buffer_load_dwordx4 v0, s[8:11], s82 offen offset:1024 nt lds
    s_waitcnt lgkmcnt(2)
    v_mfma_f32_16x16x32_bf16 a[144:147], a[240:243], v[16:19], a[144:147]
    s_mov_b32 m0, 54976
    s_nop 0
    buffer_load_dwordx4 v0, s[8:11], s82 offen offset:2048 nt lds
    s_mov_b32 m0, 55008
    s_nop 0
    buffer_load_dwordx4 v0, s[8:11], s82 offen offset:3072 nt lds
    v_mfma_f32_16x16x32_bf16 a[152:155], a[240:243], v[20:23], a[152:155]
    s_mov_b32 m0, 59136
    s_nop 0
    buffer_load_dwordx4 v0, s[12:15], s78 offen offset:0 nt lds
    v_mfma_f32_16x16x32_bf16 a[160:163], a[240:243], v[24:27], a[160:163]
    s_mov_b32 m0, 59168
    s_nop 0
    buffer_load_dwordx4 v0, s[12:15], s78 offen offset:1024 nt lds
    v_mfma_f32_16x16x32_bf16 a[168:171], a[240:243], v[28:31], a[168:171]
    s_mov_b32 m0, 59200
    s_nop 0
    buffer_load_dwordx4 v0, s[12:15], s78 offen offset:2048 nt lds
    v_mfma_f32_16x16x32_bf16 a[176:179], a[240:243], v[32:35], a[176:179]
    s_mov_b32 m0, 59232
    s_nop 0
    buffer_load_dwordx4 v0, s[12:15], s78 offen offset:3072 nt lds
    s_mov_b32 m0, 63360
    s_nop 0
    buffer_load_dwordx4 v0, s[12:15], s79 offen offset:0 nt lds
    v_mfma_f32_16x16x32_bf16 a[184:187], a[240:243], v[36:39], a[184:187]
    s_mov_b32 m0, 63392
    s_nop 0
    buffer_load_dwordx4 v0, s[12:15], s79 offen offset:1024 nt lds
    s_waitcnt lgkmcnt(0)
    v_mfma_f32_16x16x32_bf16 a[148:151], a[244:247], v[16:19], a[148:151]
    s_waitcnt vmcnt(61)
    s_mov_b32 m0, 63424
    s_nop 0
    buffer_load_dwordx4 v0, s[12:15], s79 offen offset:2048 nt lds
    v_mfma_f32_16x16x32_bf16 a[156:159], a[244:247], v[20:23], a[156:159]
    s_waitcnt vmcnt(61)
    s_mov_b32 m0, 63456
    s_nop 0
    buffer_load_dwordx4 v0, s[12:15], s79 offen offset:3072 nt lds
    s_mov_b32 s78, s81
    s_mov_b32 s79, s82
    s_add_u32 s81, s81, 8192
    s_add_u32 s82, s82, 8192
    v_mfma_f32_16x16x32_bf16 a[164:167], a[244:247], v[24:27], a[164:167]
    s_waitcnt vmcnt(40)
    s_barrier
    ds_read_b64_tr_b16 a[248:249], v3 offset:33792
    ds_read_b64_tr_b16 a[250:251], v3 offset:34304
    ds_read_b64_tr_b16 a[240:241], v3 offset:33824
    ds_read_b64_tr_b16 a[242:243], v3 offset:34336
    s_mov_b32 m0, 84480
    s_add_u32 s75, s83, 512
    buffer_load_dwordx4 v8, s[24:27], s75 offen offset:0 lds
    s_mov_b32 m0, 84256
    s_nop 0
    buffer_load_dwordx4 v8, s[24:27], s75 offen offset:1280 lds
    s_mov_b32 m0, 84032
    s_nop 0
    buffer_load_dwordx4 v8, s[24:27], s75 offen offset:2560 lds
    s_mov_b32 m0, 83808
    s_nop 0
    buffer_load_dwordx4 v8, s[24:27], s75 offen offset:3840 lds
    s_mov_b32 m0, 88704
    s_add_u32 s75, s83, 5632
    buffer_load_dwordx4 v8, s[24:27], s75 offen offset:0 lds
    s_mov_b32 m0, 88480
    s_nop 0
    buffer_load_dwordx4 v8, s[24:27], s75 offen offset:1280 lds
    s_mov_b32 m0, 88256
    s_nop 0
    buffer_load_dwordx4 v8, s[24:27], s75 offen offset:2560 lds
    s_mov_b32 m0, 88032
    s_nop 0
    buffer_load_dwordx4 v8, s[24:27], s75 offen offset:3840 lds
    v_mfma_f32_16x16x32_bf16 a[172:175], a[244:247], v[28:31], a[172:175]
    s_mov_b32 m0, 92928
    s_add_u32 s75, s83, 768
    buffer_load_dwordx4 v8, s[24:27], s75 offen offset:0 lds
    v_mfma_f32_16x16x32_bf16 a[180:183], a[244:247], v[32:35], a[180:183]
    s_mov_b32 m0, 92704
    s_nop 0
    buffer_load_dwordx4 v8, s[24:27], s75 offen offset:1280 lds
    s_mov_b32 m0, 92480
    s_nop 0
    buffer_load_dwordx4 v8, s[24:27], s75 offen offset:2560 lds
    v_mfma_f32_16x16x32_bf16 a[188:191], a[244:247], v[36:39], a[188:191]
    s_mov_b32 m0, 92256
    s_nop 0
    buffer_load_dwordx4 v8, s[24:27], s75 offen offset:3840 lds
    s_waitcnt lgkmcnt(2)
    v_mfma_f32_16x16x32_bf16 a[192:195], a[248:251], v[16:19], a[192:195]
    s_mov_b32 m0, 0
    s_nop 0
    buffer_load_dwordx4 v0, s[8:11], s81 offen offset:0 nt lds
    s_mov_b32 m0, 32
    s_nop 0
    buffer_load_dwordx4 v0, s[8:11], s81 offen offset:1024 nt lds
    v_mfma_f32_16x16x32_bf16 a[200:203], a[248:251], v[20:23], a[200:203]
    s_mov_b32 m0, 64
    s_nop 0
    buffer_load_dwordx4 v0, s[8:11], s81 offen offset:2048 nt lds
    v_mfma_f32_16x16x32_bf16 a[208:211], a[248:251], v[24:27], a[208:211]
    s_mov_b32 m0, 96
    s_nop 0
    buffer_load_dwordx4 v0, s[8:11], s81 offen offset:3072 nt lds
    s_mov_b32 m0, 4224
    s_nop 0
    buffer_load_dwordx4 v0, s[8:11], s82 offen offset:0 nt lds
    v_mfma_f32_16x16x32_bf16 a[216:219], a[248:251], v[28:31], a[216:219]
    s_mov_b32 m0, 4256
    s_nop 0
    buffer_load_dwordx4 v0, s[8:11], s82 offen offset:1024 nt lds
    v_mfma_f32_16x16x32_bf16 a[224:227], a[248:251], v[32:35], a[224:227]
    s_mov_b32 m0, 4288
    s_nop 0
    buffer_load_dwordx4 v0, s[8:11], s82 offen offset:2048 nt lds
    s_mov_b32 m0, 4320
    s_nop 0
    buffer_load_dwordx4 v0, s[8:11], s82 offen offset:3072 nt lds
    v_mfma_f32_16x16x32_bf16 a[232:235], a[248:251], v[36:39], a[232:235]
    s_mov_b32 m0, 8448
    s_nop 0
    buffer_load_dwordx4 v0, s[12:15], s78 offen offset:0 nt lds
    s_waitcnt lgkmcnt(0)
    v_mfma_f32_16x16x32_bf16 a[196:199], a[240:243], v[16:19], a[196:199]
    s_mov_b32 m0, 8480
    s_nop 0
    buffer_load_dwordx4 v0, s[12:15], s78 offen offset:1024 nt lds
    s_waitcnt vmcnt(61)
    s_mov_b32 m0, 8512
    s_nop 0
    buffer_load_dwordx4 v0, s[12:15], s78 offen offset:2048 nt lds
    v_mfma_f32_16x16x32_bf16 a[204:207], a[240:243], v[20:23], a[204:207]
    s_waitcnt vmcnt(61)
    s_mov_b32 m0, 8544
    s_nop 0
    buffer_load_dwordx4 v0, s[12:15], s78 offen offset:3072 nt lds
    v_mfma_f32_16x16x32_bf16 a[212:215], a[240:243], v[24:27], a[212:215]
    s_waitcnt vmcnt(61)
    s_mov_b32 m0, 12672
    s_nop 0
    buffer_load_dwordx4 v0, s[12:15], s79 offen offset:0 nt lds
    s_waitcnt vmcnt(61)
    s_mov_b32 m0, 12704
    s_nop 0
    buffer_load_dwordx4 v0, s[12:15], s79 offen offset:1024 nt lds
    v_mfma_f32_16x16x32_bf16 a[220:223], a[240:243], v[28:31], a[220:223]
    s_waitcnt vmcnt(61)
    s_mov_b32 m0, 12736
    s_nop 0
    buffer_load_dwordx4 v0, s[12:15], s79 offen offset:2048 nt lds
    v_mfma_f32_16x16x32_bf16 a[228:231], a[240:243], v[32:35], a[228:231]
    s_waitcnt vmcnt(61)
    s_mov_b32 m0, 12768
    s_nop 0
    buffer_load_dwordx4 v0, s[12:15], s79 offen offset:3072 nt lds
    s_mov_b32 s78, s81
    s_mov_b32 s79, s82
    s_add_u32 s81, s81, 8192
    s_add_u32 s82, s82, 8192
    v_mfma_f32_16x16x32_bf16 a[236:239], a[240:243], v[36:39], a[236:239]
    s_waitcnt vmcnt(44)
    s_barrier
    ds_read_b128 v[16:19], v4 offset:2048
    ds_read_b64_tr_b16 a[240:241], v3 offset:0
    ds_read_b64_tr_b16 a[242:243], v3 offset:512
    ds_read_b128 v[20:23], v4 offset:6144
    ds_read_b128 v[24:27], v4 offset:10240
    ds_read_b128 v[28:31], v4 offset:14336
    ds_read_b128 v[32:35], v4 offset:18432
    ds_read_b128 v[36:39], v4 offset:22528
    ds_read_b64_tr_b16 a[244:245], v3 offset:32
    ds_read_b64_tr_b16 a[246:247], v3 offset:544
    ds_read_b64_tr_b16 a[248:249], v3 offset:8448
    ds_read_b64_tr_b16 a[250:251], v3 offset:8960
    s_mov_b32 m0, 97152
    s_add_u32 s75, s83, 5888
    buffer_load_dwordx4 v8, s[24:27], s75 offen offset:0 lds
    s_mov_b32 m0, 96928
    s_nop 0
    buffer_load_dwordx4 v8, s[24:27], s75 offen offset:1280 lds
    s_mov_b32 m0, 96704
    s_nop 0
    buffer_load_dwordx4 v8, s[24:27], s75 offen offset:2560 lds
    s_mov_b32 m0, 96480
    s_nop 0
    buffer_load_dwordx4 v8, s[24:27], s75 offen offset:3840 lds
    s_mov_b32 m0, 101376
    s_add_u32 s75, s83, 1024
    buffer_load_dwordx4 v8, s[24:27], s75 offen offset:0 lds
    s_mov_b32 m0, 101152
    s_nop 0
    buffer_load_dwordx4 v8, s[24:27], s75 offen offset:1280 lds
    s_mov_b32 m0, 100928
    s_nop 0
    buffer_load_dwordx4 v8, s[24:27], s75 offen offset:2560 lds
    s_mov_b32 m0, 100704
    s_nop 0
    buffer_load_dwordx4 v8, s[24:27], s75 offen offset:3840 lds
    s_waitcnt lgkmcnt(9)
    v_mfma_f32_16x16x32_bf16 a[0:3], a[240:243], v[16:19], a[0:3]
    s_mov_b32 m0, 105600
    s_add_u32 s75, s83, 6144
    buffer_load_dwordx4 v8, s[24:27], s75 offen offset:0 lds
    s_waitcnt lgkmcnt(8)
    v_mfma_f32_16x16x32_bf16 a[8:11], a[240:243], v[20:23], a[8:11]
    s_mov_b32 m0, 105376
    s_nop 0
    buffer_load_dwordx4 v8, s[24:27], s75 offen offset:1280 lds
    s_mov_b32 m0, 105152
    s_nop 0
    buffer_load_dwordx4 v8, s[24:27], s75 offen offset:2560 lds
    s_waitcnt lgkmcnt(7)
    v_mfma_f32_16x16x32_bf16 a[16:19], a[240:243], v[24:27], a[16:19]
    s_mov_b32 m0, 104928
    s_nop 0
    buffer_load_dwordx4 v8, s[24:27], s75 offen offset:3840 lds
    s_add_u32 s83, s83, 40960
    s_waitcnt lgkmcnt(6)
    v_mfma_f32_16x16x32_bf16 a[24:27], a[240:243], v[28:31], a[24:27]
    s_mov_b32 m0, 16896
    s_nop 0
    buffer_load_dwordx4 v0, s[8:11], s81 offen offset:0 nt lds
    s_mov_b32 m0, 16928
    s_nop 0
    buffer_load_dwordx4 v0, s[8:11], s81 offen offset:1024 nt lds
    s_waitcnt lgkmcnt(5)
    v_mfma_f32_16x16x32_bf16 a[32:35], a[240:243], v[32:35], a[32:35]
    s_mov_b32 m0, 16960
    s_nop 0
    buffer_load_dwordx4 v0, s[8:11], s81 offen offset:2048 nt lds
    s_waitcnt lgkmcnt(4)
    v_mfma_f32_16x16x32_bf16 a[40:43], a[240:243], v[36:39], a[40:43]
    s_mov_b32 m0, 16992
    s_nop 0
    buffer_load_dwordx4 v0, s[8:11], s81 offen offset:3072 nt lds
    s_mov_b32 m0, 21120
    s_nop 0
    buffer_load_dwordx4 v0, s[8:11], s82 offen offset:0 nt lds
    s_waitcnt lgkmcnt(2)
    v_mfma_f32_16x16x32_bf16 a[4:7], a[244:247], v[16:19], a[4:7]
    s_mov_b32 m0, 21152
    s_nop 0
    buffer_load_dwordx4 v0, s[8:11], s82 offen offset:1024 nt lds
    v_mfma_f32_16x16x32_bf16 a[12:15], a[244:247], v[20:23], a[12:15]
    s_waitcnt vmcnt(61)
    s_mov_b32 m0, 21184
    s_nop 0
    buffer_load_dwordx4 v0, s[8:11], s82 offen offset:2048 nt lds
    s_waitcnt vmcnt(61)
    s_mov_b32 m0, 21216
    s_nop 0
    buffer_load_dwordx4 v0, s[8:11], s82 offen offset:3072 nt lds
    v_mfma_f32_16x16x32_bf16 a[20:23], a[244:247], v[24:27], a[20:23]
    s_waitcnt vmcnt(61)
    s_mov_b32 m0, 25344
    s_nop 0
    buffer_load_dwordx4 v0, s[12:15], s78 offen offset:0 nt lds
    v_mfma_f32_16x16x32_bf16 a[28:31], a[244:247], v[28:31], a[28:31]
    s_waitcnt vmcnt(61)
    s_mov_b32 m0, 25376
    s_nop 0
    buffer_load_dwordx4 v0, s[12:15], s78 offen offset:1024 nt lds
    s_waitcnt vmcnt(61)
    s_mov_b32 m0, 25408
    s_nop 0
    buffer_load_dwordx4 v0, s[12:15], s78 offen offset:2048 nt lds
    v_mfma_f32_16x16x32_bf16 a[36:39], a[244:247], v[32:35], a[36:39]
    s_waitcnt vmcnt(61)
    s_mov_b32 m0, 25440
    s_nop 0
    buffer_load_dwordx4 v0, s[12:15], s78 offen offset:3072 nt lds
    v_mfma_f32_16x16x32_bf16 a[44:47], a[244:247], v[36:39], a[44:47]
    s_waitcnt vmcnt(61)
    s_mov_b32 m0, 29568
    s_nop 0
    buffer_load_dwordx4 v0, s[12:15], s79 offen offset:0 nt lds
    s_waitcnt vmcnt(61)
    s_mov_b32 m0, 29600
    s_nop 0
    buffer_load_dwordx4 v0, s[12:15], s79 offen offset:1024 nt lds
    s_waitcnt lgkmcnt(0)
    v_mfma_f32_16x16x32_bf16 a[48:51], a[248:251], v[16:19], a[48:51]
    s_waitcnt vmcnt(61)
    s_mov_b32 m0, 29632
    s_nop 0
    buffer_load_dwordx4 v0, s[12:15], s79 offen offset:2048 nt lds
    v_mfma_f32_16x16x32_bf16 a[56:59], a[248:251], v[20:23], a[56:59]
    s_waitcnt vmcnt(61)
    s_mov_b32 m0, 29664
    s_nop 0
    buffer_load_dwordx4 v0, s[12:15], s79 offen offset:3072 nt lds
    s_mov_b32 s78, s81
    s_mov_b32 s79, s82
    s_add_u32 s81, s81, 8192
    s_add_u32 s82, s82, 8192
    v_mfma_f32_16x16x32_bf16 a[64:67], a[248:251], v[24:27], a[64:67]
    s_waitcnt vmcnt(44)
    s_barrier
    ds_read_b64_tr_b16 a[240:241], v3 offset:8480
    ds_read_b64_tr_b16 a[242:243], v3 offset:8992
    ds_read_b64_tr_b16 a[244:245], v3 offset:16896
    ds_read_b64_tr_b16 a[246:247], v3 offset:17408
    s_mov_b32 m0, 67584
    s_add_u32 s75, s83, 0
    buffer_load_dwordx4 v8, s[24:27], s75 offen offset:0 lds
    s_mov_b32 m0, 67360
    s_nop 0
    buffer_load_dwordx4 v8, s[24:27], s75 offen offset:1280 lds
    s_mov_b32 m0, 67136
    s_nop 0
    buffer_load_dwordx4 v8, s[24:27], s75 offen offset:2560 lds
    s_mov_b32 m0, 66912
    s_nop 0
    buffer_load_dwordx4 v8, s[24:27], s75 offen offset:3840 lds
    s_mov_b32 m0, 71808
    s_add_u32 s75, s83, 5120
    buffer_load_dwordx4 v8, s[24:27], s75 offen offset:0 lds
    s_mov_b32 m0, 71584
    s_nop 0
    buffer_load_dwordx4 v8, s[24:27], s75 offen offset:1280 lds
    s_mov_b32 m0, 71360
    s_nop 0
    buffer_load_dwordx4 v8, s[24:27], s75 offen offset:2560 lds
    v_mfma_f32_16x16x32_bf16 a[72:75], a[248:251], v[28:31], a[72:75]
    s_mov_b32 m0, 71136
    s_nop 0
    buffer_load_dwordx4 v8, s[24:27], s75 offen offset:3840 lds
    v_mfma_f32_16x16x32_bf16 a[80:83], a[248:251], v[32:35], a[80:83]
    s_mov_b32 m0, 33792
    s_nop 0
    buffer_load_dwordx4 v0, s[8:11], s81 offen offset:0 nt lds
    v_mfma_f32_16x16x32_bf16 a[88:91], a[248:251], v[36:39], a[88:91]
    s_mov_b32 m0, 33824
    s_nop 0
    buffer_load_dwordx4 v0, s[8:11], s81 offen offset:1024 nt lds
    s_mov_b32 m0, 33856
    s_nop 0
    buffer_load_dwordx4 v0, s[8:11], s81 offen offset:2048 nt lds
    s_waitcnt lgkmcnt(2)
    v_mfma_f32_16x16x32_bf16 a[52:55], a[240:243], v[16:19], a[52:55]
    s_mov_b32 m0, 33888
    s_nop 0
    buffer_load_dwordx4 v0, s[8:11], s81 offen offset:3072 nt lds
    v_mfma_f32_16x16x32_bf16 a[60:63], a[240:243], v[20:23], a[60:63]
    s_mov_b32 m0, 38016
    s_nop 0
    buffer_load_dwordx4 v0, s[8:11], s82 offen offset:0 nt lds
    v_mfma_f32_16x16x32_bf16 a[68:71], a[240:243], v[24:27], a[68:71]
    s_mov_b32 m0, 38048
    s_nop 0
    buffer_load_dwordx4 v0, s[8:11], s82 offen offset:1024 nt lds
    v_mfma_f32_16x16x32_bf16 a[76:79], a[240:243], v[28:31], a[76:79]
    s_mov_b32 m0, 38080
    s_nop 0
    buffer_load_dwordx4 v0, s[8:11], s82 offen offset:2048 nt lds
    s_mov_b32 m0, 38112
    s_nop 0
    buffer_load_dwordx4 v0, s[8:11], s82 offen offset:3072 nt lds
    v_mfma_f32_16x16x32_bf16 a[84:87], a[240:243], v[32:35], a[84:87]
    s_mov_b32 m0, 42240
    s_nop 0
    buffer_load_dwordx4 v0, s[12:15], s78 offen offset:0 nt lds
    v_mfma_f32_16x16x32_bf16 a[92:95], a[240:243], v[36:39], a[92:95]
    s_mov_b32 m0, 42272
    s_nop 0
    buffer_load_dwordx4 v0, s[12:15], s78 offen offset:1024 nt lds
    s_waitcnt lgkmcnt(0)
    v_mfma_f32_16x16x32_bf16 a[96:99], a[244:247], v[16:19], a[96:99]
    s_waitcnt vmcnt(61)
    s_mov_b32 m0, 42304
    s_nop 0
    buffer_load_dwordx4 v0, s[12:15], s78 offen offset:2048 nt lds
    v_mfma_f32_16x16x32_bf16 a[104:107], a[244:247], v[20:23], a[104:107]
    s_waitcnt vmcnt(61)
    s_mov_b32 m0, 42336
    s_nop 0
    buffer_load_dwordx4 v0, s[12:15], s78 offen offset:3072 nt lds
    s_waitcnt vmcnt(61)
    s_mov_b32 m0, 46464
    s_nop 0
    buffer_load_dwordx4 v0, s[12:15], s79 offen offset:0 nt lds
    v_mfma_f32_16x16x32_bf16 a[112:115], a[244:247], v[24:27], a[112:115]
    s_waitcnt vmcnt(61)
    s_mov_b32 m0, 46496
    s_nop 0
    buffer_load_dwordx4 v0, s[12:15], s79 offen offset:1024 nt lds
    v_mfma_f32_16x16x32_bf16 a[120:123], a[244:247], v[28:31], a[120:123]
    s_waitcnt vmcnt(61)
    s_mov_b32 m0, 46528
    s_nop 0
    buffer_load_dwordx4 v0, s[12:15], s79 offen offset:2048 nt lds
    v_mfma_f32_16x16x32_bf16 a[128:131], a[244:247], v[32:35], a[128:131]
    s_waitcnt vmcnt(61)
    s_mov_b32 m0, 46560
    s_nop 0
    buffer_load_dwordx4 v0, s[12:15], s79 offen offset:3072 nt lds
    s_mov_b32 s78, s81
    s_mov_b32 s79, s82
    s_add_u32 s81, s81, 8192
    s_add_u32 s82, s82, 8192
    v_mfma_f32_16x16x32_bf16 a[136:139], a[244:247], v[36:39], a[136:139]
    s_waitcnt vmcnt(40)
    s_barrier
    ds_read_b64_tr_b16 a[248:249], v3 offset:16928
    ds_read_b64_tr_b16 a[250:251], v3 offset:17440
    ds_read_b64_tr_b16 a[240:241], v3 offset:25344
    ds_read_b64_tr_b16 a[242:243], v3 offset:25856
    ds_read_b64_tr_b16 a[244:245], v3 offset:25376
    ds_read_b64_tr_b16 a[246:247], v3 offset:25888
    s_mov_b32 m0, 76032
    s_add_u32 s75, s83, 256
    buffer_load_dwordx4 v8, s[24:27], s75 offen offset:0 lds
    s_mov_b32 m0, 75808
    s_nop 0
    buffer_load_dwordx4 v8, s[24:27], s75 offen offset:1280 lds
    s_mov_b32 m0, 75584
    s_nop 0
    buffer_load_dwordx4 v8, s[24:27], s75 offen offset:2560 lds
    s_mov_b32 m0, 75360
    s_nop 0
    buffer_load_dwordx4 v8, s[24:27], s75 offen offset:3840 lds
    s_mov_b32 m0, 80256
    s_add_u32 s75, s83, 5376
    buffer_load_dwordx4 v8, s[24:27], s75 offen offset:0 lds
    s_mov_b32 m0, 80032
    s_nop 0
    buffer_load_dwordx4 v8, s[24:27], s75 offen offset:1280 lds
    s_mov_b32 m0, 79808
    s_nop 0
    buffer_load_dwordx4 v8, s[24:27], s75 offen offset:2560 lds
    s_waitcnt lgkmcnt(4)
    v_mfma_f32_16x16x32_bf16 a[100:103], a[248:251], v[16:19], a[100:103]
    s_mov_b32 m0, 79584
    s_nop 0
    buffer_load_dwordx4 v8, s[24:27], s75 offen offset:3840 lds
    v_mfma_f32_16x16x32_bf16 a[108:111], a[248:251], v[20:23], a[108:111]
    s_mov_b32 m0, 50688
    s_nop 0
    buffer_load_dwordx4 v0, s[8:11], s81 offen offset:0 nt lds
    v_mfma_f32_16x16x32_bf16 a[116:119], a[248:251], v[24:27], a[116:119]
    s_mov_b32 m0, 50720
    s_nop 0
    buffer_load_dwordx4 v0, s[8:11], s81 offen offset:1024 nt lds
    s_mov_b32 m0, 50752
    s_nop 0
    buffer_load_dwordx4 v0, s[8:11], s81 offen offset:2048 nt lds
    v_mfma_f32_16x16x32_bf16 a[124:127], a[248:251], v[28:31], a[124:127]
    s_mov_b32 m0, 50784
    s_nop 0
    buffer_load_dwordx4 v0, s[8:11], s81 offen offset:3072 nt lds
    v_mfma_f32_16x16x32_bf16 a[132:135], a[248:251], v[32:35], a[132:135]
    s_mov_b32 m0, 54912
    s_nop 0
    buffer_load_dwordx4 v0, s[8:11], s82 offen offset:0 nt lds
    v_mfma_f32_16x16x32_bf16 a[140:143], a[248:251], v[36:39], a[140:143]
    s_mov_b32 m0, 54944
    s_nop 0
    buffer_load_dwordx4 v0, s[8:11], s82 offen offset:1024 nt lds
    s_waitcnt lgkmcnt(2)
    v_mfma_f32_16x16x32_bf16 a[144:147], a[240:243], v[16:19], a[144:147]
    s_mov_b32 m0, 54976
    s_nop 0
    buffer_load_dwordx4 v0, s[8:11], s82 offen offset:2048 nt lds
    s_mov_b32 m0, 55008
    s_nop 0
    buffer_load_dwordx4 v0, s[8:11], s82 offen offset:3072 nt lds
    v_mfma_f32_16x16x32_bf16 a[152:155], a[240:243], v[20:23], a[152:155]
    s_mov_b32 m0, 59136
    s_nop 0
    buffer_load_dwordx4 v0, s[12:15], s78 offen offset:0 nt lds
    v_mfma_f32_16x16x32_bf16 a[160:163], a[240:243], v[24:27], a[160:163]
    s_mov_b32 m0, 59168
    s_nop 0
    buffer_load_dwordx4 v0, s[12:15], s78 offen offset:1024 nt lds
    v_mfma_f32_16x16x32_bf16 a[168:171], a[240:243], v[28:31], a[168:171]
    s_mov_b32 m0, 59200
    s_nop 0
    buffer_load_dwordx4 v0, s[12:15], s78 offen offset:2048 nt lds
    v_mfma_f32_16x16x32_bf16 a[176:179], a[240:243], v[32:35], a[176:179]
    s_mov_b32 m0, 59232
    s_nop 0
    buffer_load_dwordx4 v0, s[12:15], s78 offen offset:3072 nt lds
    s_mov_b32 m0, 63360
    s_nop 0
    buffer_load_dwordx4 v0, s[12:15], s79 offen offset:0 nt lds
    v_mfma_f32_16x16x32_bf16 a[184:187], a[240:243], v[36:39], a[184:187]
    s_mov_b32 m0, 63392
    s_nop 0
    buffer_load_dwordx4 v0, s[12:15], s79 offen offset:1024 nt lds
    s_waitcnt lgkmcnt(0)
    v_mfma_f32_16x16x32_bf16 a[148:151], a[244:247], v[16:19], a[148:151]
    s_waitcnt vmcnt(61)
    s_mov_b32 m0, 63424
    s_nop 0
    buffer_load_dwordx4 v0, s[12:15], s79 offen offset:2048 nt lds
    v_mfma_f32_16x16x32_bf16 a[156:159], a[244:247], v[20:23], a[156:159]
    s_waitcnt vmcnt(61)
    s_mov_b32 m0, 63456
    s_nop 0
    buffer_load_dwordx4 v0, s[12:15], s79 offen offset:3072 nt lds
    s_mov_b32 s78, s81
    s_mov_b32 s79, s82
    s_add_u32 s81, s81, 8192
    s_add_u32 s82, s82, 8192
    v_mfma_f32_16x16x32_bf16 a[164:167], a[244:247], v[24:27], a[164:167]
    s_waitcnt vmcnt(40)
    s_barrier
    ds_read_b64_tr_b16 a[248:249], v3 offset:33792
    ds_read_b64_tr_b16 a[250:251], v3 offset:34304
    ds_read_b64_tr_b16 a[240:241], v3 offset:33824
    ds_read_b64_tr_b16 a[242:243], v3 offset:34336
    s_mov_b32 m0, 84480
    s_add_u32 s75, s83, 512
    buffer_load_dwordx4 v8, s[24:27], s75 offen offset:0 lds
    s_mov_b32 m0, 84256
    s_nop 0
    buffer_load_dwordx4 v8, s[24:27], s75 offen offset:1280 lds
    s_mov_b32 m0, 84032
    s_nop 0
    buffer_load_dwordx4 v8, s[24:27], s75 offen offset:2560 lds
    s_mov_b32 m0, 83808
    s_nop 0
    buffer_load_dwordx4 v8, s[24:27], s75 offen offset:3840 lds
    s_mov_b32 m0, 88704
    s_add_u32 s75, s83, 5632
    buffer_load_dwordx4 v8, s[24:27], s75 offen offset:0 lds
    s_mov_b32 m0, 88480
    s_nop 0
    buffer_load_dwordx4 v8, s[24:27], s75 offen offset:1280 lds
    v_mfma_f32_16x16x32_bf16 a[172:175], a[244:247], v[28:31], a[172:175]
    s_mov_b32 m0, 88256
    s_nop 0
    buffer_load_dwordx4 v8, s[24:27], s75 offen offset:2560 lds
    v_mfma_f32_16x16x32_bf16 a[180:183], a[244:247], v[32:35], a[180:183]
    s_mov_b32 m0, 88032
    s_nop 0
    buffer_load_dwordx4 v8, s[24:27], s75 offen offset:3840 lds
    v_mfma_f32_16x16x32_bf16 a[188:191], a[244:247], v[36:39], a[188:191]
    s_mov_b32 m0, 92928
    s_add_u32 s75, s83, 768
    buffer_load_dwordx4 v8, s[24:27], s75 offen offset:0 lds
    s_waitcnt lgkmcnt(2)
    v_mfma_f32_16x16x32_bf16 a[192:195], a[248:251], v[16:19], a[192:195]
    s_mov_b32 m0, 92704
    s_nop 0
    buffer_load_dwordx4 v8, s[24:27], s75 offen offset:1280 lds
    v_mfma_f32_16x16x32_bf16 a[200:203], a[248:251], v[20:23], a[200:203]
    s_mov_b32 m0, 92480
    s_nop 0
    buffer_load_dwordx4 v8, s[24:27], s75 offen offset:2560 lds
    v_mfma_f32_16x16x32_bf16 a[208:211], a[248:251], v[24:27], a[208:211]
    s_mov_b32 m0, 92256
    s_nop 0
    buffer_load_dwordx4 v8, s[24:27], s75 offen offset:3840 lds
    v_mfma_f32_16x16x32_bf16 a[216:219], a[248:251], v[28:31], a[216:219]
    s_mov_b32 m0, 8448
    s_nop 0
    buffer_load_dwordx4 v0, s[12:15], s78 offen offset:0 nt lds
    v_mfma_f32_16x16x32_bf16 a[224:227], a[248:251], v[32:35], a[224:227]
    s_mov_b32 m0, 8480
    s_nop 0
    buffer_load_dwordx4 v0, s[12:15], s78 offen offset:1024 nt lds
    v_mfma_f32_16x16x32_bf16 a[232:235], a[248:251], v[36:39], a[232:235]
    s_mov_b32 m0, 8512
    s_nop 0
    buffer_load_dwordx4 v0, s[12:15], s78 offen offset:2048 nt lds
    s_waitcnt lgkmcnt(0)
    v_mfma_f32_16x16x32_bf16 a[196:199], a[240:243], v[16:19], a[196:199]
    s_mov_b32 m0, 8544
    s_nop 0
    buffer_load_dwordx4 v0, s[12:15], s78 offen offset:3072 nt lds
    v_mfma_f32_16x16x32_bf16 a[204:207], a[240:243], v[20:23], a[204:207]
    s_mov_b32 m0, 12672
    s_nop 0
    buffer_load_dwordx4 v0, s[12:15], s79 offen offset:0 nt lds
    v_mfma_f32_16x16x32_bf16 a[212:215], a[240:243], v[24:27], a[212:215]
    s_mov_b32 m0, 12704
    s_nop 0
    buffer_load_dwordx4 v0, s[12:15], s79 offen offset:1024 nt lds
    v_mfma_f32_16x16x32_bf16 a[220:223], a[240:243], v[28:31], a[220:223]
    s_mov_b32 m0, 12736
    s_nop 0
    buffer_load_dwordx4 v0, s[12:15], s79 offen offset:2048 nt lds
    v_mfma_f32_16x16x32_bf16 a[228:231], a[240:243], v[32:35], a[228:231]
    s_mov_b32 m0, 12768
    s_nop 0
    buffer_load_dwordx4 v0, s[12:15], s79 offen offset:3072 nt lds
    s_mov_b32 s78, s81
    s_mov_b32 s79, s82
    s_add_u32 s81, s81, 8192
    s_add_u32 s82, s82, 8192
    v_mfma_f32_16x16x32_bf16 a[236:239], a[240:243], v[36:39], a[236:239]
    s_waitcnt vmcnt(36)
    s_barrier
    ds_read_b128 v[16:19], v4 offset:3072
    ds_read_b64_tr_b16 a[240:241], v3 offset:0
    ds_read_b64_tr_b16 a[242:243], v3 offset:512
    ds_read_b128 v[20:23], v4 offset:7168
    ds_read_b128 v[24:27], v4 offset:11264
    ds_read_b128 v[28:31], v4 offset:15360
    ds_read_b128 v[32:35], v4 offset:19456
    ds_read_b128 v[36:39], v4 offset:23552
    ds_read_b64_tr_b16 a[244:245], v3 offset:32
    ds_read_b64_tr_b16 a[246:247], v3 offset:544
    ds_read_b64_tr_b16 a[248:249], v3 offset:8448
    ds_read_b64_tr_b16 a[250:251], v3 offset:8960
    s_mov_b32 m0, 97152
    s_add_u32 s75, s83, 5888
    buffer_load_dwordx4 v8, s[24:27], s75 offen offset:0 lds
    s_mov_b32 m0, 96928
    s_nop 0
    buffer_load_dwordx4 v8, s[24:27], s75 offen offset:1280 lds
    s_mov_b32 m0, 96704
    s_nop 0
    buffer_load_dwordx4 v8, s[24:27], s75 offen offset:2560 lds
    s_mov_b32 m0, 96480
    s_nop 0
    buffer_load_dwordx4 v8, s[24:27], s75 offen offset:3840 lds
    s_mov_b32 m0, 101376
    s_add_u32 s75, s83, 1024
    buffer_load_dwordx4 v8, s[24:27], s75 offen offset:0 lds
    s_mov_b32 m0, 101152
    s_nop 0
    buffer_load_dwordx4 v8, s[24:27], s75 offen offset:1280 lds
    s_mov_b32 m0, 100928
    s_nop 0
    buffer_load_dwordx4 v8, s[24:27], s75 offen offset:2560 lds
    s_mov_b32 m0, 100704
    s_nop 0
    buffer_load_dwordx4 v8, s[24:27], s75 offen offset:3840 lds
    s_mov_b32 m0, 105600
    s_add_u32 s75, s83, 6144
    buffer_load_dwordx4 v8, s[24:27], s75 offen offset:0 lds
    s_mov_b32 m0, 105376
    s_nop 0
    buffer_load_dwordx4 v8, s[24:27], s75 offen offset:1280 lds
    s_mov_b32 m0, 105152
    s_nop 0
    buffer_load_dwordx4 v8, s[24:27], s75 offen offset:2560 lds
    s_mov_b32 m0, 104928
    s_nop 0
    buffer_load_dwordx4 v8, s[24:27], s75 offen offset:3840 lds
    s_add_u32 s83, s83, 40960
    s_mov_b32 m0, 109824
    s_mov_b32 s75, 491520
    buffer_load_dwordx4 v8, s[24:27], s75 offen lds
    s_mov_b32 m0, 110880
    s_mov_b32 s75, 492800
    buffer_load_dwordx4 v8, s[24:27], s75 offen lds
    s_mov_b32 m0, 111936
    s_mov_b32 s75, 494080
    buffer_load_dwordx4 v8, s[24:27], s75 offen lds
    s_mov_b32 m0, 112992
    s_mov_b32 s75, 495360
    buffer_load_dwordx4 v8, s[24:27], s75 offen lds
    s_waitcnt lgkmcnt(9)
    v_mfma_f32_16x16x32_bf16 a[0:3], a[240:243], v[16:19], a[0:3]
    s_mov_b32 m0, 114048
    s_mov_b32 s75, 496640
    buffer_load_dwordx4 v8, s[24:27], s75 offen lds
    s_mov_b32 m0, 115104
    s_mov_b32 s75, 497920
    buffer_load_dwordx4 v8, s[24:27], s75 offen lds
    s_mov_b32 m0, 116160
    s_mov_b32 s75, 499200
    buffer_load_dwordx4 v8, s[24:27], s75 offen lds
    s_waitcnt lgkmcnt(8)
    v_mfma_f32_16x16x32_bf16 a[8:11], a[240:243], v[20:23], a[8:11]
    s_mov_b32 m0, 117216
    s_mov_b32 s75, 500480
    buffer_load_dwordx4 v8, s[24:27], s75 offen lds
    s_mov_b32 m0, 118272
    s_mov_b32 s75, 532480
    buffer_load_dwordx4 v8, s[24:27], s75 offen lds
    s_mov_b32 m0, 119328
    s_mov_b32 s75, 533760
    buffer_load_dwordx4 v8, s[24:27], s75 offen lds
    s_mov_b32 m0, 120384
    s_mov_b32 s75, 535040
    buffer_load_dwordx4 v8, s[24:27], s75 offen lds
    s_waitcnt lgkmcnt(7)
    v_mfma_f32_16x16x32_bf16 a[16:19], a[240:243], v[24:27], a[16:19]
    s_mov_b32 m0, 121440
    s_mov_b32 s75, 536320
    buffer_load_dwordx4 v8, s[24:27], s75 offen lds
    s_mov_b32 m0, 122496
    s_mov_b32 s75, 537600
    buffer_load_dwordx4 v8, s[24:27], s75 offen lds
    s_mov_b32 m0, 123552
    s_mov_b32 s75, 538880
    buffer_load_dwordx4 v8, s[24:27], s75 offen lds
    s_waitcnt lgkmcnt(6)
    v_mfma_f32_16x16x32_bf16 a[24:27], a[240:243], v[28:31], a[24:27]
    s_waitcnt vmcnt(61)
    s_mov_b32 m0, 124608
    s_mov_b32 s75, 540160
    buffer_load_dwordx4 v8, s[24:27], s75 offen lds
    s_waitcnt vmcnt(61)
    s_mov_b32 m0, 125664
    s_mov_b32 s75, 541440
    buffer_load_dwordx4 v8, s[24:27], s75 offen lds
    s_waitcnt vmcnt(61)
    s_mov_b32 m0, 126720
    s_mov_b32 s75, 573440
    buffer_load_dwordx4 v8, s[24:27], s75 offen lds
    s_waitcnt lgkmcnt(5)
    v_mfma_f32_16x16x32_bf16 a[32:35], a[240:243], v[32:35], a[32:35]
    s_waitcnt vmcnt(61)
    s_mov_b32 m0, 127776
    s_mov_b32 s75, 574720
    buffer_load_dwordx4 v8, s[24:27], s75 offen lds
    s_waitcnt vmcnt(61)
    s_mov_b32 m0, 128832
    s_mov_b32 s75, 576000
    buffer_load_dwordx4 v8, s[24:27], s75 offen lds
    s_waitcnt vmcnt(61)
    s_mov_b32 m0, 129888
    s_mov_b32 s75, 577280
    buffer_load_dwordx4 v8, s[24:27], s75 offen lds
    s_waitcnt lgkmcnt(4)
    v_mfma_f32_16x16x32_bf16 a[40:43], a[240:243], v[36:39], a[40:43]
    s_waitcnt vmcnt(61)
    s_mov_b32 m0, 130944
    s_mov_b32 s75, 578560
    buffer_load_dwordx4 v8, s[24:27], s75 offen lds
    s_waitcnt vmcnt(61)
    s_mov_b32 m0, 132000
    s_mov_b32 s75, 579840
    buffer_load_dwordx4 v8, s[24:27], s75 offen lds
    s_waitcnt vmcnt(61)
    s_mov_b32 m0, 133056
    s_mov_b32 s75, 581120
    buffer_load_dwordx4 v8, s[24:27], s75 offen lds
    s_waitcnt lgkmcnt(2)
    v_mfma_f32_16x16x32_bf16 a[4:7], a[244:247], v[16:19], a[4:7]
    s_waitcnt vmcnt(61)
    s_mov_b32 m0, 134112
    s_mov_b32 s75, 582400
    buffer_load_dwordx4 v8, s[24:27], s75 offen lds
    s_waitcnt vmcnt(61)
    s_mov_b32 m0, 0
    s_mov_b32 s75, 614400
    buffer_load_dwordx4 v8, s[24:27], s75 offen lds
    s_waitcnt vmcnt(61)
    s_mov_b32 m0, 1056
    s_mov_b32 s75, 615680
    buffer_load_dwordx4 v8, s[24:27], s75 offen lds
    v_mfma_f32_16x16x32_bf16 a[12:15], a[244:247], v[20:23], a[12:15]
    s_waitcnt vmcnt(61)
    s_mov_b32 m0, 2112
    s_mov_b32 s75, 616960
    buffer_load_dwordx4 v8, s[24:27], s75 offen lds
    s_waitcnt vmcnt(61)
    s_mov_b32 m0, 3168
    s_mov_b32 s75, 618240
    buffer_load_dwordx4 v8, s[24:27], s75 offen lds
    s_waitcnt vmcnt(61)
    s_mov_b32 m0, 4224
    s_mov_b32 s75, 619520
    buffer_load_dwordx4 v8, s[24:27], s75 offen lds
    s_waitcnt vmcnt(61)
    s_mov_b32 m0, 5280
    s_mov_b32 s75, 620800
    buffer_load_dwordx4 v8, s[24:27], s75 offen lds
    v_mfma_f32_16x16x32_bf16 a[20:23], a[244:247], v[24:27], a[20:23]
    s_waitcnt vmcnt(61)
    s_mov_b32 m0, 6336
    s_mov_b32 s75, 622080
    buffer_load_dwordx4 v8, s[24:27], s75 offen lds
    s_waitcnt vmcnt(61)
    s_mov_b32 m0, 7392
    s_mov_b32 s75, 623360
    buffer_load_dwordx4 v8, s[24:27], s75 offen lds
    s_waitcnt vmcnt(61)
    s_mov_b32 m0, 16896
    s_mov_b32 s75, 491776
    buffer_load_dwordx4 v8, s[24:27], s75 offen lds
    v_mfma_f32_16x16x32_bf16 a[28:31], a[244:247], v[28:31], a[28:31]
    s_waitcnt vmcnt(61)
    s_mov_b32 m0, 17952
    s_mov_b32 s75, 493056
    buffer_load_dwordx4 v8, s[24:27], s75 offen lds
    s_waitcnt vmcnt(61)
    s_mov_b32 m0, 19008
    s_mov_b32 s75, 494336
    buffer_load_dwordx4 v8, s[24:27], s75 offen lds
    s_waitcnt vmcnt(61)
    s_mov_b32 m0, 20064
    s_mov_b32 s75, 495616
    buffer_load_dwordx4 v8, s[24:27], s75 offen lds
    v_mfma_f32_16x16x32_bf16 a[36:39], a[244:247], v[32:35], a[36:39]
    s_waitcnt vmcnt(61)
    s_mov_b32 m0, 21120
    s_mov_b32 s75, 496896
    buffer_load_dwordx4 v8, s[24:27], s75 offen lds
    s_waitcnt vmcnt(61)
    s_mov_b32 m0, 22176
    s_mov_b32 s75, 498176
    buffer_load_dwordx4 v8, s[24:27], s75 offen lds
    s_waitcnt vmcnt(61)
    s_mov_b32 m0, 23232
    s_mov_b32 s75, 499456
    buffer_load_dwordx4 v8, s[24:27], s75 offen lds
    v_mfma_f32_16x16x32_bf16 a[44:47], a[244:247], v[36:39], a[44:47]
    s_waitcnt vmcnt(61)
    s_mov_b32 m0, 24288
    s_mov_b32 s75, 500736
    buffer_load_dwordx4 v8, s[24:27], s75 offen lds
    s_waitcnt vmcnt(61)
    s_mov_b32 m0, 25344
    s_mov_b32 s75, 532736
    buffer_load_dwordx4 v8, s[24:27], s75 offen lds
    s_waitcnt vmcnt(61)
    s_mov_b32 m0, 26400
    s_mov_b32 s75, 534016
    buffer_load_dwordx4 v8, s[24:27], s75 offen lds
    s_waitcnt lgkmcnt(0)
    v_mfma_f32_16x16x32_bf16 a[48:51], a[248:251], v[16:19], a[48:51]
    s_waitcnt vmcnt(61)
    s_mov_b32 m0, 27456
    s_mov_b32 s75, 535296
    buffer_load_dwordx4 v8, s[24:27], s75 offen lds
    s_waitcnt vmcnt(61)
    s_mov_b32 m0, 28512
    s_mov_b32 s75, 536576
    buffer_load_dwordx4 v8, s[24:27], s75 offen lds
    s_waitcnt vmcnt(61)
    s_mov_b32 m0, 29568
    s_mov_b32 s75, 537856
    buffer_load_dwordx4 v8, s[24:27], s75 offen lds
    v_mfma_f32_16x16x32_bf16 a[56:59], a[248:251], v[20:23], a[56:59]
    s_waitcnt vmcnt(61)
    s_mov_b32 m0, 30624
    s_mov_b32 s75, 539136
    buffer_load_dwordx4 v8, s[24:27], s75 offen lds
    s_waitcnt vmcnt(61)
    s_mov_b32 m0, 31680
    s_mov_b32 s75, 540416
    buffer_load_dwordx4 v8, s[24:27], s75 offen lds
    s_waitcnt vmcnt(61)
    s_mov_b32 m0, 32736
    s_mov_b32 s75, 541696
    buffer_load_dwordx4 v8, s[24:27], s75 offen lds
    v_mfma_f32_16x16x32_bf16 a[64:67], a[248:251], v[24:27], a[64:67]
    s_barrier
    ds_read_b64_tr_b16 a[240:241], v3 offset:8480
    ds_read_b64_tr_b16 a[242:243], v3 offset:8992
    ds_read_b64_tr_b16 a[244:245], v3 offset:16896
    ds_read_b64_tr_b16 a[246:247], v3 offset:17408
    s_waitcnt vmcnt(61)
    s_mov_b32 m0, 33792
    s_mov_b32 s75, 573696
    buffer_load_dwordx4 v8, s[24:27], s75 offen lds
    s_waitcnt vmcnt(61)
    s_mov_b32 m0, 34848
    s_mov_b32 s75, 574976
    buffer_load_dwordx4 v8, s[24:27], s75 offen lds
    s_waitcnt vmcnt(61)
    s_mov_b32 m0, 35904
    s_mov_b32 s75, 576256
    buffer_load_dwordx4 v8, s[24:27], s75 offen lds
    s_waitcnt vmcnt(61)
    s_mov_b32 m0, 36960
    s_mov_b32 s75, 577536
    buffer_load_dwordx4 v8, s[24:27], s75 offen lds
    s_waitcnt vmcnt(61)
    s_mov_b32 m0, 38016
    s_mov_b32 s75, 578816
    buffer_load_dwordx4 v8, s[24:27], s75 offen lds
    s_waitcnt vmcnt(61)
    s_mov_b32 m0, 39072
    s_mov_b32 s75, 580096
    buffer_load_dwordx4 v8, s[24:27], s75 offen lds
    s_waitcnt vmcnt(61)
    s_mov_b32 m0, 40128
    s_mov_b32 s75, 581376
    buffer_load_dwordx4 v8, s[24:27], s75 offen lds
    v_mfma_f32_16x16x32_bf16 a[72:75], a[248:251], v[28:31], a[72:75]
    s_waitcnt vmcnt(61)
    s_mov_b32 m0, 41184
    s_mov_b32 s75, 582656
    buffer_load_dwordx4 v8, s[24:27], s75 offen lds
    v_mfma_f32_16x16x32_bf16 a[80:83], a[248:251], v[32:35], a[80:83]
    s_waitcnt vmcnt(61)
    s_mov_b32 m0, 42240
    s_mov_b32 s75, 614656
    buffer_load_dwordx4 v8, s[24:27], s75 offen lds
    v_mfma_f32_16x16x32_bf16 a[88:91], a[248:251], v[36:39], a[88:91]
    s_waitcnt vmcnt(61)
    s_mov_b32 m0, 43296
    s_mov_b32 s75, 615936
    buffer_load_dwordx4 v8, s[24:27], s75 offen lds
    s_waitcnt vmcnt(61)
    s_mov_b32 m0, 44352
    s_mov_b32 s75, 617216
    buffer_load_dwordx4 v8, s[24:27], s75 offen lds
    s_waitcnt lgkmcnt(2)
    v_mfma_f32_16x16x32_bf16 a[52:55], a[240:243], v[16:19], a[52:55]
    s_waitcnt vmcnt(61)
    s_mov_b32 m0, 45408
    s_mov_b32 s75, 618496
    buffer_load_dwordx4 v8, s[24:27], s75 offen lds
    v_mfma_f32_16x16x32_bf16 a[60:63], a[240:243], v[20:23], a[60:63]
    s_waitcnt vmcnt(61)
    s_mov_b32 m0, 46464
    s_mov_b32 s75, 619776
    buffer_load_dwordx4 v8, s[24:27], s75 offen lds
    v_mfma_f32_16x16x32_bf16 a[68:71], a[240:243], v[24:27], a[68:71]
    s_waitcnt vmcnt(61)
    s_mov_b32 m0, 47520
    s_mov_b32 s75, 621056
    buffer_load_dwordx4 v8, s[24:27], s75 offen lds
    v_mfma_f32_16x16x32_bf16 a[76:79], a[240:243], v[28:31], a[76:79]
    s_waitcnt vmcnt(61)
    s_mov_b32 m0, 48576
    s_mov_b32 s75, 622336
    buffer_load_dwordx4 v8, s[24:27], s75 offen lds
    s_waitcnt vmcnt(61)
    s_mov_b32 m0, 49632
    s_mov_b32 s75, 623616
    buffer_load_dwordx4 v8, s[24:27], s75 offen lds
    v_mfma_f32_16x16x32_bf16 a[84:87], a[240:243], v[32:35], a[84:87]
    s_waitcnt vmcnt(61)
    s_mov_b32 m0, 67584
    s_mov_b32 s75, 492032
    buffer_load_dwordx4 v8, s[24:27], s75 offen lds
    v_mfma_f32_16x16x32_bf16 a[92:95], a[240:243], v[36:39], a[92:95]
    s_waitcnt vmcnt(61)
    s_mov_b32 m0, 68640
    s_mov_b32 s75, 493312
    buffer_load_dwordx4 v8, s[24:27], s75 offen lds
    s_waitcnt lgkmcnt(0)
    v_mfma_f32_16x16x32_bf16 a[96:99], a[244:247], v[16:19], a[96:99]
    s_waitcnt vmcnt(61)
    s_mov_b32 m0, 69696
    s_mov_b32 s75, 494592
    buffer_load_dwordx4 v8, s[24:27], s75 offen lds
    v_mfma_f32_16x16x32_bf16 a[104:107], a[244:247], v[20:23], a[104:107]
    s_waitcnt vmcnt(61)
    s_mov_b32 m0, 70752
    s_mov_b32 s75, 495872
    buffer_load_dwordx4 v8, s[24:27], s75 offen lds
    s_waitcnt vmcnt(61)
    s_mov_b32 m0, 71808
    s_mov_b32 s75, 497152
    buffer_load_dwordx4 v8, s[24:27], s75 offen lds
    v_mfma_f32_16x16x32_bf16 a[112:115], a[244:247], v[24:27], a[112:115]
    s_waitcnt vmcnt(61)
    s_mov_b32 m0, 72864
    s_mov_b32 s75, 498432
    buffer_load_dwordx4 v8, s[24:27], s75 offen lds
    v_mfma_f32_16x16x32_bf16 a[120:123], a[244:247], v[28:31], a[120:123]
    s_waitcnt vmcnt(61)
    s_mov_b32 m0, 73920
    s_mov_b32 s75, 499712
    buffer_load_dwordx4 v8, s[24:27], s75 offen lds
    v_mfma_f32_16x16x32_bf16 a[128:131], a[244:247], v[32:35], a[128:131]
    s_waitcnt vmcnt(61)
    s_mov_b32 m0, 74976
    s_mov_b32 s75, 500992
    buffer_load_dwordx4 v8, s[24:27], s75 offen lds
    v_mfma_f32_16x16x32_bf16 a[136:139], a[244:247], v[36:39], a[136:139]
    s_barrier
    ds_read_b64_tr_b16 a[248:249], v3 offset:16928
    ds_read_b64_tr_b16 a[250:251], v3 offset:17440
    ds_read_b64_tr_b16 a[240:241], v3 offset:25344
    ds_read_b64_tr_b16 a[242:243], v3 offset:25856
    ds_read_b64_tr_b16 a[244:245], v3 offset:25376
    ds_read_b64_tr_b16 a[246:247], v3 offset:25888
    s_waitcnt vmcnt(61)
    s_mov_b32 m0, 50688
    s_mov_b32 s75, 532992
    buffer_load_dwordx4 v8, s[24:27], s75 offen lds
    s_waitcnt vmcnt(61)
    s_mov_b32 m0, 51744
    s_mov_b32 s75, 534272
    buffer_load_dwordx4 v8, s[24:27], s75 offen lds
    s_waitcnt vmcnt(61)
    s_mov_b32 m0, 52800
    s_mov_b32 s75, 535552
    buffer_load_dwordx4 v8, s[24:27], s75 offen lds
    s_waitcnt vmcnt(61)
    s_mov_b32 m0, 53856
    s_mov_b32 s75, 536832
    buffer_load_dwordx4 v8, s[24:27], s75 offen lds
    s_waitcnt vmcnt(61)
    s_mov_b32 m0, 54912
    s_mov_b32 s75, 538112
    buffer_load_dwordx4 v8, s[24:27], s75 offen lds
    s_waitcnt vmcnt(61)
    s_mov_b32 m0, 55968
    s_mov_b32 s75, 539392
    buffer_load_dwordx4 v8, s[24:27], s75 offen lds
    s_waitcnt vmcnt(61)
    s_mov_b32 m0, 57024
    s_mov_b32 s75, 540672
    buffer_load_dwordx4 v8, s[24:27], s75 offen lds
    s_waitcnt lgkmcnt(4)
    v_mfma_f32_16x16x32_bf16 a[100:103], a[248:251], v[16:19], a[100:103]
    s_waitcnt vmcnt(61)
    s_mov_b32 m0, 58080
    s_mov_b32 s75, 541952
    buffer_load_dwordx4 v8, s[24:27], s75 offen lds
    v_mfma_f32_16x16x32_bf16 a[108:111], a[248:251], v[20:23], a[108:111]
    s_waitcnt vmcnt(61)
    s_mov_b32 m0, 59136
    s_mov_b32 s75, 573952
    buffer_load_dwordx4 v8, s[24:27], s75 offen lds
    v_mfma_f32_16x16x32_bf16 a[116:119], a[248:251], v[24:27], a[116:119]
    s_waitcnt vmcnt(61)
    s_mov_b32 m0, 60192
    s_mov_b32 s75, 575232
    buffer_load_dwordx4 v8, s[24:27], s75 offen lds
    s_waitcnt vmcnt(61)
    s_mov_b32 m0, 61248
    s_mov_b32 s75, 576512
    buffer_load_dwordx4 v8, s[24:27], s75 offen lds
    v_mfma_f32_16x16x32_bf16 a[124:127], a[248:251], v[28:31], a[124:127]
    s_waitcnt vmcnt(61)
    s_mov_b32 m0, 62304
    s_mov_b32 s75, 577792
    buffer_load_dwordx4 v8, s[24:27], s75 offen lds
    v_mfma_f32_16x16x32_bf16 a[132:135], a[248:251], v[32:35], a[132:135]
    s_waitcnt vmcnt(61)
    s_mov_b32 m0, 63360
    s_mov_b32 s75, 579072
    buffer_load_dwordx4 v8, s[24:27], s75 offen lds
    v_mfma_f32_16x16x32_bf16 a[140:143], a[248:251], v[36:39], a[140:143]
    s_waitcnt vmcnt(61)
    s_mov_b32 m0, 64416
    s_mov_b32 s75, 580352
    buffer_load_dwordx4 v8, s[24:27], s75 offen lds
    s_waitcnt lgkmcnt(2)
    v_mfma_f32_16x16x32_bf16 a[144:147], a[240:243], v[16:19], a[144:147]
    s_waitcnt vmcnt(61)
    s_mov_b32 m0, 65472
    s_mov_b32 s75, 581632
    buffer_load_dwordx4 v8, s[24:27], s75 offen lds
    s_waitcnt vmcnt(61)
    s_mov_b32 m0, 66528
    s_mov_b32 s75, 582912
    buffer_load_dwordx4 v8, s[24:27], s75 offen lds
    v_mfma_f32_16x16x32_bf16 a[152:155], a[240:243], v[20:23], a[152:155]
    s_waitcnt vmcnt(61)
    s_mov_b32 m0, 76032
    s_mov_b32 s75, 614912
    buffer_load_dwordx4 v8, s[24:27], s75 offen lds
    v_mfma_f32_16x16x32_bf16 a[160:163], a[240:243], v[24:27], a[160:163]
    s_waitcnt vmcnt(61)
    s_mov_b32 m0, 77088
    s_mov_b32 s75, 616192
    buffer_load_dwordx4 v8, s[24:27], s75 offen lds
    v_mfma_f32_16x16x32_bf16 a[168:171], a[240:243], v[28:31], a[168:171]
    s_waitcnt vmcnt(61)
    s_mov_b32 m0, 78144
    s_mov_b32 s75, 617472
    buffer_load_dwordx4 v8, s[24:27], s75 offen lds
    v_mfma_f32_16x16x32_bf16 a[176:179], a[240:243], v[32:35], a[176:179]
    s_waitcnt vmcnt(61)
    s_mov_b32 m0, 79200
    s_mov_b32 s75, 618752
    buffer_load_dwordx4 v8, s[24:27], s75 offen lds
    s_waitcnt vmcnt(61)
    s_mov_b32 m0, 80256
    s_mov_b32 s75, 620032
    buffer_load_dwordx4 v8, s[24:27], s75 offen lds
    v_mfma_f32_16x16x32_bf16 a[184:187], a[240:243], v[36:39], a[184:187]
    s_waitcnt vmcnt(61)
    s_mov_b32 m0, 81312
    s_mov_b32 s75, 621312
    buffer_load_dwordx4 v8, s[24:27], s75 offen lds
    s_waitcnt lgkmcnt(0)
    v_mfma_f32_16x16x32_bf16 a[148:151], a[244:247], v[16:19], a[148:151]
    s_waitcnt vmcnt(61)
    s_mov_b32 m0, 82368
    s_mov_b32 s75, 622592
    buffer_load_dwordx4 v8, s[24:27], s75 offen lds
    v_mfma_f32_16x16x32_bf16 a[156:159], a[244:247], v[20:23], a[156:159]
    s_waitcnt vmcnt(61)
    s_mov_b32 m0, 83424
    s_mov_b32 s75, 623872
    buffer_load_dwordx4 v8, s[24:27], s75 offen lds
    v_mfma_f32_16x16x32_bf16 a[164:167], a[244:247], v[24:27], a[164:167]
    s_barrier
    ds_read_b64_tr_b16 a[248:249], v3 offset:33792
    ds_read_b64_tr_b16 a[250:251], v3 offset:34304
    ds_read_b64_tr_b16 a[240:241], v3 offset:33824
    ds_read_b64_tr_b16 a[242:243], v3 offset:34336
    s_waitcnt vmcnt(61)
    s_mov_b32 m0, 8448
    s_mov_b32 s75, 492288
    buffer_load_dwordx4 v8, s[24:27], s75 offen lds
    s_waitcnt vmcnt(61)
    s_mov_b32 m0, 9504
    s_mov_b32 s75, 493568
    buffer_load_dwordx4 v8, s[24:27], s75 offen lds
    s_waitcnt vmcnt(61)
    s_mov_b32 m0, 10560
    s_mov_b32 s75, 494848
    buffer_load_dwordx4 v8, s[24:27], s75 offen lds
    s_waitcnt vmcnt(61)
    s_mov_b32 m0, 11616
    s_mov_b32 s75, 496128
    buffer_load_dwordx4 v8, s[24:27], s75 offen lds
    s_waitcnt vmcnt(61)
    s_mov_b32 m0, 12672
    s_mov_b32 s75, 497408
    buffer_load_dwordx4 v8, s[24:27], s75 offen lds
    s_waitcnt vmcnt(61)
    s_mov_b32 m0, 13728
    s_mov_b32 s75, 498688
    buffer_load_dwordx4 v8, s[24:27], s75 offen lds
    s_waitcnt vmcnt(61)
    s_mov_b32 m0, 14784
    s_mov_b32 s75, 499968
    buffer_load_dwordx4 v8, s[24:27], s75 offen lds
    v_mfma_f32_16x16x32_bf16 a[172:175], a[244:247], v[28:31], a[172:175]
    s_waitcnt vmcnt(61)
    s_mov_b32 m0, 15840
    s_mov_b32 s75, 501248
    buffer_load_dwordx4 v8, s[24:27], s75 offen lds
    v_mfma_f32_16x16x32_bf16 a[180:183], a[244:247], v[32:35], a[180:183]
    s_waitcnt vmcnt(61)
    s_mov_b32 m0, 84480
    s_mov_b32 s75, 533248
    buffer_load_dwordx4 v8, s[24:27], s75 offen lds
    v_mfma_f32_16x16x32_bf16 a[188:191], a[244:247], v[36:39], a[188:191]
    s_waitcnt vmcnt(61)
    s_mov_b32 m0, 85536
    s_mov_b32 s75, 534528
    buffer_load_dwordx4 v8, s[24:27], s75 offen lds
    s_waitcnt vmcnt(61)
    s_mov_b32 m0, 86592
    s_mov_b32 s75, 535808
    buffer_load_dwordx4 v8, s[24:27], s75 offen lds
    s_waitcnt lgkmcnt(2)
    v_mfma_f32_16x16x32_bf16 a[192:195], a[248:251], v[16:19], a[192:195]
    s_waitcnt vmcnt(61)
    s_mov_b32 m0, 87648
    s_mov_b32 s75, 537088
    buffer_load_dwordx4 v8, s[24:27], s75 offen lds
    v_mfma_f32_16x16x32_bf16 a[200:203], a[248:251], v[20:23], a[200:203]
    s_waitcnt vmcnt(61)
    s_mov_b32 m0, 88704
    s_mov_b32 s75, 538368
    buffer_load_dwordx4 v8, s[24:27], s75 offen lds
    v_mfma_f32_16x16x32_bf16 a[208:211], a[248:251], v[24:27], a[208:211]
    s_waitcnt vmcnt(61)
    s_mov_b32 m0, 89760
    s_mov_b32 s75, 539648
    buffer_load_dwordx4 v8, s[24:27], s75 offen lds
    v_mfma_f32_16x16x32_bf16 a[216:219], a[248:251], v[28:31], a[216:219]
    s_waitcnt vmcnt(61)
    s_mov_b32 m0, 90816
    s_mov_b32 s75, 540928
    buffer_load_dwordx4 v8, s[24:27], s75 offen lds
    s_waitcnt vmcnt(61)
    s_mov_b32 m0, 91872
    s_mov_b32 s75, 542208
    buffer_load_dwordx4 v8, s[24:27], s75 offen lds
    v_mfma_f32_16x16x32_bf16 a[224:227], a[248:251], v[32:35], a[224:227]
    s_waitcnt vmcnt(61)
    s_mov_b32 m0, 92928
    s_mov_b32 s75, 574208
    buffer_load_dwordx4 v8, s[24:27], s75 offen lds
    v_mfma_f32_16x16x32_bf16 a[232:235], a[248:251], v[36:39], a[232:235]
    s_waitcnt vmcnt(61)
    s_mov_b32 m0, 93984
    s_mov_b32 s75, 575488
    buffer_load_dwordx4 v8, s[24:27], s75 offen lds
    s_waitcnt lgkmcnt(0)
    v_mfma_f32_16x16x32_bf16 a[196:199], a[240:243], v[16:19], a[196:199]
    s_waitcnt vmcnt(61)
    s_mov_b32 m0, 95040
    s_mov_b32 s75, 576768
    buffer_load_dwordx4 v8, s[24:27], s75 offen lds
    v_mfma_f32_16x16x32_bf16 a[204:207], a[240:243], v[20:23], a[204:207]
    s_waitcnt vmcnt(61)
    s_mov_b32 m0, 96096
    s_mov_b32 s75, 578048
    buffer_load_dwordx4 v8, s[24:27], s75 offen lds
    s_waitcnt vmcnt(61)
    s_mov_b32 m0, 97152
    s_mov_b32 s75, 579328
    buffer_load_dwordx4 v8, s[24:27], s75 offen lds
    v_mfma_f32_16x16x32_bf16 a[212:215], a[240:243], v[24:27], a[212:215]
    s_waitcnt vmcnt(61)
    s_mov_b32 m0, 98208
    s_mov_b32 s75, 580608
    buffer_load_dwordx4 v8, s[24:27], s75 offen lds
    v_mfma_f32_16x16x32_bf16 a[220:223], a[240:243], v[28:31], a[220:223]
    s_waitcnt vmcnt(61)
    s_mov_b32 m0, 99264
    s_mov_b32 s75, 581888
    buffer_load_dwordx4 v8, s[24:27], s75 offen lds
    v_mfma_f32_16x16x32_bf16 a[228:231], a[240:243], v[32:35], a[228:231]
    s_waitcnt vmcnt(61)
    s_mov_b32 m0, 100320
    s_mov_b32 s75, 583168
    buffer_load_dwordx4 v8, s[24:27], s75 offen lds
    v_mfma_f32_16x16x32_bf16 a[236:239], a[240:243], v[36:39], a[236:239]
    s_waitcnt vmcnt(0) lgkmcnt(0)
L_tail:
    s_nop 7
    s_nop 7
    v_and_b32 v13, 0x300, v0
    v_mul_u32_u24 v8, 40, v13
    v_and_b32 v13, 0xf0, v0
    v_add_u32 v8, v8, v13
    s_lshl_b32 s32, s6, 4
    s_add_u32 s32, s32, s5
    s_lshl_b32 s33, s32, 3
    s_load_dwordx2 s[60:61], s[58:59], s33
    v_add_u32 v9, 4294899712, v3
    v_add_u32 v10, 4294958848, v3
    v_add_u32 v11, 50688, v3
    s_mul_i32 s34, s3, 2112
    s_mul_i32 s35, s3, 2560
    s_mov_b32 s82, 0x20000
    s_barrier
    ds_read_b128 v[64:67], v4 offset:0
    ds_read_b64_tr_b16 v[16:17], v10 offset:50688
    ds_read_b64_tr_b16 v[18:19], v10 offset:51200
    ds_read_b128 v[68:71], v4 offset:4096
    ds_read_b128 v[72:75], v4 offset:8192
    ds_read_b128 v[76:79], v4 offset:12288
    ds_read_b128 v[80:83], v4 offset:16384
    ds_read_b128 v[84:87], v4 offset:20480
    ds_read_b64_tr_b16 v[20:21], v10 offset:50720
    ds_read_b64_tr_b16 v[22:23], v10 offset:51232
    s_add_u32 m0, s34, 101376
    s_add_u32 s75, s35, 615168
    buffer_load_dwordx4 v8, s[24:27], s75 offen lds
    s_add_u32 m0, s34, 102432
    s_add_u32 s75, s35, 616448
    buffer_load_dwordx4 v8, s[24:27], s75 offen lds
    s_waitcnt lgkmcnt(7)
    v_mfma_f32_16x16x32_bf16 a[0:3], v[16:19], v[64:67], a[0:3]
    ds_read_b128 v[88:91], v4 offset:1024
    v_lshrrev_b32 v7, 4, v0
    s_waitcnt lgkmcnt(7)
    v_mfma_f32_16x16x32_bf16 a[8:11], v[16:19], v[68:71], a[8:11]
    ds_read_b128 v[92:95], v4 offset:5120
    s_waitcnt lgkmcnt(7)
    v_mfma_f32_16x16x32_bf16 a[16:19], v[16:19], v[72:75], a[16:19]
    ds_read_b128 v[96:99], v4 offset:9216
    s_waitcnt lgkmcnt(7)
    v_mfma_f32_16x16x32_bf16 a[24:27], v[16:19], v[76:79], a[24:27]
    ds_read_b128 v[100:103], v4 offset:13312
    s_waitcnt lgkmcnt(7)
    v_mfma_f32_16x16x32_bf16 a[32:35], v[16:19], v[80:83], a[32:35]
    ds_read_b128 v[104:107], v4 offset:17408
    v_and_b32 v2, 7, v7
    s_waitcnt lgkmcnt(7)
    v_mfma_f32_16x16x32_bf16 a[40:43], v[16:19], v[84:87], a[40:43]
    ds_read_b128 v[108:111], v4 offset:21504
    s_waitcnt lgkmcnt(6)
    v_mfma_f32_16x16x32_bf16 a[4:7], v[20:23], v[64:67], a[4:7]
    ds_read_b64_tr_b16 v[24:25], v11 offset:0
    v_mfma_f32_16x16x32_bf16 a[12:15], v[20:23], v[68:71], a[12:15]
    ds_read_b64_tr_b16 v[26:27], v11 offset:512
    v_mfma_f32_16x16x32_bf16 a[20:23], v[20:23], v[72:75], a[20:23]
    ds_read_b64_tr_b16 v[28:29], v11 offset:32
    v_lshlrev_b32 v1, 3, v2
    v_mfma_f32_16x16x32_bf16 a[28:31], v[20:23], v[76:79], a[28:31]
    ds_read_b64_tr_b16 v[30:31], v11 offset:544
    v_mfma_f32_16x16x32_bf16 a[36:39], v[20:23], v[80:83], a[36:39]
    v_mfma_f32_16x16x32_bf16 a[44:47], v[20:23], v[84:87], a[44:47]
    s_waitcnt lgkmcnt(2)
    v_mfma_f32_16x16x32_bf16 a[0:3], v[24:27], v[88:91], a[0:3]
    ds_read_b128 v[112:115], v4 offset:2048
    v_mfma_f32_16x16x32_bf16 a[8:11], v[24:27], v[92:95], a[8:11]
    ds_read_b128 v[116:119], v4 offset:6144
    v_bfe_u32 v5, v7, 3, 1
    v_mfma_f32_16x16x32_bf16 a[16:19], v[24:27], v[96:99], a[16:19]
    ds_read_b128 v[120:123], v4 offset:10240
    v_mfma_f32_16x16x32_bf16 a[24:27], v[24:27], v[100:103], a[24:27]
    ds_read_b128 v[124:127], v4 offset:14336
    v_mfma_f32_16x16x32_bf16 a[32:35], v[24:27], v[104:107], a[32:35]
    ds_read_b128 v[128:131], v4 offset:18432
    v_mfma_f32_16x16x32_bf16 a[40:43], v[24:27], v[108:111], a[40:43]
    ds_read_b128 v[132:135], v4 offset:22528
    v_lshl_add_u32 v2, v2, 2, v5
    s_waitcnt lgkmcnt(6)
    v_mfma_f32_16x16x32_bf16 a[4:7], v[28:31], v[88:91], a[4:7]
    ds_read_b64_tr_b16 v[32:33], v11 offset:8448
    v_mfma_f32_16x16x32_bf16 a[12:15], v[28:31], v[92:95], a[12:15]
    ds_read_b64_tr_b16 v[34:35], v11 offset:8960
    v_mfma_f32_16x16x32_bf16 a[20:23], v[28:31], v[96:99], a[20:23]
    ds_read_b64_tr_b16 v[36:37], v11 offset:8480
    v_mfma_f32_16x16x32_bf16 a[28:31], v[28:31], v[100:103], a[28:31]
    ds_read_b64_tr_b16 v[38:39], v11 offset:8992
    v_mul_u32_u24 v2, 2560, v2
    v_mfma_f32_16x16x32_bf16 a[36:39], v[28:31], v[104:107], a[36:39]
    v_mfma_f32_16x16x32_bf16 a[44:47], v[28:31], v[108:111], a[44:47]
    s_waitcnt lgkmcnt(2)
    v_mfma_f32_16x16x32_bf16 a[0:3], v[32:35], v[112:115], a[0:3]
    ds_read_b128 v[136:139], v4 offset:3072
    v_mfma_f32_16x16x32_bf16 a[8:11], v[32:35], v[116:119], a[8:11]
    ds_read_b128 v[140:143], v4 offset:7168
    v_mfma_f32_16x16x32_bf16 a[16:19], v[32:35], v[120:123], a[16:19]
    ds_read_b128 v[144:147], v4 offset:11264
    v_and_b32 v5, 0x30, v7
    v_mfma_f32_16x16x32_bf16 a[24:27], v[32:35], v[124:127], a[24:27]
    ds_read_b128 v[148:151], v4 offset:15360
    v_mfma_f32_16x16x32_bf16 a[32:35], v[32:35], v[128:131], a[32:35]
    ds_read_b128 v[152:155], v4 offset:19456
    v_mfma_f32_16x16x32_bf16 a[40:43], v[32:35], v[132:135], a[40:43]
    ds_read_b128 v[156:159], v4 offset:23552
    s_waitcnt lgkmcnt(6)
    v_mfma_f32_16x16x32_bf16 a[4:7], v[36:39], v[112:115], a[4:7]
    ds_read_b64_tr_b16 v[40:41], v9 offset:0
    v_add_u32 v2, v2, v5
    v_mfma_f32_16x16x32_bf16 a[12:15], v[36:39], v[116:119], a[12:15]
    ds_read_b64_tr_b16 v[42:43], v9 offset:512
    v_mfma_f32_16x16x32_bf16 a[20:23], v[36:39], v[120:123], a[20:23]
    ds_read_b64_tr_b16 v[44:45], v9 offset:32
    v_mfma_f32_16x16x32_bf16 a[28:31], v[36:39], v[124:127], a[28:31]
    ds_read_b64_tr_b16 v[46:47], v9 offset:544
    v_mfma_f32_16x16x32_bf16 a[36:39], v[36:39], v[128:131], a[36:39]
    v_add_u32 v5, 0x8000, v0
    v_mfma_f32_16x16x32_bf16 a[44:47], v[36:39], v[132:135], a[44:47]
    s_waitcnt lgkmcnt(0)
    s_barrier
    s_add_u32 m0, s34, 109824
    s_add_u32 s75, s35, 492544
    buffer_load_dwordx4 v8, s[24:27], s75 offen lds
    s_add_u32 m0, s34, 110880
    s_add_u32 s75, s35, 493824
    buffer_load_dwordx4 v8, s[24:27], s75 offen lds
    s_add_u32 m0, s34, 118272
    s_add_u32 s75, s35, 533504
    buffer_load_dwordx4 v8, s[24:27], s75 offen lds
    s_add_u32 m0, s34, 119328
    s_add_u32 s75, s35, 534784
    buffer_load_dwordx4 v8, s[24:27], s75 offen lds
    s_add_u32 m0, s34, 126720
    s_add_u32 s75, s35, 574464
    buffer_load_dwordx4 v8, s[24:27], s75 offen lds
    s_add_u32 m0, s34, 127776
    s_add_u32 s75, s35, 575744
    buffer_load_dwordx4 v8, s[24:27], s75 offen lds
    s_add_u32 m0, s34, 0
    s_add_u32 s75, s35, 615424
    buffer_load_dwordx4 v8, s[24:27], s75 offen lds
    s_add_u32 m0, s34, 1056
    s_add_u32 s75, s35, 616704
    buffer_load_dwordx4 v8, s[24:27], s75 offen lds
    v_mfma_f32_16x16x32_bf16 a[0:3], v[40:43], v[136:139], a[0:3]
    ds_read_b64_tr_b16 v[16:17], v9 offset:16896
    v_mfma_f32_16x16x32_bf16 a[8:11], v[40:43], v[140:143], a[8:11]
    ds_read_b64_tr_b16 v[18:19], v9 offset:17408
    v_mfma_f32_16x16x32_bf16 a[16:19], v[40:43], v[144:147], a[16:19]
    ds_read_b64_tr_b16 v[20:21], v9 offset:16928
    v_mfma_f32_16x16x32_bf16 a[24:27], v[40:43], v[148:151], a[24:27]
    ds_read_b64_tr_b16 v[22:23], v9 offset:17440
    v_add_u32 v6, 0x10000, v0
    v_mfma_f32_16x16x32_bf16 a[32:35], v[40:43], v[152:155], a[32:35]
    v_mfma_f32_16x16x32_bf16 a[40:43], v[40:43], v[156:159], a[40:43]
    v_mfma_f32_16x16x32_bf16 a[4:7], v[44:47], v[136:139], a[4:7]
    v_mfma_f32_16x16x32_bf16 a[12:15], v[44:47], v[140:143], a[12:15]
    v_add_u32 v7, 0x18000, v0
    v_mfma_f32_16x16x32_bf16 a[20:23], v[44:47], v[144:147], a[20:23]
    v_mfma_f32_16x16x32_bf16 a[28:31], v[44:47], v[148:151], a[28:31]
    v_mfma_f32_16x16x32_bf16 a[36:39], v[44:47], v[152:155], a[36:39]
    v_mfma_f32_16x16x32_bf16 a[44:47], v[44:47], v[156:159], a[44:47]
    s_waitcnt lgkmcnt(2)
    v_mfma_f32_16x16x32_bf16 a[48:51], v[16:19], v[64:67], a[48:51]
    ds_read_b64_tr_b16 v[24:25], v9 offset:25344
    v_mfma_f32_16x16x32_bf16 a[56:59], v[16:19], v[68:71], a[56:59]
    ds_read_b64_tr_b16 v[26:27], v9 offset:25856
    v_mfma_f32_16x16x32_bf16 a[64:67], v[16:19], v[72:75], a[64:67]
    ds_read_b64_tr_b16 v[28:29], v9 offset:25376
    v_mfma_f32_16x16x32_bf16 a[72:75], v[16:19], v[76:79], a[72:75]
    ds_read_b64_tr_b16 v[30:31], v9 offset:25888
    v_accvgpr_read_b32 v48, a0
    v_accvgpr_read_b32 v49, a1
    v_mfma_f32_16x16x32_bf16 a[80:83], v[16:19], v[80:83], a[80:83]
    v_accvgpr_read_b32 v50, a2
    v_accvgpr_read_b32 v51, a3
    v_mfma_f32_16x16x32_bf16 a[88:91], v[16:19], v[84:87], a[88:91]
    v_accvgpr_read_b32 v52, a4
    v_accvgpr_read_b32 v53, a5
    s_waitcnt lgkmcnt(4)
    v_mfma_f32_16x16x32_bf16 a[52:55], v[20:23], v[64:67], a[52:55]
    v_accvgpr_read_b32 v54, a6
    v_mfma_f32_16x16x32_bf16 a[60:63], v[20:23], v[68:71], a[60:63]
    v_accvgpr_read_b32 v55, a7
    v_cvt_pk_bf16_f32 v160, v48, v49
    v_mfma_f32_16x16x32_bf16 a[68:71], v[20:23], v[72:75], a[68:71]
    v_cvt_pk_bf16_f32 v161, v50, v51
    v_cvt_pk_bf16_f32 v162, v52, v53
    v_mfma_f32_16x16x32_bf16 a[76:79], v[20:23], v[76:79], a[76:79]
    v_cvt_pk_bf16_f32 v163, v54, v55
    s_cmp_eq_u32 s4, 0
    s_cbranch_scc1 L_owna0
    buffer_store_dwordx4 v[160:163], v0, s[28:31], s16 offen sc1
L_owna0:
    v_mfma_f32_16x16x32_bf16 a[84:87], v[20:23], v[80:83], a[84:87]
    v_accvgpr_read_b32 v56, a8
    v_mfma_f32_16x16x32_bf16 a[92:95], v[20:23], v[84:87], a[92:95]
    v_accvgpr_read_b32 v57, a9
    v_accvgpr_read_b32 v58, a10
    s_waitcnt lgkmcnt(2)
    v_mfma_f32_16x16x32_bf16 a[48:51], v[24:27], v[88:91], a[48:51]
    ds_read_b64_tr_b16 v[32:33], v9 offset:33792
    v_accvgpr_read_b32 v59, a11
    v_accvgpr_read_b32 v60, a12
    v_mfma_f32_16x16x32_bf16 a[56:59], v[24:27], v[92:95], a[56:59]
    ds_read_b64_tr_b16 v[34:35], v9 offset:34304
    v_accvgpr_read_b32 v61, a13
    v_accvgpr_read_b32 v62, a14
    v_mfma_f32_16x16x32_bf16 a[64:67], v[24:27], v[96:99], a[64:67]
    ds_read_b64_tr_b16 v[36:37], v9 offset:33824
    v_accvgpr_read_b32 v63, a15
    v_mfma_f32_16x16x32_bf16 a[72:75], v[24:27], v[100:103], a[72:75]
    ds_read_b64_tr_b16 v[38:39], v9 offset:34336
    v_cvt_pk_bf16_f32 v164, v56, v57
    v_cvt_pk_bf16_f32 v165, v58, v59
    v_mfma_f32_16x16x32_bf16 a[80:83], v[24:27], v[104:107], a[80:83]
    v_cvt_pk_bf16_f32 v166, v60, v61
    v_cvt_pk_bf16_f32 v167, v62, v63
    v_mfma_f32_16x16x32_bf16 a[88:91], v[24:27], v[108:111], a[88:91]
    s_cmp_eq_u32 s4, 1
    s_cbranch_scc1 L_owna1
    buffer_store_dwordx4 v[164:167], v0, s[28:31], s17 offen sc1
L_owna1:
    s_waitcnt lgkmcnt(4)
    v_mfma_f32_16x16x32_bf16 a[52:55], v[28:31], v[88:91], a[52:55]
    v_accvgpr_read_b32 v48, a16
    v_accvgpr_read_b32 v49, a17
    v_mfma_f32_16x16x32_bf16 a[60:63], v[28:31], v[92:95], a[60:63]
    v_accvgpr_read_b32 v50, a18
    v_accvgpr_read_b32 v51, a19
    v_mfma_f32_16x16x32_bf16 a[68:71], v[28:31], v[96:99], a[68:71]
    v_accvgpr_read_b32 v52, a20
    v_accvgpr_read_b32 v53, a21
    v_mfma_f32_16x16x32_bf16 a[76:79], v[28:31], v[100:103], a[76:79]
    v_accvgpr_read_b32 v54, a22
    v_mfma_f32_16x16x32_bf16 a[84:87], v[28:31], v[104:107], a[84:87]
    v_accvgpr_read_b32 v55, a23
    v_cvt_pk_bf16_f32 v168, v48, v49
    v_mfma_f32_16x16x32_bf16 a[92:95], v[28:31], v[108:111], a[92:95]
    v_cvt_pk_bf16_f32 v169, v50, v51
    v_cvt_pk_bf16_f32 v170, v52, v53
    s_waitcnt lgkmcnt(2)
    v_mfma_f32_16x16x32_bf16 a[48:51], v[32:35], v[112:115], a[48:51]
    ds_read_b64_tr_b16 v[40:41], v9 offset:42240
    v_cvt_pk_bf16_f32 v171, v54, v55
    s_cmp_eq_u32 s4, 2
    s_cbranch_scc1 L_owna2
    buffer_store_dwordx4 v[168:171], v0, s[28:31], s18 offen sc1
L_owna2:
    v_mfma_f32_16x16x32_bf16 a[56:59], v[32:35], v[116:119], a[56:59]
    ds_read_b64_tr_b16 v[42:43], v9 offset:42752
    v_accvgpr_read_b32 v56, a24
    v_mfma_f32_16x16x32_bf16 a[64:67], v[32:35], v[120:123], a[64:67]
    ds_read_b64_tr_b16 v[44:45], v9 offset:42272
    v_accvgpr_read_b32 v57, a25
    v_accvgpr_read_b32 v58, a26
    v_mfma_f32_16x16x32_bf16 a[72:75], v[32:35], v[124:127], a[72:75]
    ds_read_b64_tr_b16 v[46:47], v9 offset:42784
    v_accvgpr_read_b32 v59, a27
    v_accvgpr_read_b32 v60, a28
    v_mfma_f32_16x16x32_bf16 a[80:83], v[32:35], v[128:131], a[80:83]
    v_accvgpr_read_b32 v61, a29
    v_accvgpr_read_b32 v62, a30
    v_mfma_f32_16x16x32_bf16 a[88:91], v[32:35], v[132:135], a[88:91]
    v_accvgpr_read_b32 v63, a31
    s_waitcnt lgkmcnt(4)
    v_mfma_f32_16x16x32_bf16 a[52:55], v[36:39], v[112:115], a[52:55]
    v_cvt_pk_bf16_f32 v172, v56, v57
    v_cvt_pk_bf16_f32 v173, v58, v59
    v_mfma_f32_16x16x32_bf16 a[60:63], v[36:39], v[116:119], a[60:63]
    v_cvt_pk_bf16_f32 v174, v60, v61
    v_cvt_pk_bf16_f32 v175, v62, v63
    v_mfma_f32_16x16x32_bf16 a[68:71], v[36:39], v[120:123], a[68:71]
    s_cmp_eq_u32 s4, 3
    s_cbranch_scc1 L_owna3
    buffer_store_dwordx4 v[172:175], v0, s[28:31], s19 offen sc1
L_owna3:
    v_mfma_f32_16x16x32_bf16 a[76:79], v[36:39], v[124:127], a[76:79]
    v_accvgpr_read_b32 v48, a32
    v_accvgpr_read_b32 v49, a33
    v_mfma_f32_16x16x32_bf16 a[84:87], v[36:39], v[128:131], a[84:87]
    v_accvgpr_read_b32 v50, a34
    v_accvgpr_read_b32 v51, a35
    v_mfma_f32_16x16x32_bf16 a[92:95], v[36:39], v[132:135], a[92:95]
    v_accvgpr_read_b32 v52, a36
    v_accvgpr_read_b32 v53, a37
    s_waitcnt lgkmcnt(2)
    v_mfma_f32_16x16x32_bf16 a[48:51], v[40:43], v[136:139], a[48:51]
    ds_read_b64_tr_b16 v[16:17], v10 offset:8448
    v_accvgpr_read_b32 v54, a38
    v_mfma_f32_16x16x32_bf16 a[56:59], v[40:43], v[140:143], a[56:59]
    ds_read_b64_tr_b16 v[18:19], v10 offset:8960
    v_accvgpr_read_b32 v55, a39
    v_cvt_pk_bf16_f32 v176, v48, v49
    v_mfma_f32_16x16x32_bf16 a[64:67], v[40:43], v[144:147], a[64:67]
    ds_read_b64_tr_b16 v[20:21], v10 offset:8480
    v_cvt_pk_bf16_f32 v177, v50, v51
    v_cvt_pk_bf16_f32 v178, v52, v53
    v_mfma_f32_16x16x32_bf16 a[72:75], v[40:43], v[148:151], a[72:75]
    ds_read_b64_tr_b16 v[22:23], v10 offset:8992
    v_cvt_pk_bf16_f32 v179, v54, v55
    s_cmp_eq_u32 s4, 4
    s_cbranch_scc1 L_owna4
    buffer_store_dwordx4 v[176:179], v0, s[28:31], s20 offen sc1
L_owna4:
    v_mfma_f32_16x16x32_bf16 a[80:83], v[40:43], v[152:155], a[80:83]
    v_accvgpr_read_b32 v56, a40
    v_mfma_f32_16x16x32_bf16 a[88:91], v[40:43], v[156:159], a[88:91]
    v_accvgpr_read_b32 v57, a41
    v_accvgpr_read_b32 v58, a42
    s_waitcnt lgkmcnt(4)
    v_mfma_f32_16x16x32_bf16 a[52:55], v[44:47], v[136:139], a[52:55]
    v_accvgpr_read_b32 v59, a43
    v_accvgpr_read_b32 v60, a44
    v_mfma_f32_16x16x32_bf16 a[60:63], v[44:47], v[140:143], a[60:63]
    v_accvgpr_read_b32 v61, a45
    v_accvgpr_read_b32 v62, a46
    v_mfma_f32_16x16x32_bf16 a[68:71], v[44:47], v[144:147], a[68:71]
    v_accvgpr_read_b32 v63, a47
    v_mfma_f32_16x16x32_bf16 a[76:79], v[44:47], v[148:151], a[76:79]
    v_cvt_pk_bf16_f32 v180, v56, v57
    v_cvt_pk_bf16_f32 v181, v58, v59
    v_mfma_f32_16x16x32_bf16 a[84:87], v[44:47], v[152:155], a[84:87]
    v_cvt_pk_bf16_f32 v182, v60, v61
    v_cvt_pk_bf16_f32 v183, v62, v63
    v_mfma_f32_16x16x32_bf16 a[92:95], v[44:47], v[156:159], a[92:95]
    s_cmp_eq_u32 s4, 5
    s_cbranch_scc1 L_owna5
    buffer_store_dwordx4 v[180:183], v0, s[28:31], s21 offen sc1
L_owna5:
    s_waitcnt lgkmcnt(2)
    v_mfma_f32_16x16x32_bf16 a[96:99], v[16:19], v[64:67], a[96:99]
    ds_read_b64_tr_b16 v[24:25], v9 offset:50688
    v_mfma_f32_16x16x32_bf16 a[104:107], v[16:19], v[68:71], a[104:107]
    ds_read_b64_tr_b16 v[26:27], v9 offset:51200
    v_mfma_f32_16x16x32_bf16 a[112:115], v[16:19], v[72:75], a[112:115]
    ds_read_b64_tr_b16 v[28:29], v9 offset:50720
    v_mfma_f32_16x16x32_bf16 a[120:123], v[16:19], v[76:79], a[120:123]
    ds_read_b64_tr_b16 v[30:31], v9 offset:51232
    v_accvgpr_read_b32 v48, a48
    v_accvgpr_read_b32 v49, a49
    v_mfma_f32_16x16x32_bf16 a[128:131], v[16:19], v[80:83], a[128:131]
    v_accvgpr_read_b32 v50, a50
    v_accvgpr_read_b32 v51, a51
    v_mfma_f32_16x16x32_bf16 a[136:139], v[16:19], v[84:87], a[136:139]
    v_accvgpr_read_b32 v52, a52
    v_accvgpr_read_b32 v53, a53
    s_waitcnt lgkmcnt(4)
    v_mfma_f32_16x16x32_bf16 a[100:103], v[20:23], v[64:67], a[100:103]
    v_accvgpr_read_b32 v54, a54
    v_mfma_f32_16x16x32_bf16 a[108:111], v[20:23], v[68:71], a[108:111]
    v_accvgpr_read_b32 v55, a55
    v_cvt_pk_bf16_f32 v184, v48, v49
    v_mfma_f32_16x16x32_bf16 a[116:119], v[20:23], v[72:75], a[116:119]
    v_cvt_pk_bf16_f32 v185, v50, v51
    v_cvt_pk_bf16_f32 v186, v52, v53
    v_mfma_f32_16x16x32_bf16 a[124:127], v[20:23], v[76:79], a[124:127]
    v_cvt_pk_bf16_f32 v187, v54, v55
    s_cmp_eq_u32 s4, 6
    s_cbranch_scc1 L_owna6
    buffer_store_dwordx4 v[184:187], v0, s[28:31], s22 offen sc1
L_owna6:
    v_mfma_f32_16x16x32_bf16 a[132:135], v[20:23], v[80:83], a[132:135]
    v_accvgpr_read_b32 v56, a56
    v_mfma_f32_16x16x32_bf16 a[140:143], v[20:23], v[84:87], a[140:143]
    v_accvgpr_read_b32 v57, a57
    v_accvgpr_read_b32 v58, a58
    s_waitcnt lgkmcnt(2)
    v_mfma_f32_16x16x32_bf16 a[96:99], v[24:27], v[88:91], a[96:99]
    ds_read_b64_tr_b16 v[32:33], v10 offset:0
    v_accvgpr_read_b32 v59, a59
    v_accvgpr_read_b32 v60, a60
    v_mfma_f32_16x16x32_bf16 a[104:107], v[24:27], v[92:95], a[104:107]
    ds_read_b64_tr_b16 v[34:35], v10 offset:512
    v_accvgpr_read_b32 v61, a61
    v_accvgpr_read_b32 v62, a62
    v_mfma_f32_16x16x32_bf16 a[112:115], v[24:27], v[96:99], a[112:115]
    ds_read_b64_tr_b16 v[36:37], v10 offset:32
    v_accvgpr_read_b32 v63, a63
    v_mfma_f32_16x16x32_bf16 a[120:123], v[24:27], v[100:103], a[120:123]
    ds_read_b64_tr_b16 v[38:39], v10 offset:544
    v_cvt_pk_bf16_f32 v188, v56, v57
    v_cvt_pk_bf16_f32 v189, v58, v59
    v_mfma_f32_16x16x32_bf16 a[128:131], v[24:27], v[104:107], a[128:131]
    v_cvt_pk_bf16_f32 v190, v60, v61
    v_cvt_pk_bf16_f32 v191, v62, v63
    v_mfma_f32_16x16x32_bf16 a[136:139], v[24:27], v[108:111], a[136:139]
    s_cmp_eq_u32 s4, 7
    s_cbranch_scc1 L_owna7
    buffer_store_dwordx4 v[188:191], v0, s[28:31], s23 offen sc1
L_owna7:
    s_waitcnt lgkmcnt(4)
    v_mfma_f32_16x16x32_bf16 a[100:103], v[28:31], v[88:91], a[100:103]
    v_accvgpr_read_b32 v48, a64
    v_accvgpr_read_b32 v49, a65
    v_mfma_f32_16x16x32_bf16 a[108:111], v[28:31], v[92:95], a[108:111]
    v_accvgpr_read_b32 v50, a66
    v_accvgpr_read_b32 v51, a67
    v_mfma_f32_16x16x32_bf16 a[116:119], v[28:31], v[96:99], a[116:119]
    v_accvgpr_read_b32 v52, a68
    v_accvgpr_read_b32 v53, a69
    v_mfma_f32_16x16x32_bf16 a[124:127], v[28:31], v[100:103], a[124:127]
    v_accvgpr_read_b32 v54, a70
    v_mfma_f32_16x16x32_bf16 a[132:135], v[28:31], v[104:107], a[132:135]
    v_accvgpr_read_b32 v55, a71
    v_cvt_pk_bf16_f32 v192, v48, v49
    v_mfma_f32_16x16x32_bf16 a[140:143], v[28:31], v[108:111], a[140:143]
    v_cvt_pk_bf16_f32 v193, v50, v51
    v_cvt_pk_bf16_f32 v194, v52, v53
    s_waitcnt lgkmcnt(2)
    v_mfma_f32_16x16x32_bf16 a[96:99], v[32:35], v[112:115], a[96:99]
    ds_read_b64_tr_b16 v[40:41], v10 offset:16896
    v_cvt_pk_bf16_f32 v195, v54, v55
    s_cmp_eq_u32 s4, 0
    s_cbranch_scc1 L_owna8
    buffer_store_dwordx4 v[192:195], v5, s[28:31], s16 offen sc1
L_owna8:
    v_mfma_f32_16x16x32_bf16 a[104:107], v[32:35], v[116:119], a[104:107]
    ds_read_b64_tr_b16 v[42:43], v10 offset:17408
    v_accvgpr_read_b32 v56, a72
    v_mfma_f32_16x16x32_bf16 a[112:115], v[32:35], v[120:123], a[112:115]
    ds_read_b64_tr_b16 v[44:45], v10 offset:16928
    v_accvgpr_read_b32 v57, a73
    v_accvgpr_read_b32 v58, a74
    v_mfma_f32_16x16x32_bf16 a[120:123], v[32:35], v[124:127], a[120:123]
    ds_read_b64_tr_b16 v[46:47], v10 offset:17440
    v_accvgpr_read_b32 v59, a75
    v_accvgpr_read_b32 v60, a76
    v_mfma_f32_16x16x32_bf16 a[128:131], v[32:35], v[128:131], a[128:131]
    v_accvgpr_read_b32 v61, a77
    v_accvgpr_read_b32 v62, a78
    v_mfma_f32_16x16x32_bf16 a[136:139], v[32:35], v[132:135], a[136:139]
    v_accvgpr_read_b32 v63, a79
    s_waitcnt lgkmcnt(4)
    v_mfma_f32_16x16x32_bf16 a[100:103], v[36:39], v[112:115], a[100:103]
    v_cvt_pk_bf16_f32 v196, v56, v57
    v_cvt_pk_bf16_f32 v197, v58, v59
    v_mfma_f32_16x16x32_bf16 a[108:111], v[36:39], v[116:119], a[108:111]
    v_cvt_pk_bf16_f32 v198, v60, v61
    v_cvt_pk_bf16_f32 v199, v62, v63
    v_mfma_f32_16x16x32_bf16 a[116:119], v[36:39], v[120:123], a[116:119]
    s_cmp_eq_u32 s4, 1
    s_cbranch_scc1 L_owna9
    buffer_store_dwordx4 v[196:199], v5, s[28:31], s17 offen sc1
L_owna9:
    v_mfma_f32_16x16x32_bf16 a[124:127], v[36:39], v[124:127], a[124:127]
    v_accvgpr_read_b32 v48, a80
    v_accvgpr_read_b32 v49, a81
    v_mfma_f32_16x16x32_bf16 a[132:135], v[36:39], v[128:131], a[132:135]
    v_accvgpr_read_b32 v50, a82
    v_accvgpr_read_b32 v51, a83
    v_mfma_f32_16x16x32_bf16 a[140:143], v[36:39], v[132:135], a[140:143]
    v_accvgpr_read_b32 v52, a84
    v_accvgpr_read_b32 v53, a85
    s_waitcnt lgkmcnt(2)
    v_mfma_f32_16x16x32_bf16 a[96:99], v[40:43], v[136:139], a[96:99]
    ds_read_b64_tr_b16 v[16:17], v9 offset:8448
    v_accvgpr_read_b32 v54, a86
    v_mfma_f32_16x16x32_bf16 a[104:107], v[40:43], v[140:143], a[104:107]
    ds_read_b64_tr_b16 v[18:19], v9 offset:8960
    v_accvgpr_read_b32 v55, a87
    v_cvt_pk_bf16_f32 v200, v48, v49
    v_mfma_f32_16x16x32_bf16 a[112:115], v[40:43], v[144:147], a[112:115]
    ds_read_b64_tr_b16 v[20:21], v9 offset:8480
    v_cvt_pk_bf16_f32 v201, v50, v51
    v_cvt_pk_bf16_f32 v202, v52, v53
    v_mfma_f32_16x16x32_bf16 a[120:123], v[40:43], v[148:151], a[120:123]
    ds_read_b64_tr_b16 v[22:23], v9 offset:8992
    v_cvt_pk_bf16_f32 v203, v54, v55
    s_cmp_eq_u32 s4, 2
    s_cbranch_scc1 L_owna10
    buffer_store_dwordx4 v[200:203], v5, s[28:31], s18 offen sc1
L_owna10:
    v_mfma_f32_16x16x32_bf16 a[128:131], v[40:43], v[152:155], a[128:131]
    v_accvgpr_read_b32 v56, a88
    v_mfma_f32_16x16x32_bf16 a[136:139], v[40:43], v[156:159], a[136:139]
    v_accvgpr_read_b32 v57, a89
    v_accvgpr_read_b32 v58, a90
    s_waitcnt lgkmcnt(4)
    v_mfma_f32_16x16x32_bf16 a[100:103], v[44:47], v[136:139], a[100:103]
    v_accvgpr_read_b32 v59, a91
    v_accvgpr_read_b32 v60, a92
    v_mfma_f32_16x16x32_bf16 a[108:111], v[44:47], v[140:143], a[108:111]
    v_accvgpr_read_b32 v61, a93
    v_accvgpr_read_b32 v62, a94
    v_mfma_f32_16x16x32_bf16 a[116:119], v[44:47], v[144:147], a[116:119]
    v_accvgpr_read_b32 v63, a95
    v_mfma_f32_16x16x32_bf16 a[124:127], v[44:47], v[148:151], a[124:127]
    v_cvt_pk_bf16_f32 v204, v56, v57
    v_cvt_pk_bf16_f32 v205, v58, v59
    v_mfma_f32_16x16x32_bf16 a[132:135], v[44:47], v[152:155], a[132:135]
    v_cvt_pk_bf16_f32 v206, v60, v61
    v_cvt_pk_bf16_f32 v207, v62, v63
    v_mfma_f32_16x16x32_bf16 a[140:143], v[44:47], v[156:159], a[140:143]
    s_cmp_eq_u32 s4, 3
    s_cbranch_scc1 L_owna11
    buffer_store_dwordx4 v[204:207], v5, s[28:31], s19 offen sc1
L_owna11:
    s_waitcnt lgkmcnt(2)
    v_mfma_f32_16x16x32_bf16 a[144:147], v[16:19], v[64:67], a[144:147]
    ds_read_b64_tr_b16 v[24:25], v10 offset:25344
    v_mfma_f32_16x16x32_bf16 a[152:155], v[16:19], v[68:71], a[152:155]
    ds_read_b64_tr_b16 v[26:27], v10 offset:25856
    v_mfma_f32_16x16x32_bf16 a[160:163], v[16:19], v[72:75], a[160:163]
    ds_read_b64_tr_b16 v[28:29], v10 offset:25376
    v_mfma_f32_16x16x32_bf16 a[168:171], v[16:19], v[76:79], a[168:171]
    ds_read_b64_tr_b16 v[30:31], v10 offset:25888
    v_accvgpr_read_b32 v48, a96
    v_accvgpr_read_b32 v49, a97
    v_mfma_f32_16x16x32_bf16 a[176:179], v[16:19], v[80:83], a[176:179]
    v_accvgpr_read_b32 v50, a98
    v_accvgpr_read_b32 v51, a99
    v_mfma_f32_16x16x32_bf16 a[184:187], v[16:19], v[84:87], a[184:187]
    v_accvgpr_read_b32 v52, a100
    v_accvgpr_read_b32 v53, a101
    s_waitcnt lgkmcnt(4)
    v_mfma_f32_16x16x32_bf16 a[148:151], v[20:23], v[64:67], a[148:151]
    v_accvgpr_read_b32 v54, a102
    v_mfma_f32_16x16x32_bf16 a[156:159], v[20:23], v[68:71], a[156:159]
    v_accvgpr_read_b32 v55, a103
    v_cvt_pk_bf16_f32 v208, v48, v49
    v_mfma_f32_16x16x32_bf16 a[164:167], v[20:23], v[72:75], a[164:167]
    v_cvt_pk_bf16_f32 v209, v50, v51
    v_cvt_pk_bf16_f32 v210, v52, v53
    v_mfma_f32_16x16x32_bf16 a[172:175], v[20:23], v[76:79], a[172:175]
    v_cvt_pk_bf16_f32 v211, v54, v55
    s_cmp_eq_u32 s4, 4
    s_cbranch_scc1 L_owna12
    buffer_store_dwordx4 v[208:211], v5, s[28:31], s20 offen sc1
L_owna12:
    v_mfma_f32_16x16x32_bf16 a[180:183], v[20:23], v[80:83], a[180:183]
    v_accvgpr_read_b32 v56, a104
    v_mfma_f32_16x16x32_bf16 a[188:191], v[20:23], v[84:87], a[188:191]
    v_accvgpr_read_b32 v57, a105
    v_accvgpr_read_b32 v58, a106
    s_waitcnt lgkmcnt(2)
    v_mfma_f32_16x16x32_bf16 a[144:147], v[24:27], v[88:91], a[144:147]
    ds_read_b64_tr_b16 v[32:33], v10 offset:33792
    v_accvgpr_read_b32 v59, a107
    v_accvgpr_read_b32 v60, a108
    v_mfma_f32_16x16x32_bf16 a[152:155], v[24:27], v[92:95], a[152:155]
    ds_read_b64_tr_b16 v[34:35], v10 offset:34304
    v_accvgpr_read_b32 v61, a109
    v_accvgpr_read_b32 v62, a110
    v_mfma_f32_16x16x32_bf16 a[160:163], v[24:27], v[96:99], a[160:163]
    ds_read_b64_tr_b16 v[36:37], v10 offset:33824
    v_accvgpr_read_b32 v63, a111
    v_mfma_f32_16x16x32_bf16 a[168:171], v[24:27], v[100:103], a[168:171]
    ds_read_b64_tr_b16 v[38:39], v10 offset:34336
    v_cvt_pk_bf16_f32 v212, v56, v57
    v_cvt_pk_bf16_f32 v213, v58, v59
    v_mfma_f32_16x16x32_bf16 a[176:179], v[24:27], v[104:107], a[176:179]
    v_cvt_pk_bf16_f32 v214, v60, v61
    v_cvt_pk_bf16_f32 v215, v62, v63
    v_mfma_f32_16x16x32_bf16 a[184:187], v[24:27], v[108:111], a[184:187]
    s_cmp_eq_u32 s4, 5
    s_cbranch_scc1 L_owna13
    buffer_store_dwordx4 v[212:215], v5, s[28:31], s21 offen sc1
L_owna13:
    s_waitcnt lgkmcnt(4)
    v_mfma_f32_16x16x32_bf16 a[148:151], v[28:31], v[88:91], a[148:151]
    v_accvgpr_read_b32 v48, a112
    v_accvgpr_read_b32 v49, a113
    v_mfma_f32_16x16x32_bf16 a[156:159], v[28:31], v[92:95], a[156:159]
    v_accvgpr_read_b32 v50, a114
    v_accvgpr_read_b32 v51, a115
    v_mfma_f32_16x16x32_bf16 a[164:167], v[28:31], v[96:99], a[164:167]
    v_accvgpr_read_b32 v52, a116
    v_accvgpr_read_b32 v53, a117
    v_mfma_f32_16x16x32_bf16 a[172:175], v[28:31], v[100:103], a[172:175]
    v_accvgpr_read_b32 v54, a118
    v_mfma_f32_16x16x32_bf16 a[180:183], v[28:31], v[104:107], a[180:183]
    v_accvgpr_read_b32 v55, a119
    v_cvt_pk_bf16_f32 v216, v48, v49
    v_mfma_f32_16x16x32_bf16 a[188:191], v[28:31], v[108:111], a[188:191]
    v_cvt_pk_bf16_f32 v217, v50, v51
    v_cvt_pk_bf16_f32 v218, v52, v53
    s_waitcnt lgkmcnt(2)
    v_mfma_f32_16x16x32_bf16 a[144:147], v[32:35], v[112:115], a[144:147]
    s_waitcnt vmcnt(12)
    s_barrier
    v_cvt_pk_bf16_f32 v219, v54, v55
    s_cmp_eq_u32 s4, 6
    s_cbranch_scc1 L_owna14
    buffer_store_dwordx4 v[216:219], v5, s[28:31], s22 offen sc1
L_owna14:
    v_mfma_f32_16x16x32_bf16 a[152:155], v[32:35], v[116:119], a[152:155]
    ds_read_b64_tr_b16 v[40:41], v10 offset:42240
    v_accvgpr_read_b32 v56, a120
    v_mfma_f32_16x16x32_bf16 a[160:163], v[32:35], v[120:123], a[160:163]
    ds_read_b64_tr_b16 v[42:43], v10 offset:42752
    v_accvgpr_read_b32 v57, a121
    v_accvgpr_read_b32 v58, a122
    v_mfma_f32_16x16x32_bf16 a[168:171], v[32:35], v[124:127], a[168:171]
    ds_read_b64_tr_b16 v[44:45], v10 offset:42272
    v_accvgpr_read_b32 v59, a123
    v_accvgpr_read_b32 v60, a124
    v_mfma_f32_16x16x32_bf16 a[176:179], v[32:35], v[128:131], a[176:179]
    ds_read_b64_tr_b16 v[46:47], v10 offset:42784
    v_accvgpr_read_b32 v61, a125
    v_accvgpr_read_b32 v62, a126
    v_mfma_f32_16x16x32_bf16 a[184:187], v[32:35], v[132:135], a[184:187]
    v_accvgpr_read_b32 v63, a127
    s_waitcnt lgkmcnt(4)
    v_mfma_f32_16x16x32_bf16 a[148:151], v[36:39], v[112:115], a[148:151]
    v_cvt_pk_bf16_f32 v220, v56, v57
    v_cvt_pk_bf16_f32 v221, v58, v59
    v_mfma_f32_16x16x32_bf16 a[156:159], v[36:39], v[116:119], a[156:159]
    v_cvt_pk_bf16_f32 v222, v60, v61
    v_cvt_pk_bf16_f32 v223, v62, v63
    v_mfma_f32_16x16x32_bf16 a[164:167], v[36:39], v[120:123], a[164:167]
    s_cmp_eq_u32 s4, 7
    s_cbranch_scc1 L_owna15
    buffer_store_dwordx4 v[220:223], v5, s[28:31], s23 offen sc1
L_owna15:
    v_mfma_f32_16x16x32_bf16 a[172:175], v[36:39], v[124:127], a[172:175]
    v_accvgpr_read_b32 v48, a128
    v_accvgpr_read_b32 v49, a129
    v_mfma_f32_16x16x32_bf16 a[180:183], v[36:39], v[128:131], a[180:183]
    v_accvgpr_read_b32 v50, a130
    v_accvgpr_read_b32 v51, a131
    v_mfma_f32_16x16x32_bf16 a[188:191], v[36:39], v[132:135], a[188:191]
    v_accvgpr_read_b32 v52, a132
    v_accvgpr_read_b32 v53, a133
    s_waitcnt lgkmcnt(2)
    v_mfma_f32_16x16x32_bf16 a[144:147], v[40:43], v[136:139], a[144:147]
    ds_read_b64_tr_b16 v[16:17], v10 offset:50688
    v_accvgpr_read_b32 v54, a134
    v_mfma_f32_16x16x32_bf16 a[152:155], v[40:43], v[140:143], a[152:155]
    ds_read_b64_tr_b16 v[18:19], v10 offset:51200
    v_accvgpr_read_b32 v55, a135
    v_cvt_pk_bf16_f32 v224, v48, v49
    v_mfma_f32_16x16x32_bf16 a[160:163], v[40:43], v[144:147], a[160:163]
    ds_read_b64_tr_b16 v[20:21], v10 offset:50720
    v_cvt_pk_bf16_f32 v225, v50, v51
    v_cvt_pk_bf16_f32 v226, v52, v53
    v_mfma_f32_16x16x32_bf16 a[168:171], v[40:43], v[148:151], a[168:171]
    ds_read_b64_tr_b16 v[22:23], v10 offset:51232
    v_cvt_pk_bf16_f32 v227, v54, v55
    s_cmp_eq_u32 s4, 0
    s_cbranch_scc1 L_owna16
    buffer_store_dwordx4 v[224:227], v6, s[28:31], s16 offen sc1
L_owna16:
    v_mfma_f32_16x16x32_bf16 a[176:179], v[40:43], v[152:155], a[176:179]
    v_accvgpr_read_b32 v56, a136
    v_mfma_f32_16x16x32_bf16 a[184:187], v[40:43], v[156:159], a[184:187]
    v_accvgpr_read_b32 v57, a137
    v_accvgpr_read_b32 v58, a138
    s_waitcnt lgkmcnt(4)
    v_mfma_f32_16x16x32_bf16 a[148:151], v[44:47], v[136:139], a[148:151]
    v_accvgpr_read_b32 v59, a139
    v_accvgpr_read_b32 v60, a140
    v_mfma_f32_16x16x32_bf16 a[156:159], v[44:47], v[140:143], a[156:159]
    v_accvgpr_read_b32 v61, a141
    v_accvgpr_read_b32 v62, a142
    v_mfma_f32_16x16x32_bf16 a[164:167], v[44:47], v[144:147], a[164:167]
    v_accvgpr_read_b32 v63, a143
    v_mfma_f32_16x16x32_bf16 a[172:175], v[44:47], v[148:151], a[172:175]
    v_cvt_pk_bf16_f32 v228, v56, v57
    v_cvt_pk_bf16_f32 v229, v58, v59
    v_mfma_f32_16x16x32_bf16 a[180:183], v[44:47], v[152:155], a[180:183]
    v_cvt_pk_bf16_f32 v230, v60, v61
    v_cvt_pk_bf16_f32 v231, v62, v63
    v_mfma_f32_16x16x32_bf16 a[188:191], v[44:47], v[156:159], a[188:191]
    s_cmp_eq_u32 s4, 1
    s_cbranch_scc1 L_owna17
    buffer_store_dwordx4 v[228:231], v6, s[28:31], s17 offen sc1
L_owna17:
    s_waitcnt lgkmcnt(2)
    v_mfma_f32_16x16x32_bf16 a[192:195], v[16:19], v[64:67], a[192:195]
    ds_read_b64_tr_b16 v[24:25], v11 offset:0
    v_mfma_f32_16x16x32_bf16 a[200:203], v[16:19], v[68:71], a[200:203]
    ds_read_b64_tr_b16 v[26:27], v11 offset:512
    v_mfma_f32_16x16x32_bf16 a[208:211], v[16:19], v[72:75], a[208:211]
    ds_read_b64_tr_b16 v[28:29], v11 offset:32
    v_mfma_f32_16x16x32_bf16 a[216:219], v[16:19], v[76:79], a[216:219]
    ds_read_b64_tr_b16 v[30:31], v11 offset:544
    v_accvgpr_read_b32 v48, a144
    v_accvgpr_read_b32 v49, a145
    v_mfma_f32_16x16x32_bf16 a[224:227], v[16:19], v[80:83], a[224:227]
    v_accvgpr_read_b32 v50, a146
    v_accvgpr_read_b32 v51, a147
    v_mfma_f32_16x16x32_bf16 a[232:235], v[16:19], v[84:87], a[232:235]
    v_accvgpr_read_b32 v52, a148
    v_accvgpr_read_b32 v53, a149
    s_waitcnt lgkmcnt(4)
    v_mfma_f32_16x16x32_bf16 a[196:199], v[20:23], v[64:67], a[196:199]
    v_accvgpr_read_b32 v54, a150
    v_mfma_f32_16x16x32_bf16 a[204:207], v[20:23], v[68:71], a[204:207]
    v_accvgpr_read_b32 v55, a151
    v_cvt_pk_bf16_f32 v232, v48, v49
    v_mfma_f32_16x16x32_bf16 a[212:215], v[20:23], v[72:75], a[212:215]
    v_cvt_pk_bf16_f32 v233, v50, v51
    v_cvt_pk_bf16_f32 v234, v52, v53
    v_mfma_f32_16x16x32_bf16 a[220:223], v[20:23], v[76:79], a[220:223]
    v_cvt_pk_bf16_f32 v235, v54, v55
    s_cmp_eq_u32 s4, 2
    s_cbranch_scc1 L_owna18
    buffer_store_dwordx4 v[232:235], v6, s[28:31], s18 offen sc1
L_owna18:
    v_mfma_f32_16x16x32_bf16 a[228:231], v[20:23], v[80:83], a[228:231]
    v_accvgpr_read_b32 v56, a152
    v_mfma_f32_16x16x32_bf16 a[236:239], v[20:23], v[84:87], a[236:239]
    v_accvgpr_read_b32 v57, a153
    v_accvgpr_read_b32 v58, a154
    s_waitcnt lgkmcnt(2)
    v_mfma_f32_16x16x32_bf16 a[192:195], v[24:27], v[88:91], a[192:195]
    ds_read_b64_tr_b16 v[32:33], v11 offset:8448
    v_accvgpr_read_b32 v59, a155
    v_accvgpr_read_b32 v60, a156
    v_mfma_f32_16x16x32_bf16 a[200:203], v[24:27], v[92:95], a[200:203]
    ds_read_b64_tr_b16 v[34:35], v11 offset:8960
    v_accvgpr_read_b32 v61, a157
    v_accvgpr_read_b32 v62, a158
    v_mfma_f32_16x16x32_bf16 a[208:211], v[24:27], v[96:99], a[208:211]
    ds_read_b64_tr_b16 v[36:37], v11 offset:8480
    v_accvgpr_read_b32 v63, a159
    v_mfma_f32_16x16x32_bf16 a[216:219], v[24:27], v[100:103], a[216:219]
    ds_read_b64_tr_b16 v[38:39], v11 offset:8992
    v_cvt_pk_bf16_f32 v236, v56, v57
    v_cvt_pk_bf16_f32 v237, v58, v59
    v_mfma_f32_16x16x32_bf16 a[224:227], v[24:27], v[104:107], a[224:227]
    v_cvt_pk_bf16_f32 v238, v60, v61
    v_cvt_pk_bf16_f32 v239, v62, v63
    v_mfma_f32_16x16x32_bf16 a[232:235], v[24:27], v[108:111], a[232:235]
    s_cmp_eq_u32 s4, 3
    s_cbranch_scc1 L_owna19
    buffer_store_dwordx4 v[236:239], v6, s[28:31], s19 offen sc1
L_owna19:
    s_waitcnt lgkmcnt(4)
    v_mfma_f32_16x16x32_bf16 a[196:199], v[28:31], v[88:91], a[196:199]
    v_accvgpr_read_b32 v48, a160
    v_accvgpr_read_b32 v49, a161
    v_mfma_f32_16x16x32_bf16 a[204:207], v[28:31], v[92:95], a[204:207]
    v_accvgpr_read_b32 v50, a162
    v_accvgpr_read_b32 v51, a163
    v_mfma_f32_16x16x32_bf16 a[212:215], v[28:31], v[96:99], a[212:215]
    v_accvgpr_read_b32 v52, a164
    v_accvgpr_read_b32 v53, a165
    v_mfma_f32_16x16x32_bf16 a[220:223], v[28:31], v[100:103], a[220:223]
    v_accvgpr_read_b32 v54, a166
    v_mfma_f32_16x16x32_bf16 a[228:231], v[28:31], v[104:107], a[228:231]
    v_accvgpr_read_b32 v55, a167
    v_cvt_pk_bf16_f32 v240, v48, v49
    v_mfma_f32_16x16x32_bf16 a[236:239], v[28:31], v[108:111], a[236:239]
    v_cvt_pk_bf16_f32 v241, v50, v51
    v_cvt_pk_bf16_f32 v242, v52, v53
    s_waitcnt lgkmcnt(2)
    v_mfma_f32_16x16x32_bf16 a[192:195], v[32:35], v[112:115], a[192:195]
    ds_read_b64_tr_b16 v[40:41], v9 offset:0
    v_cvt_pk_bf16_f32 v243, v54, v55
    s_cmp_eq_u32 s4, 4
    s_cbranch_scc1 L_owna20
    buffer_store_dwordx4 v[240:243], v6, s[28:31], s20 offen sc1
L_owna20:
    v_mfma_f32_16x16x32_bf16 a[200:203], v[32:35], v[116:119], a[200:203]
    ds_read_b64_tr_b16 v[42:43], v9 offset:512
    v_accvgpr_read_b32 v56, a168
    v_mfma_f32_16x16x32_bf16 a[208:211], v[32:35], v[120:123], a[208:211]
    ds_read_b64_tr_b16 v[44:45], v9 offset:32
    v_accvgpr_read_b32 v57, a169
    v_accvgpr_read_b32 v58, a170
    v_mfma_f32_16x16x32_bf16 a[216:219], v[32:35], v[124:127], a[216:219]
    ds_read_b64_tr_b16 v[46:47], v9 offset:544
    v_accvgpr_read_b32 v59, a171
    v_accvgpr_read_b32 v60, a172
    v_mfma_f32_16x16x32_bf16 a[224:227], v[32:35], v[128:131], a[224:227]
    v_accvgpr_read_b32 v61, a173
    v_accvgpr_read_b32 v62, a174
    v_mfma_f32_16x16x32_bf16 a[232:235], v[32:35], v[132:135], a[232:235]
    v_accvgpr_read_b32 v63, a175
    s_waitcnt lgkmcnt(4)
    v_mfma_f32_16x16x32_bf16 a[196:199], v[36:39], v[112:115], a[196:199]
    v_cvt_pk_bf16_f32 v244, v56, v57
    v_cvt_pk_bf16_f32 v245, v58, v59
    v_mfma_f32_16x16x32_bf16 a[204:207], v[36:39], v[116:119], a[204:207]
    v_cvt_pk_bf16_f32 v246, v60, v61
    v_cvt_pk_bf16_f32 v247, v62, v63
    v_mfma_f32_16x16x32_bf16 a[212:215], v[36:39], v[120:123], a[212:215]
    s_cmp_eq_u32 s4, 5
    s_cbranch_scc1 L_owna21
    buffer_store_dwordx4 v[244:247], v6, s[28:31], s21 offen sc1
L_owna21:
    v_mfma_f32_16x16x32_bf16 a[220:223], v[36:39], v[124:127], a[220:223]
    v_accvgpr_read_b32 v48, a176
    v_accvgpr_read_b32 v49, a177
    v_mfma_f32_16x16x32_bf16 a[228:231], v[36:39], v[128:131], a[228:231]
    v_accvgpr_read_b32 v50, a178
    v_accvgpr_read_b32 v51, a179
    v_mfma_f32_16x16x32_bf16 a[236:239], v[36:39], v[132:135], a[236:239]
    v_accvgpr_read_b32 v52, a180
    v_accvgpr_read_b32 v53, a181
    s_waitcnt lgkmcnt(2)
    v_mfma_f32_16x16x32_bf16 a[192:195], v[40:43], v[136:139], a[192:195]
    v_accvgpr_read_b32 v54, a182
    v_mfma_f32_16x16x32_bf16 a[200:203], v[40:43], v[140:143], a[200:203]
    v_accvgpr_read_b32 v55, a183
    v_cvt_pk_bf16_f32 v248, v48, v49
    v_mfma_f32_16x16x32_bf16 a[208:211], v[40:43], v[144:147], a[208:211]
    v_cvt_pk_bf16_f32 v249, v50, v51
    v_cvt_pk_bf16_f32 v250, v52, v53
    v_mfma_f32_16x16x32_bf16 a[216:219], v[40:43], v[148:151], a[216:219]
    v_cvt_pk_bf16_f32 v251, v54, v55
    s_cmp_eq_u32 s4, 6
    s_cbranch_scc1 L_owna22
    buffer_store_dwordx4 v[248:251], v6, s[28:31], s22 offen sc1
L_owna22:
    v_mfma_f32_16x16x32_bf16 a[224:227], v[40:43], v[152:155], a[224:227]
    v_accvgpr_read_b32 v56, a184
    v_mfma_f32_16x16x32_bf16 a[232:235], v[40:43], v[156:159], a[232:235]
    v_accvgpr_read_b32 v57, a185
    v_accvgpr_read_b32 v58, a186
    s_waitcnt lgkmcnt(0)
    v_mfma_f32_16x16x32_bf16 a[196:199], v[44:47], v[136:139], a[196:199]
    v_accvgpr_read_b32 v59, a187
    v_accvgpr_read_b32 v60, a188
    v_mfma_f32_16x16x32_bf16 a[204:207], v[44:47], v[140:143], a[204:207]
    v_accvgpr_read_b32 v61, a189
    v_accvgpr_read_b32 v62, a190
    v_mfma_f32_16x16x32_bf16 a[212:215], v[44:47], v[144:147], a[212:215]
    v_accvgpr_read_b32 v63, a191
    v_mfma_f32_16x16x32_bf16 a[220:223], v[44:47], v[148:151], a[220:223]
    v_cvt_pk_bf16_f32 v252, v56, v57
    v_cvt_pk_bf16_f32 v253, v58, v59
    v_mfma_f32_16x16x32_bf16 a[228:231], v[44:47], v[152:155], a[228:231]
    v_cvt_pk_bf16_f32 v254, v60, v61
    v_cvt_pk_bf16_f32 v255, v62, v63
    v_mfma_f32_16x16x32_bf16 a[236:239], v[44:47], v[156:159], a[236:239]
    s_cmp_eq_u32 s4, 7
    s_cbranch_scc1 L_owna23
    buffer_store_dwordx4 v[252:255], v6, s[28:31], s23 offen sc1
L_owna23:
    v_accvgpr_read_b32 v48, a192
    v_accvgpr_read_b32 v49, a193
    v_accvgpr_read_b32 v50, a194
    v_accvgpr_read_b32 v51, a195
    v_accvgpr_read_b32 v52, a196
    v_accvgpr_read_b32 v53, a197
    v_accvgpr_read_b32 v54, a198
    v_accvgpr_read_b32 v55, a199
    v_cvt_pk_bf16_f32 v136, v48, v49
    v_cvt_pk_bf16_f32 v137, v50, v51
    v_cvt_pk_bf16_f32 v138, v52, v53
    v_cvt_pk_bf16_f32 v139, v54, v55
    s_cmp_eq_u32 s4, 0
    s_cbranch_scc1 L_owna24
    buffer_store_dwordx4 v[136:139], v7, s[28:31], s16 offen sc1
L_owna24:
    v_accvgpr_read_b32 v56, a200
    v_accvgpr_read_b32 v57, a201
    v_accvgpr_read_b32 v58, a202
    v_accvgpr_read_b32 v59, a203
    v_accvgpr_read_b32 v60, a204
    v_accvgpr_read_b32 v61, a205
    v_accvgpr_read_b32 v62, a206
    v_accvgpr_read_b32 v63, a207
    v_cvt_pk_bf16_f32 v140, v56, v57
    v_cvt_pk_bf16_f32 v141, v58, v59
    v_cvt_pk_bf16_f32 v142, v60, v61
    v_cvt_pk_bf16_f32 v143, v62, v63
    s_cmp_eq_u32 s4, 1
    s_cbranch_scc1 L_owna25
    buffer_store_dwordx4 v[140:143], v7, s[28:31], s17 offen sc1
L_owna25:
    v_accvgpr_read_b32 v48, a208
    v_accvgpr_read_b32 v49, a209
    v_accvgpr_read_b32 v50, a210
    v_accvgpr_read_b32 v51, a211
    v_accvgpr_read_b32 v52, a212
    v_accvgpr_read_b32 v53, a213
    v_accvgpr_read_b32 v54, a214
    v_accvgpr_read_b32 v55, a215
    v_cvt_pk_bf16_f32 v144, v48, v49
    v_cvt_pk_bf16_f32 v145, v50, v51
    v_cvt_pk_bf16_f32 v146, v52, v53
    v_cvt_pk_bf16_f32 v147, v54, v55
    s_cmp_eq_u32 s4, 2
    s_cbranch_scc1 L_owna26
    buffer_store_dwordx4 v[144:147], v7, s[28:31], s18 offen sc1
L_owna26:
    v_accvgpr_read_b32 v56, a216
    v_accvgpr_read_b32 v57, a217
    v_accvgpr_read_b32 v58, a218
    v_accvgpr_read_b32 v59, a219
    v_accvgpr_read_b32 v60, a220
    v_accvgpr_read_b32 v61, a221
    v_accvgpr_read_b32 v62, a222
    v_accvgpr_read_b32 v63, a223
    v_cvt_pk_bf16_f32 v148, v56, v57
    v_cvt_pk_bf16_f32 v149, v58, v59
    v_cvt_pk_bf16_f32 v150, v60, v61
    v_cvt_pk_bf16_f32 v151, v62, v63
    s_cmp_eq_u32 s4, 3
    s_cbranch_scc1 L_owna27
    buffer_store_dwordx4 v[148:151], v7, s[28:31], s19 offen sc1
L_owna27:
    v_accvgpr_read_b32 v48, a224
    v_accvgpr_read_b32 v49, a225
    v_accvgpr_read_b32 v50, a226
    v_accvgpr_read_b32 v51, a227
    v_accvgpr_read_b32 v52, a228
    v_accvgpr_read_b32 v53, a229
    v_accvgpr_read_b32 v54, a230
    v_accvgpr_read_b32 v55, a231
    v_cvt_pk_bf16_f32 v152, v48, v49
    v_cvt_pk_bf16_f32 v153, v50, v51
    v_cvt_pk_bf16_f32 v154, v52, v53
    v_cvt_pk_bf16_f32 v155, v54, v55
    s_cmp_eq_u32 s4, 4
    s_cbranch_scc1 L_owna28
    buffer_store_dwordx4 v[152:155], v7, s[28:31], s20 offen sc1
L_owna28:
    v_accvgpr_read_b32 v56, a232
    v_accvgpr_read_b32 v57, a233
    v_accvgpr_read_b32 v58, a234
    v_accvgpr_read_b32 v59, a235
    v_accvgpr_read_b32 v60, a236
    v_accvgpr_read_b32 v61, a237
    v_accvgpr_read_b32 v62, a238
    v_accvgpr_read_b32 v63, a239
    v_cvt_pk_bf16_f32 v156, v56, v57
    v_cvt_pk_bf16_f32 v157, v58, v59
    v_cvt_pk_bf16_f32 v158, v60, v61
    v_cvt_pk_bf16_f32 v159, v62, v63
    s_cmp_eq_u32 s4, 5
    s_cbranch_scc1 L_owna29
    buffer_store_dwordx4 v[156:159], v7, s[28:31], s21 offen sc1
L_owna29:
L_tj:
    s_cmp_eq_u32 s4, 0
    s_cbranch_scc1 L_g0
    s_cmp_eq_u32 s4, 1
    s_cbranch_scc1 L_g1
    s_cmp_eq_u32 s4, 2
    s_cbranch_scc1 L_g2
    s_cmp_eq_u32 s4, 3
    s_cbranch_scc1 L_g3
    s_cmp_eq_u32 s4, 4
    s_cbranch_scc1 L_g4
    s_cmp_eq_u32 s4, 5
    s_cbranch_scc1 L_g5
    s_cmp_eq_u32 s4, 6
    s_cbranch_scc1 L_g6
    v_accvgpr_read_b32 v216, a56
    v_accvgpr_read_b32 v217, a57
    v_accvgpr_read_b32 v218, a58
    v_accvgpr_read_b32 v219, a59
    v_accvgpr_read_b32 v220, a60
    v_accvgpr_read_b32 v221, a61
    v_accvgpr_read_b32 v222, a62
    v_accvgpr_read_b32 v223, a63
    v_accvgpr_read_b32 v224, a120
    v_accvgpr_read_b32 v225, a121
    v_accvgpr_read_b32 v226, a122
    v_accvgpr_read_b32 v227, a123
    v_accvgpr_read_b32 v228, a124
    v_accvgpr_read_b32 v229, a125
    v_accvgpr_read_b32 v230, a126
    v_accvgpr_read_b32 v231, a127
    v_accvgpr_read_b32 v232, a184
    v_accvgpr_read_b32 v233, a185
    v_accvgpr_read_b32 v234, a186
    v_accvgpr_read_b32 v235, a187
    v_accvgpr_read_b32 v236, a188
    v_accvgpr_read_b32 v237, a189
    v_accvgpr_read_b32 v238, a190
    v_accvgpr_read_b32 v239, a191
    s_branch L_gj
L_g0:
    v_accvgpr_read_b32 v216, a0
    v_accvgpr_read_b32 v217, a1
    v_accvgpr_read_b32 v218, a2
    v_accvgpr_read_b32 v219, a3
    v_accvgpr_read_b32 v220, a4
    v_accvgpr_read_b32 v221, a5
    v_accvgpr_read_b32 v222, a6
    v_accvgpr_read_b32 v223, a7
    v_accvgpr_read_b32 v224, a64
    v_accvgpr_read_b32 v225, a65
    v_accvgpr_read_b32 v226, a66
    v_accvgpr_read_b32 v227, a67
    v_accvgpr_read_b32 v228, a68
    v_accvgpr_read_b32 v229, a69
    v_accvgpr_read_b32 v230, a70
    v_accvgpr_read_b32 v231, a71
    v_accvgpr_read_b32 v232, a128
    v_accvgpr_read_b32 v233, a129
    v_accvgpr_read_b32 v234, a130
    v_accvgpr_read_b32 v235, a131
    v_accvgpr_read_b32 v236, a132
    v_accvgpr_read_b32 v237, a133
    v_accvgpr_read_b32 v238, a134
    v_accvgpr_read_b32 v239, a135
    v_accvgpr_read_b32 v240, a192
    v_accvgpr_read_b32 v241, a193
    v_accvgpr_read_b32 v242, a194
    v_accvgpr_read_b32 v243, a195
    v_accvgpr_read_b32 v244, a196
    v_accvgpr_read_b32 v245, a197
    v_accvgpr_read_b32 v246, a198
    v_accvgpr_read_b32 v247, a199
    s_branch L_gj
L_g1:
    v_accvgpr_read_b32 v216, a8
    v_accvgpr_read_b32 v217, a9
    v_accvgpr_read_b32 v218, a10
    v_accvgpr_read_b32 v219, a11
    v_accvgpr_read_b32 v220, a12
    v_accvgpr_read_b32 v221, a13
    v_accvgpr_read_b32 v222, a14
    v_accvgpr_read_b32 v223, a15
    v_accvgpr_read_b32 v224, a72
    v_accvgpr_read_b32 v225, a73
    v_accvgpr_read_b32 v226, a74
    v_accvgpr_read_b32 v227, a75
    v_accvgpr_read_b32 v228, a76
    v_accvgpr_read_b32 v229, a77
    v_accvgpr_read_b32 v230, a78
    v_accvgpr_read_b32 v231, a79
    v_accvgpr_read_b32 v232, a136
    v_accvgpr_read_b32 v233, a137
    v_accvgpr_read_b32 v234, a138
    v_accvgpr_read_b32 v235, a139
    v_accvgpr_read_b32 v236, a140
    v_accvgpr_read_b32 v237, a141
    v_accvgpr_read_b32 v238, a142
    v_accvgpr_read_b32 v239, a143
    v_accvgpr_read_b32 v240, a200
    v_accvgpr_read_b32 v241, a201
    v_accvgpr_read_b32 v242, a202
    v_accvgpr_read_b32 v243, a203
    v_accvgpr_read_b32 v244, a204
    v_accvgpr_read_b32 v245, a205
    v_accvgpr_read_b32 v246, a206
    v_accvgpr_read_b32 v247, a207
    s_branch L_gj
L_g2:
    v_accvgpr_read_b32 v216, a16
    v_accvgpr_read_b32 v217, a17
    v_accvgpr_read_b32 v218, a18
    v_accvgpr_read_b32 v219, a19
    v_accvgpr_read_b32 v220, a20
    v_accvgpr_read_b32 v221, a21
    v_accvgpr_read_b32 v222, a22
    v_accvgpr_read_b32 v223, a23
    v_accvgpr_read_b32 v224, a80
    v_accvgpr_read_b32 v225, a81
    v_accvgpr_read_b32 v226, a82
    v_accvgpr_read_b32 v227, a83
    v_accvgpr_read_b32 v228, a84
    v_accvgpr_read_b32 v229, a85
    v_accvgpr_read_b32 v230, a86
    v_accvgpr_read_b32 v231, a87
    v_accvgpr_read_b32 v232, a144
    v_accvgpr_read_b32 v233, a145
    v_accvgpr_read_b32 v234, a146
    v_accvgpr_read_b32 v235, a147
    v_accvgpr_read_b32 v236, a148
    v_accvgpr_read_b32 v237, a149
    v_accvgpr_read_b32 v238, a150
    v_accvgpr_read_b32 v239, a151
    v_accvgpr_read_b32 v240, a208
    v_accvgpr_read_b32 v241, a209
    v_accvgpr_read_b32 v242, a210
    v_accvgpr_read_b32 v243, a211
    v_accvgpr_read_b32 v244, a212
    v_accvgpr_read_b32 v245, a213
    v_accvgpr_read_b32 v246, a214
    v_accvgpr_read_b32 v247, a215
    s_branch L_gj
L_g3:
    v_accvgpr_read_b32 v216, a24
    v_accvgpr_read_b32 v217, a25
    v_accvgpr_read_b32 v218, a26
    v_accvgpr_read_b32 v219, a27
    v_accvgpr_read_b32 v220, a28
    v_accvgpr_read_b32 v221, a29
    v_accvgpr_read_b32 v222, a30
    v_accvgpr_read_b32 v223, a31
    v_accvgpr_read_b32 v224, a88
    v_accvgpr_read_b32 v225, a89
    v_accvgpr_read_b32 v226, a90
    v_accvgpr_read_b32 v227, a91
    v_accvgpr_read_b32 v228, a92
    v_accvgpr_read_b32 v229, a93
    v_accvgpr_read_b32 v230, a94
    v_accvgpr_read_b32 v231, a95
    v_accvgpr_read_b32 v232, a152
    v_accvgpr_read_b32 v233, a153
    v_accvgpr_read_b32 v234, a154
    v_accvgpr_read_b32 v235, a155
    v_accvgpr_read_b32 v236, a156
    v_accvgpr_read_b32 v237, a157
    v_accvgpr_read_b32 v238, a158
    v_accvgpr_read_b32 v239, a159
    v_accvgpr_read_b32 v240, a216
    v_accvgpr_read_b32 v241, a217
    v_accvgpr_read_b32 v242, a218
    v_accvgpr_read_b32 v243, a219
    v_accvgpr_read_b32 v244, a220
    v_accvgpr_read_b32 v245, a221
    v_accvgpr_read_b32 v246, a222
    v_accvgpr_read_b32 v247, a223
    s_branch L_gj
L_g4:
    v_accvgpr_read_b32 v216, a32
    v_accvgpr_read_b32 v217, a33
    v_accvgpr_read_b32 v218, a34
    v_accvgpr_read_b32 v219, a35
    v_accvgpr_read_b32 v220, a36
    v_accvgpr_read_b32 v221, a37
    v_accvgpr_read_b32 v222, a38
    v_accvgpr_read_b32 v223, a39
    v_accvgpr_read_b32 v224, a96
    v_accvgpr_read_b32 v225, a97
    v_accvgpr_read_b32 v226, a98
    v_accvgpr_read_b32 v227, a99
    v_accvgpr_read_b32 v228, a100
    v_accvgpr_read_b32 v229, a101
    v_accvgpr_read_b32 v230, a102
    v_accvgpr_read_b32 v231, a103
    v_accvgpr_read_b32 v232, a160
    v_accvgpr_read_b32 v233, a161
    v_accvgpr_read_b32 v234, a162
    v_accvgpr_read_b32 v235, a163
    v_accvgpr_read_b32 v236, a164
    v_accvgpr_read_b32 v237, a165
    v_accvgpr_read_b32 v238, a166
    v_accvgpr_read_b32 v239, a167
    v_accvgpr_read_b32 v240, a224
    v_accvgpr_read_b32 v241, a225
    v_accvgpr_read_b32 v242, a226
    v_accvgpr_read_b32 v243, a227
    v_accvgpr_read_b32 v244, a228
    v_accvgpr_read_b32 v245, a229
    v_accvgpr_read_b32 v246, a230
    v_accvgpr_read_b32 v247, a231
    s_branch L_gj
L_g5:
    v_accvgpr_read_b32 v216, a40
    v_accvgpr_read_b32 v217, a41
    v_accvgpr_read_b32 v218, a42
    v_accvgpr_read_b32 v219, a43
    v_accvgpr_read_b32 v220, a44
    v_accvgpr_read_b32 v221, a45
    v_accvgpr_read_b32 v222, a46
    v_accvgpr_read_b32 v223, a47
    v_accvgpr_read_b32 v224, a104
    v_accvgpr_read_b32 v225, a105
    v_accvgpr_read_b32 v226, a106
    v_accvgpr_read_b32 v227, a107
    v_accvgpr_read_b32 v228, a108
    v_accvgpr_read_b32 v229, a109
    v_accvgpr_read_b32 v230, a110
    v_accvgpr_read_b32 v231, a111
    v_accvgpr_read_b32 v232, a168
    v_accvgpr_read_b32 v233, a169
    v_accvgpr_read_b32 v234, a170
    v_accvgpr_read_b32 v235, a171
    v_accvgpr_read_b32 v236, a172
    v_accvgpr_read_b32 v237, a173
    v_accvgpr_read_b32 v238, a174
    v_accvgpr_read_b32 v239, a175
    v_accvgpr_read_b32 v240, a232
    v_accvgpr_read_b32 v241, a233
    v_accvgpr_read_b32 v242, a234
    v_accvgpr_read_b32 v243, a235
    v_accvgpr_read_b32 v244, a236
    v_accvgpr_read_b32 v245, a237
    v_accvgpr_read_b32 v246, a238
    v_accvgpr_read_b32 v247, a239
    s_branch L_gj
L_g6:
    v_accvgpr_read_b32 v216, a48
    v_accvgpr_read_b32 v217, a49
    v_accvgpr_read_b32 v218, a50
    v_accvgpr_read_b32 v219, a51
    v_accvgpr_read_b32 v220, a52
    v_accvgpr_read_b32 v221, a53
    v_accvgpr_read_b32 v222, a54
    v_accvgpr_read_b32 v223, a55
    v_accvgpr_read_b32 v224, a112
    v_accvgpr_read_b32 v225, a113
    v_accvgpr_read_b32 v226, a114
    v_accvgpr_read_b32 v227, a115
    v_accvgpr_read_b32 v228, a116
    v_accvgpr_read_b32 v229, a117
    v_accvgpr_read_b32 v230, a118
    v_accvgpr_read_b32 v231, a119
    v_accvgpr_read_b32 v232, a176
    v_accvgpr_read_b32 v233, a177
    v_accvgpr_read_b32 v234, a178
    v_accvgpr_read_b32 v235, a179
    v_accvgpr_read_b32 v236, a180
    v_accvgpr_read_b32 v237, a181
    v_accvgpr_read_b32 v238, a182
    v_accvgpr_read_b32 v239, a183
L_gj:
    s_cmp_lg_u32 s60, 0
    s_cbranch_scc1 L_tagok
    v_mov_b32 v14, s33
L_tagpoll:
    global_load_dwordx2 v[12:13], v14, s[58:59] sc1
    s_waitcnt vmcnt(0)
    v_readfirstlane_b32 s60, v12
    v_readfirstlane_b32 s61, v13
    s_sub_u32 s82, s82, 1
    s_cbranch_scc1 L_tagok
    s_cmp_eq_u32 s60, 0
    s_cbranch_scc1 L_tagpoll
L_tagok:
    v_mov_b32 v12, s60
    v_mov_b32 v13, s61
    s_mov_b32 s58, 3932160
    s_mov_b32 s59, 0x20000
    s_mov_b64 exec, 1
    s_waitcnt vmcnt(0)
    buffer_store_dwordx2 v[12:13], off, s[28:31], s50 sc1
    s_mov_b64 exec, -1
L_chk:
    buffer_load_dwordx2 v[14:15], v1, s[28:31], s51 offen sc1
    s_waitcnt vmcnt(0)
    v_cmp_eq_u64 vcc, v[14:15], s[60:61]
    s_sub_u32 s82, s82, 1
    s_cbranch_scc1 L_ok
    s_or_b64 vcc, vcc, s[52:53]
    s_cmp_eq_u64 vcc, -1
    s_cbranch_scc0 L_chk
L_ok:
    s_cmp_ge_u32 s4, 6
    s_cbranch_scc1 L_l3
    buffer_load_dwordx4 v[188:191], v7, s[28:31], s66 offen sc1
    buffer_load_dwordx4 v[192:195], v7, s[28:31], s67 offen sc1
    buffer_load_dwordx4 v[196:199], v7, s[28:31], s68 offen sc1
    buffer_load_dwordx4 v[200:203], v7, s[28:31], s69 offen sc1
    buffer_load_dwordx4 v[204:207], v7, s[28:31], s70 offen sc1
    buffer_load_dwordx4 v[208:211], v7, s[28:31], s71 offen sc1
    buffer_load_dwordx4 v[212:215], v7, s[28:31], s72 offen sc1
L_l3:
    buffer_load_dwordx4 v[64:67], v0, s[28:31], s66 offen sc1
    buffer_load_dwordx4 v[68:71], v0, s[28:31], s67 offen sc1
    buffer_load_dwordx4 v[72:75], v0, s[28:31], s68 offen sc1
    buffer_load_dwordx4 v[76:79], v0, s[28:31], s69 offen sc1
    buffer_load_dwordx4 v[80:83], v0, s[28:31], s70 offen sc1
    buffer_load_dwordx4 v[84:87], v0, s[28:31], s71 offen sc1
    buffer_load_dwordx4 v[88:91], v0, s[28:31], s72 offen sc1
    buffer_load_dwordx4 v[92:95], v5, s[28:31], s66 offen sc1
    buffer_load_dwordx4 v[96:99], v5, s[28:31], s67 offen sc1
    buffer_load_dwordx4 v[100:103], v5, s[28:31], s68 offen sc1
    buffer_load_dwordx4 v[104:107], v5, s[28:31], s69 offen sc1
    buffer_load_dwordx4 v[108:111], v5, s[28:31], s70 offen sc1
    buffer_load_dwordx4 v[112:115], v5, s[28:31], s71 offen sc1
    buffer_load_dwordx4 v[116:119], v5, s[28:31], s72 offen sc1
    buffer_load_dwordx4 v[160:163], v6, s[28:31], s66 offen sc1
    buffer_load_dwordx4 v[164:167], v6, s[28:31], s67 offen sc1
    buffer_load_dwordx4 v[168:171], v6, s[28:31], s68 offen sc1
    buffer_load_dwordx4 v[172:175], v6, s[28:31], s69 offen sc1
    buffer_load_dwordx4 v[176:179], v6, s[28:31], s70 offen sc1
    buffer_load_dwordx4 v[180:183], v6, s[28:31], s71 offen sc1
    buffer_load_dwordx4 v[184:187], v6, s[28:31], s72 offen sc1
    s_cbranch_scc1 L_r3
    s_waitcnt vmcnt(27)
    v_lshlrev_b32 v60, 16, v188
    v_and_b32 v61, 0xffff0000, v188
    v_pk_add_f32 v[240:241], v[240:241], v[60:61]
    v_lshlrev_b32 v62, 16, v189
    v_and_b32 v63, 0xffff0000, v189
    v_pk_add_f32 v[242:243], v[242:243], v[62:63]
    v_lshlrev_b32 v60, 16, v190
    v_and_b32 v61, 0xffff0000, v190
    v_pk_add_f32 v[244:245], v[244:245], v[60:61]
    v_lshlrev_b32 v62, 16, v191
    v_and_b32 v63, 0xffff0000, v191
    v_pk_add_f32 v[246:247], v[246:247], v[62:63]
    s_waitcnt vmcnt(26)
    v_lshlrev_b32 v60, 16, v192
    v_and_b32 v61, 0xffff0000, v192
    v_pk_add_f32 v[240:241], v[240:241], v[60:61]
    v_lshlrev_b32 v62, 16, v193
    v_and_b32 v63, 0xffff0000, v193
    v_pk_add_f32 v[242:243], v[242:243], v[62:63]
    v_lshlrev_b32 v60, 16, v194
    v_and_b32 v61, 0xffff0000, v194
    v_pk_add_f32 v[244:245], v[244:245], v[60:61]
    v_lshlrev_b32 v62, 16, v195
    v_and_b32 v63, 0xffff0000, v195
    v_pk_add_f32 v[246:247], v[246:247], v[62:63]
    s_waitcnt vmcnt(25)
    v_lshlrev_b32 v60, 16, v196
    v_and_b32 v61, 0xffff0000, v196
    v_pk_add_f32 v[240:241], v[240:241], v[60:61]
    v_lshlrev_b32 v62, 16, v197
    v_and_b32 v63, 0xffff0000, v197
    v_pk_add_f32 v[242:243], v[242:243], v[62:63]
    v_lshlrev_b32 v60, 16, v198
    v_and_b32 v61, 0xffff0000, v198
    v_pk_add_f32 v[244:245], v[244:245], v[60:61]
    v_lshlrev_b32 v62, 16, v199
    v_and_b32 v63, 0xffff0000, v199
    v_pk_add_f32 v[246:247], v[246:247], v[62:63]
    s_waitcnt vmcnt(24)
    v_lshlrev_b32 v60, 16, v200
    v_and_b32 v61, 0xffff0000, v200
    v_pk_add_f32 v[240:241], v[240:241], v[60:61]
    v_lshlrev_b32 v62, 16, v201
    v_and_b32 v63, 0xffff0000, v201
    v_pk_add_f32 v[242:243], v[242:243], v[62:63]
    v_lshlrev_b32 v60, 16, v202
    v_and_b32 v61, 0xffff0000, v202
    v_pk_add_f32 v[244:245], v[244:245], v[60:61]
    v_lshlrev_b32 v62, 16, v203
    v_and_b32 v63, 0xffff0000, v203
    v_pk_add_f32 v[246:247], v[246:247], v[62:63]
    s_waitcnt vmcnt(23)
    v_lshlrev_b32 v60, 16, v204
    v_and_b32 v61, 0xffff0000, v204
    v_pk_add_f32 v[240:241], v[240:241], v[60:61]
    v_lshlrev_b32 v62, 16, v205
    v_and_b32 v63, 0xffff0000, v205
    v_pk_add_f32 v[242:243], v[242:243], v[62:63]
    v_lshlrev_b32 v60, 16, v206
    v_and_b32 v61, 0xffff0000, v206
    v_pk_add_f32 v[244:245], v[244:245], v[60:61]
    v_lshlrev_b32 v62, 16, v207
    v_and_b32 v63, 0xffff0000, v207
    v_pk_add_f32 v[246:247], v[246:247], v[62:63]
    s_waitcnt vmcnt(22)
    v_lshlrev_b32 v60, 16, v208
    v_and_b32 v61, 0xffff0000, v208
    v_pk_add_f32 v[240:241], v[240:241], v[60:61]
    v_lshlrev_b32 v62, 16, v209
    v_and_b32 v63, 0xffff0000, v209
    v_pk_add_f32 v[242:243], v[242:243], v[62:63]
    v_lshlrev_b32 v60, 16, v210
    v_and_b32 v61, 0xffff0000, v210
    v_pk_add_f32 v[244:245], v[244:245], v[60:61]
    v_lshlrev_b32 v62, 16, v211
    v_and_b32 v63, 0xffff0000, v211
    v_pk_add_f32 v[246:247], v[246:247], v[62:63]
    s_waitcnt vmcnt(21)
    v_lshlrev_b32 v60, 16, v212
    v_and_b32 v61, 0xffff0000, v212
    v_pk_add_f32 v[240:241], v[240:241], v[60:61]
    v_lshlrev_b32 v62, 16, v213
    v_and_b32 v63, 0xffff0000, v213
    v_pk_add_f32 v[242:243], v[242:243], v[62:63]
    v_lshlrev_b32 v60, 16, v214
    v_and_b32 v61, 0xffff0000, v214
    v_pk_add_f32 v[244:245], v[244:245], v[60:61]
    v_lshlrev_b32 v62, 16, v215
    v_and_b32 v63, 0xffff0000, v215
    v_pk_add_f32 v[246:247], v[246:247], v[62:63]
    v_cvt_pk_bf16_f32 v188, v240, v241
    v_cvt_pk_bf16_f32 v189, v242, v243
    v_cvt_pk_bf16_f32 v190, v244, v245
    v_cvt_pk_bf16_f32 v191, v246, v247
    s_nop 0
    v_permlane32_swap_b32 v188, v190
    v_permlane32_swap_b32 v189, v191
    s_nop 0
    v_permlane16_swap_b32 v188, v190
    v_permlane16_swap_b32 v189, v191
    s_nop 1
    buffer_store_dwordx4 v[188:191], v2, s[56:59], s55 offen
L_r3:
    s_waitcnt vmcnt(20)
    v_lshlrev_b32 v60, 16, v64
    v_and_b32 v61, 0xffff0000, v64
    v_pk_add_f32 v[216:217], v[216:217], v[60:61]
    v_lshlrev_b32 v62, 16, v65
    v_and_b32 v63, 0xffff0000, v65
    v_pk_add_f32 v[218:219], v[218:219], v[62:63]
    v_lshlrev_b32 v60, 16, v66
    v_and_b32 v61, 0xffff0000, v66
    v_pk_add_f32 v[220:221], v[220:221], v[60:61]
    v_lshlrev_b32 v62, 16, v67
    v_and_b32 v63, 0xffff0000, v67
    v_pk_add_f32 v[222:223], v[222:223], v[62:63]
    s_waitcnt vmcnt(19)
    v_lshlrev_b32 v60, 16, v68
    v_and_b32 v61, 0xffff0000, v68
    v_pk_add_f32 v[216:217], v[216:217], v[60:61]
    v_lshlrev_b32 v62, 16, v69
    v_and_b32 v63, 0xffff0000, v69
    v_pk_add_f32 v[218:219], v[218:219], v[62:63]
    v_lshlrev_b32 v60, 16, v70
    v_and_b32 v61, 0xffff0000, v70
    v_pk_add_f32 v[220:221], v[220:221], v[60:61]
    v_lshlrev_b32 v62, 16, v71
    v_and_b32 v63, 0xffff0000, v71
    v_pk_add_f32 v[222:223], v[222:223], v[62:63]
    s_waitcnt vmcnt(18)
    v_lshlrev_b32 v60, 16, v72
    v_and_b32 v61, 0xffff0000, v72
    v_pk_add_f32 v[216:217], v[216:217], v[60:61]
    v_lshlrev_b32 v62, 16, v73
    v_and_b32 v63, 0xffff0000, v73
    v_pk_add_f32 v[218:219], v[218:219], v[62:63]
    v_lshlrev_b32 v60, 16, v74
    v_and_b32 v61, 0xffff0000, v74
    v_pk_add_f32 v[220:221], v[220:221], v[60:61]
    v_lshlrev_b32 v62, 16, v75
    v_and_b32 v63, 0xffff0000, v75
    v_pk_add_f32 v[222:223], v[222:223], v[62:63]
    s_waitcnt vmcnt(17)
    v_lshlrev_b32 v60, 16, v76
    v_and_b32 v61, 0xffff0000, v76
    v_pk_add_f32 v[216:217], v[216:217], v[60:61]
    v_lshlrev_b32 v62, 16, v77
    v_and_b32 v63, 0xffff0000, v77
    v_pk_add_f32 v[218:219], v[218:219], v[62:63]
    v_lshlrev_b32 v60, 16, v78
    v_and_b32 v61, 0xffff0000, v78
    v_pk_add_f32 v[220:221], v[220:221], v[60:61]
    v_lshlrev_b32 v62, 16, v79
    v_and_b32 v63, 0xffff0000, v79
    v_pk_add_f32 v[222:223], v[222:223], v[62:63]
    s_waitcnt vmcnt(16)
    v_lshlrev_b32 v60, 16, v80
    v_and_b32 v61, 0xffff0000, v80
    v_pk_add_f32 v[216:217], v[216:217], v[60:61]
    v_lshlrev_b32 v62, 16, v81
    v_and_b32 v63, 0xffff0000, v81
    v_pk_add_f32 v[218:219], v[218:219], v[62:63]
    v_lshlrev_b32 v60, 16, v82
    v_and_b32 v61, 0xffff0000, v82
    v_pk_add_f32 v[220:221], v[220:221], v[60:61]
    v_lshlrev_b32 v62, 16, v83
    v_and_b32 v63, 0xffff0000, v83
    v_pk_add_f32 v[222:223], v[222:223], v[62:63]
    s_waitcnt vmcnt(15)
    v_lshlrev_b32 v60, 16, v84
    v_and_b32 v61, 0xffff0000, v84
    v_pk_add_f32 v[216:217], v[216:217], v[60:61]
    v_lshlrev_b32 v62, 16, v85
    v_and_b32 v63, 0xffff0000, v85
    v_pk_add_f32 v[218:219], v[218:219], v[62:63]
    v_lshlrev_b32 v60, 16, v86
    v_and_b32 v61, 0xffff0000, v86
    v_pk_add_f32 v[220:221], v[220:221], v[60:61]
    v_lshlrev_b32 v62, 16, v87
    v_and_b32 v63, 0xffff0000, v87
    v_pk_add_f32 v[222:223], v[222:223], v[62:63]
    s_waitcnt vmcnt(14)
    v_lshlrev_b32 v60, 16, v88
    v_and_b32 v61, 0xffff0000, v88
    v_pk_add_f32 v[216:217], v[216:217], v[60:61]
    v_lshlrev_b32 v62, 16, v89
    v_and_b32 v63, 0xffff0000, v89
    v_pk_add_f32 v[218:219], v[218:219], v[62:63]
    v_lshlrev_b32 v60, 16, v90
    v_and_b32 v61, 0xffff0000, v90
    v_pk_add_f32 v[220:221], v[220:221], v[60:61]
    v_lshlrev_b32 v62, 16, v91
    v_and_b32 v63, 0xffff0000, v91
    v_pk_add_f32 v[222:223], v[222:223], v[62:63]
    v_cvt_pk_bf16_f32 v64, v216, v217
    v_cvt_pk_bf16_f32 v65, v218, v219
    v_cvt_pk_bf16_f32 v66, v220, v221
    v_cvt_pk_bf16_f32 v67, v222, v223
    s_nop 0
    v_permlane32_swap_b32 v64, v66
    v_permlane32_swap_b32 v65, v67
    s_nop 0
    v_permlane16_swap_b32 v64, v66
    v_permlane16_swap_b32 v65, v67
    s_nop 1
    buffer_store_dwordx4 v[64:67], v2, s[56:59], s73 offen
    s_waitcnt vmcnt(14)
    v_lshlrev_b32 v60, 16, v92
    v_and_b32 v61, 0xffff0000, v92
    v_pk_add_f32 v[224:225], v[224:225], v[60:61]
    v_lshlrev_b32 v62, 16, v93
    v_and_b32 v63, 0xffff0000, v93
    v_pk_add_f32 v[226:227], v[226:227], v[62:63]
    v_lshlrev_b32 v60, 16, v94
    v_and_b32 v61, 0xffff0000, v94
    v_pk_add_f32 v[228:229], v[228:229], v[60:61]
    v_lshlrev_b32 v62, 16, v95
    v_and_b32 v63, 0xffff0000, v95
    v_pk_add_f32 v[230:231], v[230:231], v[62:63]
    s_waitcnt vmcnt(13)
    v_lshlrev_b32 v60, 16, v96
    v_and_b32 v61, 0xffff0000, v96
    v_pk_add_f32 v[224:225], v[224:225], v[60:61]
    v_lshlrev_b32 v62, 16, v97
    v_and_b32 v63, 0xffff0000, v97
    v_pk_add_f32 v[226:227], v[226:227], v[62:63]
    v_lshlrev_b32 v60, 16, v98
    v_and_b32 v61, 0xffff0000, v98
    v_pk_add_f32 v[228:229], v[228:229], v[60:61]
    v_lshlrev_b32 v62, 16, v99
    v_and_b32 v63, 0xffff0000, v99
    v_pk_add_f32 v[230:231], v[230:231], v[62:63]
    s_waitcnt vmcnt(12)
    v_lshlrev_b32 v60, 16, v100
    v_and_b32 v61, 0xffff0000, v100
    v_pk_add_f32 v[224:225], v[224:225], v[60:61]
    v_lshlrev_b32 v62, 16, v101
    v_and_b32 v63, 0xffff0000, v101
    v_pk_add_f32 v[226:227], v[226:227], v[62:63]
    v_lshlrev_b32 v60, 16, v102
    v_and_b32 v61, 0xffff0000, v102
    v_pk_add_f32 v[228:229], v[228:229], v[60:61]
    v_lshlrev_b32 v62, 16, v103
    v_and_b32 v63, 0xffff0000, v103
    v_pk_add_f32 v[230:231], v[230:231], v[62:63]
    s_waitcnt vmcnt(11)
    v_lshlrev_b32 v60, 16, v104
    v_and_b32 v61, 0xffff0000, v104
    v_pk_add_f32 v[224:225], v[224:225], v[60:61]
    v_lshlrev_b32 v62, 16, v105
    v_and_b32 v63, 0xffff0000, v105
    v_pk_add_f32 v[226:227], v[226:227], v[62:63]
    v_lshlrev_b32 v60, 16, v106
    v_and_b32 v61, 0xffff0000, v106
    v_pk_add_f32 v[228:229], v[228:229], v[60:61]
    v_lshlrev_b32 v62, 16, v107
    v_and_b32 v63, 0xffff0000, v107
    v_pk_add_f32 v[230:231], v[230:231], v[62:63]
    s_waitcnt vmcnt(10)
    v_lshlrev_b32 v60, 16, v108
    v_and_b32 v61, 0xffff0000, v108
    v_pk_add_f32 v[224:225], v[224:225], v[60:61]
    v_lshlrev_b32 v62, 16, v109
    v_and_b32 v63, 0xffff0000, v109
    v_pk_add_f32 v[226:227], v[226:227], v[62:63]
    v_lshlrev_b32 v60, 16, v110
    v_and_b32 v61, 0xffff0000, v110
    v_pk_add_f32 v[228:229], v[228:229], v[60:61]
    v_lshlrev_b32 v62, 16, v111
    v_and_b32 v63, 0xffff0000, v111
    v_pk_add_f32 v[230:231], v[230:231], v[62:63]
    s_waitcnt vmcnt(9)
    v_lshlrev_b32 v60, 16, v112
    v_and_b32 v61, 0xffff0000, v112
    v_pk_add_f32 v[224:225], v[224:225], v[60:61]
    v_lshlrev_b32 v62, 16, v113
    v_and_b32 v63, 0xffff0000, v113
    v_pk_add_f32 v[226:227], v[226:227], v[62:63]
    v_lshlrev_b32 v60, 16, v114
    v_and_b32 v61, 0xffff0000, v114
    v_pk_add_f32 v[228:229], v[228:229], v[60:61]
    v_lshlrev_b32 v62, 16, v115
    v_and_b32 v63, 0xffff0000, v115
    v_pk_add_f32 v[230:231], v[230:231], v[62:63]
    s_waitcnt vmcnt(8)
    v_lshlrev_b32 v60, 16, v116
    v_and_b32 v61, 0xffff0000, v116
    v_pk_add_f32 v[224:225], v[224:225], v[60:61]
    v_lshlrev_b32 v62, 16, v117
    v_and_b32 v63, 0xffff0000, v117
    v_pk_add_f32 v[226:227], v[226:227], v[62:63]
    v_lshlrev_b32 v60, 16, v118
    v_and_b32 v61, 0xffff0000, v118
    v_pk_add_f32 v[228:229], v[228:229], v[60:61]
    v_lshlrev_b32 v62, 16, v119
    v_and_b32 v63, 0xffff0000, v119
    v_pk_add_f32 v[230:231], v[230:231], v[62:63]
    v_cvt_pk_bf16_f32 v92, v224, v225
    v_cvt_pk_bf16_f32 v93, v226, v227
    v_cvt_pk_bf16_f32 v94, v228, v229
    v_cvt_pk_bf16_f32 v95, v230, v231
    s_nop 0
    v_permlane32_swap_b32 v92, v94
    v_permlane32_swap_b32 v93, v95
    s_nop 0
    v_permlane16_swap_b32 v92, v94
    v_permlane16_swap_b32 v93, v95
    s_nop 1
    buffer_store_dwordx4 v[92:95], v2, s[56:59], s74 offen
    s_waitcnt vmcnt(8)
    v_lshlrev_b32 v60, 16, v160
    v_and_b32 v61, 0xffff0000, v160
    v_pk_add_f32 v[232:233], v[232:233], v[60:61]
    v_lshlrev_b32 v62, 16, v161
    v_and_b32 v63, 0xffff0000, v161
    v_pk_add_f32 v[234:235], v[234:235], v[62:63]
    v_lshlrev_b32 v60, 16, v162
    v_and_b32 v61, 0xffff0000, v162
    v_pk_add_f32 v[236:237], v[236:237], v[60:61]
    v_lshlrev_b32 v62, 16, v163
    v_and_b32 v63, 0xffff0000, v163
    v_pk_add_f32 v[238:239], v[238:239], v[62:63]
    s_waitcnt vmcnt(7)
    v_lshlrev_b32 v60, 16, v164
    v_and_b32 v61, 0xffff0000, v164
    v_pk_add_f32 v[232:233], v[232:233], v[60:61]
    v_lshlrev_b32 v62, 16, v165
    v_and_b32 v63, 0xffff0000, v165
    v_pk_add_f32 v[234:235], v[234:235], v[62:63]
    v_lshlrev_b32 v60, 16, v166
    v_and_b32 v61, 0xffff0000, v166
    v_pk_add_f32 v[236:237], v[236:237], v[60:61]
    v_lshlrev_b32 v62, 16, v167
    v_and_b32 v63, 0xffff0000, v167
    v_pk_add_f32 v[238:239], v[238:239], v[62:63]
    s_waitcnt vmcnt(6)
    v_lshlrev_b32 v60, 16, v168
    v_and_b32 v61, 0xffff0000, v168
    v_pk_add_f32 v[232:233], v[232:233], v[60:61]
    v_lshlrev_b32 v62, 16, v169
    v_and_b32 v63, 0xffff0000, v169
    v_pk_add_f32 v[234:235], v[234:235], v[62:63]
    v_lshlrev_b32 v60, 16, v170
    v_and_b32 v61, 0xffff0000, v170
    v_pk_add_f32 v[236:237], v[236:237], v[60:61]
    v_lshlrev_b32 v62, 16, v171
    v_and_b32 v63, 0xffff0000, v171
    v_pk_add_f32 v[238:239], v[238:239], v[62:63]
    s_waitcnt vmcnt(5)
    v_lshlrev_b32 v60, 16, v172
    v_and_b32 v61, 0xffff0000, v172
    v_pk_add_f32 v[232:233], v[232:233], v[60:61]
    v_lshlrev_b32 v62, 16, v173
    v_and_b32 v63, 0xffff0000, v173
    v_pk_add_f32 v[234:235], v[234:235], v[62:63]
    v_lshlrev_b32 v60, 16, v174
    v_and_b32 v61, 0xffff0000, v174
    v_pk_add_f32 v[236:237], v[236:237], v[60:61]
    v_lshlrev_b32 v62, 16, v175
    v_and_b32 v63, 0xffff0000, v175
    v_pk_add_f32 v[238:239], v[238:239], v[62:63]
    s_waitcnt vmcnt(4)
    v_lshlrev_b32 v60, 16, v176
    v_and_b32 v61, 0xffff0000, v176
    v_pk_add_f32 v[232:233], v[232:233], v[60:61]
    v_lshlrev_b32 v62, 16, v177
    v_and_b32 v63, 0xffff0000, v177
    v_pk_add_f32 v[234:235], v[234:235], v[62:63]
    v_lshlrev_b32 v60, 16, v178
    v_and_b32 v61, 0xffff0000, v178
    v_pk_add_f32 v[236:237], v[236:237], v[60:61]
    v_lshlrev_b32 v62, 16, v179
    v_and_b32 v63, 0xffff0000, v179
    v_pk_add_f32 v[238:239], v[238:239], v[62:63]
    s_waitcnt vmcnt(3)
    v_lshlrev_b32 v60, 16, v180
    v_and_b32 v61, 0xffff0000, v180
    v_pk_add_f32 v[232:233], v[232:233], v[60:61]
    v_lshlrev_b32 v62, 16, v181
    v_and_b32 v63, 0xffff0000, v181
    v_pk_add_f32 v[234:235], v[234:235], v[62:63]
    v_lshlrev_b32 v60, 16, v182
    v_and_b32 v61, 0xffff0000, v182
    v_pk_add_f32 v[236:237], v[236:237], v[60:61]
    v_lshlrev_b32 v62, 16, v183
    v_and_b32 v63, 0xffff0000, v183
    v_pk_add_f32 v[238:239], v[238:239], v[62:63]
    s_waitcnt vmcnt(2)
    v_lshlrev_b32 v60, 16, v184
    v_and_b32 v61, 0xffff0000, v184
    v_pk_add_f32 v[232:233], v[232:233], v[60:61]
    v_lshlrev_b32 v62, 16, v185
    v_and_b32 v63, 0xffff0000, v185
    v_pk_add_f32 v[234:235], v[234:235], v[62:63]
    v_lshlrev_b32 v60, 16, v186
    v_and_b32 v61, 0xffff0000, v186
    v_pk_add_f32 v[236:237], v[236:237], v[60:61]
    v_lshlrev_b32 v62, 16, v187
    v_and_b32 v63, 0xffff0000, v187
    v_pk_add_f32 v[238:239], v[238:239], v[62:63]
    v_cvt_pk_bf16_f32 v160, v232, v233
    v_cvt_pk_bf16_f32 v161, v234, v235
    v_cvt_pk_bf16_f32 v162, v236, v237
    v_cvt_pk_bf16_f32 v163, v238, v239
    s_nop 0
    v_permlane32_swap_b32 v160, v162
    v_permlane32_swap_b32 v161, v163
    s_nop 0
    v_permlane16_swap_b32 v160, v162
    v_permlane16_swap_b32 v161, v163
    s_nop 1
    buffer_store_dwordx4 v[160:163], v2, s[56:59], s7 offen
L_done:
L_exit:
    s_endpgm
L_rs_a0:
    s_nop 7
    s_nop 7
    v_max3_f32 v186, v96, v97, v98
    v_max3_f32 v187, v104, v105, v106
    v_max3_f32 v186, v186, v99, v100
    v_max3_f32 v187, v187, v107, v108
    v_max3_f32 v186, v186, v101, v102
    v_max3_f32 v187, v187, v109, v110
    v_max_f32 v186, v186, v103
    v_max_f32 v187, v187, v111
    s_nop 1
    v_permlane32_swap_b32 v186, v187
    v_max_f32 v187, v186, v187
    v_mov_b32 v191, v187
    s_nop 1
    v_permlane16_swap_b32 v191, v187
    v_max_f32 v187, v191, v187
    v_add_f32 v187, 0x41800000, v187
    v_max_f32 v187, 0, v187
    v_mov_b32 v186, v187
    s_nop 1
    v_permlane32_swap_b32 v186, v187
    v_exp_f32 v184, -v186
    v_exp_f32 v185, -v187
    v_mul_f32 v8, v8, v184
    v_mul_f32 v9, v9, v184
    v_mul_f32 v10, v10, v184
    v_mul_f32 v11, v11, v184
    v_mul_f32 v192, v192, v184
    v_mul_f32 v193, v193, v184
    v_mul_f32 v194, v194, v184
    v_mul_f32 v195, v195, v184
    v_mul_f32 v196, v196, v184
    v_mul_f32 v197, v197, v184
    v_mul_f32 v198, v198, v184
    v_mul_f32 v199, v199, v184
    v_mul_f32 v200, v200, v184
    v_mul_f32 v201, v201, v184
    v_mul_f32 v202, v202, v184
    v_mul_f32 v203, v203, v184
    v_mul_f32 v204, v204, v184
    v_mul_f32 v205, v205, v184
    v_mul_f32 v206, v206, v184
    v_mul_f32 v207, v207, v184
    v_mul_f32 v208, v208, v184
    v_mul_f32 v209, v209, v184
    v_mul_f32 v210, v210, v184
    v_mul_f32 v211, v211, v184
    v_mul_f32 v212, v212, v184
    v_mul_f32 v213, v213, v184
    v_mul_f32 v214, v214, v184
    v_mul_f32 v215, v215, v184
    v_mul_f32 v216, v216, v184
    v_mul_f32 v217, v217, v184
    v_mul_f32 v218, v218, v184
    v_mul_f32 v219, v219, v184
    v_mul_f32 v220, v220, v184
    v_mul_f32 v221, v221, v184
    v_mul_f32 v222, v222, v184
    v_mul_f32 v223, v223, v184
    v_sub_f32 v96, v96, v186
    v_sub_f32 v97, v97, v186
    v_sub_f32 v98, v98, v186
    v_sub_f32 v99, v99, v186
    v_sub_f32 v100, v100, v186
    v_sub_f32 v101, v101, v186
    v_sub_f32 v102, v102, v186
    v_sub_f32 v103, v103, v186
    v_sub_f32 v112, v112, v186
    v_sub_f32 v113, v113, v186
    v_sub_f32 v114, v114, v186
    v_sub_f32 v115, v115, v186
    v_sub_f32 v116, v116, v186
    v_sub_f32 v117, v117, v186
    v_sub_f32 v118, v118, v186
    v_sub_f32 v119, v119, v186
    v_sub_f32 v176, v176, v186
    v_sub_f32 v177, v177, v186
    v_sub_f32 v178, v178, v186
    v_sub_f32 v179, v179, v186
    v_mul_f32 v12, v12, v185
    v_mul_f32 v13, v13, v185
    v_mul_f32 v14, v14, v185
    v_mul_f32 v15, v15, v185
    v_mul_f32 v224, v224, v185
    v_mul_f32 v225, v225, v185
    v_mul_f32 v226, v226, v185
    v_mul_f32 v227, v227, v185
    v_mul_f32 v228, v228, v185
    v_mul_f32 v229, v229, v185
    v_mul_f32 v230, v230, v185
    v_mul_f32 v231, v231, v185
    v_mul_f32 v232, v232, v185
    v_mul_f32 v233, v233, v185
    v_mul_f32 v234, v234, v185
    v_mul_f32 v235, v235, v185
    v_mul_f32 v236, v236, v185
    v_mul_f32 v237, v237, v185
    v_mul_f32 v238, v238, v185
    v_mul_f32 v239, v239, v185
    v_mul_f32 v240, v240, v185
    v_mul_f32 v241, v241, v185
    v_mul_f32 v242, v242, v185
    v_mul_f32 v243, v243, v185
    v_mul_f32 v244, v244, v185
    v_mul_f32 v245, v245, v185
    v_mul_f32 v246, v246, v185
    v_mul_f32 v247, v247, v185
    v_mul_f32 v248, v248, v185
    v_mul_f32 v249, v249, v185
    v_mul_f32 v250, v250, v185
    v_mul_f32 v251, v251, v185
    v_mul_f32 v252, v252, v185
    v_mul_f32 v253, v253, v185
    v_mul_f32 v254, v254, v185
    v_mul_f32 v255, v255, v185
    v_sub_f32 v104, v104, v187
    v_sub_f32 v105, v105, v187
    v_sub_f32 v106, v106, v187
    v_sub_f32 v107, v107, v187
    v_sub_f32 v108, v108, v187
    v_sub_f32 v109, v109, v187
    v_sub_f32 v110, v110, v187
    v_sub_f32 v111, v111, v187
    v_sub_f32 v120, v120, v187
    v_sub_f32 v121, v121, v187
    v_sub_f32 v122, v122, v187
    v_sub_f32 v123, v123, v187
    v_sub_f32 v124, v124, v187
    v_sub_f32 v125, v125, v187
    v_sub_f32 v126, v126, v187
    v_sub_f32 v127, v127, v187
    v_sub_f32 v180, v180, v187
    v_sub_f32 v181, v181, v187
    v_sub_f32 v182, v182, v187
    v_sub_f32 v183, v183, v187
    v_exp_f32 v160, v96
    v_exp_f32 v161, v97
    v_exp_f32 v162, v98
    v_exp_f32 v163, v99
    v_exp_f32 v164, v100
    v_exp_f32 v165, v101
    v_exp_f32 v166, v102
    v_exp_f32 v167, v103
    v_exp_f32 v168, v104
    v_exp_f32 v169, v105
    v_exp_f32 v170, v106
    v_exp_f32 v171, v107
    v_exp_f32 v172, v108
    v_exp_f32 v173, v109
    v_exp_f32 v174, v110
    v_exp_f32 v175, v111
    v_cvt_pk_bf16_f32 v40, v160, v161
    v_cvt_pk_bf16_f32 v41, v162, v163
    v_cvt_pk_bf16_f32 v42, v164, v165
    v_cvt_pk_bf16_f32 v43, v166, v167
    v_cvt_pk_bf16_f32 v44, v168, v169
    v_cvt_pk_bf16_f32 v45, v170, v171
    v_cvt_pk_bf16_f32 v46, v172, v173
    v_cvt_pk_bf16_f32 v47, v174, v175
    s_nop 1
    s_branch L_rr_a0
L_rs_a1:
    s_nop 7
    s_nop 7
    v_max3_f32 v186, v112, v113, v114
    v_max3_f32 v187, v120, v121, v122
    v_max3_f32 v186, v186, v115, v116
    v_max3_f32 v187, v187, v123, v124
    v_max3_f32 v186, v186, v117, v118
    v_max3_f32 v187, v187, v125, v126
    v_max_f32 v186, v186, v119
    v_max_f32 v187, v187, v127
    s_nop 1
    v_permlane32_swap_b32 v186, v187
    v_max_f32 v187, v186, v187
    v_mov_b32 v191, v187
    s_nop 1
    v_permlane16_swap_b32 v191, v187
    v_max_f32 v187, v191, v187
    v_add_f32 v187, 0x41800000, v187
    v_max_f32 v187, 0, v187
    v_mov_b32 v186, v187
    s_nop 1
    v_permlane32_swap_b32 v186, v187
    v_exp_f32 v184, -v186
    v_exp_f32 v185, -v187
    v_mul_f32 v8, v8, v184
    v_mul_f32 v9, v9, v184
    v_mul_f32 v10, v10, v184
    v_mul_f32 v11, v11, v184
    v_mul_f32 v192, v192, v184
    v_mul_f32 v193, v193, v184
    v_mul_f32 v194, v194, v184
    v_mul_f32 v195, v195, v184
    v_mul_f32 v196, v196, v184
    v_mul_f32 v197, v197, v184
    v_mul_f32 v198, v198, v184
    v_mul_f32 v199, v199, v184
    v_mul_f32 v200, v200, v184
    v_mul_f32 v201, v201, v184
    v_mul_f32 v202, v202, v184
    v_mul_f32 v203, v203, v184
    v_mul_f32 v204, v204, v184
    v_mul_f32 v205, v205, v184
    v_mul_f32 v206, v206, v184
    v_mul_f32 v207, v207, v184
    v_mul_f32 v208, v208, v184
    v_mul_f32 v209, v209, v184
    v_mul_f32 v210, v210, v184
    v_mul_f32 v211, v211, v184
    v_mul_f32 v212, v212, v184
    v_mul_f32 v213, v213, v184
    v_mul_f32 v214, v214, v184
    v_mul_f32 v215, v215, v184
    v_mul_f32 v216, v216, v184
    v_mul_f32 v217, v217, v184
    v_mul_f32 v218, v218, v184
    v_mul_f32 v219, v219, v184
    v_mul_f32 v220, v220, v184
    v_mul_f32 v221, v221, v184
    v_mul_f32 v222, v222, v184
    v_mul_f32 v223, v223, v184
    v_sub_f32 v112, v112, v186
    v_sub_f32 v113, v113, v186
    v_sub_f32 v114, v114, v186
    v_sub_f32 v115, v115, v186
    v_sub_f32 v116, v116, v186
    v_sub_f32 v117, v117, v186
    v_sub_f32 v118, v118, v186
    v_sub_f32 v119, v119, v186
    v_sub_f32 v96, v96, v186
    v_sub_f32 v97, v97, v186
    v_sub_f32 v98, v98, v186
    v_sub_f32 v99, v99, v186
    v_sub_f32 v100, v100, v186
    v_sub_f32 v101, v101, v186
    v_sub_f32 v102, v102, v186
    v_sub_f32 v103, v103, v186
    v_sub_f32 v176, v176, v186
    v_sub_f32 v177, v177, v186
    v_sub_f32 v178, v178, v186
    v_sub_f32 v179, v179, v186
    v_mul_f32 v12, v12, v185
    v_mul_f32 v13, v13, v185
    v_mul_f32 v14, v14, v185
    v_mul_f32 v15, v15, v185
    v_mul_f32 v224, v224, v185
    v_mul_f32 v225, v225, v185
    v_mul_f32 v226, v226, v185
    v_mul_f32 v227, v227, v185
    v_mul_f32 v228, v228, v185
    v_mul_f32 v229, v229, v185
    v_mul_f32 v230, v230, v185
    v_mul_f32 v231, v231, v185
    v_mul_f32 v232, v232, v185
    v_mul_f32 v233, v233, v185
    v_mul_f32 v234, v234, v185
    v_mul_f32 v235, v235, v185
    v_mul_f32 v236, v236, v185
    v_mul_f32 v237, v237, v185
    v_mul_f32 v238, v238, v185
    v_mul_f32 v239, v239, v185
    v_mul_f32 v240, v240, v185
    v_mul_f32 v241, v241, v185
    v_mul_f32 v242, v242, v185
    v_mul_f32 v243, v243, v185
    v_mul_f32 v244, v244, v185
    v_mul_f32 v245, v245, v185
    v_mul_f32 v246, v246, v185
    v_mul_f32 v247, v247, v185
    v_mul_f32 v248, v248, v185
    v_mul_f32 v249, v249, v185
    v_mul_f32 v250, v250, v185
    v_mul_f32 v251, v251, v185
    v_mul_f32 v252, v252, v185
    v_mul_f32 v253, v253, v185
    v_mul_f32 v254, v254, v185
    v_mul_f32 v255, v255, v185
    v_sub_f32 v120, v120, v187
    v_sub_f32 v121, v121, v187
    v_sub_f32 v122, v122, v187
    v_sub_f32 v123, v123, v187
    v_sub_f32 v124, v124, v187
    v_sub_f32 v125, v125, v187
    v_sub_f32 v126, v126, v187
    v_sub_f32 v127, v127, v187
    v_sub_f32 v104, v104, v187
    v_sub_f32 v105, v105, v187
    v_sub_f32 v106, v106, v187
    v_sub_f32 v107, v107, v187
    v_sub_f32 v108, v108, v187
    v_sub_f32 v109, v109, v187
    v_sub_f32 v110, v110, v187
    v_sub_f32 v111, v111, v187
    v_sub_f32 v180, v180, v187
    v_sub_f32 v181, v181, v187
    v_sub_f32 v182, v182, v187
    v_sub_f32 v183, v183, v187
    v_exp_f32 v160, v112
    v_exp_f32 v161, v113
    v_exp_f32 v162, v114
    v_exp_f32 v163, v115
    v_exp_f32 v164, v116
    v_exp_f32 v165, v117
    v_exp_f32 v166, v118
    v_exp_f32 v167, v119
    v_exp_f32 v168, v120
    v_exp_f32 v169, v121
    v_exp_f32 v170, v122
    v_exp_f32 v171, v123
    v_exp_f32 v172, v124
    v_exp_f32 v173, v125
    v_exp_f32 v174, v126
    v_exp_f32 v175, v127
    v_cvt_pk_bf16_f32 v40, v160, v161
    v_cvt_pk_bf16_f32 v41, v162, v163
    v_cvt_pk_bf16_f32 v42, v164, v165
    v_cvt_pk_bf16_f32 v43, v166, v167
    v_cvt_pk_bf16_f32 v44, v168, v169
    v_cvt_pk_bf16_f32 v45, v170, v171
    v_cvt_pk_bf16_f32 v46, v172, v173
    v_cvt_pk_bf16_f32 v47, v174, v175
    s_nop 1
    s_branch L_rr_a1
L_rs_a2:
    s_nop 7
    s_nop 7
    v_max3_f32 v186, v96, v97, v98
    v_max3_f32 v187, v104, v105, v106
    v_max3_f32 v186, v186, v99, v100
    v_max3_f32 v187, v187, v107, v108
    v_max3_f32 v186, v186, v101, v102
    v_max3_f32 v187, v187, v109, v110
    v_max_f32 v186, v186, v103
    v_max_f32 v187, v187, v111
    s_nop 1
    v_permlane32_swap_b32 v186, v187
    v_max_f32 v187, v186, v187
    v_mov_b32 v191, v187
    s_nop 1
    v_permlane16_swap_b32 v191, v187
    v_max_f32 v187, v191, v187
    v_add_f32 v187, 0x41800000, v187
    v_max_f32 v187, 0, v187
    v_mov_b32 v186, v187
    s_nop 1
    v_permlane32_swap_b32 v186, v187
    v_exp_f32 v184, -v186
    v_exp_f32 v185, -v187
    v_mul_f32 v8, v8, v184
    v_mul_f32 v9, v9, v184
    v_mul_f32 v10, v10, v184
    v_mul_f32 v11, v11, v184
    v_mul_f32 v192, v192, v184
    v_mul_f32 v193, v193, v184
    v_mul_f32 v194, v194, v184
    v_mul_f32 v195, v195, v184
    v_mul_f32 v196, v196, v184
    v_mul_f32 v197, v197, v184
    v_mul_f32 v198, v198, v184
    v_mul_f32 v199, v199, v184
    v_mul_f32 v200, v200, v184
    v_mul_f32 v201, v201, v184
    v_mul_f32 v202, v202, v184
    v_mul_f32 v203, v203, v184
    v_mul_f32 v204, v204, v184
    v_mul_f32 v205, v205, v184
    v_mul_f32 v206, v206, v184
    v_mul_f32 v207, v207, v184
    v_mul_f32 v208, v208, v184
    v_mul_f32 v209, v209, v184
    v_mul_f32 v210, v210, v184
    v_mul_f32 v211, v211, v184
    v_mul_f32 v212, v212, v184
    v_mul_f32 v213, v213, v184
    v_mul_f32 v214, v214, v184
    v_mul_f32 v215, v215, v184
    v_mul_f32 v216, v216, v184
    v_mul_f32 v217, v217, v184
    v_mul_f32 v218, v218, v184
    v_mul_f32 v219, v219, v184
    v_mul_f32 v220, v220, v184
    v_mul_f32 v221, v221, v184
    v_mul_f32 v222, v222, v184
    v_mul_f32 v223, v223, v184
    v_sub_f32 v96, v96, v186
    v_sub_f32 v97, v97, v186
    v_sub_f32 v98, v98, v186
    v_sub_f32 v99, v99, v186
    v_sub_f32 v100, v100, v186
    v_sub_f32 v101, v101, v186
    v_sub_f32 v102, v102, v186
    v_sub_f32 v103, v103, v186
    v_sub_f32 v112, v112, v186
    v_sub_f32 v113, v113, v186
    v_sub_f32 v114, v114, v186
    v_sub_f32 v115, v115, v186
    v_sub_f32 v116, v116, v186
    v_sub_f32 v117, v117, v186
    v_sub_f32 v118, v118, v186
    v_sub_f32 v119, v119, v186
    v_sub_f32 v176, v176, v186
    v_sub_f32 v177, v177, v186
    v_sub_f32 v178, v178, v186
    v_sub_f32 v179, v179, v186
    v_mul_f32 v12, v12, v185
    v_mul_f32 v13, v13, v185
    v_mul_f32 v14, v14, v185
    v_mul_f32 v15, v15, v185
    v_mul_f32 v224, v224, v185
    v_mul_f32 v225, v225, v185
    v_mul_f32 v226, v226, v185
    v_mul_f32 v227, v227, v185
    v_mul_f32 v228, v228, v185
    v_mul_f32 v229, v229, v185
    v_mul_f32 v230, v230, v185
    v_mul_f32 v231, v231, v185
    v_mul_f32 v232, v232, v185
    v_mul_f32 v233, v233, v185
    v_mul_f32 v234, v234, v185
    v_mul_f32 v235, v235, v185
    v_mul_f32 v236, v236, v185
    v_mul_f32 v237, v237, v185
    v_mul_f32 v238, v238, v185
    v_mul_f32 v239, v239, v185
    v_mul_f32 v240, v240, v185
    v_mul_f32 v241, v241, v185
    v_mul_f32 v242, v242, v185
    v_mul_f32 v243, v243, v185
    v_mul_f32 v244, v244, v185
    v_mul_f32 v245, v245, v185
    v_mul_f32 v246, v246, v185
    v_mul_f32 v247, v247, v185
    v_mul_f32 v248, v248, v185
    v_mul_f32 v249, v249, v185
    v_mul_f32 v250, v250, v185
    v_mul_f32 v251, v251, v185
    v_mul_f32 v252, v252, v185
    v_mul_f32 v253, v253, v185
    v_mul_f32 v254, v254, v185
    v_mul_f32 v255, v255, v185
    v_sub_f32 v104, v104, v187
    v_sub_f32 v105, v105, v187
    v_sub_f32 v106, v106, v187
    v_sub_f32 v107, v107, v187
    v_sub_f32 v108, v108, v187
    v_sub_f32 v109, v109, v187
    v_sub_f32 v110, v110, v187
    v_sub_f32 v111, v111, v187
    v_sub_f32 v120, v120, v187
    v_sub_f32 v121, v121, v187
    v_sub_f32 v122, v122, v187
    v_sub_f32 v123, v123, v187
    v_sub_f32 v124, v124, v187
    v_sub_f32 v125, v125, v187
    v_sub_f32 v126, v126, v187
    v_sub_f32 v127, v127, v187
    v_sub_f32 v180, v180, v187
    v_sub_f32 v181, v181, v187
    v_sub_f32 v182, v182, v187
    v_sub_f32 v183, v183, v187
    v_exp_f32 v160, v96
    v_exp_f32 v161, v97
    v_exp_f32 v162, v98
    v_exp_f32 v163, v99
    v_exp_f32 v164, v100
    v_exp_f32 v165, v101
    v_exp_f32 v166, v102
    v_exp_f32 v167, v103
    v_exp_f32 v168, v104
    v_exp_f32 v169, v105
    v_exp_f32 v170, v106
    v_exp_f32 v171, v107
    v_exp_f32 v172, v108
    v_exp_f32 v173, v109
    v_exp_f32 v174, v110
    v_exp_f32 v175, v111
    v_cvt_pk_bf16_f32 v40, v160, v161
    v_cvt_pk_bf16_f32 v41, v162, v163
    v_cvt_pk_bf16_f32 v42, v164, v165
    v_cvt_pk_bf16_f32 v43, v166, v167
    v_cvt_pk_bf16_f32 v44, v168, v169
    v_cvt_pk_bf16_f32 v45, v170, v171
    v_cvt_pk_bf16_f32 v46, v172, v173
    v_cvt_pk_bf16_f32 v47, v174, v175
    s_nop 1
    s_branch L_rr_a2
L_rs_a3:
    s_nop 7
    s_nop 7
    v_max3_f32 v186, v112, v113, v114
    v_max3_f32 v187, v120, v121, v122
    v_max3_f32 v186, v186, v115, v116
    v_max3_f32 v187, v187, v123, v124
    v_max3_f32 v186, v186, v117, v118
    v_max3_f32 v187, v187, v125, v126
    v_max_f32 v186, v186, v119
    v_max_f32 v187, v187, v127
    s_nop 1
    v_permlane32_swap_b32 v186, v187
    v_max_f32 v187, v186, v187
    v_mov_b32 v191, v187
    s_nop 1
    v_permlane16_swap_b32 v191, v187
    v_max_f32 v187, v191, v187
    v_add_f32 v187, 0x41800000, v187
    v_max_f32 v187, 0, v187
    v_mov_b32 v186, v187
    s_nop 1
    v_permlane32_swap_b32 v186, v187
    v_exp_f32 v184, -v186
    v_exp_f32 v185, -v187
    v_mul_f32 v8, v8, v184
    v_mul_f32 v9, v9, v184
    v_mul_f32 v10, v10, v184
    v_mul_f32 v11, v11, v184
    v_mul_f32 v192, v192, v184
    v_mul_f32 v193, v193, v184
    v_mul_f32 v194, v194, v184
    v_mul_f32 v195, v195, v184
    v_mul_f32 v196, v196, v184
    v_mul_f32 v197, v197, v184
    v_mul_f32 v198, v198, v184
    v_mul_f32 v199, v199, v184
    v_mul_f32 v200, v200, v184
    v_mul_f32 v201, v201, v184
    v_mul_f32 v202, v202, v184
    v_mul_f32 v203, v203, v184
    v_mul_f32 v204, v204, v184
    v_mul_f32 v205, v205, v184
    v_mul_f32 v206, v206, v184
    v_mul_f32 v207, v207, v184
    v_mul_f32 v208, v208, v184
    v_mul_f32 v209, v209, v184
    v_mul_f32 v210, v210, v184
    v_mul_f32 v211, v211, v184
    v_mul_f32 v212, v212, v184
    v_mul_f32 v213, v213, v184
    v_mul_f32 v214, v214, v184
    v_mul_f32 v215, v215, v184
    v_mul_f32 v216, v216, v184
    v_mul_f32 v217, v217, v184
    v_mul_f32 v218, v218, v184
    v_mul_f32 v219, v219, v184
    v_mul_f32 v220, v220, v184
    v_mul_f32 v221, v221, v184
    v_mul_f32 v222, v222, v184
    v_mul_f32 v223, v223, v184
    v_sub_f32 v112, v112, v186
    v_sub_f32 v113, v113, v186
    v_sub_f32 v114, v114, v186
    v_sub_f32 v115, v115, v186
    v_sub_f32 v116, v116, v186
    v_sub_f32 v117, v117, v186
    v_sub_f32 v118, v118, v186
    v_sub_f32 v119, v119, v186
    v_sub_f32 v96, v96, v186
    v_sub_f32 v97, v97, v186
    v_sub_f32 v98, v98, v186
    v_sub_f32 v99, v99, v186
    v_sub_f32 v100, v100, v186
    v_sub_f32 v101, v101, v186
    v_sub_f32 v102, v102, v186
    v_sub_f32 v103, v103, v186
    v_sub_f32 v176, v176, v186
    v_sub_f32 v177, v177, v186
    v_sub_f32 v178, v178, v186
    v_sub_f32 v179, v179, v186
    v_mul_f32 v12, v12, v185
    v_mul_f32 v13, v13, v185
    v_mul_f32 v14, v14, v185
    v_mul_f32 v15, v15, v185
    v_mul_f32 v224, v224, v185
    v_mul_f32 v225, v225, v185
    v_mul_f32 v226, v226, v185
    v_mul_f32 v227, v227, v185
    v_mul_f32 v228, v228, v185
    v_mul_f32 v229, v229, v185
    v_mul_f32 v230, v230, v185
    v_mul_f32 v231, v231, v185
    v_mul_f32 v232, v232, v185
    v_mul_f32 v233, v233, v185
    v_mul_f32 v234, v234, v185
    v_mul_f32 v235, v235, v185
    v_mul_f32 v236, v236, v185
    v_mul_f32 v237, v237, v185
    v_mul_f32 v238, v238, v185
    v_mul_f32 v239, v239, v185
    v_mul_f32 v240, v240, v185
    v_mul_f32 v241, v241, v185
    v_mul_f32 v242, v242, v185
    v_mul_f32 v243, v243, v185
    v_mul_f32 v244, v244, v185
    v_mul_f32 v245, v245, v185
    v_mul_f32 v246, v246, v185
    v_mul_f32 v247, v247, v185
    v_mul_f32 v248, v248, v185
    v_mul_f32 v249, v249, v185
    v_mul_f32 v250, v250, v185
    v_mul_f32 v251, v251, v185
    v_mul_f32 v252, v252, v185
    v_mul_f32 v253, v253, v185
    v_mul_f32 v254, v254, v185
    v_mul_f32 v255, v255, v185
    v_sub_f32 v120, v120, v187
    v_sub_f32 v121, v121, v187
    v_sub_f32 v122, v122, v187
    v_sub_f32 v123, v123, v187
    v_sub_f32 v124, v124, v187
    v_sub_f32 v125, v125, v187
    v_sub_f32 v126, v126, v187
    v_sub_f32 v127, v127, v187
    v_sub_f32 v104, v104, v187
    v_sub_f32 v105, v105, v187
    v_sub_f32 v106, v106, v187
    v_sub_f32 v107, v107, v187
    v_sub_f32 v108, v108, v187
    v_sub_f32 v109, v109, v187
    v_sub_f32 v110, v110, v187
    v_sub_f32 v111, v111, v187
    v_sub_f32 v180, v180, v187
    v_sub_f32 v181, v181, v187
    v_sub_f32 v182, v182, v187
    v_sub_f32 v183, v183, v187
    v_exp_f32 v160, v112
    v_exp_f32 v161, v113
    v_exp_f32 v162, v114
    v_exp_f32 v163, v115
    v_exp_f32 v164, v116
    v_exp_f32 v165, v117
    v_exp_f32 v166, v118
    v_exp_f32 v167, v119
    v_exp_f32 v168, v120
    v_exp_f32 v169, v121
    v_exp_f32 v170, v122
    v_exp_f32 v171, v123
    v_exp_f32 v172, v124
    v_exp_f32 v173, v125
    v_exp_f32 v174, v126
    v_exp_f32 v175, v127
    v_cvt_pk_bf16_f32 v40, v160, v161
    v_cvt_pk_bf16_f32 v41, v162, v163
    v_cvt_pk_bf16_f32 v42, v164, v165
    v_cvt_pk_bf16_f32 v43, v166, v167
    v_cvt_pk_bf16_f32 v44, v168, v169
    v_cvt_pk_bf16_f32 v45, v170, v171
    v_cvt_pk_bf16_f32 v46, v172, v173
    v_cvt_pk_bf16_f32 v47, v174, v175
    s_nop 1
    s_branch L_rr_a3
L_rs_a4:
    s_nop 7
    s_nop 7
    v_max3_f32 v186, v96, v97, v98
    v_max3_f32 v187, v104, v105, v106
    v_max3_f32 v186, v186, v99, v100
    v_max3_f32 v187, v187, v107, v108
    v_max3_f32 v186, v186, v101, v102
    v_max3_f32 v187, v187, v109, v110
    v_max_f32 v186, v186, v103
    v_max_f32 v187, v187, v111
    s_nop 1
    v_permlane32_swap_b32 v186, v187
    v_max_f32 v187, v186, v187
    v_mov_b32 v191, v187
    s_nop 1
    v_permlane16_swap_b32 v191, v187
    v_max_f32 v187, v191, v187
    v_add_f32 v187, 0x41800000, v187
    v_max_f32 v187, 0, v187
    v_mov_b32 v186, v187
    s_nop 1
    v_permlane32_swap_b32 v186, v187
    v_exp_f32 v184, -v186
    v_exp_f32 v185, -v187
    v_mul_f32 v8, v8, v184
    v_mul_f32 v9, v9, v184
    v_mul_f32 v10, v10, v184
    v_mul_f32 v11, v11, v184
    v_mul_f32 v192, v192, v184
    v_mul_f32 v193, v193, v184
    v_mul_f32 v194, v194, v184
    v_mul_f32 v195, v195, v184
    v_mul_f32 v196, v196, v184
    v_mul_f32 v197, v197, v184
    v_mul_f32 v198, v198, v184
    v_mul_f32 v199, v199, v184
    v_mul_f32 v200, v200, v184
    v_mul_f32 v201, v201, v184
    v_mul_f32 v202, v202, v184
    v_mul_f32 v203, v203, v184
    v_mul_f32 v204, v204, v184
    v_mul_f32 v205, v205, v184
    v_mul_f32 v206, v206, v184
    v_mul_f32 v207, v207, v184
    v_mul_f32 v208, v208, v184
    v_mul_f32 v209, v209, v184
    v_mul_f32 v210, v210, v184
    v_mul_f32 v211, v211, v184
    v_mul_f32 v212, v212, v184
    v_mul_f32 v213, v213, v184
    v_mul_f32 v214, v214, v184
    v_mul_f32 v215, v215, v184
    v_mul_f32 v216, v216, v184
    v_mul_f32 v217, v217, v184
    v_mul_f32 v218, v218, v184
    v_mul_f32 v219, v219, v184
    v_mul_f32 v220, v220, v184
    v_mul_f32 v221, v221, v184
    v_mul_f32 v222, v222, v184
    v_mul_f32 v223, v223, v184
    v_sub_f32 v96, v96, v186
    v_sub_f32 v97, v97, v186
    v_sub_f32 v98, v98, v186
    v_sub_f32 v99, v99, v186
    v_sub_f32 v100, v100, v186
    v_sub_f32 v101, v101, v186
    v_sub_f32 v102, v102, v186
    v_sub_f32 v103, v103, v186
    v_sub_f32 v112, v112, v186
    v_sub_f32 v113, v113, v186
    v_sub_f32 v114, v114, v186
    v_sub_f32 v115, v115, v186
    v_sub_f32 v116, v116, v186
    v_sub_f32 v117, v117, v186
    v_sub_f32 v118, v118, v186
    v_sub_f32 v119, v119, v186
    v_sub_f32 v176, v176, v186
    v_sub_f32 v177, v177, v186
    v_sub_f32 v178, v178, v186
    v_sub_f32 v179, v179, v186
    v_mul_f32 v12, v12, v185
    v_mul_f32 v13, v13, v185
    v_mul_f32 v14, v14, v185
    v_mul_f32 v15, v15, v185
    v_mul_f32 v224, v224, v185
    v_mul_f32 v225, v225, v185
    v_mul_f32 v226, v226, v185
    v_mul_f32 v227, v227, v185
    v_mul_f32 v228, v228, v185
    v_mul_f32 v229, v229, v185
    v_mul_f32 v230, v230, v185
    v_mul_f32 v231, v231, v185
    v_mul_f32 v232, v232, v185
    v_mul_f32 v233, v233, v185
    v_mul_f32 v234, v234, v185
    v_mul_f32 v235, v235, v185
    v_mul_f32 v236, v236, v185
    v_mul_f32 v237, v237, v185
    v_mul_f32 v238, v238, v185
    v_mul_f32 v239, v239, v185
    v_mul_f32 v240, v240, v185
    v_mul_f32 v241, v241, v185
    v_mul_f32 v242, v242, v185
    v_mul_f32 v243, v243, v185
    v_mul_f32 v244, v244, v185
    v_mul_f32 v245, v245, v185
    v_mul_f32 v246, v246, v185
    v_mul_f32 v247, v247, v185
    v_mul_f32 v248, v248, v185
    v_mul_f32 v249, v249, v185
    v_mul_f32 v250, v250, v185
    v_mul_f32 v251, v251, v185
    v_mul_f32 v252, v252, v185
    v_mul_f32 v253, v253, v185
    v_mul_f32 v254, v254, v185
    v_mul_f32 v255, v255, v185
    v_sub_f32 v104, v104, v187
    v_sub_f32 v105, v105, v187
    v_sub_f32 v106, v106, v187
    v_sub_f32 v107, v107, v187
    v_sub_f32 v108, v108, v187
    v_sub_f32 v109, v109, v187
    v_sub_f32 v110, v110, v187
    v_sub_f32 v111, v111, v187
    v_sub_f32 v120, v120, v187
    v_sub_f32 v121, v121, v187
    v_sub_f32 v122, v122, v187
    v_sub_f32 v123, v123, v187
    v_sub_f32 v124, v124, v187
    v_sub_f32 v125, v125, v187
    v_sub_f32 v126, v126, v187
    v_sub_f32 v127, v127, v187
    v_sub_f32 v180, v180, v187
    v_sub_f32 v181, v181, v187
    v_sub_f32 v182, v182, v187
    v_sub_f32 v183, v183, v187
    v_exp_f32 v160, v96
    v_exp_f32 v161, v97
    v_exp_f32 v162, v98
    v_exp_f32 v163, v99
    v_exp_f32 v164, v100
    v_exp_f32 v165, v101
    v_exp_f32 v166, v102
    v_exp_f32 v167, v103
    v_exp_f32 v168, v104
    v_exp_f32 v169, v105
    v_exp_f32 v170, v106
    v_exp_f32 v171, v107
    v_exp_f32 v172, v108
    v_exp_f32 v173, v109
    v_exp_f32 v174, v110
    v_exp_f32 v175, v111
    v_cvt_pk_bf16_f32 v40, v160, v161
    v_cvt_pk_bf16_f32 v41, v162, v163
    v_cvt_pk_bf16_f32 v42, v164, v165
    v_cvt_pk_bf16_f32 v43, v166, v167
    v_cvt_pk_bf16_f32 v44, v168, v169
    v_cvt_pk_bf16_f32 v45, v170, v171
    v_cvt_pk_bf16_f32 v46, v172, v173
    v_cvt_pk_bf16_f32 v47, v174, v175
    s_nop 1
    s_branch L_rr_a4
L_rs_a5:
    s_nop 7
    s_nop 7
    v_max3_f32 v186, v112, v113, v114
    v_max3_f32 v187, v120, v121, v122
    v_max3_f32 v186, v186, v115, v116
    v_max3_f32 v187, v187, v123, v124
    v_max3_f32 v186, v186, v117, v118
    v_max3_f32 v187, v187, v125, v126
    v_max_f32 v186, v186, v119
    v_max_f32 v187, v187, v127
    s_nop 1
    v_permlane32_swap_b32 v186, v187
    v_max_f32 v187, v186, v187
    v_mov_b32 v191, v187
    s_nop 1
    v_permlane16_swap_b32 v191, v187
    v_max_f32 v187, v191, v187
    v_add_f32 v187, 0x41800000, v187
    v_max_f32 v187, 0, v187
    v_mov_b32 v186, v187
    s_nop 1
    v_permlane32_swap_b32 v186, v187
    v_exp_f32 v184, -v186
    v_exp_f32 v185, -v187
    v_mul_f32 v8, v8, v184
    v_mul_f32 v9, v9, v184
    v_mul_f32 v10, v10, v184
    v_mul_f32 v11, v11, v184
    v_mul_f32 v192, v192, v184
    v_mul_f32 v193, v193, v184
    v_mul_f32 v194, v194, v184
    v_mul_f32 v195, v195, v184
    v_mul_f32 v196, v196, v184
    v_mul_f32 v197, v197, v184
    v_mul_f32 v198, v198, v184
    v_mul_f32 v199, v199, v184
    v_mul_f32 v200, v200, v184
    v_mul_f32 v201, v201, v184
    v_mul_f32 v202, v202, v184
    v_mul_f32 v203, v203, v184
    v_mul_f32 v204, v204, v184
    v_mul_f32 v205, v205, v184
    v_mul_f32 v206, v206, v184
    v_mul_f32 v207, v207, v184
    v_mul_f32 v208, v208, v184
    v_mul_f32 v209, v209, v184
    v_mul_f32 v210, v210, v184
    v_mul_f32 v211, v211, v184
    v_mul_f32 v212, v212, v184
    v_mul_f32 v213, v213, v184
    v_mul_f32 v214, v214, v184
    v_mul_f32 v215, v215, v184
    v_mul_f32 v216, v216, v184
    v_mul_f32 v217, v217, v184
    v_mul_f32 v218, v218, v184
    v_mul_f32 v219, v219, v184
    v_mul_f32 v220, v220, v184
    v_mul_f32 v221, v221, v184
    v_mul_f32 v222, v222, v184
    v_mul_f32 v223, v223, v184
    v_sub_f32 v112, v112, v186
    v_sub_f32 v113, v113, v186
    v_sub_f32 v114, v114, v186
    v_sub_f32 v115, v115, v186
    v_sub_f32 v116, v116, v186
    v_sub_f32 v117, v117, v186
    v_sub_f32 v118, v118, v186
    v_sub_f32 v119, v119, v186
    v_sub_f32 v96, v96, v186
    v_sub_f32 v97, v97, v186
    v_sub_f32 v98, v98, v186
    v_sub_f32 v99, v99, v186
    v_sub_f32 v100, v100, v186
    v_sub_f32 v101, v101, v186
    v_sub_f32 v102, v102, v186
    v_sub_f32 v103, v103, v186
    v_sub_f32 v176, v176, v186
    v_sub_f32 v177, v177, v186
    v_sub_f32 v178, v178, v186
    v_sub_f32 v179, v179, v186
    v_mul_f32 v12, v12, v185
    v_mul_f32 v13, v13, v185
    v_mul_f32 v14, v14, v185
    v_mul_f32 v15, v15, v185
    v_mul_f32 v224, v224, v185
    v_mul_f32 v225, v225, v185
    v_mul_f32 v226, v226, v185
    v_mul_f32 v227, v227, v185
    v_mul_f32 v228, v228, v185
    v_mul_f32 v229, v229, v185
    v_mul_f32 v230, v230, v185
    v_mul_f32 v231, v231, v185
    v_mul_f32 v232, v232, v185
    v_mul_f32 v233, v233, v185
    v_mul_f32 v234, v234, v185
    v_mul_f32 v235, v235, v185
    v_mul_f32 v236, v236, v185
    v_mul_f32 v237, v237, v185
    v_mul_f32 v238, v238, v185
    v_mul_f32 v239, v239, v185
    v_mul_f32 v240, v240, v185
    v_mul_f32 v241, v241, v185
    v_mul_f32 v242, v242, v185
    v_mul_f32 v243, v243, v185
    v_mul_f32 v244, v244, v185
    v_mul_f32 v245, v245, v185
    v_mul_f32 v246, v246, v185
    v_mul_f32 v247, v247, v185
    v_mul_f32 v248, v248, v185
    v_mul_f32 v249, v249, v185
    v_mul_f32 v250, v250, v185
    v_mul_f32 v251, v251, v185
    v_mul_f32 v252, v252, v185
    v_mul_f32 v253, v253, v185
    v_mul_f32 v254, v254, v185
    v_mul_f32 v255, v255, v185
    v_sub_f32 v120, v120, v187
    v_sub_f32 v121, v121, v187
    v_sub_f32 v122, v122, v187
    v_sub_f32 v123, v123, v187
    v_sub_f32 v124, v124, v187
    v_sub_f32 v125, v125, v187
    v_sub_f32 v126, v126, v187
    v_sub_f32 v127, v127, v187
    v_sub_f32 v104, v104, v187
    v_sub_f32 v105, v105, v187
    v_sub_f32 v106, v106, v187
    v_sub_f32 v107, v107, v187
    v_sub_f32 v108, v108, v187
    v_sub_f32 v109, v109, v187
    v_sub_f32 v110, v110, v187
    v_sub_f32 v111, v111, v187
    v_sub_f32 v180, v180, v187
    v_sub_f32 v181, v181, v187
    v_sub_f32 v182, v182, v187
    v_sub_f32 v183, v183, v187
    v_exp_f32 v160, v112
    v_exp_f32 v161, v113
    v_exp_f32 v162, v114
    v_exp_f32 v163, v115
    v_exp_f32 v164, v116
    v_exp_f32 v165, v117
    v_exp_f32 v166, v118
    v_exp_f32 v167, v119
    v_exp_f32 v168, v120
    v_exp_f32 v169, v121
    v_exp_f32 v170, v122
    v_exp_f32 v171, v123
    v_exp_f32 v172, v124
    v_exp_f32 v173, v125
    v_exp_f32 v174, v126
    v_exp_f32 v175, v127
    v_cvt_pk_bf16_f32 v40, v160, v161
    v_cvt_pk_bf16_f32 v41, v162, v163
    v_cvt_pk_bf16_f32 v42, v164, v165
    v_cvt_pk_bf16_f32 v43, v166, v167
    v_cvt_pk_bf16_f32 v44, v168, v169
    v_cvt_pk_bf16_f32 v45, v170, v171
    v_cvt_pk_bf16_f32 v46, v172, v173
    v_cvt_pk_bf16_f32 v47, v174, v175
    s_nop 1
    s_branch L_rr_a5
L_rs_a6:
    s_nop 7
    s_nop 7
    v_max3_f32 v186, v96, v97, v98
    v_max3_f32 v187, v104, v105, v106
    v_max3_f32 v186, v186, v99, v100
    v_max3_f32 v187, v187, v107, v108
    v_max3_f32 v186, v186, v101, v102
    v_max3_f32 v187, v187, v109, v110
    v_max_f32 v186, v186, v103
    v_max_f32 v187, v187, v111
    s_nop 1
    v_permlane32_swap_b32 v186, v187
    v_max_f32 v187, v186, v187
    v_mov_b32 v191, v187
    s_nop 1
    v_permlane16_swap_b32 v191, v187
    v_max_f32 v187, v191, v187
    v_add_f32 v187, 0x41800000, v187
    v_max_f32 v187, 0, v187
    v_mov_b32 v186, v187
    s_nop 1
    v_permlane32_swap_b32 v186, v187
    v_exp_f32 v184, -v186
    v_exp_f32 v185, -v187
    v_mul_f32 v8, v8, v184
    v_mul_f32 v9, v9, v184
    v_mul_f32 v10, v10, v184
    v_mul_f32 v11, v11, v184
    v_mul_f32 v192, v192, v184
    v_mul_f32 v193, v193, v184
    v_mul_f32 v194, v194, v184
    v_mul_f32 v195, v195, v184
    v_mul_f32 v196, v196, v184
    v_mul_f32 v197, v197, v184
    v_mul_f32 v198, v198, v184
    v_mul_f32 v199, v199, v184
    v_mul_f32 v200, v200, v184
    v_mul_f32 v201, v201, v184
    v_mul_f32 v202, v202, v184
    v_mul_f32 v203, v203, v184
    v_mul_f32 v204, v204, v184
    v_mul_f32 v205, v205, v184
    v_mul_f32 v206, v206, v184
    v_mul_f32 v207, v207, v184
    v_mul_f32 v208, v208, v184
    v_mul_f32 v209, v209, v184
    v_mul_f32 v210, v210, v184
    v_mul_f32 v211, v211, v184
    v_mul_f32 v212, v212, v184
    v_mul_f32 v213, v213, v184
    v_mul_f32 v214, v214, v184
    v_mul_f32 v215, v215, v184
    v_mul_f32 v216, v216, v184
    v_mul_f32 v217, v217, v184
    v_mul_f32 v218, v218, v184
    v_mul_f32 v219, v219, v184
    v_mul_f32 v220, v220, v184
    v_mul_f32 v221, v221, v184
    v_mul_f32 v222, v222, v184
    v_mul_f32 v223, v223, v184
    v_sub_f32 v96, v96, v186
    v_sub_f32 v97, v97, v186
    v_sub_f32 v98, v98, v186
    v_sub_f32 v99, v99, v186
    v_sub_f32 v100, v100, v186
    v_sub_f32 v101, v101, v186
    v_sub_f32 v102, v102, v186
    v_sub_f32 v103, v103, v186
    v_sub_f32 v112, v112, v186
    v_sub_f32 v113, v113, v186
    v_sub_f32 v114, v114, v186
    v_sub_f32 v115, v115, v186
    v_sub_f32 v116, v116, v186
    v_sub_f32 v117, v117, v186
    v_sub_f32 v118, v118, v186
    v_sub_f32 v119, v119, v186
    v_sub_f32 v176, v176, v186
    v_sub_f32 v177, v177, v186
    v_sub_f32 v178, v178, v186
    v_sub_f32 v179, v179, v186
    v_mul_f32 v12, v12, v185
    v_mul_f32 v13, v13, v185
    v_mul_f32 v14, v14, v185
    v_mul_f32 v15, v15, v185
    v_mul_f32 v224, v224, v185
    v_mul_f32 v225, v225, v185
    v_mul_f32 v226, v226, v185
    v_mul_f32 v227, v227, v185
    v_mul_f32 v228, v228, v185
    v_mul_f32 v229, v229, v185
    v_mul_f32 v230, v230, v185
    v_mul_f32 v231, v231, v185
    v_mul_f32 v232, v232, v185
    v_mul_f32 v233, v233, v185
    v_mul_f32 v234, v234, v185
    v_mul_f32 v235, v235, v185
    v_mul_f32 v236, v236, v185
    v_mul_f32 v237, v237, v185
    v_mul_f32 v238, v238, v185
    v_mul_f32 v239, v239, v185
    v_mul_f32 v240, v240, v185
    v_mul_f32 v241, v241, v185
    v_mul_f32 v242, v242, v185
    v_mul_f32 v243, v243, v185
    v_mul_f32 v244, v244, v185
    v_mul_f32 v245, v245, v185
    v_mul_f32 v246, v246, v185
    v_mul_f32 v247, v247, v185
    v_mul_f32 v248, v248, v185
    v_mul_f32 v249, v249, v185
    v_mul_f32 v250, v250, v185
    v_mul_f32 v251, v251, v185
    v_mul_f32 v252, v252, v185
    v_mul_f32 v253, v253, v185
    v_mul_f32 v254, v254, v185
    v_mul_f32 v255, v255, v185
    v_sub_f32 v104, v104, v187
    v_sub_f32 v105, v105, v187
    v_sub_f32 v106, v106, v187
    v_sub_f32 v107, v107, v187
    v_sub_f32 v108, v108, v187
    v_sub_f32 v109, v109, v187
    v_sub_f32 v110, v110, v187
    v_sub_f32 v111, v111, v187
    v_sub_f32 v120, v120, v187
    v_sub_f32 v121, v121, v187
    v_sub_f32 v122, v122, v187
    v_sub_f32 v123, v123, v187
    v_sub_f32 v124, v124, v187
    v_sub_f32 v125, v125, v187
    v_sub_f32 v126, v126, v187
    v_sub_f32 v127, v127, v187
    v_sub_f32 v180, v180, v187
    v_sub_f32 v181, v181, v187
    v_sub_f32 v182, v182, v187
    v_sub_f32 v183, v183, v187
    v_exp_f32 v160, v96
    v_exp_f32 v161, v97
    v_exp_f32 v162, v98
    v_exp_f32 v163, v99
    v_exp_f32 v164, v100
    v_exp_f32 v165, v101
    v_exp_f32 v166, v102
    v_exp_f32 v167, v103
    v_exp_f32 v168, v104
    v_exp_f32 v169, v105
    v_exp_f32 v170, v106
    v_exp_f32 v171, v107
    v_exp_f32 v172, v108
    v_exp_f32 v173, v109
    v_exp_f32 v174, v110
    v_exp_f32 v175, v111
    v_cvt_pk_bf16_f32 v40, v160, v161
    v_cvt_pk_bf16_f32 v41, v162, v163
    v_cvt_pk_bf16_f32 v42, v164, v165
    v_cvt_pk_bf16_f32 v43, v166, v167
    v_cvt_pk_bf16_f32 v44, v168, v169
    v_cvt_pk_bf16_f32 v45, v170, v171
    v_cvt_pk_bf16_f32 v46, v172, v173
    v_cvt_pk_bf16_f32 v47, v174, v175
    s_nop 1
    s_branch L_rr_a6
L_rs_a7:
    s_nop 7
    s_nop 7
    v_max3_f32 v186, v112, v113, v114
    v_max3_f32 v187, v120, v121, v122
    v_max3_f32 v186, v186, v115, v116
    v_max3_f32 v187, v187, v123, v124
    v_max3_f32 v186, v186, v117, v118
    v_max3_f32 v187, v187, v125, v126
    v_max_f32 v186, v186, v119
    v_max_f32 v187, v187, v127
    s_nop 1
    v_permlane32_swap_b32 v186, v187
    v_max_f32 v187, v186, v187
    v_mov_b32 v191, v187
    s_nop 1
    v_permlane16_swap_b32 v191, v187
    v_max_f32 v187, v191, v187
    v_add_f32 v187, 0x41800000, v187
    v_max_f32 v187, 0, v187
    v_mov_b32 v186, v187
    s_nop 1
    v_permlane32_swap_b32 v186, v187
    v_exp_f32 v184, -v186
    v_exp_f32 v185, -v187
    v_mul_f32 v8, v8, v184
    v_mul_f32 v9, v9, v184
    v_mul_f32 v10, v10, v184
    v_mul_f32 v11, v11, v184
    v_mul_f32 v192, v192, v184
    v_mul_f32 v193, v193, v184
    v_mul_f32 v194, v194, v184
    v_mul_f32 v195, v195, v184
    v_mul_f32 v196, v196, v184
    v_mul_f32 v197, v197, v184
    v_mul_f32 v198, v198, v184
    v_mul_f32 v199, v199, v184
    v_mul_f32 v200, v200, v184
    v_mul_f32 v201, v201, v184
    v_mul_f32 v202, v202, v184
    v_mul_f32 v203, v203, v184
    v_mul_f32 v204, v204, v184
    v_mul_f32 v205, v205, v184
    v_mul_f32 v206, v206, v184
    v_mul_f32 v207, v207, v184
    v_mul_f32 v208, v208, v184
    v_mul_f32 v209, v209, v184
    v_mul_f32 v210, v210, v184
    v_mul_f32 v211, v211, v184
    v_mul_f32 v212, v212, v184
    v_mul_f32 v213, v213, v184
    v_mul_f32 v214, v214, v184
    v_mul_f32 v215, v215, v184
    v_mul_f32 v216, v216, v184
    v_mul_f32 v217, v217, v184
    v_mul_f32 v218, v218, v184
    v_mul_f32 v219, v219, v184
    v_mul_f32 v220, v220, v184
    v_mul_f32 v221, v221, v184
    v_mul_f32 v222, v222, v184
    v_mul_f32 v223, v223, v184
    v_sub_f32 v112, v112, v186
    v_sub_f32 v113, v113, v186
    v_sub_f32 v114, v114, v186
    v_sub_f32 v115, v115, v186
    v_sub_f32 v116, v116, v186
    v_sub_f32 v117, v117, v186
    v_sub_f32 v118, v118, v186
    v_sub_f32 v119, v119, v186
    v_sub_f32 v96, v96, v186
    v_sub_f32 v97, v97, v186
    v_sub_f32 v98, v98, v186
    v_sub_f32 v99, v99, v186
    v_sub_f32 v100, v100, v186
    v_sub_f32 v101, v101, v186
    v_sub_f32 v102, v102, v186
    v_sub_f32 v103, v103, v186
    v_sub_f32 v176, v176, v186
    v_sub_f32 v177, v177, v186
    v_sub_f32 v178, v178, v186
    v_sub_f32 v179, v179, v186
    v_mul_f32 v12, v12, v185
    v_mul_f32 v13, v13, v185
    v_mul_f32 v14, v14, v185
    v_mul_f32 v15, v15, v185
    v_mul_f32 v224, v224, v185
    v_mul_f32 v225, v225, v185
    v_mul_f32 v226, v226, v185
    v_mul_f32 v227, v227, v185
    v_mul_f32 v228, v228, v185
    v_mul_f32 v229, v229, v185
    v_mul_f32 v230, v230, v185
    v_mul_f32 v231, v231, v185
    v_mul_f32 v232, v232, v185
    v_mul_f32 v233, v233, v185
    v_mul_f32 v234, v234, v185
    v_mul_f32 v235, v235, v185
    v_mul_f32 v236, v236, v185
    v_mul_f32 v237, v237, v185
    v_mul_f32 v238, v238, v185
    v_mul_f32 v239, v239, v185
    v_mul_f32 v240, v240, v185
    v_mul_f32 v241, v241, v185
    v_mul_f32 v242, v242, v185
    v_mul_f32 v243, v243, v185
    v_mul_f32 v244, v244, v185
    v_mul_f32 v245, v245, v185
    v_mul_f32 v246, v246, v185
    v_mul_f32 v247, v247, v185
    v_mul_f32 v248, v248, v185
    v_mul_f32 v249, v249, v185
    v_mul_f32 v250, v250, v185
    v_mul_f32 v251, v251, v185
    v_mul_f32 v252, v252, v185
    v_mul_f32 v253, v253, v185
    v_mul_f32 v254, v254, v185
    v_mul_f32 v255, v255, v185
    v_sub_f32 v120, v120, v187
    v_sub_f32 v121, v121, v187
    v_sub_f32 v122, v122, v187
    v_sub_f32 v123, v123, v187
    v_sub_f32 v124, v124, v187
    v_sub_f32 v125, v125, v187
    v_sub_f32 v126, v126, v187
    v_sub_f32 v127, v127, v187
    v_sub_f32 v104, v104, v187
    v_sub_f32 v105, v105, v187
    v_sub_f32 v106, v106, v187
    v_sub_f32 v107, v107, v187
    v_sub_f32 v108, v108, v187
    v_sub_f32 v109, v109, v187
    v_sub_f32 v110, v110, v187
    v_sub_f32 v111, v111, v187
    v_sub_f32 v180, v180, v187
    v_sub_f32 v181, v181, v187
    v_sub_f32 v182, v182, v187
    v_sub_f32 v183, v183, v187
    v_exp_f32 v160, v112
    v_exp_f32 v161, v113
    v_exp_f32 v162, v114
    v_exp_f32 v163, v115
    v_exp_f32 v164, v116
    v_exp_f32 v165, v117
    v_exp_f32 v166, v118
    v_exp_f32 v167, v119
    v_exp_f32 v168, v120
    v_exp_f32 v169, v121
    v_exp_f32 v170, v122
    v_exp_f32 v171, v123
    v_exp_f32 v172, v124
    v_exp_f32 v173, v125
    v_exp_f32 v174, v126
    v_exp_f32 v175, v127
    v_cvt_pk_bf16_f32 v40, v160, v161
    v_cvt_pk_bf16_f32 v41, v162, v163
    v_cvt_pk_bf16_f32 v42, v164, v165
    v_cvt_pk_bf16_f32 v43, v166, v167
    v_cvt_pk_bf16_f32 v44, v168, v169
    v_cvt_pk_bf16_f32 v45, v170, v171
    v_cvt_pk_bf16_f32 v46, v172, v173
    v_cvt_pk_bf16_f32 v47, v174, v175
    s_nop 1
    s_branch L_rr_a7
L_rs_a8:
    s_nop 7
    s_nop 7
    v_max3_f32 v186, v96, v97, v98
    v_max3_f32 v187, v104, v105, v106
    v_max3_f32 v186, v186, v99, v100
    v_max3_f32 v187, v187, v107, v108
    v_max3_f32 v186, v186, v101, v102
    v_max3_f32 v187, v187, v109, v110
    v_max_f32 v186, v186, v103
    v_max_f32 v187, v187, v111
    s_nop 1
    v_permlane32_swap_b32 v186, v187
    v_max_f32 v187, v186, v187
    v_mov_b32 v191, v187
    s_nop 1
    v_permlane16_swap_b32 v191, v187
    v_max_f32 v187, v191, v187
    v_add_f32 v187, 0x41800000, v187
    v_max_f32 v187, 0, v187
    v_mov_b32 v186, v187
    s_nop 1
    v_permlane32_swap_b32 v186, v187
    v_exp_f32 v184, -v186
    v_exp_f32 v185, -v187
    v_mul_f32 v8, v8, v184
    v_mul_f32 v9, v9, v184
    v_mul_f32 v10, v10, v184
    v_mul_f32 v11, v11, v184
    v_mul_f32 v192, v192, v184
    v_mul_f32 v193, v193, v184
    v_mul_f32 v194, v194, v184
    v_mul_f32 v195, v195, v184
    v_mul_f32 v196, v196, v184
    v_mul_f32 v197, v197, v184
    v_mul_f32 v198, v198, v184
    v_mul_f32 v199, v199, v184
    v_mul_f32 v200, v200, v184
    v_mul_f32 v201, v201, v184
    v_mul_f32 v202, v202, v184
    v_mul_f32 v203, v203, v184
    v_mul_f32 v204, v204, v184
    v_mul_f32 v205, v205, v184
    v_mul_f32 v206, v206, v184
    v_mul_f32 v207, v207, v184
    v_mul_f32 v208, v208, v184
    v_mul_f32 v209, v209, v184
    v_mul_f32 v210, v210, v184
    v_mul_f32 v211, v211, v184
    v_mul_f32 v212, v212, v184
    v_mul_f32 v213, v213, v184
    v_mul_f32 v214, v214, v184
    v_mul_f32 v215, v215, v184
    v_mul_f32 v216, v216, v184
    v_mul_f32 v217, v217, v184
    v_mul_f32 v218, v218, v184
    v_mul_f32 v219, v219, v184
    v_mul_f32 v220, v220, v184
    v_mul_f32 v221, v221, v184
    v_mul_f32 v222, v222, v184
    v_mul_f32 v223, v223, v184
    v_sub_f32 v96, v96, v186
    v_sub_f32 v97, v97, v186
    v_sub_f32 v98, v98, v186
    v_sub_f32 v99, v99, v186
    v_sub_f32 v100, v100, v186
    v_sub_f32 v101, v101, v186
    v_sub_f32 v102, v102, v186
    v_sub_f32 v103, v103, v186
    v_sub_f32 v112, v112, v186
    v_sub_f32 v113, v113, v186
    v_sub_f32 v114, v114, v186
    v_sub_f32 v115, v115, v186
    v_sub_f32 v116, v116, v186
    v_sub_f32 v117, v117, v186
    v_sub_f32 v118, v118, v186
    v_sub_f32 v119, v119, v186
    v_sub_f32 v176, v176, v186
    v_sub_f32 v177, v177, v186
    v_sub_f32 v178, v178, v186
    v_sub_f32 v179, v179, v186
    v_mul_f32 v12, v12, v185
    v_mul_f32 v13, v13, v185
    v_mul_f32 v14, v14, v185
    v_mul_f32 v15, v15, v185
    v_mul_f32 v224, v224, v185
    v_mul_f32 v225, v225, v185
    v_mul_f32 v226, v226, v185
    v_mul_f32 v227, v227, v185
    v_mul_f32 v228, v228, v185
    v_mul_f32 v229, v229, v185
    v_mul_f32 v230, v230, v185
    v_mul_f32 v231, v231, v185
    v_mul_f32 v232, v232, v185
    v_mul_f32 v233, v233, v185
    v_mul_f32 v234, v234, v185
    v_mul_f32 v235, v235, v185
    v_mul_f32 v236, v236, v185
    v_mul_f32 v237, v237, v185
    v_mul_f32 v238, v238, v185
    v_mul_f32 v239, v239, v185
    v_mul_f32 v240, v240, v185
    v_mul_f32 v241, v241, v185
    v_mul_f32 v242, v242, v185
    v_mul_f32 v243, v243, v185
    v_mul_f32 v244, v244, v185
    v_mul_f32 v245, v245, v185
    v_mul_f32 v246, v246, v185
    v_mul_f32 v247, v247, v185
    v_mul_f32 v248, v248, v185
    v_mul_f32 v249, v249, v185
    v_mul_f32 v250, v250, v185
    v_mul_f32 v251, v251, v185
    v_mul_f32 v252, v252, v185
    v_mul_f32 v253, v253, v185
    v_mul_f32 v254, v254, v185
    v_mul_f32 v255, v255, v185
    v_sub_f32 v104, v104, v187
    v_sub_f32 v105, v105, v187
    v_sub_f32 v106, v106, v187
    v_sub_f32 v107, v107, v187
    v_sub_f32 v108, v108, v187
    v_sub_f32 v109, v109, v187
    v_sub_f32 v110, v110, v187
    v_sub_f32 v111, v111, v187
    v_sub_f32 v120, v120, v187
    v_sub_f32 v121, v121, v187
    v_sub_f32 v122, v122, v187
    v_sub_f32 v123, v123, v187
    v_sub_f32 v124, v124, v187
    v_sub_f32 v125, v125, v187
    v_sub_f32 v126, v126, v187
    v_sub_f32 v127, v127, v187
    v_sub_f32 v180, v180, v187
    v_sub_f32 v181, v181, v187
    v_sub_f32 v182, v182, v187
    v_sub_f32 v183, v183, v187
    v_exp_f32 v160, v96
    v_exp_f32 v161, v97
    v_exp_f32 v162, v98
    v_exp_f32 v163, v99
    v_exp_f32 v164, v100
    v_exp_f32 v165, v101
    v_exp_f32 v166, v102
    v_exp_f32 v167, v103
    v_exp_f32 v168, v104
    v_exp_f32 v169, v105
    v_exp_f32 v170, v106
    v_exp_f32 v171, v107
    v_exp_f32 v172, v108
    v_exp_f32 v173, v109
    v_exp_f32 v174, v110
    v_exp_f32 v175, v111
    v_cvt_pk_bf16_f32 v40, v160, v161
    v_cvt_pk_bf16_f32 v41, v162, v163
    v_cvt_pk_bf16_f32 v42, v164, v165
    v_cvt_pk_bf16_f32 v43, v166, v167
    v_cvt_pk_bf16_f32 v44, v168, v169
    v_cvt_pk_bf16_f32 v45, v170, v171
    v_cvt_pk_bf16_f32 v46, v172, v173
    v_cvt_pk_bf16_f32 v47, v174, v175
    s_nop 1
    s_branch L_rr_a8
L_rs_a9:
    s_nop 7
    s_nop 7
    v_max3_f32 v186, v112, v113, v114
    v_max3_f32 v187, v120, v121, v122
    v_max3_f32 v186, v186, v115, v116
    v_max3_f32 v187, v187, v123, v124
    v_max3_f32 v186, v186, v117, v118
    v_max3_f32 v187, v187, v125, v126
    v_max_f32 v186, v186, v119
    v_max_f32 v187, v187, v127
    s_nop 1
    v_permlane32_swap_b32 v186, v187
    v_max_f32 v187, v186, v187
    v_mov_b32 v191, v187
    s_nop 1
    v_permlane16_swap_b32 v191, v187
    v_max_f32 v187, v191, v187
    v_add_f32 v187, 0x41800000, v187
    v_max_f32 v187, 0, v187
    v_mov_b32 v186, v187
    s_nop 1
    v_permlane32_swap_b32 v186, v187
    v_exp_f32 v184, -v186
    v_exp_f32 v185, -v187
    v_mul_f32 v8, v8, v184
    v_mul_f32 v9, v9, v184
    v_mul_f32 v10, v10, v184
    v_mul_f32 v11, v11, v184
    v_mul_f32 v192, v192, v184
    v_mul_f32 v193, v193, v184
    v_mul_f32 v194, v194, v184
    v_mul_f32 v195, v195, v184
    v_mul_f32 v196, v196, v184
    v_mul_f32 v197, v197, v184
    v_mul_f32 v198, v198, v184
    v_mul_f32 v199, v199, v184
    v_mul_f32 v200, v200, v184
    v_mul_f32 v201, v201, v184
    v_mul_f32 v202, v202, v184
    v_mul_f32 v203, v203, v184
    v_mul_f32 v204, v204, v184
    v_mul_f32 v205, v205, v184
    v_mul_f32 v206, v206, v184
    v_mul_f32 v207, v207, v184
    v_mul_f32 v208, v208, v184
    v_mul_f32 v209, v209, v184
    v_mul_f32 v210, v210, v184
    v_mul_f32 v211, v211, v184
    v_mul_f32 v212, v212, v184
    v_mul_f32 v213, v213, v184
    v_mul_f32 v214, v214, v184
    v_mul_f32 v215, v215, v184
    v_mul_f32 v216, v216, v184
    v_mul_f32 v217, v217, v184
    v_mul_f32 v218, v218, v184
    v_mul_f32 v219, v219, v184
    v_mul_f32 v220, v220, v184
    v_mul_f32 v221, v221, v184
    v_mul_f32 v222, v222, v184
    v_mul_f32 v223, v223, v184
    v_sub_f32 v112, v112, v186
    v_sub_f32 v113, v113, v186
    v_sub_f32 v114, v114, v186
    v_sub_f32 v115, v115, v186
    v_sub_f32 v116, v116, v186
    v_sub_f32 v117, v117, v186
    v_sub_f32 v118, v118, v186
    v_sub_f32 v119, v119, v186
    v_sub_f32 v96, v96, v186
    v_sub_f32 v97, v97, v186
    v_sub_f32 v98, v98, v186
    v_sub_f32 v99, v99, v186
    v_sub_f32 v100, v100, v186
    v_sub_f32 v101, v101, v186
    v_sub_f32 v102, v102, v186
    v_sub_f32 v103, v103, v186
    v_sub_f32 v176, v176, v186
    v_sub_f32 v177, v177, v186
    v_sub_f32 v178, v178, v186
    v_sub_f32 v179, v179, v186
    v_mul_f32 v12, v12, v185
    v_mul_f32 v13, v13, v185
    v_mul_f32 v14, v14, v185
    v_mul_f32 v15, v15, v185
    v_mul_f32 v224, v224, v185
    v_mul_f32 v225, v225, v185
    v_mul_f32 v226, v226, v185
    v_mul_f32 v227, v227, v185
    v_mul_f32 v228, v228, v185
    v_mul_f32 v229, v229, v185
    v_mul_f32 v230, v230, v185
    v_mul_f32 v231, v231, v185
    v_mul_f32 v232, v232, v185
    v_mul_f32 v233, v233, v185
    v_mul_f32 v234, v234, v185
    v_mul_f32 v235, v235, v185
    v_mul_f32 v236, v236, v185
    v_mul_f32 v237, v237, v185
    v_mul_f32 v238, v238, v185
    v_mul_f32 v239, v239, v185
    v_mul_f32 v240, v240, v185
    v_mul_f32 v241, v241, v185
    v_mul_f32 v242, v242, v185
    v_mul_f32 v243, v243, v185
    v_mul_f32 v244, v244, v185
    v_mul_f32 v245, v245, v185
    v_mul_f32 v246, v246, v185
    v_mul_f32 v247, v247, v185
    v_mul_f32 v248, v248, v185
    v_mul_f32 v249, v249, v185
    v_mul_f32 v250, v250, v185
    v_mul_f32 v251, v251, v185
    v_mul_f32 v252, v252, v185
    v_mul_f32 v253, v253, v185
    v_mul_f32 v254, v254, v185
    v_mul_f32 v255, v255, v185
    v_sub_f32 v120, v120, v187
    v_sub_f32 v121, v121, v187
    v_sub_f32 v122, v122, v187
    v_sub_f32 v123, v123, v187
    v_sub_f32 v124, v124, v187
    v_sub_f32 v125, v125, v187
    v_sub_f32 v126, v126, v187
    v_sub_f32 v127, v127, v187
    v_sub_f32 v104, v104, v187
    v_sub_f32 v105, v105, v187
    v_sub_f32 v106, v106, v187
    v_sub_f32 v107, v107, v187
    v_sub_f32 v108, v108, v187
    v_sub_f32 v109, v109, v187
    v_sub_f32 v110, v110, v187
    v_sub_f32 v111, v111, v187
    v_sub_f32 v180, v180, v187
    v_sub_f32 v181, v181, v187
    v_sub_f32 v182, v182, v187
    v_sub_f32 v183, v183, v187
    v_exp_f32 v160, v112
    v_exp_f32 v161, v113
    v_exp_f32 v162, v114
    v_exp_f32 v163, v115
    v_exp_f32 v164, v116
    v_exp_f32 v165, v117
    v_exp_f32 v166, v118
    v_exp_f32 v167, v119
    v_exp_f32 v168, v120
    v_exp_f32 v169, v121
    v_exp_f32 v170, v122
    v_exp_f32 v171, v123
    v_exp_f32 v172, v124
    v_exp_f32 v173, v125
    v_exp_f32 v174, v126
    v_exp_f32 v175, v127
    v_cvt_pk_bf16_f32 v40, v160, v161
    v_cvt_pk_bf16_f32 v41, v162, v163
    v_cvt_pk_bf16_f32 v42, v164, v165
    v_cvt_pk_bf16_f32 v43, v166, v167
    v_cvt_pk_bf16_f32 v44, v168, v169
    v_cvt_pk_bf16_f32 v45, v170, v171
    v_cvt_pk_bf16_f32 v46, v172, v173
    v_cvt_pk_bf16_f32 v47, v174, v175
    s_nop 1
    s_branch L_rr_a9
L_rs_a10:
    s_nop 7
    s_nop 7
    v_max3_f32 v186, v96, v97, v98
    v_max3_f32 v187, v104, v105, v106
    v_max3_f32 v186, v186, v99, v100
    v_max3_f32 v187, v187, v107, v108
    v_max3_f32 v186, v186, v101, v102
    v_max3_f32 v187, v187, v109, v110
    v_max_f32 v186, v186, v103
    v_max_f32 v187, v187, v111
    s_nop 1
    v_permlane32_swap_b32 v186, v187
    v_max_f32 v187, v186, v187
    v_mov_b32 v191, v187
    s_nop 1
    v_permlane16_swap_b32 v191, v187
    v_max_f32 v187, v191, v187
    v_add_f32 v187, 0x41800000, v187
    v_max_f32 v187, 0, v187
    v_mov_b32 v186, v187
    s_nop 1
    v_permlane32_swap_b32 v186, v187
    v_exp_f32 v184, -v186
    v_exp_f32 v185, -v187
    v_mul_f32 v8, v8, v184
    v_mul_f32 v9, v9, v184
    v_mul_f32 v10, v10, v184
    v_mul_f32 v11, v11, v184
    v_mul_f32 v192, v192, v184
    v_mul_f32 v193, v193, v184
    v_mul_f32 v194, v194, v184
    v_mul_f32 v195, v195, v184
    v_mul_f32 v196, v196, v184
    v_mul_f32 v197, v197, v184
    v_mul_f32 v198, v198, v184
    v_mul_f32 v199, v199, v184
    v_mul_f32 v200, v200, v184
    v_mul_f32 v201, v201, v184
    v_mul_f32 v202, v202, v184
    v_mul_f32 v203, v203, v184
    v_mul_f32 v204, v204, v184
    v_mul_f32 v205, v205, v184
    v_mul_f32 v206, v206, v184
    v_mul_f32 v207, v207, v184
    v_mul_f32 v208, v208, v184
    v_mul_f32 v209, v209, v184
    v_mul_f32 v210, v210, v184
    v_mul_f32 v211, v211, v184
    v_mul_f32 v212, v212, v184
    v_mul_f32 v213, v213, v184
    v_mul_f32 v214, v214, v184
    v_mul_f32 v215, v215, v184
    v_mul_f32 v216, v216, v184
    v_mul_f32 v217, v217, v184
    v_mul_f32 v218, v218, v184
    v_mul_f32 v219, v219, v184
    v_mul_f32 v220, v220, v184
    v_mul_f32 v221, v221, v184
    v_mul_f32 v222, v222, v184
    v_mul_f32 v223, v223, v184
    v_sub_f32 v96, v96, v186
    v_sub_f32 v97, v97, v186
    v_sub_f32 v98, v98, v186
    v_sub_f32 v99, v99, v186
    v_sub_f32 v100, v100, v186
    v_sub_f32 v101, v101, v186
    v_sub_f32 v102, v102, v186
    v_sub_f32 v103, v103, v186
    v_sub_f32 v112, v112, v186
    v_sub_f32 v113, v113, v186
    v_sub_f32 v114, v114, v186
    v_sub_f32 v115, v115, v186
    v_sub_f32 v116, v116, v186
    v_sub_f32 v117, v117, v186
    v_sub_f32 v118, v118, v186
    v_sub_f32 v119, v119, v186
    v_sub_f32 v176, v176, v186
    v_sub_f32 v177, v177, v186
    v_sub_f32 v178, v178, v186
    v_sub_f32 v179, v179, v186
    v_mul_f32 v12, v12, v185
    v_mul_f32 v13, v13, v185
    v_mul_f32 v14, v14, v185
    v_mul_f32 v15, v15, v185
    v_mul_f32 v224, v224, v185
    v_mul_f32 v225, v225, v185
    v_mul_f32 v226, v226, v185
    v_mul_f32 v227, v227, v185
    v_mul_f32 v228, v228, v185
    v_mul_f32 v229, v229, v185
    v_mul_f32 v230, v230, v185
    v_mul_f32 v231, v231, v185
    v_mul_f32 v232, v232, v185
    v_mul_f32 v233, v233, v185
    v_mul_f32 v234, v234, v185
    v_mul_f32 v235, v235, v185
    v_mul_f32 v236, v236, v185
    v_mul_f32 v237, v237, v185
    v_mul_f32 v238, v238, v185
    v_mul_f32 v239, v239, v185
    v_mul_f32 v240, v240, v185
    v_mul_f32 v241, v241, v185
    v_mul_f32 v242, v242, v185
    v_mul_f32 v243, v243, v185
    v_mul_f32 v244, v244, v185
    v_mul_f32 v245, v245, v185
    v_mul_f32 v246, v246, v185
    v_mul_f32 v247, v247, v185
    v_mul_f32 v248, v248, v185
    v_mul_f32 v249, v249, v185
    v_mul_f32 v250, v250, v185
    v_mul_f32 v251, v251, v185
    v_mul_f32 v252, v252, v185
    v_mul_f32 v253, v253, v185
    v_mul_f32 v254, v254, v185
    v_mul_f32 v255, v255, v185
    v_sub_f32 v104, v104, v187
    v_sub_f32 v105, v105, v187
    v_sub_f32 v106, v106, v187
    v_sub_f32 v107, v107, v187
    v_sub_f32 v108, v108, v187
    v_sub_f32 v109, v109, v187
    v_sub_f32 v110, v110, v187
    v_sub_f32 v111, v111, v187
    v_sub_f32 v120, v120, v187
    v_sub_f32 v121, v121, v187
    v_sub_f32 v122, v122, v187
    v_sub_f32 v123, v123, v187
    v_sub_f32 v124, v124, v187
    v_sub_f32 v125, v125, v187
    v_sub_f32 v126, v126, v187
    v_sub_f32 v127, v127, v187
    v_sub_f32 v180, v180, v187
    v_sub_f32 v181, v181, v187
    v_sub_f32 v182, v182, v187
    v_sub_f32 v183, v183, v187
    v_exp_f32 v160, v96
    v_exp_f32 v161, v97
    v_exp_f32 v162, v98
    v_exp_f32 v163, v99
    v_exp_f32 v164, v100
    v_exp_f32 v165, v101
    v_exp_f32 v166, v102
    v_exp_f32 v167, v103
    v_exp_f32 v168, v104
    v_exp_f32 v169, v105
    v_exp_f32 v170, v106
    v_exp_f32 v171, v107
    v_exp_f32 v172, v108
    v_exp_f32 v173, v109
    v_exp_f32 v174, v110
    v_exp_f32 v175, v111
    v_cvt_pk_bf16_f32 v40, v160, v161
    v_cvt_pk_bf16_f32 v41, v162, v163
    v_cvt_pk_bf16_f32 v42, v164, v165
    v_cvt_pk_bf16_f32 v43, v166, v167
    v_cvt_pk_bf16_f32 v44, v168, v169
    v_cvt_pk_bf16_f32 v45, v170, v171
    v_cvt_pk_bf16_f32 v46, v172, v173
    v_cvt_pk_bf16_f32 v47, v174, v175
    s_nop 1
    s_branch L_rr_a10
L_rs_a11:
    s_nop 7
    s_nop 7
    v_max3_f32 v186, v112, v113, v114
    v_max3_f32 v187, v120, v121, v122
    v_max3_f32 v186, v186, v115, v116
    v_max3_f32 v187, v187, v123, v124
    v_max3_f32 v186, v186, v117, v118
    v_max3_f32 v187, v187, v125, v126
    v_max_f32 v186, v186, v119
    v_max_f32 v187, v187, v127
    s_nop 1
    v_permlane32_swap_b32 v186, v187
    v_max_f32 v187, v186, v187
    v_mov_b32 v191, v187
    s_nop 1
    v_permlane16_swap_b32 v191, v187
    v_max_f32 v187, v191, v187
    v_add_f32 v187, 0x41800000, v187
    v_max_f32 v187, 0, v187
    v_mov_b32 v186, v187
    s_nop 1
    v_permlane32_swap_b32 v186, v187
    v_exp_f32 v184, -v186
    v_exp_f32 v185, -v187
    v_mul_f32 v8, v8, v184
    v_mul_f32 v9, v9, v184
    v_mul_f32 v10, v10, v184
    v_mul_f32 v11, v11, v184
    v_mul_f32 v192, v192, v184
    v_mul_f32 v193, v193, v184
    v_mul_f32 v194, v194, v184
    v_mul_f32 v195, v195, v184
    v_mul_f32 v196, v196, v184
    v_mul_f32 v197, v197, v184
    v_mul_f32 v198, v198, v184
    v_mul_f32 v199, v199, v184
    v_mul_f32 v200, v200, v184
    v_mul_f32 v201, v201, v184
    v_mul_f32 v202, v202, v184
    v_mul_f32 v203, v203, v184
    v_mul_f32 v204, v204, v184
    v_mul_f32 v205, v205, v184
    v_mul_f32 v206, v206, v184
    v_mul_f32 v207, v207, v184
    v_mul_f32 v208, v208, v184
    v_mul_f32 v209, v209, v184
    v_mul_f32 v210, v210, v184
    v_mul_f32 v211, v211, v184
    v_mul_f32 v212, v212, v184
    v_mul_f32 v213, v213, v184
    v_mul_f32 v214, v214, v184
    v_mul_f32 v215, v215, v184
    v_mul_f32 v216, v216, v184
    v_mul_f32 v217, v217, v184
    v_mul_f32 v218, v218, v184
    v_mul_f32 v219, v219, v184
    v_mul_f32 v220, v220, v184
    v_mul_f32 v221, v221, v184
    v_mul_f32 v222, v222, v184
    v_mul_f32 v223, v223, v184
    v_sub_f32 v112, v112, v186
    v_sub_f32 v113, v113, v186
    v_sub_f32 v114, v114, v186
    v_sub_f32 v115, v115, v186
    v_sub_f32 v116, v116, v186
    v_sub_f32 v117, v117, v186
    v_sub_f32 v118, v118, v186
    v_sub_f32 v119, v119, v186
    v_sub_f32 v96, v96, v186
    v_sub_f32 v97, v97, v186
    v_sub_f32 v98, v98, v186
    v_sub_f32 v99, v99, v186
    v_sub_f32 v100, v100, v186
    v_sub_f32 v101, v101, v186
    v_sub_f32 v102, v102, v186
    v_sub_f32 v103, v103, v186
    v_sub_f32 v176, v176, v186
    v_sub_f32 v177, v177, v186
    v_sub_f32 v178, v178, v186
    v_sub_f32 v179, v179, v186
    v_mul_f32 v12, v12, v185
    v_mul_f32 v13, v13, v185
    v_mul_f32 v14, v14, v185
    v_mul_f32 v15, v15, v185
    v_mul_f32 v224, v224, v185
    v_mul_f32 v225, v225, v185
    v_mul_f32 v226, v226, v185
    v_mul_f32 v227, v227, v185
    v_mul_f32 v228, v228, v185
    v_mul_f32 v229, v229, v185
    v_mul_f32 v230, v230, v185
    v_mul_f32 v231, v231, v185
    v_mul_f32 v232, v232, v185
    v_mul_f32 v233, v233, v185
    v_mul_f32 v234, v234, v185
    v_mul_f32 v235, v235, v185
    v_mul_f32 v236, v236, v185
    v_mul_f32 v237, v237, v185
    v_mul_f32 v238, v238, v185
    v_mul_f32 v239, v239, v185
    v_mul_f32 v240, v240, v185
    v_mul_f32 v241, v241, v185
    v_mul_f32 v242, v242, v185
    v_mul_f32 v243, v243, v185
    v_mul_f32 v244, v244, v185
    v_mul_f32 v245, v245, v185
    v_mul_f32 v246, v246, v185
    v_mul_f32 v247, v247, v185
    v_mul_f32 v248, v248, v185
    v_mul_f32 v249, v249, v185
    v_mul_f32 v250, v250, v185
    v_mul_f32 v251, v251, v185
    v_mul_f32 v252, v252, v185
    v_mul_f32 v253, v253, v185
    v_mul_f32 v254, v254, v185
    v_mul_f32 v255, v255, v185
    v_sub_f32 v120, v120, v187
    v_sub_f32 v121, v121, v187
    v_sub_f32 v122, v122, v187
    v_sub_f32 v123, v123, v187
    v_sub_f32 v124, v124, v187
    v_sub_f32 v125, v125, v187
    v_sub_f32 v126, v126, v187
    v_sub_f32 v127, v127, v187
    v_sub_f32 v104, v104, v187
    v_sub_f32 v105, v105, v187
    v_sub_f32 v106, v106, v187
    v_sub_f32 v107, v107, v187
    v_sub_f32 v108, v108, v187
    v_sub_f32 v109, v109, v187
    v_sub_f32 v110, v110, v187
    v_sub_f32 v111, v111, v187
    v_sub_f32 v180, v180, v187
    v_sub_f32 v181, v181, v187
    v_sub_f32 v182, v182, v187
    v_sub_f32 v183, v183, v187
    v_exp_f32 v160, v112
    v_exp_f32 v161, v113
    v_exp_f32 v162, v114
    v_exp_f32 v163, v115
    v_exp_f32 v164, v116
    v_exp_f32 v165, v117
    v_exp_f32 v166, v118
    v_exp_f32 v167, v119
    v_exp_f32 v168, v120
    v_exp_f32 v169, v121
    v_exp_f32 v170, v122
    v_exp_f32 v171, v123
    v_exp_f32 v172, v124
    v_exp_f32 v173, v125
    v_exp_f32 v174, v126
    v_exp_f32 v175, v127
    v_cvt_pk_bf16_f32 v40, v160, v161
    v_cvt_pk_bf16_f32 v41, v162, v163
    v_cvt_pk_bf16_f32 v42, v164, v165
    v_cvt_pk_bf16_f32 v43, v166, v167
    v_cvt_pk_bf16_f32 v44, v168, v169
    v_cvt_pk_bf16_f32 v45, v170, v171
    v_cvt_pk_bf16_f32 v46, v172, v173
    v_cvt_pk_bf16_f32 v47, v174, v175
    s_nop 1
    s_branch L_rr_a11
L_rs_a12:
    s_nop 7
    s_nop 7
    v_max3_f32 v186, v96, v97, v98
    v_max3_f32 v187, v104, v105, v106
    v_max3_f32 v186, v186, v99, v100
    v_max3_f32 v187, v187, v107, v108
    v_max3_f32 v186, v186, v101, v102
    v_max3_f32 v187, v187, v109, v110
    v_max_f32 v186, v186, v103
    v_max_f32 v187, v187, v111
    s_nop 1
    v_permlane32_swap_b32 v186, v187
    v_max_f32 v187, v186, v187
    v_mov_b32 v191, v187
    s_nop 1
    v_permlane16_swap_b32 v191, v187
    v_max_f32 v187, v191, v187
    v_add_f32 v187, 0x41800000, v187
    v_max_f32 v187, 0, v187
    v_mov_b32 v186, v187
    s_nop 1
    v_permlane32_swap_b32 v186, v187
    v_exp_f32 v184, -v186
    v_exp_f32 v185, -v187
    v_mul_f32 v8, v8, v184
    v_mul_f32 v9, v9, v184
    v_mul_f32 v10, v10, v184
    v_mul_f32 v11, v11, v184
    v_mul_f32 v192, v192, v184
    v_mul_f32 v193, v193, v184
    v_mul_f32 v194, v194, v184
    v_mul_f32 v195, v195, v184
    v_mul_f32 v196, v196, v184
    v_mul_f32 v197, v197, v184
    v_mul_f32 v198, v198, v184
    v_mul_f32 v199, v199, v184
    v_mul_f32 v200, v200, v184
    v_mul_f32 v201, v201, v184
    v_mul_f32 v202, v202, v184
    v_mul_f32 v203, v203, v184
    v_mul_f32 v204, v204, v184
    v_mul_f32 v205, v205, v184
    v_mul_f32 v206, v206, v184
    v_mul_f32 v207, v207, v184
    v_mul_f32 v208, v208, v184
    v_mul_f32 v209, v209, v184
    v_mul_f32 v210, v210, v184
    v_mul_f32 v211, v211, v184
    v_mul_f32 v212, v212, v184
    v_mul_f32 v213, v213, v184
    v_mul_f32 v214, v214, v184
    v_mul_f32 v215, v215, v184
    v_mul_f32 v216, v216, v184
    v_mul_f32 v217, v217, v184
    v_mul_f32 v218, v218, v184
    v_mul_f32 v219, v219, v184
    v_mul_f32 v220, v220, v184
    v_mul_f32 v221, v221, v184
    v_mul_f32 v222, v222, v184
    v_mul_f32 v223, v223, v184
    v_sub_f32 v96, v96, v186
    v_sub_f32 v97, v97, v186
    v_sub_f32 v98, v98, v186
    v_sub_f32 v99, v99, v186
    v_sub_f32 v100, v100, v186
    v_sub_f32 v101, v101, v186
    v_sub_f32 v102, v102, v186
    v_sub_f32 v103, v103, v186
    v_sub_f32 v112, v112, v186
    v_sub_f32 v113, v113, v186
    v_sub_f32 v114, v114, v186
    v_sub_f32 v115, v115, v186
    v_sub_f32 v116, v116, v186
    v_sub_f32 v117, v117, v186
    v_sub_f32 v118, v118, v186
    v_sub_f32 v119, v119, v186
    v_sub_f32 v176, v176, v186
    v_sub_f32 v177, v177, v186
    v_sub_f32 v178, v178, v186
    v_sub_f32 v179, v179, v186
    v_mul_f32 v12, v12, v185
    v_mul_f32 v13, v13, v185
    v_mul_f32 v14, v14, v185
    v_mul_f32 v15, v15, v185
    v_mul_f32 v224, v224, v185
    v_mul_f32 v225, v225, v185
    v_mul_f32 v226, v226, v185
    v_mul_f32 v227, v227, v185
    v_mul_f32 v228, v228, v185
    v_mul_f32 v229, v229, v185
    v_mul_f32 v230, v230, v185
    v_mul_f32 v231, v231, v185
    v_mul_f32 v232, v232, v185
    v_mul_f32 v233, v233, v185
    v_mul_f32 v234, v234, v185
    v_mul_f32 v235, v235, v185
    v_mul_f32 v236, v236, v185
    v_mul_f32 v237, v237, v185
    v_mul_f32 v238, v238, v185
    v_mul_f32 v239, v239, v185
    v_mul_f32 v240, v240, v185
    v_mul_f32 v241, v241, v185
    v_mul_f32 v242, v242, v185
    v_mul_f32 v243, v243, v185
    v_mul_f32 v244, v244, v185
    v_mul_f32 v245, v245, v185
    v_mul_f32 v246, v246, v185
    v_mul_f32 v247, v247, v185
    v_mul_f32 v248, v248, v185
    v_mul_f32 v249, v249, v185
    v_mul_f32 v250, v250, v185
    v_mul_f32 v251, v251, v185
    v_mul_f32 v252, v252, v185
    v_mul_f32 v253, v253, v185
    v_mul_f32 v254, v254, v185
    v_mul_f32 v255, v255, v185
    v_sub_f32 v104, v104, v187
    v_sub_f32 v105, v105, v187
    v_sub_f32 v106, v106, v187
    v_sub_f32 v107, v107, v187
    v_sub_f32 v108, v108, v187
    v_sub_f32 v109, v109, v187
    v_sub_f32 v110, v110, v187
    v_sub_f32 v111, v111, v187
    v_sub_f32 v120, v120, v187
    v_sub_f32 v121, v121, v187
    v_sub_f32 v122, v122, v187
    v_sub_f32 v123, v123, v187
    v_sub_f32 v124, v124, v187
    v_sub_f32 v125, v125, v187
    v_sub_f32 v126, v126, v187
    v_sub_f32 v127, v127, v187
    v_sub_f32 v180, v180, v187
    v_sub_f32 v181, v181, v187
    v_sub_f32 v182, v182, v187
    v_sub_f32 v183, v183, v187
    v_exp_f32 v160, v96
    v_exp_f32 v161, v97
    v_exp_f32 v162, v98
    v_exp_f32 v163, v99
    v_exp_f32 v164, v100
    v_exp_f32 v165, v101
    v_exp_f32 v166, v102
    v_exp_f32 v167, v103
    v_exp_f32 v168, v104
    v_exp_f32 v169, v105
    v_exp_f32 v170, v106
    v_exp_f32 v171, v107
    v_exp_f32 v172, v108
    v_exp_f32 v173, v109
    v_exp_f32 v174, v110
    v_exp_f32 v175, v111
    v_cvt_pk_bf16_f32 v40, v160, v161
    v_cvt_pk_bf16_f32 v41, v162, v163
    v_cvt_pk_bf16_f32 v42, v164, v165
    v_cvt_pk_bf16_f32 v43, v166, v167
    v_cvt_pk_bf16_f32 v44, v168, v169
    v_cvt_pk_bf16_f32 v45, v170, v171
    v_cvt_pk_bf16_f32 v46, v172, v173
    v_cvt_pk_bf16_f32 v47, v174, v175
    s_nop 1
    s_branch L_rr_a12
L_rs_a13:
    s_nop 7
    s_nop 7
    v_max3_f32 v186, v112, v113, v114
    v_max3_f32 v187, v120, v121, v122
    v_max3_f32 v186, v186, v115, v116
    v_max3_f32 v187, v187, v123, v124
    v_max3_f32 v186, v186, v117, v118
    v_max3_f32 v187, v187, v125, v126
    v_max_f32 v186, v186, v119
    v_max_f32 v187, v187, v127
    s_nop 1
    v_permlane32_swap_b32 v186, v187
    v_max_f32 v187, v186, v187
    v_mov_b32 v191, v187
    s_nop 1
    v_permlane16_swap_b32 v191, v187
    v_max_f32 v187, v191, v187
    v_add_f32 v187, 0x41800000, v187
    v_max_f32 v187, 0, v187
    v_mov_b32 v186, v187
    s_nop 1
    v_permlane32_swap_b32 v186, v187
    v_exp_f32 v184, -v186
    v_exp_f32 v185, -v187
    v_mul_f32 v8, v8, v184
    v_mul_f32 v9, v9, v184
    v_mul_f32 v10, v10, v184
    v_mul_f32 v11, v11, v184
    v_mul_f32 v192, v192, v184
    v_mul_f32 v193, v193, v184
    v_mul_f32 v194, v194, v184
    v_mul_f32 v195, v195, v184
    v_mul_f32 v196, v196, v184
    v_mul_f32 v197, v197, v184
    v_mul_f32 v198, v198, v184
    v_mul_f32 v199, v199, v184
    v_mul_f32 v200, v200, v184
    v_mul_f32 v201, v201, v184
    v_mul_f32 v202, v202, v184
    v_mul_f32 v203, v203, v184
    v_mul_f32 v204, v204, v184
    v_mul_f32 v205, v205, v184
    v_mul_f32 v206, v206, v184
    v_mul_f32 v207, v207, v184
    v_mul_f32 v208, v208, v184
    v_mul_f32 v209, v209, v184
    v_mul_f32 v210, v210, v184
    v_mul_f32 v211, v211, v184
    v_mul_f32 v212, v212, v184
    v_mul_f32 v213, v213, v184
    v_mul_f32 v214, v214, v184
    v_mul_f32 v215, v215, v184
    v_mul_f32 v216, v216, v184
    v_mul_f32 v217, v217, v184
    v_mul_f32 v218, v218, v184
    v_mul_f32 v219, v219, v184
    v_mul_f32 v220, v220, v184
    v_mul_f32 v221, v221, v184
    v_mul_f32 v222, v222, v184
    v_mul_f32 v223, v223, v184
    v_sub_f32 v112, v112, v186
    v_sub_f32 v113, v113, v186
    v_sub_f32 v114, v114, v186
    v_sub_f32 v115, v115, v186
    v_sub_f32 v116, v116, v186
    v_sub_f32 v117, v117, v186
    v_sub_f32 v118, v118, v186
    v_sub_f32 v119, v119, v186
    v_sub_f32 v96, v96, v186
    v_sub_f32 v97, v97, v186
    v_sub_f32 v98, v98, v186
    v_sub_f32 v99, v99, v186
    v_sub_f32 v100, v100, v186
    v_sub_f32 v101, v101, v186
    v_sub_f32 v102, v102, v186
    v_sub_f32 v103, v103, v186
    v_sub_f32 v176, v176, v186
    v_sub_f32 v177, v177, v186
    v_sub_f32 v178, v178, v186
    v_sub_f32 v179, v179, v186
    v_mul_f32 v12, v12, v185
    v_mul_f32 v13, v13, v185
    v_mul_f32 v14, v14, v185
    v_mul_f32 v15, v15, v185
    v_mul_f32 v224, v224, v185
    v_mul_f32 v225, v225, v185
    v_mul_f32 v226, v226, v185
    v_mul_f32 v227, v227, v185
    v_mul_f32 v228, v228, v185
    v_mul_f32 v229, v229, v185
    v_mul_f32 v230, v230, v185
    v_mul_f32 v231, v231, v185
    v_mul_f32 v232, v232, v185
    v_mul_f32 v233, v233, v185
    v_mul_f32 v234, v234, v185
    v_mul_f32 v235, v235, v185
    v_mul_f32 v236, v236, v185
    v_mul_f32 v237, v237, v185
    v_mul_f32 v238, v238, v185
    v_mul_f32 v239, v239, v185
    v_mul_f32 v240, v240, v185
    v_mul_f32 v241, v241, v185
    v_mul_f32 v242, v242, v185
    v_mul_f32 v243, v243, v185
    v_mul_f32 v244, v244, v185
    v_mul_f32 v245, v245, v185
    v_mul_f32 v246, v246, v185
    v_mul_f32 v247, v247, v185
    v_mul_f32 v248, v248, v185
    v_mul_f32 v249, v249, v185
    v_mul_f32 v250, v250, v185
    v_mul_f32 v251, v251, v185
    v_mul_f32 v252, v252, v185
    v_mul_f32 v253, v253, v185
    v_mul_f32 v254, v254, v185
    v_mul_f32 v255, v255, v185
    v_sub_f32 v120, v120, v187
    v_sub_f32 v121, v121, v187
    v_sub_f32 v122, v122, v187
    v_sub_f32 v123, v123, v187
    v_sub_f32 v124, v124, v187
    v_sub_f32 v125, v125, v187
    v_sub_f32 v126, v126, v187
    v_sub_f32 v127, v127, v187
    v_sub_f32 v104, v104, v187
    v_sub_f32 v105, v105, v187
    v_sub_f32 v106, v106, v187
    v_sub_f32 v107, v107, v187
    v_sub_f32 v108, v108, v187
    v_sub_f32 v109, v109, v187
    v_sub_f32 v110, v110, v187
    v_sub_f32 v111, v111, v187
    v_sub_f32 v180, v180, v187
    v_sub_f32 v181, v181, v187
    v_sub_f32 v182, v182, v187
    v_sub_f32 v183, v183, v187
    v_exp_f32 v160, v112
    v_exp_f32 v161, v113
    v_exp_f32 v162, v114
    v_exp_f32 v163, v115
    v_exp_f32 v164, v116
    v_exp_f32 v165, v117
    v_exp_f32 v166, v118
    v_exp_f32 v167, v119
    v_exp_f32 v168, v120
    v_exp_f32 v169, v121
    v_exp_f32 v170, v122
    v_exp_f32 v171, v123
    v_exp_f32 v172, v124
    v_exp_f32 v173, v125
    v_exp_f32 v174, v126
    v_exp_f32 v175, v127
    v_cvt_pk_bf16_f32 v40, v160, v161
    v_cvt_pk_bf16_f32 v41, v162, v163
    v_cvt_pk_bf16_f32 v42, v164, v165
    v_cvt_pk_bf16_f32 v43, v166, v167
    v_cvt_pk_bf16_f32 v44, v168, v169
    v_cvt_pk_bf16_f32 v45, v170, v171
    v_cvt_pk_bf16_f32 v46, v172, v173
    v_cvt_pk_bf16_f32 v47, v174, v175
    s_nop 1
    s_branch L_rr_a13
L_rs_a14:
    s_nop 7
    s_nop 7
    v_max3_f32 v186, v96, v97, v98
    v_max3_f32 v187, v104, v105, v106
    v_max3_f32 v186, v186, v99, v100
    v_max3_f32 v187, v187, v107, v108
    v_max3_f32 v186, v186, v101, v102
    v_max3_f32 v187, v187, v109, v110
    v_max_f32 v186, v186, v103
    v_max_f32 v187, v187, v111
    s_nop 1
    v_permlane32_swap_b32 v186, v187
    v_max_f32 v187, v186, v187
    v_mov_b32 v191, v187
    s_nop 1
    v_permlane16_swap_b32 v191, v187
    v_max_f32 v187, v191, v187
    v_add_f32 v187, 0x41800000, v187
    v_max_f32 v187, 0, v187
    v_mov_b32 v186, v187
    s_nop 1
    v_permlane32_swap_b32 v186, v187
    v_exp_f32 v184, -v186
    v_exp_f32 v185, -v187
    v_mul_f32 v8, v8, v184
    v_mul_f32 v9, v9, v184
    v_mul_f32 v10, v10, v184
    v_mul_f32 v11, v11, v184
    v_mul_f32 v192, v192, v184
    v_mul_f32 v193, v193, v184
    v_mul_f32 v194, v194, v184
    v_mul_f32 v195, v195, v184
    v_mul_f32 v196, v196, v184
    v_mul_f32 v197, v197, v184
    v_mul_f32 v198, v198, v184
    v_mul_f32 v199, v199, v184
    v_mul_f32 v200, v200, v184
    v_mul_f32 v201, v201, v184
    v_mul_f32 v202, v202, v184
    v_mul_f32 v203, v203, v184
    v_mul_f32 v204, v204, v184
    v_mul_f32 v205, v205, v184
    v_mul_f32 v206, v206, v184
    v_mul_f32 v207, v207, v184
    v_mul_f32 v208, v208, v184
    v_mul_f32 v209, v209, v184
    v_mul_f32 v210, v210, v184
    v_mul_f32 v211, v211, v184
    v_mul_f32 v212, v212, v184
    v_mul_f32 v213, v213, v184
    v_mul_f32 v214, v214, v184
    v_mul_f32 v215, v215, v184
    v_mul_f32 v216, v216, v184
    v_mul_f32 v217, v217, v184
    v_mul_f32 v218, v218, v184
    v_mul_f32 v219, v219, v184
    v_mul_f32 v220, v220, v184
    v_mul_f32 v221, v221, v184
    v_mul_f32 v222, v222, v184
    v_mul_f32 v223, v223, v184
    v_sub_f32 v96, v96, v186
    v_sub_f32 v97, v97, v186
    v_sub_f32 v98, v98, v186
    v_sub_f32 v99, v99, v186
    v_sub_f32 v100, v100, v186
    v_sub_f32 v101, v101, v186
    v_sub_f32 v102, v102, v186
    v_sub_f32 v103, v103, v186
    v_sub_f32 v112, v112, v186
    v_sub_f32 v113, v113, v186
    v_sub_f32 v114, v114, v186
    v_sub_f32 v115, v115, v186
    v_sub_f32 v116, v116, v186
    v_sub_f32 v117, v117, v186
    v_sub_f32 v118, v118, v186
    v_sub_f32 v119, v119, v186
    v_sub_f32 v176, v176, v186
    v_sub_f32 v177, v177, v186
    v_sub_f32 v178, v178, v186
    v_sub_f32 v179, v179, v186
    v_mul_f32 v12, v12, v185
    v_mul_f32 v13, v13, v185
    v_mul_f32 v14, v14, v185
    v_mul_f32 v15, v15, v185
    v_mul_f32 v224, v224, v185
    v_mul_f32 v225, v225, v185
    v_mul_f32 v226, v226, v185
    v_mul_f32 v227, v227, v185
    v_mul_f32 v228, v228, v185
    v_mul_f32 v229, v229, v185
    v_mul_f32 v230, v230, v185
    v_mul_f32 v231, v231, v185
    v_mul_f32 v232, v232, v185
    v_mul_f32 v233, v233, v185
    v_mul_f32 v234, v234, v185
    v_mul_f32 v235, v235, v185
    v_mul_f32 v236, v236, v185
    v_mul_f32 v237, v237, v185
    v_mul_f32 v238, v238, v185
    v_mul_f32 v239, v239, v185
    v_mul_f32 v240, v240, v185
    v_mul_f32 v241, v241, v185
    v_mul_f32 v242, v242, v185
    v_mul_f32 v243, v243, v185
    v_mul_f32 v244, v244, v185
    v_mul_f32 v245, v245, v185
    v_mul_f32 v246, v246, v185
    v_mul_f32 v247, v247, v185
    v_mul_f32 v248, v248, v185
    v_mul_f32 v249, v249, v185
    v_mul_f32 v250, v250, v185
    v_mul_f32 v251, v251, v185
    v_mul_f32 v252, v252, v185
    v_mul_f32 v253, v253, v185
    v_mul_f32 v254, v254, v185
    v_mul_f32 v255, v255, v185
    v_sub_f32 v104, v104, v187
    v_sub_f32 v105, v105, v187
    v_sub_f32 v106, v106, v187
    v_sub_f32 v107, v107, v187
    v_sub_f32 v108, v108, v187
    v_sub_f32 v109, v109, v187
    v_sub_f32 v110, v110, v187
    v_sub_f32 v111, v111, v187
    v_sub_f32 v120, v120, v187
    v_sub_f32 v121, v121, v187
    v_sub_f32 v122, v122, v187
    v_sub_f32 v123, v123, v187
    v_sub_f32 v124, v124, v187
    v_sub_f32 v125, v125, v187
    v_sub_f32 v126, v126, v187
    v_sub_f32 v127, v127, v187
    v_sub_f32 v180, v180, v187
    v_sub_f32 v181, v181, v187
    v_sub_f32 v182, v182, v187
    v_sub_f32 v183, v183, v187
    v_exp_f32 v160, v96
    v_exp_f32 v161, v97
    v_exp_f32 v162, v98
    v_exp_f32 v163, v99
    v_exp_f32 v164, v100
    v_exp_f32 v165, v101
    v_exp_f32 v166, v102
    v_exp_f32 v167, v103
    v_exp_f32 v168, v104
    v_exp_f32 v169, v105
    v_exp_f32 v170, v106
    v_exp_f32 v171, v107
    v_exp_f32 v172, v108
    v_exp_f32 v173, v109
    v_exp_f32 v174, v110
    v_exp_f32 v175, v111
    v_cvt_pk_bf16_f32 v40, v160, v161
    v_cvt_pk_bf16_f32 v41, v162, v163
    v_cvt_pk_bf16_f32 v42, v164, v165
    v_cvt_pk_bf16_f32 v43, v166, v167
    v_cvt_pk_bf16_f32 v44, v168, v169
    v_cvt_pk_bf16_f32 v45, v170, v171
    v_cvt_pk_bf16_f32 v46, v172, v173
    v_cvt_pk_bf16_f32 v47, v174, v175
    s_nop 1
    s_branch L_rr_a14
L_rs_a15:
    s_nop 7
    s_nop 7
    v_max3_f32 v186, v112, v113, v114
    v_max3_f32 v187, v120, v121, v122
    v_max3_f32 v186, v186, v115, v116
    v_max3_f32 v187, v187, v123, v124
    v_max3_f32 v186, v186, v117, v118
    v_max3_f32 v187, v187, v125, v126
    v_max_f32 v186, v186, v119
    v_max_f32 v187, v187, v127
    s_nop 1
    v_permlane32_swap_b32 v186, v187
    v_max_f32 v187, v186, v187
    v_mov_b32 v191, v187
    s_nop 1
    v_permlane16_swap_b32 v191, v187
    v_max_f32 v187, v191, v187
    v_add_f32 v187, 0x41800000, v187
    v_max_f32 v187, 0, v187
    v_mov_b32 v186, v187
    s_nop 1
    v_permlane32_swap_b32 v186, v187
    v_exp_f32 v184, -v186
    v_exp_f32 v185, -v187
    v_mul_f32 v8, v8, v184
    v_mul_f32 v9, v9, v184
    v_mul_f32 v10, v10, v184
    v_mul_f32 v11, v11, v184
    v_mul_f32 v192, v192, v184
    v_mul_f32 v193, v193, v184
    v_mul_f32 v194, v194, v184
    v_mul_f32 v195, v195, v184
    v_mul_f32 v196, v196, v184
    v_mul_f32 v197, v197, v184
    v_mul_f32 v198, v198, v184
    v_mul_f32 v199, v199, v184
    v_mul_f32 v200, v200, v184
    v_mul_f32 v201, v201, v184
    v_mul_f32 v202, v202, v184
    v_mul_f32 v203, v203, v184
    v_mul_f32 v204, v204, v184
    v_mul_f32 v205, v205, v184
    v_mul_f32 v206, v206, v184
    v_mul_f32 v207, v207, v184
    v_mul_f32 v208, v208, v184
    v_mul_f32 v209, v209, v184
    v_mul_f32 v210, v210, v184
    v_mul_f32 v211, v211, v184
    v_mul_f32 v212, v212, v184
    v_mul_f32 v213, v213, v184
    v_mul_f32 v214, v214, v184
    v_mul_f32 v215, v215, v184
    v_mul_f32 v216, v216, v184
    v_mul_f32 v217, v217, v184
    v_mul_f32 v218, v218, v184
    v_mul_f32 v219, v219, v184
    v_mul_f32 v220, v220, v184
    v_mul_f32 v221, v221, v184
    v_mul_f32 v222, v222, v184
    v_mul_f32 v223, v223, v184
    v_sub_f32 v112, v112, v186
    v_sub_f32 v113, v113, v186
    v_sub_f32 v114, v114, v186
    v_sub_f32 v115, v115, v186
    v_sub_f32 v116, v116, v186
    v_sub_f32 v117, v117, v186
    v_sub_f32 v118, v118, v186
    v_sub_f32 v119, v119, v186
    v_mul_f32 v12, v12, v185
    v_mul_f32 v13, v13, v185
    v_mul_f32 v14, v14, v185
    v_mul_f32 v15, v15, v185
    v_mul_f32 v224, v224, v185
    v_mul_f32 v225, v225, v185
    v_mul_f32 v226, v226, v185
    v_mul_f32 v227, v227, v185
    v_mul_f32 v228, v228, v185
    v_mul_f32 v229, v229, v185
    v_mul_f32 v230, v230, v185
    v_mul_f32 v231, v231, v185
    v_mul_f32 v232, v232, v185
    v_mul_f32 v233, v233, v185
    v_mul_f32 v234, v234, v185
    v_mul_f32 v235, v235, v185
    v_mul_f32 v236, v236, v185
    v_mul_f32 v237, v237, v185
    v_mul_f32 v238, v238, v185
    v_mul_f32 v239, v239, v185
    v_mul_f32 v240, v240, v185
    v_mul_f32 v241, v241, v185
    v_mul_f32 v242, v242, v185
    v_mul_f32 v243, v243, v185
    v_mul_f32 v244, v244, v185
    v_mul_f32 v245, v245, v185
    v_mul_f32 v246, v246, v185
    v_mul_f32 v247, v247, v185
    v_mul_f32 v248, v248, v185
    v_mul_f32 v249, v249, v185
    v_mul_f32 v250, v250, v185
    v_mul_f32 v251, v251, v185
    v_mul_f32 v252, v252, v185
    v_mul_f32 v253, v253, v185
    v_mul_f32 v254, v254, v185
    v_mul_f32 v255, v255, v185
    v_sub_f32 v120, v120, v187
    v_sub_f32 v121, v121, v187
    v_sub_f32 v122, v122, v187
    v_sub_f32 v123, v123, v187
    v_sub_f32 v124, v124, v187
    v_sub_f32 v125, v125, v187
    v_sub_f32 v126, v126, v187
    v_sub_f32 v127, v127, v187
    v_exp_f32 v160, v112
    v_exp_f32 v161, v113
    v_exp_f32 v162, v114
    v_exp_f32 v163, v115
    v_exp_f32 v164, v116
    v_exp_f32 v165, v117
    v_exp_f32 v166, v118
    v_exp_f32 v167, v119
    v_exp_f32 v168, v120
    v_exp_f32 v169, v121
    v_exp_f32 v170, v122
    v_exp_f32 v171, v123
    v_exp_f32 v172, v124
    v_exp_f32 v173, v125
    v_exp_f32 v174, v126
    v_exp_f32 v175, v127
    v_cvt_pk_bf16_f32 v40, v160, v161
    v_cvt_pk_bf16_f32 v41, v162, v163
    v_cvt_pk_bf16_f32 v42, v164, v165
    v_cvt_pk_bf16_f32 v43, v166, v167
    v_cvt_pk_bf16_f32 v44, v168, v169
    v_cvt_pk_bf16_f32 v45, v170, v171
    v_cvt_pk_bf16_f32 v46, v172, v173
    v_cvt_pk_bf16_f32 v47, v174, v175
    s_nop 1
    s_branch L_rr_a15
L_rs_a16:
    s_nop 7
    s_nop 7
    v_max3_f32 v186, v96, v97, v98
    v_max3_f32 v187, v104, v105, v106
    v_max3_f32 v186, v186, v99, v100
    v_max3_f32 v187, v187, v107, v108
    v_max3_f32 v186, v186, v101, v102
    v_max3_f32 v187, v187, v109, v110
    v_max_f32 v186, v186, v103
    v_max_f32 v187, v187, v111
    s_nop 1
    v_permlane32_swap_b32 v186, v187
    v_max_f32 v187, v186, v187
    v_mov_b32 v191, v187
    s_nop 1
    v_permlane16_swap_b32 v191, v187
    v_max_f32 v187, v191, v187
    v_add_f32 v187, 0x41800000, v187
    v_max_f32 v187, 0, v187
    v_mov_b32 v186, v187
    s_nop 1
    v_permlane32_swap_b32 v186, v187
    v_exp_f32 v184, -v186
    v_exp_f32 v185, -v187
    v_mul_f32 v8, v8, v184
    v_mul_f32 v9, v9, v184
    v_mul_f32 v10, v10, v184
    v_mul_f32 v11, v11, v184
    v_mul_f32 v192, v192, v184
    v_mul_f32 v193, v193, v184
    v_mul_f32 v194, v194, v184
    v_mul_f32 v195, v195, v184
    v_mul_f32 v196, v196, v184
    v_mul_f32 v197, v197, v184
    v_mul_f32 v198, v198, v184
    v_mul_f32 v199, v199, v184
    v_mul_f32 v200, v200, v184
    v_mul_f32 v201, v201, v184
    v_mul_f32 v202, v202, v184
    v_mul_f32 v203, v203, v184
    v_mul_f32 v204, v204, v184
    v_mul_f32 v205, v205, v184
    v_mul_f32 v206, v206, v184
    v_mul_f32 v207, v207, v184
    v_mul_f32 v208, v208, v184
    v_mul_f32 v209, v209, v184
    v_mul_f32 v210, v210, v184
    v_mul_f32 v211, v211, v184
    v_mul_f32 v212, v212, v184
    v_mul_f32 v213, v213, v184
    v_mul_f32 v214, v214, v184
    v_mul_f32 v215, v215, v184
    v_mul_f32 v216, v216, v184
    v_mul_f32 v217, v217, v184
    v_mul_f32 v218, v218, v184
    v_mul_f32 v219, v219, v184
    v_mul_f32 v220, v220, v184
    v_mul_f32 v221, v221, v184
    v_mul_f32 v222, v222, v184
    v_mul_f32 v223, v223, v184
    v_sub_f32 v96, v96, v186
    v_sub_f32 v97, v97, v186
    v_sub_f32 v98, v98, v186
    v_sub_f32 v99, v99, v186
    v_sub_f32 v100, v100, v186
    v_sub_f32 v101, v101, v186
    v_sub_f32 v102, v102, v186
    v_sub_f32 v103, v103, v186
    v_sub_f32 v112, v112, v186
    v_sub_f32 v113, v113, v186
    v_sub_f32 v114, v114, v186
    v_sub_f32 v115, v115, v186
    v_sub_f32 v116, v116, v186
    v_sub_f32 v117, v117, v186
    v_sub_f32 v118, v118, v186
    v_sub_f32 v119, v119, v186
    v_sub_f32 v176, v176, v186
    v_sub_f32 v177, v177, v186
    v_sub_f32 v178, v178, v186
    v_sub_f32 v179, v179, v186
    v_mul_f32 v12, v12, v185
    v_mul_f32 v13, v13, v185
    v_mul_f32 v14, v14, v185
    v_mul_f32 v15, v15, v185
    v_mul_f32 v224, v224, v185
    v_mul_f32 v225, v225, v185
    v_mul_f32 v226, v226, v185
    v_mul_f32 v227, v227, v185
    v_mul_f32 v228, v228, v185
    v_mul_f32 v229, v229, v185
    v_mul_f32 v230, v230, v185
    v_mul_f32 v231, v231, v185
    v_mul_f32 v232, v232, v185
    v_mul_f32 v233, v233, v185
    v_mul_f32 v234, v234, v185
    v_mul_f32 v235, v235, v185
    v_mul_f32 v236, v236, v185
    v_mul_f32 v237, v237, v185
    v_mul_f32 v238, v238, v185
    v_mul_f32 v239, v239, v185
    v_mul_f32 v240, v240, v185
    v_mul_f32 v241, v241, v185
    v_mul_f32 v242, v242, v185
    v_mul_f32 v243, v243, v185
    v_mul_f32 v244, v244, v185
    v_mul_f32 v245, v245, v185
    v_mul_f32 v246, v246, v185
    v_mul_f32 v247, v247, v185
    v_mul_f32 v248, v248, v185
    v_mul_f32 v249, v249, v185
    v_mul_f32 v250, v250, v185
    v_mul_f32 v251, v251, v185
    v_mul_f32 v252, v252, v185
    v_mul_f32 v253, v253, v185
    v_mul_f32 v254, v254, v185
    v_mul_f32 v255, v255, v185
    v_sub_f32 v104, v104, v187
    v_sub_f32 v105, v105, v187
    v_sub_f32 v106, v106, v187
    v_sub_f32 v107, v107, v187
    v_sub_f32 v108, v108, v187
    v_sub_f32 v109, v109, v187
    v_sub_f32 v110, v110, v187
    v_sub_f32 v111, v111, v187
    v_sub_f32 v120, v120, v187
    v_sub_f32 v121, v121, v187
    v_sub_f32 v122, v122, v187
    v_sub_f32 v123, v123, v187
    v_sub_f32 v124, v124, v187
    v_sub_f32 v125, v125, v187
    v_sub_f32 v126, v126, v187
    v_sub_f32 v127, v127, v187
    v_sub_f32 v180, v180, v187
    v_sub_f32 v181, v181, v187
    v_sub_f32 v182, v182, v187
    v_sub_f32 v183, v183, v187
    v_exp_f32 v160, v96
    v_exp_f32 v161, v97
    v_exp_f32 v162, v98
    v_exp_f32 v163, v99
    v_exp_f32 v164, v100
    v_exp_f32 v165, v101
    v_exp_f32 v166, v102
    v_exp_f32 v167, v103
    v_exp_f32 v168, v104
    v_exp_f32 v169, v105
    v_exp_f32 v170, v106
    v_exp_f32 v171, v107
    v_exp_f32 v172, v108
    v_exp_f32 v173, v109
    v_exp_f32 v174, v110
    v_exp_f32 v175, v111
    v_cvt_pk_bf16_f32 v40, v160, v161
    v_cvt_pk_bf16_f32 v41, v162, v163
    v_cvt_pk_bf16_f32 v42, v164, v165
    v_cvt_pk_bf16_f32 v43, v166, v167
    v_cvt_pk_bf16_f32 v44, v168, v169
    v_cvt_pk_bf16_f32 v45, v170, v171
    v_cvt_pk_bf16_f32 v46, v172, v173
    v_cvt_pk_bf16_f32 v47, v174, v175
    s_nop 1
    s_branch L_rr_a16
L_rs_b1:
    s_nop 7
    s_nop 7
    v_max3_f32 v186, v112, v113, v114
    v_max3_f32 v187, v120, v121, v122
    v_max3_f32 v186, v186, v115, v116
    v_max3_f32 v187, v187, v123, v124
    v_max3_f32 v186, v186, v117, v118
    v_max3_f32 v187, v187, v125, v126
    v_max_f32 v186, v186, v119
    v_max_f32 v187, v187, v127
    s_nop 1
    v_permlane32_swap_b32 v186, v187
    v_max_f32 v187, v186, v187
    v_mov_b32 v191, v187
    s_nop 1
    v_permlane16_swap_b32 v191, v187
    v_max_f32 v187, v191, v187
    v_add_f32 v187, 0x41800000, v187
    v_max_f32 v187, 0, v187
    v_mov_b32 v186, v187
    s_nop 1
    v_permlane32_swap_b32 v186, v187
    v_exp_f32 v184, -v186
    v_exp_f32 v185, -v187
    v_mul_f32 v8, v8, v184
    v_mul_f32 v9, v9, v184
    v_mul_f32 v10, v10, v184
    v_mul_f32 v11, v11, v184
    v_mul_f32 v192, v192, v184
    v_mul_f32 v193, v193, v184
    v_mul_f32 v194, v194, v184
    v_mul_f32 v195, v195, v184
    v_mul_f32 v196, v196, v184
    v_mul_f32 v197, v197, v184
    v_mul_f32 v198, v198, v184
    v_mul_f32 v199, v199, v184
    v_mul_f32 v200, v200, v184
    v_mul_f32 v201, v201, v184
    v_mul_f32 v202, v202, v184
    v_mul_f32 v203, v203, v184
    v_mul_f32 v204, v204, v184
    v_mul_f32 v205, v205, v184
    v_mul_f32 v206, v206, v184
    v_mul_f32 v207, v207, v184
    v_mul_f32 v208, v208, v184
    v_mul_f32 v209, v209, v184
    v_mul_f32 v210, v210, v184
    v_mul_f32 v211, v211, v184
    v_mul_f32 v212, v212, v184
    v_mul_f32 v213, v213, v184
    v_mul_f32 v214, v214, v184
    v_mul_f32 v215, v215, v184
    v_mul_f32 v216, v216, v184
    v_mul_f32 v217, v217, v184
    v_mul_f32 v218, v218, v184
    v_mul_f32 v219, v219, v184
    v_mul_f32 v220, v220, v184
    v_mul_f32 v221, v221, v184
    v_mul_f32 v222, v222, v184
    v_mul_f32 v223, v223, v184
    v_sub_f32 v112, v112, v186
    v_sub_f32 v113, v113, v186
    v_sub_f32 v114, v114, v186
    v_sub_f32 v115, v115, v186
    v_sub_f32 v116, v116, v186
    v_sub_f32 v117, v117, v186
    v_sub_f32 v118, v118, v186
    v_sub_f32 v119, v119, v186
    v_sub_f32 v96, v96, v186
    v_sub_f32 v97, v97, v186
    v_sub_f32 v98, v98, v186
    v_sub_f32 v99, v99, v186
    v_sub_f32 v100, v100, v186
    v_sub_f32 v101, v101, v186
    v_sub_f32 v102, v102, v186
    v_sub_f32 v103, v103, v186
    v_sub_f32 v176, v176, v186
    v_sub_f32 v177, v177, v186
    v_sub_f32 v178, v178, v186
    v_sub_f32 v179, v179, v186
    v_mul_f32 v12, v12, v185
    v_mul_f32 v13, v13, v185
    v_mul_f32 v14, v14, v185
    v_mul_f32 v15, v15, v185
    v_mul_f32 v224, v224, v185
    v_mul_f32 v225, v225, v185
    v_mul_f32 v226, v226, v185
    v_mul_f32 v227, v227, v185
    v_mul_f32 v228, v228, v185
    v_mul_f32 v229, v229, v185
    v_mul_f32 v230, v230, v185
    v_mul_f32 v231, v231, v185
    v_mul_f32 v232, v232, v185
    v_mul_f32 v233, v233, v185
    v_mul_f32 v234, v234, v185
    v_mul_f32 v235, v235, v185
    v_mul_f32 v236, v236, v185
    v_mul_f32 v237, v237, v185
    v_mul_f32 v238, v238, v185
    v_mul_f32 v239, v239, v185
    v_mul_f32 v240, v240, v185
    v_mul_f32 v241, v241, v185
    v_mul_f32 v242, v242, v185
    v_mul_f32 v243, v243, v185
    v_mul_f32 v244, v244, v185
    v_mul_f32 v245, v245, v185
    v_mul_f32 v246, v246, v185
    v_mul_f32 v247, v247, v185
    v_mul_f32 v248, v248, v185
    v_mul_f32 v249, v249, v185
    v_mul_f32 v250, v250, v185
    v_mul_f32 v251, v251, v185
    v_mul_f32 v252, v252, v185
    v_mul_f32 v253, v253, v185
    v_mul_f32 v254, v254, v185
    v_mul_f32 v255, v255, v185
    v_sub_f32 v120, v120, v187
    v_sub_f32 v121, v121, v187
    v_sub_f32 v122, v122, v187
    v_sub_f32 v123, v123, v187
    v_sub_f32 v124, v124, v187
    v_sub_f32 v125, v125, v187
    v_sub_f32 v126, v126, v187
    v_sub_f32 v127, v127, v187
    v_sub_f32 v104, v104, v187
    v_sub_f32 v105, v105, v187
    v_sub_f32 v106, v106, v187
    v_sub_f32 v107, v107, v187
    v_sub_f32 v108, v108, v187
    v_sub_f32 v109, v109, v187
    v_sub_f32 v110, v110, v187
    v_sub_f32 v111, v111, v187
    v_sub_f32 v180, v180, v187
    v_sub_f32 v181, v181, v187
    v_sub_f32 v182, v182, v187
    v_sub_f32 v183, v183, v187
    v_exp_f32 v160, v112
    v_exp_f32 v161, v113
    v_exp_f32 v162, v114
    v_exp_f32 v163, v115
    v_exp_f32 v164, v116
    v_exp_f32 v165, v117
    v_exp_f32 v166, v118
    v_exp_f32 v167, v119
    v_exp_f32 v168, v120
    v_exp_f32 v169, v121
    v_exp_f32 v170, v122
    v_exp_f32 v171, v123
    v_exp_f32 v172, v124
    v_exp_f32 v173, v125
    v_exp_f32 v174, v126
    v_exp_f32 v175, v127
    v_cvt_pk_bf16_f32 v40, v160, v161
    v_cvt_pk_bf16_f32 v41, v162, v163
    v_cvt_pk_bf16_f32 v42, v164, v165
    v_cvt_pk_bf16_f32 v43, v166, v167
    v_cvt_pk_bf16_f32 v44, v168, v169
    v_cvt_pk_bf16_f32 v45, v170, v171
    v_cvt_pk_bf16_f32 v46, v172, v173
    v_cvt_pk_bf16_f32 v47, v174, v175
    s_nop 1
    s_branch L_rr_b1
L_rs_b2:
    s_nop 7
    s_nop 7
    v_max3_f32 v186, v96, v97, v98
    v_max3_f32 v187, v104, v105, v106
    v_max3_f32 v186, v186, v99, v100
    v_max3_f32 v187, v187, v107, v108
    v_max3_f32 v186, v186, v101, v102
    v_max3_f32 v187, v187, v109, v110
    v_max_f32 v186, v186, v103
    v_max_f32 v187, v187, v111
    s_nop 1
    v_permlane32_swap_b32 v186, v187
    v_max_f32 v187, v186, v187
    v_mov_b32 v191, v187
    s_nop 1
    v_permlane16_swap_b32 v191, v187
    v_max_f32 v187, v191, v187
    v_add_f32 v187, 0x41800000, v187
    v_max_f32 v187, 0, v187
    v_mov_b32 v186, v187
    s_nop 1
    v_permlane32_swap_b32 v186, v187
    v_exp_f32 v184, -v186
    v_exp_f32 v185, -v187
    v_mul_f32 v8, v8, v184
    v_mul_f32 v9, v9, v184
    v_mul_f32 v10, v10, v184
    v_mul_f32 v11, v11, v184
    v_mul_f32 v192, v192, v184
    v_mul_f32 v193, v193, v184
    v_mul_f32 v194, v194, v184
    v_mul_f32 v195, v195, v184
    v_mul_f32 v196, v196, v184
    v_mul_f32 v197, v197, v184
    v_mul_f32 v198, v198, v184
    v_mul_f32 v199, v199, v184
    v_mul_f32 v200, v200, v184
    v_mul_f32 v201, v201, v184
    v_mul_f32 v202, v202, v184
    v_mul_f32 v203, v203, v184
    v_mul_f32 v204, v204, v184
    v_mul_f32 v205, v205, v184
    v_mul_f32 v206, v206, v184
    v_mul_f32 v207, v207, v184
    v_mul_f32 v208, v208, v184
    v_mul_f32 v209, v209, v184
    v_mul_f32 v210, v210, v184
    v_mul_f32 v211, v211, v184
    v_mul_f32 v212, v212, v184
    v_mul_f32 v213, v213, v184
    v_mul_f32 v214, v214, v184
    v_mul_f32 v215, v215, v184
    v_mul_f32 v216, v216, v184
    v_mul_f32 v217, v217, v184
    v_mul_f32 v218, v218, v184
    v_mul_f32 v219, v219, v184
    v_mul_f32 v220, v220, v184
    v_mul_f32 v221, v221, v184
    v_mul_f32 v222, v222, v184
    v_mul_f32 v223, v223, v184
    v_sub_f32 v96, v96, v186
    v_sub_f32 v97, v97, v186
    v_sub_f32 v98, v98, v186
    v_sub_f32 v99, v99, v186
    v_sub_f32 v100, v100, v186
    v_sub_f32 v101, v101, v186
    v_sub_f32 v102, v102, v186
    v_sub_f32 v103, v103, v186
    v_sub_f32 v112, v112, v186
    v_sub_f32 v113, v113, v186
    v_sub_f32 v114, v114, v186
    v_sub_f32 v115, v115, v186
    v_sub_f32 v116, v116, v186
    v_sub_f32 v117, v117, v186
    v_sub_f32 v118, v118, v186
    v_sub_f32 v119, v119, v186
    v_sub_f32 v176, v176, v186
    v_sub_f32 v177, v177, v186
    v_sub_f32 v178, v178, v186
    v_sub_f32 v179, v179, v186
    v_mul_f32 v12, v12, v185
    v_mul_f32 v13, v13, v185
    v_mul_f32 v14, v14, v185
    v_mul_f32 v15, v15, v185
    v_mul_f32 v224, v224, v185
    v_mul_f32 v225, v225, v185
    v_mul_f32 v226, v226, v185
    v_mul_f32 v227, v227, v185
    v_mul_f32 v228, v228, v185
    v_mul_f32 v229, v229, v185
    v_mul_f32 v230, v230, v185
    v_mul_f32 v231, v231, v185
    v_mul_f32 v232, v232, v185
    v_mul_f32 v233, v233, v185
    v_mul_f32 v234, v234, v185
    v_mul_f32 v235, v235, v185
    v_mul_f32 v236, v236, v185
    v_mul_f32 v237, v237, v185
    v_mul_f32 v238, v238, v185
    v_mul_f32 v239, v239, v185
    v_mul_f32 v240, v240, v185
    v_mul_f32 v241, v241, v185
    v_mul_f32 v242, v242, v185
    v_mul_f32 v243, v243, v185
    v_mul_f32 v244, v244, v185
    v_mul_f32 v245, v245, v185
    v_mul_f32 v246, v246, v185
    v_mul_f32 v247, v247, v185
    v_mul_f32 v248, v248, v185
    v_mul_f32 v249, v249, v185
    v_mul_f32 v250, v250, v185
    v_mul_f32 v251, v251, v185
    v_mul_f32 v252, v252, v185
    v_mul_f32 v253, v253, v185
    v_mul_f32 v254, v254, v185
    v_mul_f32 v255, v255, v185
    v_sub_f32 v104, v104, v187
    v_sub_f32 v105, v105, v187
    v_sub_f32 v106, v106, v187
    v_sub_f32 v107, v107, v187
    v_sub_f32 v108, v108, v187
    v_sub_f32 v109, v109, v187
    v_sub_f32 v110, v110, v187
    v_sub_f32 v111, v111, v187
    v_sub_f32 v120, v120, v187
    v_sub_f32 v121, v121, v187
    v_sub_f32 v122, v122, v187
    v_sub_f32 v123, v123, v187
    v_sub_f32 v124, v124, v187
    v_sub_f32 v125, v125, v187
    v_sub_f32 v126, v126, v187
    v_sub_f32 v127, v127, v187
    v_sub_f32 v180, v180, v187
    v_sub_f32 v181, v181, v187
    v_sub_f32 v182, v182, v187
    v_sub_f32 v183, v183, v187
    v_exp_f32 v160, v96
    v_exp_f32 v161, v97
    v_exp_f32 v162, v98
    v_exp_f32 v163, v99
    v_exp_f32 v164, v100
    v_exp_f32 v165, v101
    v_exp_f32 v166, v102
    v_exp_f32 v167, v103
    v_exp_f32 v168, v104
    v_exp_f32 v169, v105
    v_exp_f32 v170, v106
    v_exp_f32 v171, v107
    v_exp_f32 v172, v108
    v_exp_f32 v173, v109
    v_exp_f32 v174, v110
    v_exp_f32 v175, v111
    v_cvt_pk_bf16_f32 v40, v160, v161
    v_cvt_pk_bf16_f32 v41, v162, v163
    v_cvt_pk_bf16_f32 v42, v164, v165
    v_cvt_pk_bf16_f32 v43, v166, v167
    v_cvt_pk_bf16_f32 v44, v168, v169
    v_cvt_pk_bf16_f32 v45, v170, v171
    v_cvt_pk_bf16_f32 v46, v172, v173
    v_cvt_pk_bf16_f32 v47, v174, v175
    s_nop 1
    s_branch L_rr_b2
L_rs_b3:
    s_nop 7
    s_nop 7
    v_max3_f32 v186, v112, v113, v114
    v_max3_f32 v187, v120, v121, v122
    v_max3_f32 v186, v186, v115, v116
    v_max3_f32 v187, v187, v123, v124
    v_max3_f32 v186, v186, v117, v118
    v_max3_f32 v187, v187, v125, v126
    v_max_f32 v186, v186, v119
    v_max_f32 v187, v187, v127
    s_nop 1
    v_permlane32_swap_b32 v186, v187
    v_max_f32 v187, v186, v187
    v_mov_b32 v191, v187
    s_nop 1
    v_permlane16_swap_b32 v191, v187
    v_max_f32 v187, v191, v187
    v_add_f32 v187, 0x41800000, v187
    v_max_f32 v187, 0, v187
    v_mov_b32 v186, v187
    s_nop 1
    v_permlane32_swap_b32 v186, v187
    v_exp_f32 v184, -v186
    v_exp_f32 v185, -v187
    v_mul_f32 v8, v8, v184
    v_mul_f32 v9, v9, v184
    v_mul_f32 v10, v10, v184
    v_mul_f32 v11, v11, v184
    v_mul_f32 v192, v192, v184
    v_mul_f32 v193, v193, v184
    v_mul_f32 v194, v194, v184
    v_mul_f32 v195, v195, v184
    v_mul_f32 v196, v196, v184
    v_mul_f32 v197, v197, v184
    v_mul_f32 v198, v198, v184
    v_mul_f32 v199, v199, v184
    v_mul_f32 v200, v200, v184
    v_mul_f32 v201, v201, v184
    v_mul_f32 v202, v202, v184
    v_mul_f32 v203, v203, v184
    v_mul_f32 v204, v204, v184
    v_mul_f32 v205, v205, v184
    v_mul_f32 v206, v206, v184
    v_mul_f32 v207, v207, v184
    v_mul_f32 v208, v208, v184
    v_mul_f32 v209, v209, v184
    v_mul_f32 v210, v210, v184
    v_mul_f32 v211, v211, v184
    v_mul_f32 v212, v212, v184
    v_mul_f32 v213, v213, v184
    v_mul_f32 v214, v214, v184
    v_mul_f32 v215, v215, v184
    v_mul_f32 v216, v216, v184
    v_mul_f32 v217, v217, v184
    v_mul_f32 v218, v218, v184
    v_mul_f32 v219, v219, v184
    v_mul_f32 v220, v220, v184
    v_mul_f32 v221, v221, v184
    v_mul_f32 v222, v222, v184
    v_mul_f32 v223, v223, v184
    v_sub_f32 v112, v112, v186
    v_sub_f32 v113, v113, v186
    v_sub_f32 v114, v114, v186
    v_sub_f32 v115, v115, v186
    v_sub_f32 v116, v116, v186
    v_sub_f32 v117, v117, v186
    v_sub_f32 v118, v118, v186
    v_sub_f32 v119, v119, v186
    v_sub_f32 v96, v96, v186
    v_sub_f32 v97, v97, v186
    v_sub_f32 v98, v98, v186
    v_sub_f32 v99, v99, v186
    v_sub_f32 v100, v100, v186
    v_sub_f32 v101, v101, v186
    v_sub_f32 v102, v102, v186
    v_sub_f32 v103, v103, v186
    v_sub_f32 v176, v176, v186
    v_sub_f32 v177, v177, v186
    v_sub_f32 v178, v178, v186
    v_sub_f32 v179, v179, v186
    v_mul_f32 v12, v12, v185
    v_mul_f32 v13, v13, v185
    v_mul_f32 v14, v14, v185
    v_mul_f32 v15, v15, v185
    v_mul_f32 v224, v224, v185
    v_mul_f32 v225, v225, v185
    v_mul_f32 v226, v226, v185
    v_mul_f32 v227, v227, v185
    v_mul_f32 v228, v228, v185
    v_mul_f32 v229, v229, v185
    v_mul_f32 v230, v230, v185
    v_mul_f32 v231, v231, v185
    v_mul_f32 v232, v232, v185
    v_mul_f32 v233, v233, v185
    v_mul_f32 v234, v234, v185
    v_mul_f32 v235, v235, v185
    v_mul_f32 v236, v236, v185
    v_mul_f32 v237, v237, v185
    v_mul_f32 v238, v238, v185
    v_mul_f32 v239, v239, v185
    v_mul_f32 v240, v240, v185
    v_mul_f32 v241, v241, v185
    v_mul_f32 v242, v242, v185
    v_mul_f32 v243, v243, v185
    v_mul_f32 v244, v244, v185
    v_mul_f32 v245, v245, v185
    v_mul_f32 v246, v246, v185
    v_mul_f32 v247, v247, v185
    v_mul_f32 v248, v248, v185
    v_mul_f32 v249, v249, v185
    v_mul_f32 v250, v250, v185
    v_mul_f32 v251, v251, v185
    v_mul_f32 v252, v252, v185
    v_mul_f32 v253, v253, v185
    v_mul_f32 v254, v254, v185
    v_mul_f32 v255, v255, v185
    v_sub_f32 v120, v120, v187
    v_sub_f32 v121, v121, v187
    v_sub_f32 v122, v122, v187
    v_sub_f32 v123, v123, v187
    v_sub_f32 v124, v124, v187
    v_sub_f32 v125, v125, v187
    v_sub_f32 v126, v126, v187
    v_sub_f32 v127, v127, v187
    v_sub_f32 v104, v104, v187
    v_sub_f32 v105, v105, v187
    v_sub_f32 v106, v106, v187
    v_sub_f32 v107, v107, v187
    v_sub_f32 v108, v108, v187
    v_sub_f32 v109, v109, v187
    v_sub_f32 v110, v110, v187
    v_sub_f32 v111, v111, v187
    v_sub_f32 v180, v180, v187
    v_sub_f32 v181, v181, v187
    v_sub_f32 v182, v182, v187
    v_sub_f32 v183, v183, v187
    v_exp_f32 v160, v112
    v_exp_f32 v161, v113
    v_exp_f32 v162, v114
    v_exp_f32 v163, v115
    v_exp_f32 v164, v116
    v_exp_f32 v165, v117
    v_exp_f32 v166, v118
    v_exp_f32 v167, v119
    v_exp_f32 v168, v120
    v_exp_f32 v169, v121
    v_exp_f32 v170, v122
    v_exp_f32 v171, v123
    v_exp_f32 v172, v124
    v_exp_f32 v173, v125
    v_exp_f32 v174, v126
    v_exp_f32 v175, v127
    v_cvt_pk_bf16_f32 v40, v160, v161
    v_cvt_pk_bf16_f32 v41, v162, v163
    v_cvt_pk_bf16_f32 v42, v164, v165
    v_cvt_pk_bf16_f32 v43, v166, v167
    v_cvt_pk_bf16_f32 v44, v168, v169
    v_cvt_pk_bf16_f32 v45, v170, v171
    v_cvt_pk_bf16_f32 v46, v172, v173
    v_cvt_pk_bf16_f32 v47, v174, v175
    s_nop 1
    s_branch L_rr_b3
L_rs_b4:
    s_nop 7
    s_nop 7
    v_max3_f32 v186, v96, v97, v98
    v_max3_f32 v187, v104, v105, v106
    v_max3_f32 v186, v186, v99, v100
    v_max3_f32 v187, v187, v107, v108
    v_max3_f32 v186, v186, v101, v102
    v_max3_f32 v187, v187, v109, v110
    v_max_f32 v186, v186, v103
    v_max_f32 v187, v187, v111
    s_nop 1
    v_permlane32_swap_b32 v186, v187
    v_max_f32 v187, v186, v187
    v_mov_b32 v191, v187
    s_nop 1
    v_permlane16_swap_b32 v191, v187
    v_max_f32 v187, v191, v187
    v_add_f32 v187, 0x41800000, v187
    v_max_f32 v187, 0, v187
    v_mov_b32 v186, v187
    s_nop 1
    v_permlane32_swap_b32 v186, v187
    v_exp_f32 v184, -v186
    v_exp_f32 v185, -v187
    v_mul_f32 v8, v8, v184
    v_mul_f32 v9, v9, v184
    v_mul_f32 v10, v10, v184
    v_mul_f32 v11, v11, v184
    v_mul_f32 v192, v192, v184
    v_mul_f32 v193, v193, v184
    v_mul_f32 v194, v194, v184
    v_mul_f32 v195, v195, v184
    v_mul_f32 v196, v196, v184
    v_mul_f32 v197, v197, v184
    v_mul_f32 v198, v198, v184
    v_mul_f32 v199, v199, v184
    v_mul_f32 v200, v200, v184
    v_mul_f32 v201, v201, v184
    v_mul_f32 v202, v202, v184
    v_mul_f32 v203, v203, v184
    v_mul_f32 v204, v204, v184
    v_mul_f32 v205, v205, v184
    v_mul_f32 v206, v206, v184
    v_mul_f32 v207, v207, v184
    v_mul_f32 v208, v208, v184
    v_mul_f32 v209, v209, v184
    v_mul_f32 v210, v210, v184
    v_mul_f32 v211, v211, v184
    v_mul_f32 v212, v212, v184
    v_mul_f32 v213, v213, v184
    v_mul_f32 v214, v214, v184
    v_mul_f32 v215, v215, v184
    v_mul_f32 v216, v216, v184
    v_mul_f32 v217, v217, v184
    v_mul_f32 v218, v218, v184
    v_mul_f32 v219, v219, v184
    v_mul_f32 v220, v220, v184
    v_mul_f32 v221, v221, v184
    v_mul_f32 v222, v222, v184
    v_mul_f32 v223, v223, v184
    v_sub_f32 v96, v96, v186
    v_sub_f32 v97, v97, v186
    v_sub_f32 v98, v98, v186
    v_sub_f32 v99, v99, v186
    v_sub_f32 v100, v100, v186
    v_sub_f32 v101, v101, v186
    v_sub_f32 v102, v102, v186
    v_sub_f32 v103, v103, v186
    v_sub_f32 v112, v112, v186
    v_sub_f32 v113, v113, v186
    v_sub_f32 v114, v114, v186
    v_sub_f32 v115, v115, v186
    v_sub_f32 v116, v116, v186
    v_sub_f32 v117, v117, v186
    v_sub_f32 v118, v118, v186
    v_sub_f32 v119, v119, v186
    v_sub_f32 v176, v176, v186
    v_sub_f32 v177, v177, v186
    v_sub_f32 v178, v178, v186
    v_sub_f32 v179, v179, v186
    v_mul_f32 v12, v12, v185
    v_mul_f32 v13, v13, v185
    v_mul_f32 v14, v14, v185
    v_mul_f32 v15, v15, v185
    v_mul_f32 v224, v224, v185
    v_mul_f32 v225, v225, v185
    v_mul_f32 v226, v226, v185
    v_mul_f32 v227, v227, v185
    v_mul_f32 v228, v228, v185
    v_mul_f32 v229, v229, v185
    v_mul_f32 v230, v230, v185
    v_mul_f32 v231, v231, v185
    v_mul_f32 v232, v232, v185
    v_mul_f32 v233, v233, v185
    v_mul_f32 v234, v234, v185
    v_mul_f32 v235, v235, v185
    v_mul_f32 v236, v236, v185
    v_mul_f32 v237, v237, v185
    v_mul_f32 v238, v238, v185
    v_mul_f32 v239, v239, v185
    v_mul_f32 v240, v240, v185
    v_mul_f32 v241, v241, v185
    v_mul_f32 v242, v242, v185
    v_mul_f32 v243, v243, v185
    v_mul_f32 v244, v244, v185
    v_mul_f32 v245, v245, v185
    v_mul_f32 v246, v246, v185
    v_mul_f32 v247, v247, v185
    v_mul_f32 v248, v248, v185
    v_mul_f32 v249, v249, v185
    v_mul_f32 v250, v250, v185
    v_mul_f32 v251, v251, v185
    v_mul_f32 v252, v252, v185
    v_mul_f32 v253, v253, v185
    v_mul_f32 v254, v254, v185
    v_mul_f32 v255, v255, v185
    v_sub_f32 v104, v104, v187
    v_sub_f32 v105, v105, v187
    v_sub_f32 v106, v106, v187
    v_sub_f32 v107, v107, v187
    v_sub_f32 v108, v108, v187
    v_sub_f32 v109, v109, v187
    v_sub_f32 v110, v110, v187
    v_sub_f32 v111, v111, v187
    v_sub_f32 v120, v120, v187
    v_sub_f32 v121, v121, v187
    v_sub_f32 v122, v122, v187
    v_sub_f32 v123, v123, v187
    v_sub_f32 v124, v124, v187
    v_sub_f32 v125, v125, v187
    v_sub_f32 v126, v126, v187
    v_sub_f32 v127, v127, v187
    v_sub_f32 v180, v180, v187
    v_sub_f32 v181, v181, v187
    v_sub_f32 v182, v182, v187
    v_sub_f32 v183, v183, v187
    v_exp_f32 v160, v96
    v_exp_f32 v161, v97
    v_exp_f32 v162, v98
    v_exp_f32 v163, v99
    v_exp_f32 v164, v100
    v_exp_f32 v165, v101
    v_exp_f32 v166, v102
    v_exp_f32 v167, v103
    v_exp_f32 v168, v104
    v_exp_f32 v169, v105
    v_exp_f32 v170, v106
    v_exp_f32 v171, v107
    v_exp_f32 v172, v108
    v_exp_f32 v173, v109
    v_exp_f32 v174, v110
    v_exp_f32 v175, v111
    v_cvt_pk_bf16_f32 v40, v160, v161
    v_cvt_pk_bf16_f32 v41, v162, v163
    v_cvt_pk_bf16_f32 v42, v164, v165
    v_cvt_pk_bf16_f32 v43, v166, v167
    v_cvt_pk_bf16_f32 v44, v168, v169
    v_cvt_pk_bf16_f32 v45, v170, v171
    v_cvt_pk_bf16_f32 v46, v172, v173
    v_cvt_pk_bf16_f32 v47, v174, v175
    s_nop 1
    s_branch L_rr_b4
L_rs_b5:
    s_nop 7
    s_nop 7
    v_max3_f32 v186, v112, v113, v114
    v_max3_f32 v187, v120, v121, v122
    v_max3_f32 v186, v186, v115, v116
    v_max3_f32 v187, v187, v123, v124
    v_max3_f32 v186, v186, v117, v118
    v_max3_f32 v187, v187, v125, v126
    v_max_f32 v186, v186, v119
    v_max_f32 v187, v187, v127
    s_nop 1
    v_permlane32_swap_b32 v186, v187
    v_max_f32 v187, v186, v187
    v_mov_b32 v191, v187
    s_nop 1
    v_permlane16_swap_b32 v191, v187
    v_max_f32 v187, v191, v187
    v_add_f32 v187, 0x41800000, v187
    v_max_f32 v187, 0, v187
    v_mov_b32 v186, v187
    s_nop 1
    v_permlane32_swap_b32 v186, v187
    v_exp_f32 v184, -v186
    v_exp_f32 v185, -v187
    v_mul_f32 v8, v8, v184
    v_mul_f32 v9, v9, v184
    v_mul_f32 v10, v10, v184
    v_mul_f32 v11, v11, v184
    v_mul_f32 v192, v192, v184
    v_mul_f32 v193, v193, v184
    v_mul_f32 v194, v194, v184
    v_mul_f32 v195, v195, v184
    v_mul_f32 v196, v196, v184
    v_mul_f32 v197, v197, v184
    v_mul_f32 v198, v198, v184
    v_mul_f32 v199, v199, v184
    v_mul_f32 v200, v200, v184
    v_mul_f32 v201, v201, v184
    v_mul_f32 v202, v202, v184
    v_mul_f32 v203, v203, v184
    v_mul_f32 v204, v204, v184
    v_mul_f32 v205, v205, v184
    v_mul_f32 v206, v206, v184
    v_mul_f32 v207, v207, v184
    v_mul_f32 v208, v208, v184
    v_mul_f32 v209, v209, v184
    v_mul_f32 v210, v210, v184
    v_mul_f32 v211, v211, v184
    v_mul_f32 v212, v212, v184
    v_mul_f32 v213, v213, v184
    v_mul_f32 v214, v214, v184
    v_mul_f32 v215, v215, v184
    v_mul_f32 v216, v216, v184
    v_mul_f32 v217, v217, v184
    v_mul_f32 v218, v218, v184
    v_mul_f32 v219, v219, v184
    v_mul_f32 v220, v220, v184
    v_mul_f32 v221, v221, v184
    v_mul_f32 v222, v222, v184
    v_mul_f32 v223, v223, v184
    v_sub_f32 v112, v112, v186
    v_sub_f32 v113, v113, v186
    v_sub_f32 v114, v114, v186
    v_sub_f32 v115, v115, v186
    v_sub_f32 v116, v116, v186
    v_sub_f32 v117, v117, v186
    v_sub_f32 v118, v118, v186
    v_sub_f32 v119, v119, v186
    v_sub_f32 v96, v96, v186
    v_sub_f32 v97, v97, v186
    v_sub_f32 v98, v98, v186
    v_sub_f32 v99, v99, v186
    v_sub_f32 v100, v100, v186
    v_sub_f32 v101, v101, v186
    v_sub_f32 v102, v102, v186
    v_sub_f32 v103, v103, v186
    v_sub_f32 v176, v176, v186
    v_sub_f32 v177, v177, v186
    v_sub_f32 v178, v178, v186
    v_sub_f32 v179, v179, v186
    v_mul_f32 v12, v12, v185
    v_mul_f32 v13, v13, v185
    v_mul_f32 v14, v14, v185
    v_mul_f32 v15, v15, v185
    v_mul_f32 v224, v224, v185
    v_mul_f32 v225, v225, v185
    v_mul_f32 v226, v226, v185
    v_mul_f32 v227, v227, v185
    v_mul_f32 v228, v228, v185
    v_mul_f32 v229, v229, v185
    v_mul_f32 v230, v230, v185
    v_mul_f32 v231, v231, v185
    v_mul_f32 v232, v232, v185
    v_mul_f32 v233, v233, v185
    v_mul_f32 v234, v234, v185
    v_mul_f32 v235, v235, v185
    v_mul_f32 v236, v236, v185
    v_mul_f32 v237, v237, v185
    v_mul_f32 v238, v238, v185
    v_mul_f32 v239, v239, v185
    v_mul_f32 v240, v240, v185
    v_mul_f32 v241, v241, v185
    v_mul_f32 v242, v242, v185
    v_mul_f32 v243, v243, v185
    v_mul_f32 v244, v244, v185
    v_mul_f32 v245, v245, v185
    v_mul_f32 v246, v246, v185
    v_mul_f32 v247, v247, v185
    v_mul_f32 v248, v248, v185
    v_mul_f32 v249, v249, v185
    v_mul_f32 v250, v250, v185
    v_mul_f32 v251, v251, v185
    v_mul_f32 v252, v252, v185
    v_mul_f32 v253, v253, v185
    v_mul_f32 v254, v254, v185
    v_mul_f32 v255, v255, v185
    v_sub_f32 v120, v120, v187
    v_sub_f32 v121, v121, v187
    v_sub_f32 v122, v122, v187
    v_sub_f32 v123, v123, v187
    v_sub_f32 v124, v124, v187
    v_sub_f32 v125, v125, v187
    v_sub_f32 v126, v126, v187
    v_sub_f32 v127, v127, v187
    v_sub_f32 v104, v104, v187
    v_sub_f32 v105, v105, v187
    v_sub_f32 v106, v106, v187
    v_sub_f32 v107, v107, v187
    v_sub_f32 v108, v108, v187
    v_sub_f32 v109, v109, v187
    v_sub_f32 v110, v110, v187
    v_sub_f32 v111, v111, v187
    v_sub_f32 v180, v180, v187
    v_sub_f32 v181, v181, v187
    v_sub_f32 v182, v182, v187
    v_sub_f32 v183, v183, v187
    v_exp_f32 v160, v112
    v_exp_f32 v161, v113
    v_exp_f32 v162, v114
    v_exp_f32 v163, v115
    v_exp_f32 v164, v116
    v_exp_f32 v165, v117
    v_exp_f32 v166, v118
    v_exp_f32 v167, v119
    v_exp_f32 v168, v120
    v_exp_f32 v169, v121
    v_exp_f32 v170, v122
    v_exp_f32 v171, v123
    v_exp_f32 v172, v124
    v_exp_f32 v173, v125
    v_exp_f32 v174, v126
    v_exp_f32 v175, v127
    v_cvt_pk_bf16_f32 v40, v160, v161
    v_cvt_pk_bf16_f32 v41, v162, v163
    v_cvt_pk_bf16_f32 v42, v164, v165
    v_cvt_pk_bf16_f32 v43, v166, v167
    v_cvt_pk_bf16_f32 v44, v168, v169
    v_cvt_pk_bf16_f32 v45, v170, v171
    v_cvt_pk_bf16_f32 v46, v172, v173
    v_cvt_pk_bf16_f32 v47, v174, v175
    s_nop 1
    s_branch L_rr_b5
L_rs_b6:
    s_nop 7
    s_nop 7
    v_max3_f32 v186, v96, v97, v98
    v_max3_f32 v187, v104, v105, v106
    v_max3_f32 v186, v186, v99, v100
    v_max3_f32 v187, v187, v107, v108
    v_max3_f32 v186, v186, v101, v102
    v_max3_f32 v187, v187, v109, v110
    v_max_f32 v186, v186, v103
    v_max_f32 v187, v187, v111
    s_nop 1
    v_permlane32_swap_b32 v186, v187
    v_max_f32 v187, v186, v187
    v_mov_b32 v191, v187
    s_nop 1
    v_permlane16_swap_b32 v191, v187
    v_max_f32 v187, v191, v187
    v_add_f32 v187, 0x41800000, v187
    v_max_f32 v187, 0, v187
    v_mov_b32 v186, v187
    s_nop 1
    v_permlane32_swap_b32 v186, v187
    v_exp_f32 v184, -v186
    v_exp_f32 v185, -v187
    v_mul_f32 v8, v8, v184
    v_mul_f32 v9, v9, v184
    v_mul_f32 v10, v10, v184
    v_mul_f32 v11, v11, v184
    v_mul_f32 v192, v192, v184
    v_mul_f32 v193, v193, v184
    v_mul_f32 v194, v194, v184
    v_mul_f32 v195, v195, v184
    v_mul_f32 v196, v196, v184
    v_mul_f32 v197, v197, v184
    v_mul_f32 v198, v198, v184
    v_mul_f32 v199, v199, v184
    v_mul_f32 v200, v200, v184
    v_mul_f32 v201, v201, v184
    v_mul_f32 v202, v202, v184
    v_mul_f32 v203, v203, v184
    v_mul_f32 v204, v204, v184
    v_mul_f32 v205, v205, v184
    v_mul_f32 v206, v206, v184
    v_mul_f32 v207, v207, v184
    v_mul_f32 v208, v208, v184
    v_mul_f32 v209, v209, v184
    v_mul_f32 v210, v210, v184
    v_mul_f32 v211, v211, v184
    v_mul_f32 v212, v212, v184
    v_mul_f32 v213, v213, v184
    v_mul_f32 v214, v214, v184
    v_mul_f32 v215, v215, v184
    v_mul_f32 v216, v216, v184
    v_mul_f32 v217, v217, v184
    v_mul_f32 v218, v218, v184
    v_mul_f32 v219, v219, v184
    v_mul_f32 v220, v220, v184
    v_mul_f32 v221, v221, v184
    v_mul_f32 v222, v222, v184
    v_mul_f32 v223, v223, v184
    v_sub_f32 v96, v96, v186
    v_sub_f32 v97, v97, v186
    v_sub_f32 v98, v98, v186
    v_sub_f32 v99, v99, v186
    v_sub_f32 v100, v100, v186
    v_sub_f32 v101, v101, v186
    v_sub_f32 v102, v102, v186
    v_sub_f32 v103, v103, v186
    v_sub_f32 v112, v112, v186
    v_sub_f32 v113, v113, v186
    v_sub_f32 v114, v114, v186
    v_sub_f32 v115, v115, v186
    v_sub_f32 v116, v116, v186
    v_sub_f32 v117, v117, v186
    v_sub_f32 v118, v118, v186
    v_sub_f32 v119, v119, v186
    v_sub_f32 v176, v176, v186
    v_sub_f32 v177, v177, v186
    v_sub_f32 v178, v178, v186
    v_sub_f32 v179, v179, v186
    v_mul_f32 v12, v12, v185
    v_mul_f32 v13, v13, v185
    v_mul_f32 v14, v14, v185
    v_mul_f32 v15, v15, v185
    v_mul_f32 v224, v224, v185
    v_mul_f32 v225, v225, v185
    v_mul_f32 v226, v226, v185
    v_mul_f32 v227, v227, v185
    v_mul_f32 v228, v228, v185
    v_mul_f32 v229, v229, v185
    v_mul_f32 v230, v230, v185
    v_mul_f32 v231, v231, v185
    v_mul_f32 v232, v232, v185
    v_mul_f32 v233, v233, v185
    v_mul_f32 v234, v234, v185
    v_mul_f32 v235, v235, v185
    v_mul_f32 v236, v236, v185
    v_mul_f32 v237, v237, v185
    v_mul_f32 v238, v238, v185
    v_mul_f32 v239, v239, v185
    v_mul_f32 v240, v240, v185
    v_mul_f32 v241, v241, v185
    v_mul_f32 v242, v242, v185
    v_mul_f32 v243, v243, v185
    v_mul_f32 v244, v244, v185
    v_mul_f32 v245, v245, v185
    v_mul_f32 v246, v246, v185
    v_mul_f32 v247, v247, v185
    v_mul_f32 v248, v248, v185
    v_mul_f32 v249, v249, v185
    v_mul_f32 v250, v250, v185
    v_mul_f32 v251, v251, v185
    v_mul_f32 v252, v252, v185
    v_mul_f32 v253, v253, v185
    v_mul_f32 v254, v254, v185
    v_mul_f32 v255, v255, v185
    v_sub_f32 v104, v104, v187
    v_sub_f32 v105, v105, v187
    v_sub_f32 v106, v106, v187
    v_sub_f32 v107, v107, v187
    v_sub_f32 v108, v108, v187
    v_sub_f32 v109, v109, v187
    v_sub_f32 v110, v110, v187
    v_sub_f32 v111, v111, v187
    v_sub_f32 v120, v120, v187
    v_sub_f32 v121, v121, v187
    v_sub_f32 v122, v122, v187
    v_sub_f32 v123, v123, v187
    v_sub_f32 v124, v124, v187
    v_sub_f32 v125, v125, v187
    v_sub_f32 v126, v126, v187
    v_sub_f32 v127, v127, v187
    v_sub_f32 v180, v180, v187
    v_sub_f32 v181, v181, v187
    v_sub_f32 v182, v182, v187
    v_sub_f32 v183, v183, v187
    v_exp_f32 v160, v96
    v_exp_f32 v161, v97
    v_exp_f32 v162, v98
    v_exp_f32 v163, v99
    v_exp_f32 v164, v100
    v_exp_f32 v165, v101
    v_exp_f32 v166, v102
    v_exp_f32 v167, v103
    v_exp_f32 v168, v104
    v_exp_f32 v169, v105
    v_exp_f32 v170, v106
    v_exp_f32 v171, v107
    v_exp_f32 v172, v108
    v_exp_f32 v173, v109
    v_exp_f32 v174, v110
    v_exp_f32 v175, v111
    v_cvt_pk_bf16_f32 v40, v160, v161
    v_cvt_pk_bf16_f32 v41, v162, v163
    v_cvt_pk_bf16_f32 v42, v164, v165
    v_cvt_pk_bf16_f32 v43, v166, v167
    v_cvt_pk_bf16_f32 v44, v168, v169
    v_cvt_pk_bf16_f32 v45, v170, v171
    v_cvt_pk_bf16_f32 v46, v172, v173
    v_cvt_pk_bf16_f32 v47, v174, v175
    s_nop 1
    s_branch L_rr_b6
L_rs_b7:
    s_nop 7
    s_nop 7
    v_max3_f32 v186, v112, v113, v114
    v_max3_f32 v187, v120, v121, v122
    v_max3_f32 v186, v186, v115, v116
    v_max3_f32 v187, v187, v123, v124
    v_max3_f32 v186, v186, v117, v118
    v_max3_f32 v187, v187, v125, v126
    v_max_f32 v186, v186, v119
    v_max_f32 v187, v187, v127
    s_nop 1
    v_permlane32_swap_b32 v186, v187
    v_max_f32 v187, v186, v187
    v_mov_b32 v191, v187
    s_nop 1
    v_permlane16_swap_b32 v191, v187
    v_max_f32 v187, v191, v187
    v_add_f32 v187, 0x41800000, v187
    v_max_f32 v187, 0, v187
    v_mov_b32 v186, v187
    s_nop 1
    v_permlane32_swap_b32 v186, v187
    v_exp_f32 v184, -v186
    v_exp_f32 v185, -v187
    v_mul_f32 v8, v8, v184
    v_mul_f32 v9, v9, v184
    v_mul_f32 v10, v10, v184
    v_mul_f32 v11, v11, v184
    v_mul_f32 v192, v192, v184
    v_mul_f32 v193, v193, v184
    v_mul_f32 v194, v194, v184
    v_mul_f32 v195, v195, v184
    v_mul_f32 v196, v196, v184
    v_mul_f32 v197, v197, v184
    v_mul_f32 v198, v198, v184
    v_mul_f32 v199, v199, v184
    v_mul_f32 v200, v200, v184
    v_mul_f32 v201, v201, v184
    v_mul_f32 v202, v202, v184
    v_mul_f32 v203, v203, v184
    v_mul_f32 v204, v204, v184
    v_mul_f32 v205, v205, v184
    v_mul_f32 v206, v206, v184
    v_mul_f32 v207, v207, v184
    v_mul_f32 v208, v208, v184
    v_mul_f32 v209, v209, v184
    v_mul_f32 v210, v210, v184
    v_mul_f32 v211, v211, v184
    v_mul_f32 v212, v212, v184
    v_mul_f32 v213, v213, v184
    v_mul_f32 v214, v214, v184
    v_mul_f32 v215, v215, v184
    v_mul_f32 v216, v216, v184
    v_mul_f32 v217, v217, v184
    v_mul_f32 v218, v218, v184
    v_mul_f32 v219, v219, v184
    v_mul_f32 v220, v220, v184
    v_mul_f32 v221, v221, v184
    v_mul_f32 v222, v222, v184
    v_mul_f32 v223, v223, v184
    v_sub_f32 v112, v112, v186
    v_sub_f32 v113, v113, v186
    v_sub_f32 v114, v114, v186
    v_sub_f32 v115, v115, v186
    v_sub_f32 v116, v116, v186
    v_sub_f32 v117, v117, v186
    v_sub_f32 v118, v118, v186
    v_sub_f32 v119, v119, v186
    v_sub_f32 v96, v96, v186
    v_sub_f32 v97, v97, v186
    v_sub_f32 v98, v98, v186
    v_sub_f32 v99, v99, v186
    v_sub_f32 v100, v100, v186
    v_sub_f32 v101, v101, v186
    v_sub_f32 v102, v102, v186
    v_sub_f32 v103, v103, v186
    v_sub_f32 v176, v176, v186
    v_sub_f32 v177, v177, v186
    v_sub_f32 v178, v178, v186
    v_sub_f32 v179, v179, v186
    v_mul_f32 v12, v12, v185
    v_mul_f32 v13, v13, v185
    v_mul_f32 v14, v14, v185
    v_mul_f32 v15, v15, v185
    v_mul_f32 v224, v224, v185
    v_mul_f32 v225, v225, v185
    v_mul_f32 v226, v226, v185
    v_mul_f32 v227, v227, v185
    v_mul_f32 v228, v228, v185
    v_mul_f32 v229, v229, v185
    v_mul_f32 v230, v230, v185
    v_mul_f32 v231, v231, v185
    v_mul_f32 v232, v232, v185
    v_mul_f32 v233, v233, v185
    v_mul_f32 v234, v234, v185
    v_mul_f32 v235, v235, v185
    v_mul_f32 v236, v236, v185
    v_mul_f32 v237, v237, v185
    v_mul_f32 v238, v238, v185
    v_mul_f32 v239, v239, v185
    v_mul_f32 v240, v240, v185
    v_mul_f32 v241, v241, v185
    v_mul_f32 v242, v242, v185
    v_mul_f32 v243, v243, v185
    v_mul_f32 v244, v244, v185
    v_mul_f32 v245, v245, v185
    v_mul_f32 v246, v246, v185
    v_mul_f32 v247, v247, v185
    v_mul_f32 v248, v248, v185
    v_mul_f32 v249, v249, v185
    v_mul_f32 v250, v250, v185
    v_mul_f32 v251, v251, v185
    v_mul_f32 v252, v252, v185
    v_mul_f32 v253, v253, v185
    v_mul_f32 v254, v254, v185
    v_mul_f32 v255, v255, v185
    v_sub_f32 v120, v120, v187
    v_sub_f32 v121, v121, v187
    v_sub_f32 v122, v122, v187
    v_sub_f32 v123, v123, v187
    v_sub_f32 v124, v124, v187
    v_sub_f32 v125, v125, v187
    v_sub_f32 v126, v126, v187
    v_sub_f32 v127, v127, v187
    v_sub_f32 v104, v104, v187
    v_sub_f32 v105, v105, v187
    v_sub_f32 v106, v106, v187
    v_sub_f32 v107, v107, v187
    v_sub_f32 v108, v108, v187
    v_sub_f32 v109, v109, v187
    v_sub_f32 v110, v110, v187
    v_sub_f32 v111, v111, v187
    v_sub_f32 v180, v180, v187
    v_sub_f32 v181, v181, v187
    v_sub_f32 v182, v182, v187
    v_sub_f32 v183, v183, v187
    v_exp_f32 v160, v112
    v_exp_f32 v161, v113
    v_exp_f32 v162, v114
    v_exp_f32 v163, v115
    v_exp_f32 v164, v116
    v_exp_f32 v165, v117
    v_exp_f32 v166, v118
    v_exp_f32 v167, v119
    v_exp_f32 v168, v120
    v_exp_f32 v169, v121
    v_exp_f32 v170, v122
    v_exp_f32 v171, v123
    v_exp_f32 v172, v124
    v_exp_f32 v173, v125
    v_exp_f32 v174, v126
    v_exp_f32 v175, v127
    v_cvt_pk_bf16_f32 v40, v160, v161
    v_cvt_pk_bf16_f32 v41, v162, v163
    v_cvt_pk_bf16_f32 v42, v164, v165
    v_cvt_pk_bf16_f32 v43, v166, v167
    v_cvt_pk_bf16_f32 v44, v168, v169
    v_cvt_pk_bf16_f32 v45, v170, v171
    v_cvt_pk_bf16_f32 v46, v172, v173
    v_cvt_pk_bf16_f32 v47, v174, v175
    s_nop 1
    s_branch L_rr_b7
L_rs_b8:
    s_nop 7
    s_nop 7
    v_max3_f32 v186, v96, v97, v98
    v_max3_f32 v187, v104, v105, v106
    v_max3_f32 v186, v186, v99, v100
    v_max3_f32 v187, v187, v107, v108
    v_max3_f32 v186, v186, v101, v102
    v_max3_f32 v187, v187, v109, v110
    v_max_f32 v186, v186, v103
    v_max_f32 v187, v187, v111
    s_nop 1
    v_permlane32_swap_b32 v186, v187
    v_max_f32 v187, v186, v187
    v_mov_b32 v191, v187
    s_nop 1
    v_permlane16_swap_b32 v191, v187
    v_max_f32 v187, v191, v187
    v_add_f32 v187, 0x41800000, v187
    v_max_f32 v187, 0, v187
    v_mov_b32 v186, v187
    s_nop 1
    v_permlane32_swap_b32 v186, v187
    v_exp_f32 v184, -v186
    v_exp_f32 v185, -v187
    v_mul_f32 v8, v8, v184
    v_mul_f32 v9, v9, v184
    v_mul_f32 v10, v10, v184
    v_mul_f32 v11, v11, v184
    v_mul_f32 v192, v192, v184
    v_mul_f32 v193, v193, v184
    v_mul_f32 v194, v194, v184
    v_mul_f32 v195, v195, v184
    v_mul_f32 v196, v196, v184
    v_mul_f32 v197, v197, v184
    v_mul_f32 v198, v198, v184
    v_mul_f32 v199, v199, v184
    v_mul_f32 v200, v200, v184
    v_mul_f32 v201, v201, v184
    v_mul_f32 v202, v202, v184
    v_mul_f32 v203, v203, v184
    v_mul_f32 v204, v204, v184
    v_mul_f32 v205, v205, v184
    v_mul_f32 v206, v206, v184
    v_mul_f32 v207, v207, v184
    v_mul_f32 v208, v208, v184
    v_mul_f32 v209, v209, v184
    v_mul_f32 v210, v210, v184
    v_mul_f32 v211, v211, v184
    v_mul_f32 v212, v212, v184
    v_mul_f32 v213, v213, v184
    v_mul_f32 v214, v214, v184
    v_mul_f32 v215, v215, v184
    v_mul_f32 v216, v216, v184
    v_mul_f32 v217, v217, v184
    v_mul_f32 v218, v218, v184
    v_mul_f32 v219, v219, v184
    v_mul_f32 v220, v220, v184
    v_mul_f32 v221, v221, v184
    v_mul_f32 v222, v222, v184
    v_mul_f32 v223, v223, v184
    v_sub_f32 v96, v96, v186
    v_sub_f32 v97, v97, v186
    v_sub_f32 v98, v98, v186
    v_sub_f32 v99, v99, v186
    v_sub_f32 v100, v100, v186
    v_sub_f32 v101, v101, v186
    v_sub_f32 v102, v102, v186
    v_sub_f32 v103, v103, v186
    v_sub_f32 v112, v112, v186
    v_sub_f32 v113, v113, v186
    v_sub_f32 v114, v114, v186
    v_sub_f32 v115, v115, v186
    v_sub_f32 v116, v116, v186
    v_sub_f32 v117, v117, v186
    v_sub_f32 v118, v118, v186
    v_sub_f32 v119, v119, v186
    v_sub_f32 v176, v176, v186
    v_sub_f32 v177, v177, v186
    v_sub_f32 v178, v178, v186
    v_sub_f32 v179, v179, v186
    v_mul_f32 v12, v12, v185
    v_mul_f32 v13, v13, v185
    v_mul_f32 v14, v14, v185
    v_mul_f32 v15, v15, v185
    v_mul_f32 v224, v224, v185
    v_mul_f32 v225, v225, v185
    v_mul_f32 v226, v226, v185
    v_mul_f32 v227, v227, v185
    v_mul_f32 v228, v228, v185
    v_mul_f32 v229, v229, v185
    v_mul_f32 v230, v230, v185
    v_mul_f32 v231, v231, v185
    v_mul_f32 v232, v232, v185
    v_mul_f32 v233, v233, v185
    v_mul_f32 v234, v234, v185
    v_mul_f32 v235, v235, v185
    v_mul_f32 v236, v236, v185
    v_mul_f32 v237, v237, v185
    v_mul_f32 v238, v238, v185
    v_mul_f32 v239, v239, v185
    v_mul_f32 v240, v240, v185
    v_mul_f32 v241, v241, v185
    v_mul_f32 v242, v242, v185
    v_mul_f32 v243, v243, v185
    v_mul_f32 v244, v244, v185
    v_mul_f32 v245, v245, v185
    v_mul_f32 v246, v246, v185
    v_mul_f32 v247, v247, v185
    v_mul_f32 v248, v248, v185
    v_mul_f32 v249, v249, v185
    v_mul_f32 v250, v250, v185
    v_mul_f32 v251, v251, v185
    v_mul_f32 v252, v252, v185
    v_mul_f32 v253, v253, v185
    v_mul_f32 v254, v254, v185
    v_mul_f32 v255, v255, v185
    v_sub_f32 v104, v104, v187
    v_sub_f32 v105, v105, v187
    v_sub_f32 v106, v106, v187
    v_sub_f32 v107, v107, v187
    v_sub_f32 v108, v108, v187
    v_sub_f32 v109, v109, v187
    v_sub_f32 v110, v110, v187
    v_sub_f32 v111, v111, v187
    v_sub_f32 v120, v120, v187
    v_sub_f32 v121, v121, v187
    v_sub_f32 v122, v122, v187
    v_sub_f32 v123, v123, v187
    v_sub_f32 v124, v124, v187
    v_sub_f32 v125, v125, v187
    v_sub_f32 v126, v126, v187
    v_sub_f32 v127, v127, v187
    v_sub_f32 v180, v180, v187
    v_sub_f32 v181, v181, v187
    v_sub_f32 v182, v182, v187
    v_sub_f32 v183, v183, v187
    v_exp_f32 v160, v96
    v_exp_f32 v161, v97
    v_exp_f32 v162, v98
    v_exp_f32 v163, v99
    v_exp_f32 v164, v100
    v_exp_f32 v165, v101
    v_exp_f32 v166, v102
    v_exp_f32 v167, v103
    v_exp_f32 v168, v104
    v_exp_f32 v169, v105
    v_exp_f32 v170, v106
    v_exp_f32 v171, v107
    v_exp_f32 v172, v108
    v_exp_f32 v173, v109
    v_exp_f32 v174, v110
    v_exp_f32 v175, v111
    v_cvt_pk_bf16_f32 v40, v160, v161
    v_cvt_pk_bf16_f32 v41, v162, v163
    v_cvt_pk_bf16_f32 v42, v164, v165
    v_cvt_pk_bf16_f32 v43, v166, v167
    v_cvt_pk_bf16_f32 v44, v168, v169
    v_cvt_pk_bf16_f32 v45, v170, v171
    v_cvt_pk_bf16_f32 v46, v172, v173
    v_cvt_pk_bf16_f32 v47, v174, v175
    s_nop 1
    s_branch L_rr_b8
L_rs_b9:
    s_nop 7
    s_nop 7
    v_max3_f32 v186, v112, v113, v114
    v_max3_f32 v187, v120, v121, v122
    v_max3_f32 v186, v186, v115, v116
    v_max3_f32 v187, v187, v123, v124
    v_max3_f32 v186, v186, v117, v118
    v_max3_f32 v187, v187, v125, v126
    v_max_f32 v186, v186, v119
    v_max_f32 v187, v187, v127
    s_nop 1
    v_permlane32_swap_b32 v186, v187
    v_max_f32 v187, v186, v187
    v_mov_b32 v191, v187
    s_nop 1
    v_permlane16_swap_b32 v191, v187
    v_max_f32 v187, v191, v187
    v_add_f32 v187, 0x41800000, v187
    v_max_f32 v187, 0, v187
    v_mov_b32 v186, v187
    s_nop 1
    v_permlane32_swap_b32 v186, v187
    v_exp_f32 v184, -v186
    v_exp_f32 v185, -v187
    v_mul_f32 v8, v8, v184
    v_mul_f32 v9, v9, v184
    v_mul_f32 v10, v10, v184
    v_mul_f32 v11, v11, v184
    v_mul_f32 v192, v192, v184
    v_mul_f32 v193, v193, v184
    v_mul_f32 v194, v194, v184
    v_mul_f32 v195, v195, v184
    v_mul_f32 v196, v196, v184
    v_mul_f32 v197, v197, v184
    v_mul_f32 v198, v198, v184
    v_mul_f32 v199, v199, v184
    v_mul_f32 v200, v200, v184
    v_mul_f32 v201, v201, v184
    v_mul_f32 v202, v202, v184
    v_mul_f32 v203, v203, v184
    v_mul_f32 v204, v204, v184
    v_mul_f32 v205, v205, v184
    v_mul_f32 v206, v206, v184
    v_mul_f32 v207, v207, v184
    v_mul_f32 v208, v208, v184
    v_mul_f32 v209, v209, v184
    v_mul_f32 v210, v210, v184
    v_mul_f32 v211, v211, v184
    v_mul_f32 v212, v212, v184
    v_mul_f32 v213, v213, v184
    v_mul_f32 v214, v214, v184
    v_mul_f32 v215, v215, v184
    v_mul_f32 v216, v216, v184
    v_mul_f32 v217, v217, v184
    v_mul_f32 v218, v218, v184
    v_mul_f32 v219, v219, v184
    v_mul_f32 v220, v220, v184
    v_mul_f32 v221, v221, v184
    v_mul_f32 v222, v222, v184
    v_mul_f32 v223, v223, v184
    v_sub_f32 v112, v112, v186
    v_sub_f32 v113, v113, v186
    v_sub_f32 v114, v114, v186
    v_sub_f32 v115, v115, v186
    v_sub_f32 v116, v116, v186
    v_sub_f32 v117, v117, v186
    v_sub_f32 v118, v118, v186
    v_sub_f32 v119, v119, v186
    v_sub_f32 v96, v96, v186
    v_sub_f32 v97, v97, v186
    v_sub_f32 v98, v98, v186
    v_sub_f32 v99, v99, v186
    v_sub_f32 v100, v100, v186
    v_sub_f32 v101, v101, v186
    v_sub_f32 v102, v102, v186
    v_sub_f32 v103, v103, v186
    v_sub_f32 v176, v176, v186
    v_sub_f32 v177, v177, v186
    v_sub_f32 v178, v178, v186
    v_sub_f32 v179, v179, v186
    v_mul_f32 v12, v12, v185
    v_mul_f32 v13, v13, v185
    v_mul_f32 v14, v14, v185
    v_mul_f32 v15, v15, v185
    v_mul_f32 v224, v224, v185
    v_mul_f32 v225, v225, v185
    v_mul_f32 v226, v226, v185
    v_mul_f32 v227, v227, v185
    v_mul_f32 v228, v228, v185
    v_mul_f32 v229, v229, v185
    v_mul_f32 v230, v230, v185
    v_mul_f32 v231, v231, v185
    v_mul_f32 v232, v232, v185
    v_mul_f32 v233, v233, v185
    v_mul_f32 v234, v234, v185
    v_mul_f32 v235, v235, v185
    v_mul_f32 v236, v236, v185
    v_mul_f32 v237, v237, v185
    v_mul_f32 v238, v238, v185
    v_mul_f32 v239, v239, v185
    v_mul_f32 v240, v240, v185
    v_mul_f32 v241, v241, v185
    v_mul_f32 v242, v242, v185
    v_mul_f32 v243, v243, v185
    v_mul_f32 v244, v244, v185
    v_mul_f32 v245, v245, v185
    v_mul_f32 v246, v246, v185
    v_mul_f32 v247, v247, v185
    v_mul_f32 v248, v248, v185
    v_mul_f32 v249, v249, v185
    v_mul_f32 v250, v250, v185
    v_mul_f32 v251, v251, v185
    v_mul_f32 v252, v252, v185
    v_mul_f32 v253, v253, v185
    v_mul_f32 v254, v254, v185
    v_mul_f32 v255, v255, v185
    v_sub_f32 v120, v120, v187
    v_sub_f32 v121, v121, v187
    v_sub_f32 v122, v122, v187
    v_sub_f32 v123, v123, v187
    v_sub_f32 v124, v124, v187
    v_sub_f32 v125, v125, v187
    v_sub_f32 v126, v126, v187
    v_sub_f32 v127, v127, v187
    v_sub_f32 v104, v104, v187
    v_sub_f32 v105, v105, v187
    v_sub_f32 v106, v106, v187
    v_sub_f32 v107, v107, v187
    v_sub_f32 v108, v108, v187
    v_sub_f32 v109, v109, v187
    v_sub_f32 v110, v110, v187
    v_sub_f32 v111, v111, v187
    v_sub_f32 v180, v180, v187
    v_sub_f32 v181, v181, v187
    v_sub_f32 v182, v182, v187
    v_sub_f32 v183, v183, v187
    v_exp_f32 v160, v112
    v_exp_f32 v161, v113
    v_exp_f32 v162, v114
    v_exp_f32 v163, v115
    v_exp_f32 v164, v116
    v_exp_f32 v165, v117
    v_exp_f32 v166, v118
    v_exp_f32 v167, v119
    v_exp_f32 v168, v120
    v_exp_f32 v169, v121
    v_exp_f32 v170, v122
    v_exp_f32 v171, v123
    v_exp_f32 v172, v124
    v_exp_f32 v173, v125
    v_exp_f32 v174, v126
    v_exp_f32 v175, v127
    v_cvt_pk_bf16_f32 v40, v160, v161
    v_cvt_pk_bf16_f32 v41, v162, v163
    v_cvt_pk_bf16_f32 v42, v164, v165
    v_cvt_pk_bf16_f32 v43, v166, v167
    v_cvt_pk_bf16_f32 v44, v168, v169
    v_cvt_pk_bf16_f32 v45, v170, v171
    v_cvt_pk_bf16_f32 v46, v172, v173
    v_cvt_pk_bf16_f32 v47, v174, v175
    s_nop 1
    s_branch L_rr_b9
L_rs_b10:
    s_nop 7
    s_nop 7
    v_max3_f32 v186, v96, v97, v98
    v_max3_f32 v187, v104, v105, v106
    v_max3_f32 v186, v186, v99, v100
    v_max3_f32 v187, v187, v107, v108
    v_max3_f32 v186, v186, v101, v102
    v_max3_f32 v187, v187, v109, v110
    v_max_f32 v186, v186, v103
    v_max_f32 v187, v187, v111
    s_nop 1
    v_permlane32_swap_b32 v186, v187
    v_max_f32 v187, v186, v187
    v_mov_b32 v191, v187
    s_nop 1
    v_permlane16_swap_b32 v191, v187
    v_max_f32 v187, v191, v187
    v_add_f32 v187, 0x41800000, v187
    v_max_f32 v187, 0, v187
    v_mov_b32 v186, v187
    s_nop 1
    v_permlane32_swap_b32 v186, v187
    v_exp_f32 v184, -v186
    v_exp_f32 v185, -v187
    v_mul_f32 v8, v8, v184
    v_mul_f32 v9, v9, v184
    v_mul_f32 v10, v10, v184
    v_mul_f32 v11, v11, v184
    v_mul_f32 v192, v192, v184
    v_mul_f32 v193, v193, v184
    v_mul_f32 v194, v194, v184
    v_mul_f32 v195, v195, v184
    v_mul_f32 v196, v196, v184
    v_mul_f32 v197, v197, v184
    v_mul_f32 v198, v198, v184
    v_mul_f32 v199, v199, v184
    v_mul_f32 v200, v200, v184
    v_mul_f32 v201, v201, v184
    v_mul_f32 v202, v202, v184
    v_mul_f32 v203, v203, v184
    v_mul_f32 v204, v204, v184
    v_mul_f32 v205, v205, v184
    v_mul_f32 v206, v206, v184
    v_mul_f32 v207, v207, v184
    v_mul_f32 v208, v208, v184
    v_mul_f32 v209, v209, v184
    v_mul_f32 v210, v210, v184
    v_mul_f32 v211, v211, v184
    v_mul_f32 v212, v212, v184
    v_mul_f32 v213, v213, v184
    v_mul_f32 v214, v214, v184
    v_mul_f32 v215, v215, v184
    v_mul_f32 v216, v216, v184
    v_mul_f32 v217, v217, v184
    v_mul_f32 v218, v218, v184
    v_mul_f32 v219, v219, v184
    v_mul_f32 v220, v220, v184
    v_mul_f32 v221, v221, v184
    v_mul_f32 v222, v222, v184
    v_mul_f32 v223, v223, v184
    v_sub_f32 v96, v96, v186
    v_sub_f32 v97, v97, v186
    v_sub_f32 v98, v98, v186
    v_sub_f32 v99, v99, v186
    v_sub_f32 v100, v100, v186
    v_sub_f32 v101, v101, v186
    v_sub_f32 v102, v102, v186
    v_sub_f32 v103, v103, v186
    v_sub_f32 v112, v112, v186
    v_sub_f32 v113, v113, v186
    v_sub_f32 v114, v114, v186
    v_sub_f32 v115, v115, v186
    v_sub_f32 v116, v116, v186
    v_sub_f32 v117, v117, v186
    v_sub_f32 v118, v118, v186
    v_sub_f32 v119, v119, v186
    v_sub_f32 v176, v176, v186
    v_sub_f32 v177, v177, v186
    v_sub_f32 v178, v178, v186
    v_sub_f32 v179, v179, v186
    v_mul_f32 v12, v12, v185
    v_mul_f32 v13, v13, v185
    v_mul_f32 v14, v14, v185
    v_mul_f32 v15, v15, v185
    v_mul_f32 v224, v224, v185
    v_mul_f32 v225, v225, v185
    v_mul_f32 v226, v226, v185
    v_mul_f32 v227, v227, v185
    v_mul_f32 v228, v228, v185
    v_mul_f32 v229, v229, v185
    v_mul_f32 v230, v230, v185
    v_mul_f32 v231, v231, v185
    v_mul_f32 v232, v232, v185
    v_mul_f32 v233, v233, v185
    v_mul_f32 v234, v234, v185
    v_mul_f32 v235, v235, v185
    v_mul_f32 v236, v236, v185
    v_mul_f32 v237, v237, v185
    v_mul_f32 v238, v238, v185
    v_mul_f32 v239, v239, v185
    v_mul_f32 v240, v240, v185
    v_mul_f32 v241, v241, v185
    v_mul_f32 v242, v242, v185
    v_mul_f32 v243, v243, v185
    v_mul_f32 v244, v244, v185
    v_mul_f32 v245, v245, v185
    v_mul_f32 v246, v246, v185
    v_mul_f32 v247, v247, v185
    v_mul_f32 v248, v248, v185
    v_mul_f32 v249, v249, v185
    v_mul_f32 v250, v250, v185
    v_mul_f32 v251, v251, v185
    v_mul_f32 v252, v252, v185
    v_mul_f32 v253, v253, v185
    v_mul_f32 v254, v254, v185
    v_mul_f32 v255, v255, v185
    v_sub_f32 v104, v104, v187
    v_sub_f32 v105, v105, v187
    v_sub_f32 v106, v106, v187
    v_sub_f32 v107, v107, v187
    v_sub_f32 v108, v108, v187
    v_sub_f32 v109, v109, v187
    v_sub_f32 v110, v110, v187
    v_sub_f32 v111, v111, v187
    v_sub_f32 v120, v120, v187
    v_sub_f32 v121, v121, v187
    v_sub_f32 v122, v122, v187
    v_sub_f32 v123, v123, v187
    v_sub_f32 v124, v124, v187
    v_sub_f32 v125, v125, v187
    v_sub_f32 v126, v126, v187
    v_sub_f32 v127, v127, v187
    v_sub_f32 v180, v180, v187
    v_sub_f32 v181, v181, v187
    v_sub_f32 v182, v182, v187
    v_sub_f32 v183, v183, v187
    v_exp_f32 v160, v96
    v_exp_f32 v161, v97
    v_exp_f32 v162, v98
    v_exp_f32 v163, v99
    v_exp_f32 v164, v100
    v_exp_f32 v165, v101
    v_exp_f32 v166, v102
    v_exp_f32 v167, v103
    v_exp_f32 v168, v104
    v_exp_f32 v169, v105
    v_exp_f32 v170, v106
    v_exp_f32 v171, v107
    v_exp_f32 v172, v108
    v_exp_f32 v173, v109
    v_exp_f32 v174, v110
    v_exp_f32 v175, v111
    v_cvt_pk_bf16_f32 v40, v160, v161
    v_cvt_pk_bf16_f32 v41, v162, v163
    v_cvt_pk_bf16_f32 v42, v164, v165
    v_cvt_pk_bf16_f32 v43, v166, v167
    v_cvt_pk_bf16_f32 v44, v168, v169
    v_cvt_pk_bf16_f32 v45, v170, v171
    v_cvt_pk_bf16_f32 v46, v172, v173
    v_cvt_pk_bf16_f32 v47, v174, v175
    s_nop 1
    s_branch L_rr_b10
L_rs_b11:
    s_nop 7
    s_nop 7
    v_max3_f32 v186, v112, v113, v114
    v_max3_f32 v187, v120, v121, v122
    v_max3_f32 v186, v186, v115, v116
    v_max3_f32 v187, v187, v123, v124
    v_max3_f32 v186, v186, v117, v118
    v_max3_f32 v187, v187, v125, v126
    v_max_f32 v186, v186, v119
    v_max_f32 v187, v187, v127
    s_nop 1
    v_permlane32_swap_b32 v186, v187
    v_max_f32 v187, v186, v187
    v_mov_b32 v191, v187
    s_nop 1
    v_permlane16_swap_b32 v191, v187
    v_max_f32 v187, v191, v187
    v_add_f32 v187, 0x41800000, v187
    v_max_f32 v187, 0, v187
    v_mov_b32 v186, v187
    s_nop 1
    v_permlane32_swap_b32 v186, v187
    v_exp_f32 v184, -v186
    v_exp_f32 v185, -v187
    v_mul_f32 v8, v8, v184
    v_mul_f32 v9, v9, v184
    v_mul_f32 v10, v10, v184
    v_mul_f32 v11, v11, v184
    v_mul_f32 v192, v192, v184
    v_mul_f32 v193, v193, v184
    v_mul_f32 v194, v194, v184
    v_mul_f32 v195, v195, v184
    v_mul_f32 v196, v196, v184
    v_mul_f32 v197, v197, v184
    v_mul_f32 v198, v198, v184
    v_mul_f32 v199, v199, v184
    v_mul_f32 v200, v200, v184
    v_mul_f32 v201, v201, v184
    v_mul_f32 v202, v202, v184
    v_mul_f32 v203, v203, v184
    v_mul_f32 v204, v204, v184
    v_mul_f32 v205, v205, v184
    v_mul_f32 v206, v206, v184
    v_mul_f32 v207, v207, v184
    v_mul_f32 v208, v208, v184
    v_mul_f32 v209, v209, v184
    v_mul_f32 v210, v210, v184
    v_mul_f32 v211, v211, v184
    v_mul_f32 v212, v212, v184
    v_mul_f32 v213, v213, v184
    v_mul_f32 v214, v214, v184
    v_mul_f32 v215, v215, v184
    v_mul_f32 v216, v216, v184
    v_mul_f32 v217, v217, v184
    v_mul_f32 v218, v218, v184
    v_mul_f32 v219, v219, v184
    v_mul_f32 v220, v220, v184
    v_mul_f32 v221, v221, v184
    v_mul_f32 v222, v222, v184
    v_mul_f32 v223, v223, v184
    v_sub_f32 v112, v112, v186
    v_sub_f32 v113, v113, v186
    v_sub_f32 v114, v114, v186
    v_sub_f32 v115, v115, v186
    v_sub_f32 v116, v116, v186
    v_sub_f32 v117, v117, v186
    v_sub_f32 v118, v118, v186
    v_sub_f32 v119, v119, v186
    v_sub_f32 v96, v96, v186
    v_sub_f32 v97, v97, v186
    v_sub_f32 v98, v98, v186
    v_sub_f32 v99, v99, v186
    v_sub_f32 v100, v100, v186
    v_sub_f32 v101, v101, v186
    v_sub_f32 v102, v102, v186
    v_sub_f32 v103, v103, v186
    v_sub_f32 v176, v176, v186
    v_sub_f32 v177, v177, v186
    v_sub_f32 v178, v178, v186
    v_sub_f32 v179, v179, v186
    v_mul_f32 v12, v12, v185
    v_mul_f32 v13, v13, v185
    v_mul_f32 v14, v14, v185
    v_mul_f32 v15, v15, v185
    v_mul_f32 v224, v224, v185
    v_mul_f32 v225, v225, v185
    v_mul_f32 v226, v226, v185
    v_mul_f32 v227, v227, v185
    v_mul_f32 v228, v228, v185
    v_mul_f32 v229, v229, v185
    v_mul_f32 v230, v230, v185
    v_mul_f32 v231, v231, v185
    v_mul_f32 v232, v232, v185
    v_mul_f32 v233, v233, v185
    v_mul_f32 v234, v234, v185
    v_mul_f32 v235, v235, v185
    v_mul_f32 v236, v236, v185
    v_mul_f32 v237, v237, v185
    v_mul_f32 v238, v238, v185
    v_mul_f32 v239, v239, v185
    v_mul_f32 v240, v240, v185
    v_mul_f32 v241, v241, v185
    v_mul_f32 v242, v242, v185
    v_mul_f32 v243, v243, v185
    v_mul_f32 v244, v244, v185
    v_mul_f32 v245, v245, v185
    v_mul_f32 v246, v246, v185
    v_mul_f32 v247, v247, v185
    v_mul_f32 v248, v248, v185
    v_mul_f32 v249, v249, v185
    v_mul_f32 v250, v250, v185
    v_mul_f32 v251, v251, v185
    v_mul_f32 v252, v252, v185
    v_mul_f32 v253, v253, v185
    v_mul_f32 v254, v254, v185
    v_mul_f32 v255, v255, v185
    v_sub_f32 v120, v120, v187
    v_sub_f32 v121, v121, v187
    v_sub_f32 v122, v122, v187
    v_sub_f32 v123, v123, v187
    v_sub_f32 v124, v124, v187
    v_sub_f32 v125, v125, v187
    v_sub_f32 v126, v126, v187
    v_sub_f32 v127, v127, v187
    v_sub_f32 v104, v104, v187
    v_sub_f32 v105, v105, v187
    v_sub_f32 v106, v106, v187
    v_sub_f32 v107, v107, v187
    v_sub_f32 v108, v108, v187
    v_sub_f32 v109, v109, v187
    v_sub_f32 v110, v110, v187
    v_sub_f32 v111, v111, v187
    v_sub_f32 v180, v180, v187
    v_sub_f32 v181, v181, v187
    v_sub_f32 v182, v182, v187
    v_sub_f32 v183, v183, v187
    v_exp_f32 v160, v112
    v_exp_f32 v161, v113
    v_exp_f32 v162, v114
    v_exp_f32 v163, v115
    v_exp_f32 v164, v116
    v_exp_f32 v165, v117
    v_exp_f32 v166, v118
    v_exp_f32 v167, v119
    v_exp_f32 v168, v120
    v_exp_f32 v169, v121
    v_exp_f32 v170, v122
    v_exp_f32 v171, v123
    v_exp_f32 v172, v124
    v_exp_f32 v173, v125
    v_exp_f32 v174, v126
    v_exp_f32 v175, v127
    v_cvt_pk_bf16_f32 v40, v160, v161
    v_cvt_pk_bf16_f32 v41, v162, v163
    v_cvt_pk_bf16_f32 v42, v164, v165
    v_cvt_pk_bf16_f32 v43, v166, v167
    v_cvt_pk_bf16_f32 v44, v168, v169
    v_cvt_pk_bf16_f32 v45, v170, v171
    v_cvt_pk_bf16_f32 v46, v172, v173
    v_cvt_pk_bf16_f32 v47, v174, v175
    s_nop 1
    s_branch L_rr_b11
L_rs_b12:
    s_nop 7
    s_nop 7
    v_max3_f32 v186, v96, v97, v98
    v_max3_f32 v187, v104, v105, v106
    v_max3_f32 v186, v186, v99, v100
    v_max3_f32 v187, v187, v107, v108
    v_max3_f32 v186, v186, v101, v102
    v_max3_f32 v187, v187, v109, v110
    v_max_f32 v186, v186, v103
    v_max_f32 v187, v187, v111
    s_nop 1
    v_permlane32_swap_b32 v186, v187
    v_max_f32 v187, v186, v187
    v_mov_b32 v191, v187
    s_nop 1
    v_permlane16_swap_b32 v191, v187
    v_max_f32 v187, v191, v187
    v_add_f32 v187, 0x41800000, v187
    v_max_f32 v187, 0, v187
    v_mov_b32 v186, v187
    s_nop 1
    v_permlane32_swap_b32 v186, v187
    v_exp_f32 v184, -v186
    v_exp_f32 v185, -v187
    v_mul_f32 v8, v8, v184
    v_mul_f32 v9, v9, v184
    v_mul_f32 v10, v10, v184
    v_mul_f32 v11, v11, v184
    v_mul_f32 v192, v192, v184
    v_mul_f32 v193, v193, v184
    v_mul_f32 v194, v194, v184
    v_mul_f32 v195, v195, v184
    v_mul_f32 v196, v196, v184
    v_mul_f32 v197, v197, v184
    v_mul_f32 v198, v198, v184
    v_mul_f32 v199, v199, v184
    v_mul_f32 v200, v200, v184
    v_mul_f32 v201, v201, v184
    v_mul_f32 v202, v202, v184
    v_mul_f32 v203, v203, v184
    v_mul_f32 v204, v204, v184
    v_mul_f32 v205, v205, v184
    v_mul_f32 v206, v206, v184
    v_mul_f32 v207, v207, v184
    v_mul_f32 v208, v208, v184
    v_mul_f32 v209, v209, v184
    v_mul_f32 v210, v210, v184
    v_mul_f32 v211, v211, v184
    v_mul_f32 v212, v212, v184
    v_mul_f32 v213, v213, v184
    v_mul_f32 v214, v214, v184
    v_mul_f32 v215, v215, v184
    v_mul_f32 v216, v216, v184
    v_mul_f32 v217, v217, v184
    v_mul_f32 v218, v218, v184
    v_mul_f32 v219, v219, v184
    v_mul_f32 v220, v220, v184
    v_mul_f32 v221, v221, v184
    v_mul_f32 v222, v222, v184
    v_mul_f32 v223, v223, v184
    v_sub_f32 v96, v96, v186
    v_sub_f32 v97, v97, v186
    v_sub_f32 v98, v98, v186
    v_sub_f32 v99, v99, v186
    v_sub_f32 v100, v100, v186
    v_sub_f32 v101, v101, v186
    v_sub_f32 v102, v102, v186
    v_sub_f32 v103, v103, v186
    v_sub_f32 v112, v112, v186
    v_sub_f32 v113, v113, v186
    v_sub_f32 v114, v114, v186
    v_sub_f32 v115, v115, v186
    v_sub_f32 v116, v116, v186
    v_sub_f32 v117, v117, v186
    v_sub_f32 v118, v118, v186
    v_sub_f32 v119, v119, v186
    v_sub_f32 v176, v176, v186
    v_sub_f32 v177, v177, v186
    v_sub_f32 v178, v178, v186
    v_sub_f32 v179, v179, v186
    v_mul_f32 v12, v12, v185
    v_mul_f32 v13, v13, v185
    v_mul_f32 v14, v14, v185
    v_mul_f32 v15, v15, v185
    v_mul_f32 v224, v224, v185
    v_mul_f32 v225, v225, v185
    v_mul_f32 v226, v226, v185
    v_mul_f32 v227, v227, v185
    v_mul_f32 v228, v228, v185
    v_mul_f32 v229, v229, v185
    v_mul_f32 v230, v230, v185
    v_mul_f32 v231, v231, v185
    v_mul_f32 v232, v232, v185
    v_mul_f32 v233, v233, v185
    v_mul_f32 v234, v234, v185
    v_mul_f32 v235, v235, v185
    v_mul_f32 v236, v236, v185
    v_mul_f32 v237, v237, v185
    v_mul_f32 v238, v238, v185
    v_mul_f32 v239, v239, v185
    v_mul_f32 v240, v240, v185
    v_mul_f32 v241, v241, v185
    v_mul_f32 v242, v242, v185
    v_mul_f32 v243, v243, v185
    v_mul_f32 v244, v244, v185
    v_mul_f32 v245, v245, v185
    v_mul_f32 v246, v246, v185
    v_mul_f32 v247, v247, v185
    v_mul_f32 v248, v248, v185
    v_mul_f32 v249, v249, v185
    v_mul_f32 v250, v250, v185
    v_mul_f32 v251, v251, v185
    v_mul_f32 v252, v252, v185
    v_mul_f32 v253, v253, v185
    v_mul_f32 v254, v254, v185
    v_mul_f32 v255, v255, v185
    v_sub_f32 v104, v104, v187
    v_sub_f32 v105, v105, v187
    v_sub_f32 v106, v106, v187
    v_sub_f32 v107, v107, v187
    v_sub_f32 v108, v108, v187
    v_sub_f32 v109, v109, v187
    v_sub_f32 v110, v110, v187
    v_sub_f32 v111, v111, v187
    v_sub_f32 v120, v120, v187
    v_sub_f32 v121, v121, v187
    v_sub_f32 v122, v122, v187
    v_sub_f32 v123, v123, v187
    v_sub_f32 v124, v124, v187
    v_sub_f32 v125, v125, v187
    v_sub_f32 v126, v126, v187
    v_sub_f32 v127, v127, v187
    v_sub_f32 v180, v180, v187
    v_sub_f32 v181, v181, v187
    v_sub_f32 v182, v182, v187
    v_sub_f32 v183, v183, v187
    v_exp_f32 v160, v96
    v_exp_f32 v161, v97
    v_exp_f32 v162, v98
    v_exp_f32 v163, v99
    v_exp_f32 v164, v100
    v_exp_f32 v165, v101
    v_exp_f32 v166, v102
    v_exp_f32 v167, v103
    v_exp_f32 v168, v104
    v_exp_f32 v169, v105
    v_exp_f32 v170, v106
    v_exp_f32 v171, v107
    v_exp_f32 v172, v108
    v_exp_f32 v173, v109
    v_exp_f32 v174, v110
    v_exp_f32 v175, v111
    v_cvt_pk_bf16_f32 v40, v160, v161
    v_cvt_pk_bf16_f32 v41, v162, v163
    v_cvt_pk_bf16_f32 v42, v164, v165
    v_cvt_pk_bf16_f32 v43, v166, v167
    v_cvt_pk_bf16_f32 v44, v168, v169
    v_cvt_pk_bf16_f32 v45, v170, v171
    v_cvt_pk_bf16_f32 v46, v172, v173
    v_cvt_pk_bf16_f32 v47, v174, v175
    s_nop 1
    s_branch L_rr_b12
L_rs_b13:
    s_nop 7
    s_nop 7
    v_max3_f32 v186, v112, v113, v114
    v_max3_f32 v187, v120, v121, v122
    v_max3_f32 v186, v186, v115, v116
    v_max3_f32 v187, v187, v123, v124
    v_max3_f32 v186, v186, v117, v118
    v_max3_f32 v187, v187, v125, v126
    v_max_f32 v186, v186, v119
    v_max_f32 v187, v187, v127
    s_nop 1
    v_permlane32_swap_b32 v186, v187
    v_max_f32 v187, v186, v187
    v_mov_b32 v191, v187
    s_nop 1
    v_permlane16_swap_b32 v191, v187
    v_max_f32 v187, v191, v187
    v_add_f32 v187, 0x41800000, v187
    v_max_f32 v187, 0, v187
    v_mov_b32 v186, v187
    s_nop 1
    v_permlane32_swap_b32 v186, v187
    v_exp_f32 v184, -v186
    v_exp_f32 v185, -v187
    v_mul_f32 v8, v8, v184
    v_mul_f32 v9, v9, v184
    v_mul_f32 v10, v10, v184
    v_mul_f32 v11, v11, v184
    v_mul_f32 v192, v192, v184
    v_mul_f32 v193, v193, v184
    v_mul_f32 v194, v194, v184
    v_mul_f32 v195, v195, v184
    v_mul_f32 v196, v196, v184
    v_mul_f32 v197, v197, v184
    v_mul_f32 v198, v198, v184
    v_mul_f32 v199, v199, v184
    v_mul_f32 v200, v200, v184
    v_mul_f32 v201, v201, v184
    v_mul_f32 v202, v202, v184
    v_mul_f32 v203, v203, v184
    v_mul_f32 v204, v204, v184
    v_mul_f32 v205, v205, v184
    v_mul_f32 v206, v206, v184
    v_mul_f32 v207, v207, v184
    v_mul_f32 v208, v208, v184
    v_mul_f32 v209, v209, v184
    v_mul_f32 v210, v210, v184
    v_mul_f32 v211, v211, v184
    v_mul_f32 v212, v212, v184
    v_mul_f32 v213, v213, v184
    v_mul_f32 v214, v214, v184
    v_mul_f32 v215, v215, v184
    v_mul_f32 v216, v216, v184
    v_mul_f32 v217, v217, v184
    v_mul_f32 v218, v218, v184
    v_mul_f32 v219, v219, v184
    v_mul_f32 v220, v220, v184
    v_mul_f32 v221, v221, v184
    v_mul_f32 v222, v222, v184
    v_mul_f32 v223, v223, v184
    v_sub_f32 v112, v112, v186
    v_sub_f32 v113, v113, v186
    v_sub_f32 v114, v114, v186
    v_sub_f32 v115, v115, v186
    v_sub_f32 v116, v116, v186
    v_sub_f32 v117, v117, v186
    v_sub_f32 v118, v118, v186
    v_sub_f32 v119, v119, v186
    v_sub_f32 v96, v96, v186
    v_sub_f32 v97, v97, v186
    v_sub_f32 v98, v98, v186
    v_sub_f32 v99, v99, v186
    v_sub_f32 v100, v100, v186
    v_sub_f32 v101, v101, v186
    v_sub_f32 v102, v102, v186
    v_sub_f32 v103, v103, v186
    v_sub_f32 v176, v176, v186
    v_sub_f32 v177, v177, v186
    v_sub_f32 v178, v178, v186
    v_sub_f32 v179, v179, v186
    v_mul_f32 v12, v12, v185
    v_mul_f32 v13, v13, v185
    v_mul_f32 v14, v14, v185
    v_mul_f32 v15, v15, v185
    v_mul_f32 v224, v224, v185
    v_mul_f32 v225, v225, v185
    v_mul_f32 v226, v226, v185
    v_mul_f32 v227, v227, v185
    v_mul_f32 v228, v228, v185
    v_mul_f32 v229, v229, v185
    v_mul_f32 v230, v230, v185
    v_mul_f32 v231, v231, v185
    v_mul_f32 v232, v232, v185
    v_mul_f32 v233, v233, v185
    v_mul_f32 v234, v234, v185
    v_mul_f32 v235, v235, v185
    v_mul_f32 v236, v236, v185
    v_mul_f32 v237, v237, v185
    v_mul_f32 v238, v238, v185
    v_mul_f32 v239, v239, v185
    v_mul_f32 v240, v240, v185
    v_mul_f32 v241, v241, v185
    v_mul_f32 v242, v242, v185
    v_mul_f32 v243, v243, v185
    v_mul_f32 v244, v244, v185
    v_mul_f32 v245, v245, v185
    v_mul_f32 v246, v246, v185
    v_mul_f32 v247, v247, v185
    v_mul_f32 v248, v248, v185
    v_mul_f32 v249, v249, v185
    v_mul_f32 v250, v250, v185
    v_mul_f32 v251, v251, v185
    v_mul_f32 v252, v252, v185
    v_mul_f32 v253, v253, v185
    v_mul_f32 v254, v254, v185
    v_mul_f32 v255, v255, v185
    v_sub_f32 v120, v120, v187
    v_sub_f32 v121, v121, v187
    v_sub_f32 v122, v122, v187
    v_sub_f32 v123, v123, v187
    v_sub_f32 v124, v124, v187
    v_sub_f32 v125, v125, v187
    v_sub_f32 v126, v126, v187
    v_sub_f32 v127, v127, v187
    v_sub_f32 v104, v104, v187
    v_sub_f32 v105, v105, v187
    v_sub_f32 v106, v106, v187
    v_sub_f32 v107, v107, v187
    v_sub_f32 v108, v108, v187
    v_sub_f32 v109, v109, v187
    v_sub_f32 v110, v110, v187
    v_sub_f32 v111, v111, v187
    v_sub_f32 v180, v180, v187
    v_sub_f32 v181, v181, v187
    v_sub_f32 v182, v182, v187
    v_sub_f32 v183, v183, v187
    v_exp_f32 v160, v112
    v_exp_f32 v161, v113
    v_exp_f32 v162, v114
    v_exp_f32 v163, v115
    v_exp_f32 v164, v116
    v_exp_f32 v165, v117
    v_exp_f32 v166, v118
    v_exp_f32 v167, v119
    v_exp_f32 v168, v120
    v_exp_f32 v169, v121
    v_exp_f32 v170, v122
    v_exp_f32 v171, v123
    v_exp_f32 v172, v124
    v_exp_f32 v173, v125
    v_exp_f32 v174, v126
    v_exp_f32 v175, v127
    v_cvt_pk_bf16_f32 v40, v160, v161
    v_cvt_pk_bf16_f32 v41, v162, v163
    v_cvt_pk_bf16_f32 v42, v164, v165
    v_cvt_pk_bf16_f32 v43, v166, v167
    v_cvt_pk_bf16_f32 v44, v168, v169
    v_cvt_pk_bf16_f32 v45, v170, v171
    v_cvt_pk_bf16_f32 v46, v172, v173
    v_cvt_pk_bf16_f32 v47, v174, v175
    s_nop 1
    s_branch L_rr_b13
L_rs_b14:
    s_nop 7
    s_nop 7
    v_max3_f32 v186, v96, v97, v98
    v_max3_f32 v187, v104, v105, v106
    v_max3_f32 v186, v186, v99, v100
    v_max3_f32 v187, v187, v107, v108
    v_max3_f32 v186, v186, v101, v102
    v_max3_f32 v187, v187, v109, v110
    v_max_f32 v186, v186, v103
    v_max_f32 v187, v187, v111
    s_nop 1
    v_permlane32_swap_b32 v186, v187
    v_max_f32 v187, v186, v187
    v_mov_b32 v191, v187
    s_nop 1
    v_permlane16_swap_b32 v191, v187
    v_max_f32 v187, v191, v187
    v_add_f32 v187, 0x41800000, v187
    v_max_f32 v187, 0, v187
    v_mov_b32 v186, v187
    s_nop 1
    v_permlane32_swap_b32 v186, v187
    v_exp_f32 v184, -v186
    v_exp_f32 v185, -v187
    v_mul_f32 v8, v8, v184
    v_mul_f32 v9, v9, v184
    v_mul_f32 v10, v10, v184
    v_mul_f32 v11, v11, v184
    v_mul_f32 v192, v192, v184
    v_mul_f32 v193, v193, v184
    v_mul_f32 v194, v194, v184
    v_mul_f32 v195, v195, v184
    v_mul_f32 v196, v196, v184
    v_mul_f32 v197, v197, v184
    v_mul_f32 v198, v198, v184
    v_mul_f32 v199, v199, v184
    v_mul_f32 v200, v200, v184
    v_mul_f32 v201, v201, v184
    v_mul_f32 v202, v202, v184
    v_mul_f32 v203, v203, v184
    v_mul_f32 v204, v204, v184
    v_mul_f32 v205, v205, v184
    v_mul_f32 v206, v206, v184
    v_mul_f32 v207, v207, v184
    v_mul_f32 v208, v208, v184
    v_mul_f32 v209, v209, v184
    v_mul_f32 v210, v210, v184
    v_mul_f32 v211, v211, v184
    v_mul_f32 v212, v212, v184
    v_mul_f32 v213, v213, v184
    v_mul_f32 v214, v214, v184
    v_mul_f32 v215, v215, v184
    v_mul_f32 v216, v216, v184
    v_mul_f32 v217, v217, v184
    v_mul_f32 v218, v218, v184
    v_mul_f32 v219, v219, v184
    v_mul_f32 v220, v220, v184
    v_mul_f32 v221, v221, v184
    v_mul_f32 v222, v222, v184
    v_mul_f32 v223, v223, v184
    v_sub_f32 v96, v96, v186
    v_sub_f32 v97, v97, v186
    v_sub_f32 v98, v98, v186
    v_sub_f32 v99, v99, v186
    v_sub_f32 v100, v100, v186
    v_sub_f32 v101, v101, v186
    v_sub_f32 v102, v102, v186
    v_sub_f32 v103, v103, v186
    v_sub_f32 v112, v112, v186
    v_sub_f32 v113, v113, v186
    v_sub_f32 v114, v114, v186
    v_sub_f32 v115, v115, v186
    v_sub_f32 v116, v116, v186
    v_sub_f32 v117, v117, v186
    v_sub_f32 v118, v118, v186
    v_sub_f32 v119, v119, v186
    v_sub_f32 v176, v176, v186
    v_sub_f32 v177, v177, v186
    v_sub_f32 v178, v178, v186
    v_sub_f32 v179, v179, v186
    v_mul_f32 v12, v12, v185
    v_mul_f32 v13, v13, v185
    v_mul_f32 v14, v14, v185
    v_mul_f32 v15, v15, v185
    v_mul_f32 v224, v224, v185
    v_mul_f32 v225, v225, v185
    v_mul_f32 v226, v226, v185
    v_mul_f32 v227, v227, v185
    v_mul_f32 v228, v228, v185
    v_mul_f32 v229, v229, v185
    v_mul_f32 v230, v230, v185
    v_mul_f32 v231, v231, v185
    v_mul_f32 v232, v232, v185
    v_mul_f32 v233, v233, v185
    v_mul_f32 v234, v234, v185
    v_mul_f32 v235, v235, v185
    v_mul_f32 v236, v236, v185
    v_mul_f32 v237, v237, v185
    v_mul_f32 v238, v238, v185
    v_mul_f32 v239, v239, v185
    v_mul_f32 v240, v240, v185
    v_mul_f32 v241, v241, v185
    v_mul_f32 v242, v242, v185
    v_mul_f32 v243, v243, v185
    v_mul_f32 v244, v244, v185
    v_mul_f32 v245, v245, v185
    v_mul_f32 v246, v246, v185
    v_mul_f32 v247, v247, v185
    v_mul_f32 v248, v248, v185
    v_mul_f32 v249, v249, v185
    v_mul_f32 v250, v250, v185
    v_mul_f32 v251, v251, v185
    v_mul_f32 v252, v252, v185
    v_mul_f32 v253, v253, v185
    v_mul_f32 v254, v254, v185
    v_mul_f32 v255, v255, v185
    v_sub_f32 v104, v104, v187
    v_sub_f32 v105, v105, v187
    v_sub_f32 v106, v106, v187
    v_sub_f32 v107, v107, v187
    v_sub_f32 v108, v108, v187
    v_sub_f32 v109, v109, v187
    v_sub_f32 v110, v110, v187
    v_sub_f32 v111, v111, v187
    v_sub_f32 v120, v120, v187
    v_sub_f32 v121, v121, v187
    v_sub_f32 v122, v122, v187
    v_sub_f32 v123, v123, v187
    v_sub_f32 v124, v124, v187
    v_sub_f32 v125, v125, v187
    v_sub_f32 v126, v126, v187
    v_sub_f32 v127, v127, v187
    v_sub_f32 v180, v180, v187
    v_sub_f32 v181, v181, v187
    v_sub_f32 v182, v182, v187
    v_sub_f32 v183, v183, v187
    v_exp_f32 v160, v96
    v_exp_f32 v161, v97
    v_exp_f32 v162, v98
    v_exp_f32 v163, v99
    v_exp_f32 v164, v100
    v_exp_f32 v165, v101
    v_exp_f32 v166, v102
    v_exp_f32 v167, v103
    v_exp_f32 v168, v104
    v_exp_f32 v169, v105
    v_exp_f32 v170, v106
    v_exp_f32 v171, v107
    v_exp_f32 v172, v108
    v_exp_f32 v173, v109
    v_exp_f32 v174, v110
    v_exp_f32 v175, v111
    v_cvt_pk_bf16_f32 v40, v160, v161
    v_cvt_pk_bf16_f32 v41, v162, v163
    v_cvt_pk_bf16_f32 v42, v164, v165
    v_cvt_pk_bf16_f32 v43, v166, v167
    v_cvt_pk_bf16_f32 v44, v168, v169
    v_cvt_pk_bf16_f32 v45, v170, v171
    v_cvt_pk_bf16_f32 v46, v172, v173
    v_cvt_pk_bf16_f32 v47, v174, v175
    s_nop 1
    s_branch L_rr_b14
L_rs_b15:
    s_nop 7
    s_nop 7
    v_max3_f32 v186, v112, v113, v114
    v_max3_f32 v187, v120, v121, v122
    v_max3_f32 v186, v186, v115, v116
    v_max3_f32 v187, v187, v123, v124
    v_max3_f32 v186, v186, v117, v118
    v_max3_f32 v187, v187, v125, v126
    v_max_f32 v186, v186, v119
    v_max_f32 v187, v187, v127
    s_nop 1
    v_permlane32_swap_b32 v186, v187
    v_max_f32 v187, v186, v187
    v_mov_b32 v191, v187
    s_nop 1
    v_permlane16_swap_b32 v191, v187
    v_max_f32 v187, v191, v187
    v_add_f32 v187, 0x41800000, v187
    v_max_f32 v187, 0, v187
    v_mov_b32 v186, v187
    s_nop 1
    v_permlane32_swap_b32 v186, v187
    v_exp_f32 v184, -v186
    v_exp_f32 v185, -v187
    v_mul_f32 v8, v8, v184
    v_mul_f32 v9, v9, v184
    v_mul_f32 v10, v10, v184
    v_mul_f32 v11, v11, v184
    v_mul_f32 v192, v192, v184
    v_mul_f32 v193, v193, v184
    v_mul_f32 v194, v194, v184
    v_mul_f32 v195, v195, v184
    v_mul_f32 v196, v196, v184
    v_mul_f32 v197, v197, v184
    v_mul_f32 v198, v198, v184
    v_mul_f32 v199, v199, v184
    v_mul_f32 v200, v200, v184
    v_mul_f32 v201, v201, v184
    v_mul_f32 v202, v202, v184
    v_mul_f32 v203, v203, v184
    v_mul_f32 v204, v204, v184
    v_mul_f32 v205, v205, v184
    v_mul_f32 v206, v206, v184
    v_mul_f32 v207, v207, v184
    v_mul_f32 v208, v208, v184
    v_mul_f32 v209, v209, v184
    v_mul_f32 v210, v210, v184
    v_mul_f32 v211, v211, v184
    v_mul_f32 v212, v212, v184
    v_mul_f32 v213, v213, v184
    v_mul_f32 v214, v214, v184
    v_mul_f32 v215, v215, v184
    v_mul_f32 v216, v216, v184
    v_mul_f32 v217, v217, v184
    v_mul_f32 v218, v218, v184
    v_mul_f32 v219, v219, v184
    v_mul_f32 v220, v220, v184
    v_mul_f32 v221, v221, v184
    v_mul_f32 v222, v222, v184
    v_mul_f32 v223, v223, v184
    v_sub_f32 v112, v112, v186
    v_sub_f32 v113, v113, v186
    v_sub_f32 v114, v114, v186
    v_sub_f32 v115, v115, v186
    v_sub_f32 v116, v116, v186
    v_sub_f32 v117, v117, v186
    v_sub_f32 v118, v118, v186
    v_sub_f32 v119, v119, v186
    v_mul_f32 v12, v12, v185
    v_mul_f32 v13, v13, v185
    v_mul_f32 v14, v14, v185
    v_mul_f32 v15, v15, v185
    v_mul_f32 v224, v224, v185
    v_mul_f32 v225, v225, v185
    v_mul_f32 v226, v226, v185
    v_mul_f32 v227, v227, v185
    v_mul_f32 v228, v228, v185
    v_mul_f32 v229, v229, v185
    v_mul_f32 v230, v230, v185
    v_mul_f32 v231, v231, v185
    v_mul_f32 v232, v232, v185
    v_mul_f32 v233, v233, v185
    v_mul_f32 v234, v234, v185
    v_mul_f32 v235, v235, v185
    v_mul_f32 v236, v236, v185
    v_mul_f32 v237, v237, v185
    v_mul_f32 v238, v238, v185
    v_mul_f32 v239, v239, v185
    v_mul_f32 v240, v240, v185
    v_mul_f32 v241, v241, v185
    v_mul_f32 v242, v242, v185
    v_mul_f32 v243, v243, v185
    v_mul_f32 v244, v244, v185
    v_mul_f32 v245, v245, v185
    v_mul_f32 v246, v246, v185
    v_mul_f32 v247, v247, v185
    v_mul_f32 v248, v248, v185
    v_mul_f32 v249, v249, v185
    v_mul_f32 v250, v250, v185
    v_mul_f32 v251, v251, v185
    v_mul_f32 v252, v252, v185
    v_mul_f32 v253, v253, v185
    v_mul_f32 v254, v254, v185
    v_mul_f32 v255, v255, v185
    v_sub_f32 v120, v120, v187
    v_sub_f32 v121, v121, v187
    v_sub_f32 v122, v122, v187
    v_sub_f32 v123, v123, v187
    v_sub_f32 v124, v124, v187
    v_sub_f32 v125, v125, v187
    v_sub_f32 v126, v126, v187
    v_sub_f32 v127, v127, v187
    v_exp_f32 v160, v112
    v_exp_f32 v161, v113
    v_exp_f32 v162, v114
    v_exp_f32 v163, v115
    v_exp_f32 v164, v116
    v_exp_f32 v165, v117
    v_exp_f32 v166, v118
    v_exp_f32 v167, v119
    v_exp_f32 v168, v120
    v_exp_f32 v169, v121
    v_exp_f32 v170, v122
    v_exp_f32 v171, v123
    v_exp_f32 v172, v124
    v_exp_f32 v173, v125
    v_exp_f32 v174, v126
    v_exp_f32 v175, v127
    v_cvt_pk_bf16_f32 v40, v160, v161
    v_cvt_pk_bf16_f32 v41, v162, v163
    v_cvt_pk_bf16_f32 v42, v164, v165
    v_cvt_pk_bf16_f32 v43, v166, v167
    v_cvt_pk_bf16_f32 v44, v168, v169
    v_cvt_pk_bf16_f32 v45, v170, v171
    v_cvt_pk_bf16_f32 v46, v172, v173
    v_cvt_pk_bf16_f32 v47, v174, v175
    s_nop 1
    s_branch L_rr_b15
L_rs_b16:
    s_nop 7
    s_nop 7
    v_max3_f32 v186, v96, v97, v98
    v_max3_f32 v187, v104, v105, v106
    v_max3_f32 v186, v186, v99, v100
    v_max3_f32 v187, v187, v107, v108
    v_max3_f32 v186, v186, v101, v102
    v_max3_f32 v187, v187, v109, v110
    v_max_f32 v186, v186, v103
    v_max_f32 v187, v187, v111
    s_nop 1
    v_permlane32_swap_b32 v186, v187
    v_max_f32 v187, v186, v187
    v_mov_b32 v191, v187
    s_nop 1
    v_permlane16_swap_b32 v191, v187
    v_max_f32 v187, v191, v187
    v_add_f32 v187, 0x41800000, v187
    v_max_f32 v187, 0, v187
    v_mov_b32 v186, v187
    s_nop 1
    v_permlane32_swap_b32 v186, v187
    v_exp_f32 v184, -v186
    v_exp_f32 v185, -v187
    v_mul_f32 v8, v8, v184
    v_mul_f32 v9, v9, v184
    v_mul_f32 v10, v10, v184
    v_mul_f32 v11, v11, v184
    v_mul_f32 v192, v192, v184
    v_mul_f32 v193, v193, v184
    v_mul_f32 v194, v194, v184
    v_mul_f32 v195, v195, v184
    v_mul_f32 v196, v196, v184
    v_mul_f32 v197, v197, v184
    v_mul_f32 v198, v198, v184
    v_mul_f32 v199, v199, v184
    v_mul_f32 v200, v200, v184
    v_mul_f32 v201, v201, v184
    v_mul_f32 v202, v202, v184
    v_mul_f32 v203, v203, v184
    v_mul_f32 v204, v204, v184
    v_mul_f32 v205, v205, v184
    v_mul_f32 v206, v206, v184
    v_mul_f32 v207, v207, v184
    v_mul_f32 v208, v208, v184
    v_mul_f32 v209, v209, v184
    v_mul_f32 v210, v210, v184
    v_mul_f32 v211, v211, v184
    v_mul_f32 v212, v212, v184
    v_mul_f32 v213, v213, v184
    v_mul_f32 v214, v214, v184
    v_mul_f32 v215, v215, v184
    v_mul_f32 v216, v216, v184
    v_mul_f32 v217, v217, v184
    v_mul_f32 v218, v218, v184
    v_mul_f32 v219, v219, v184
    v_mul_f32 v220, v220, v184
    v_mul_f32 v221, v221, v184
    v_mul_f32 v222, v222, v184
    v_mul_f32 v223, v223, v184
    v_sub_f32 v96, v96, v186
    v_sub_f32 v97, v97, v186
    v_sub_f32 v98, v98, v186
    v_sub_f32 v99, v99, v186
    v_sub_f32 v100, v100, v186
    v_sub_f32 v101, v101, v186
    v_sub_f32 v102, v102, v186
    v_sub_f32 v103, v103, v186
    v_sub_f32 v112, v112, v186
    v_sub_f32 v113, v113, v186
    v_sub_f32 v114, v114, v186
    v_sub_f32 v115, v115, v186
    v_sub_f32 v116, v116, v186
    v_sub_f32 v117, v117, v186
    v_sub_f32 v118, v118, v186
    v_sub_f32 v119, v119, v186
    v_sub_f32 v176, v176, v186
    v_sub_f32 v177, v177, v186
    v_sub_f32 v178, v178, v186
    v_sub_f32 v179, v179, v186
    v_mul_f32 v12, v12, v185
    v_mul_f32 v13, v13, v185
    v_mul_f32 v14, v14, v185
    v_mul_f32 v15, v15, v185
    v_mul_f32 v224, v224, v185
    v_mul_f32 v225, v225, v185
    v_mul_f32 v226, v226, v185
    v_mul_f32 v227, v227, v185
    v_mul_f32 v228, v228, v185
    v_mul_f32 v229, v229, v185
    v_mul_f32 v230, v230, v185
    v_mul_f32 v231, v231, v185
    v_mul_f32 v232, v232, v185
    v_mul_f32 v233, v233, v185
    v_mul_f32 v234, v234, v185
    v_mul_f32 v235, v235, v185
    v_mul_f32 v236, v236, v185
    v_mul_f32 v237, v237, v185
    v_mul_f32 v238, v238, v185
    v_mul_f32 v239, v239, v185
    v_mul_f32 v240, v240, v185
    v_mul_f32 v241, v241, v185
    v_mul_f32 v242, v242, v185
    v_mul_f32 v243, v243, v185
    v_mul_f32 v244, v244, v185
    v_mul_f32 v245, v245, v185
    v_mul_f32 v246, v246, v185
    v_mul_f32 v247, v247, v185
    v_mul_f32 v248, v248, v185
    v_mul_f32 v249, v249, v185
    v_mul_f32 v250, v250, v185
    v_mul_f32 v251, v251, v185
    v_mul_f32 v252, v252, v185
    v_mul_f32 v253, v253, v185
    v_mul_f32 v254, v254, v185
    v_mul_f32 v255, v255, v185
    v_sub_f32 v104, v104, v187
    v_sub_f32 v105, v105, v187
    v_sub_f32 v106, v106, v187
    v_sub_f32 v107, v107, v187
    v_sub_f32 v108, v108, v187
    v_sub_f32 v109, v109, v187
    v_sub_f32 v110, v110, v187
    v_sub_f32 v111, v111, v187
    v_sub_f32 v120, v120, v187
    v_sub_f32 v121, v121, v187
    v_sub_f32 v122, v122, v187
    v_sub_f32 v123, v123, v187
    v_sub_f32 v124, v124, v187
    v_sub_f32 v125, v125, v187
    v_sub_f32 v126, v126, v187
    v_sub_f32 v127, v127, v187
    v_sub_f32 v180, v180, v187
    v_sub_f32 v181, v181, v187
    v_sub_f32 v182, v182, v187
    v_sub_f32 v183, v183, v187
    v_exp_f32 v160, v96
    v_exp_f32 v161, v97
    v_exp_f32 v162, v98
    v_exp_f32 v163, v99
    v_exp_f32 v164, v100
    v_exp_f32 v165, v101
    v_exp_f32 v166, v102
    v_exp_f32 v167, v103
    v_exp_f32 v168, v104
    v_exp_f32 v169, v105
    v_exp_f32 v170, v106
    v_exp_f32 v171, v107
    v_exp_f32 v172, v108
    v_exp_f32 v173, v109
    v_exp_f32 v174, v110
    v_exp_f32 v175, v111
    v_cvt_pk_bf16_f32 v40, v160, v161
    v_cvt_pk_bf16_f32 v41, v162, v163
    v_cvt_pk_bf16_f32 v42, v164, v165
    v_cvt_pk_bf16_f32 v43, v166, v167
    v_cvt_pk_bf16_f32 v44, v168, v169
    v_cvt_pk_bf16_f32 v45, v170, v171
    v_cvt_pk_bf16_f32 v46, v172, v173
    v_cvt_pk_bf16_f32 v47, v174, v175
    s_nop 1
    s_branch L_rr_b16
L_rs_f15:
    s_nop 7
    s_nop 7
    v_max3_f32 v186, v112, v113, v114
    v_max3_f32 v187, v120, v121, v122
    v_max3_f32 v186, v186, v115, v116
    v_max3_f32 v187, v187, v123, v124
    v_max3_f32 v186, v186, v117, v118
    v_max3_f32 v187, v187, v125, v126
    v_max_f32 v186, v186, v119
    v_max_f32 v187, v187, v127
    s_nop 1
    v_permlane32_swap_b32 v186, v187
    v_max_f32 v187, v186, v187
    v_mov_b32 v191, v187
    s_nop 1
    v_permlane16_swap_b32 v191, v187
    v_max_f32 v187, v191, v187
    v_add_f32 v187, 0x41800000, v187
    v_max_f32 v187, 0, v187
    v_mov_b32 v186, v187
    s_nop 1
    v_permlane32_swap_b32 v186, v187
    v_exp_f32 v184, -v186
    v_exp_f32 v185, -v187
    v_mul_f32 v8, v8, v184
    v_mul_f32 v9, v9, v184
    v_mul_f32 v10, v10, v184
    v_mul_f32 v11, v11, v184
    v_mul_f32 v192, v192, v184
    v_mul_f32 v193, v193, v184
    v_mul_f32 v194, v194, v184
    v_mul_f32 v195, v195, v184
    v_mul_f32 v196, v196, v184
    v_mul_f32 v197, v197, v184
    v_mul_f32 v198, v198, v184
    v_mul_f32 v199, v199, v184
    v_mul_f32 v200, v200, v184
    v_mul_f32 v201, v201, v184
    v_mul_f32 v202, v202, v184
    v_mul_f32 v203, v203, v184
    v_mul_f32 v204, v204, v184
    v_mul_f32 v205, v205, v184
    v_mul_f32 v206, v206, v184
    v_mul_f32 v207, v207, v184
    v_mul_f32 v208, v208, v184
    v_mul_f32 v209, v209, v184
    v_mul_f32 v210, v210, v184
    v_mul_f32 v211, v211, v184
    v_mul_f32 v212, v212, v184
    v_mul_f32 v213, v213, v184
    v_mul_f32 v214, v214, v184
    v_mul_f32 v215, v215, v184
    v_mul_f32 v216, v216, v184
    v_mul_f32 v217, v217, v184
    v_mul_f32 v218, v218, v184
    v_mul_f32 v219, v219, v184
    v_mul_f32 v220, v220, v184
    v_mul_f32 v221, v221, v184
    v_mul_f32 v222, v222, v184
    v_mul_f32 v223, v223, v184
    v_sub_f32 v112, v112, v186
    v_sub_f32 v113, v113, v186
    v_sub_f32 v114, v114, v186
    v_sub_f32 v115, v115, v186
    v_sub_f32 v116, v116, v186
    v_sub_f32 v117, v117, v186
    v_sub_f32 v118, v118, v186
    v_sub_f32 v119, v119, v186
    v_mul_f32 v12, v12, v185
    v_mul_f32 v13, v13, v185
    v_mul_f32 v14, v14, v185
    v_mul_f32 v15, v15, v185
    v_mul_f32 v224, v224, v185
    v_mul_f32 v225, v225, v185
    v_mul_f32 v226, v226, v185
    v_mul_f32 v227, v227, v185
    v_mul_f32 v228, v228, v185
    v_mul_f32 v229, v229, v185
    v_mul_f32 v230, v230, v185
    v_mul_f32 v231, v231, v185
    v_mul_f32 v232, v232, v185
    v_mul_f32 v233, v233, v185
    v_mul_f32 v234, v234, v185
    v_mul_f32 v235, v235, v185
    v_mul_f32 v236, v236, v185
    v_mul_f32 v237, v237, v185
    v_mul_f32 v238, v238, v185
    v_mul_f32 v239, v239, v185
    v_mul_f32 v240, v240, v185
    v_mul_f32 v241, v241, v185
    v_mul_f32 v242, v242, v185
    v_mul_f32 v243, v243, v185
    v_mul_f32 v244, v244, v185
    v_mul_f32 v245, v245, v185
    v_mul_f32 v246, v246, v185
    v_mul_f32 v247, v247, v185
    v_mul_f32 v248, v248, v185
    v_mul_f32 v249, v249, v185
    v_mul_f32 v250, v250, v185
    v_mul_f32 v251, v251, v185
    v_mul_f32 v252, v252, v185
    v_mul_f32 v253, v253, v185
    v_mul_f32 v254, v254, v185
    v_mul_f32 v255, v255, v185
    v_sub_f32 v120, v120, v187
    v_sub_f32 v121, v121, v187
    v_sub_f32 v122, v122, v187
    v_sub_f32 v123, v123, v187
    v_sub_f32 v124, v124, v187
    v_sub_f32 v125, v125, v187
    v_sub_f32 v126, v126, v187
    v_sub_f32 v127, v127, v187
    v_exp_f32 v160, v112
    v_exp_f32 v161, v113
    v_exp_f32 v162, v114
    v_exp_f32 v163, v115
    v_exp_f32 v164, v116
    v_exp_f32 v165, v117
    v_exp_f32 v166, v118
    v_exp_f32 v167, v119
    v_exp_f32 v168, v120
    v_exp_f32 v169, v121
    v_exp_f32 v170, v122
    v_exp_f32 v171, v123
    v_exp_f32 v172, v124
    v_exp_f32 v173, v125
    v_exp_f32 v174, v126
    v_exp_f32 v175, v127
    v_cvt_pk_bf16_f32 v40, v160, v161
    v_cvt_pk_bf16_f32 v41, v162, v163
    v_cvt_pk_bf16_f32 v42, v164, v165
    v_cvt_pk_bf16_f32 v43, v166, v167
    v_cvt_pk_bf16_f32 v44, v168, v169
    v_cvt_pk_bf16_f32 v45, v170, v171
    v_cvt_pk_bf16_f32 v46, v172, v173
    v_cvt_pk_bf16_f32 v47, v174, v175
    s_nop 1
    s_branch L_rr_f15
.section .rodata,"a"
.p2align 6
.amdhsa_kernel concat_heads__gqa_block_cached__gqa_block_cached__near_ridge_kernel
  .amdhsa_next_free_vgpr 512
  .amdhsa_next_free_sgpr 102
  .amdhsa_accum_offset 256
  .amdhsa_group_segment_fixed_size 0
  .amdhsa_kernarg_size 104
  .amdhsa_user_sgpr_count 2
  .amdhsa_user_sgpr_kernarg_segment_ptr 1
  .amdhsa_system_sgpr_workgroup_id_x 1
.end_amdhsa_kernel
```
